```python
import torch

def _softmax(x, axis=-1):
    return torch.softmax(x, dim=axis)
def _gelu(x):
    return torch.nn.functional.gelu(x, approximate="tanh")
def _silu(x):
    return torch.nn.functional.silu(x)
def _sigmoid(x):
    return torch.sigmoid(x)
def _layernorm(x, axis=-1, eps=1e-5):
    m = x.mean(dim=axis, keepdim=True)
    v = x.var(dim=axis, keepdim=True, unbiased=False)
    return (x - m) / torch.sqrt(v + eps)
def _scatter_add(tgt, idx, src, axis=0):
    return tgt.clone().index_add_(axis, idx, src)
def _segment_sum(src, seg, n):
    out = torch.zeros((n,) + src.shape[1:], dtype=src.dtype)
    return out.index_add_(0, seg, src)
def _pad(x, pw):
    flat = tuple(v for pair in reversed(pw) for v in pair)
    return torch.nn.functional.pad(x, flat)

kernel_name = 'concat_heads__gqa_block_cached__gqa_block_cached__near_ridge'

def setup_inputs():

    _w = (lambda a: (lambda t: t.to(torch.bfloat16) if t.is_floating_point() else t)(torch.as_tensor(a)))
    def _A_setup():
        B, Sq, D = 8, 224, 640
        Hq, Hkv, Sk, Dh = 32, 32, 512, 192
        assert Hq % Hkv == 0, (Hq, Hkv)
        return {
            "x": _w((lambda *s: torch.randn(*s, dtype=torch.bfloat16) * 0.8)(B, Sq, D)),
            "k_cache": _w((lambda *s: torch.randn(*s, dtype=torch.bfloat16) * 0.8)(B, Hkv, Sk, Dh)),
            "v_cache": _w((lambda *s: torch.randn(*s, dtype=torch.bfloat16) * 0.05)(B, Hkv, Sk, Dh)),
            "wq": _w((lambda *s: torch.randn(*s, dtype=torch.bfloat16) * 0.8)(D, Hq * Dh) * (D ** -0.5)),
            "wo": _w((lambda *s: torch.randn(*s, dtype=torch.bfloat16) * 0.05)(Hq * Dh, D) * ((Hq * Dh) ** -0.5)),
        }
    _A_in = _A_setup()

    def _B_setup():
        B, Sq, D = 8, 224, 640
        Hq, Hkv, Sk, Dh = 32, 32, 512, 192
        assert Hq % Hkv == 0, (Hq, Hkv)
        return {
            "x": _w((lambda *s: torch.randn(*s, dtype=torch.bfloat16) * 0.8)(B, Sq, D)),
            "k_cache": _w((lambda *s: torch.randn(*s, dtype=torch.bfloat16) * 0.8)(B, Hkv, Sk, Dh)),
            "v_cache": _w((lambda *s: torch.randn(*s, dtype=torch.bfloat16) * 0.05)(B, Hkv, Sk, Dh)),
            "wq": _w((lambda *s: torch.randn(*s, dtype=torch.bfloat16) * 0.8)(D, Hq * Dh) * (D ** -0.5)),
            "wo": _w((lambda *s: torch.randn(*s, dtype=torch.bfloat16) * 0.05)(Hq * Dh, D) * ((Hq * Dh) ** -0.5)),
        }
    _B_in = _B_setup()

    return {
        "A_x": _A_in["x"],
        "A_k_cache": _A_in["k_cache"],
        "A_v_cache": _A_in["v_cache"],
        "A_wq": _A_in["wq"],
        "A_wo": _A_in["wo"],
        "B_x": _B_in["x"],
        "B_k_cache": _B_in["k_cache"],
        "B_v_cache": _B_in["v_cache"],
        "B_wq": _B_in["wq"],
        "B_wo": _B_in["wo"],
    }

def reference(A_x, A_k_cache, A_v_cache, A_wq, A_wo, B_x, B_k_cache, B_v_cache, B_wq, B_wo):
    def _A_ref(x, k_cache, v_cache, wq, wo):
        B, Sq, D = x.shape
        Hq, Dh = 32, 192
        Hkv = k_cache.shape[1]
        rep = Hq // Hkv
        q = (lambda x, *d: x.permute(*d))((x @ wq).reshape(B, Sq, Hq, Dh), 0, 2, 1, 3)
        k = (lambda x, n, axis: torch.repeat_interleave(x, n, dim=axis))(k_cache, rep, axis=1)
        v = (lambda x, n, axis: torch.repeat_interleave(x, n, dim=axis))(v_cache, rep, axis=1)
        scores = torch.einsum("bhqd,bhkd->bhqk", q, k) * (Dh ** -0.5)
        p = _softmax(scores, axis=-1)
        o = torch.einsum("bhqk,bhkd->bhqd", p, v)
        return (lambda x, *d: x.permute(*d))(o, 0, 2, 1, 3).reshape(B, Sq, Hq * Dh) @ wo

    def _B_ref(x, k_cache, v_cache, wq, wo):
        B, Sq, D = x.shape
        Hq, Dh = 32, 192
        Hkv = k_cache.shape[1]
        rep = Hq // Hkv
        q = (lambda x, *d: x.permute(*d))((x @ wq).reshape(B, Sq, Hq, Dh), 0, 2, 1, 3)
        k = (lambda x, n, axis: torch.repeat_interleave(x, n, dim=axis))(k_cache, rep, axis=1)
        v = (lambda x, n, axis: torch.repeat_interleave(x, n, dim=axis))(v_cache, rep, axis=1)
        scores = torch.einsum("bhqd,bhkd->bhqk", q, k) * (Dh ** -0.5)
        p = _softmax(scores, axis=-1)
        o = torch.einsum("bhqk,bhkd->bhqd", p, v)
        return (lambda x, *d: x.permute(*d))(o, 0, 2, 1, 3).reshape(B, Sq, Hq * Dh) @ wo

    a = _A_ref(A_x, A_k_cache, A_v_cache, A_wq, A_wo)
    b = _B_ref(B_x, B_k_cache, B_v_cache, B_wq, B_wo)
    return torch.concatenate([a, b], axis=-1)
```

```asm
; @launch grid=(256,1,1) block=(512,1,1) lds=159808
.amdgcn_target "amdgcn-amd-amdhsa--gfx950"
.text
.globl concat_heads__gqa_block_cached__gqa_block_cached__near_ridge_kernel
.p2align 8
.type concat_heads__gqa_block_cached__gqa_block_cached__near_ridge_kernel,@function
concat_heads__gqa_block_cached__gqa_block_cached__near_ridge_kernel:
  s_cmp_ge_u32 s2, 256
  s_cbranch_scc1 L_exit
  s_memrealtime s[98:99]
  s_memtime s[94:95]
  s_load_dwordx16 s[64:79], s[0:1], 0
  s_load_dwordx8 s[80:87], s[0:1], 64
  s_load_dwordx2 s[88:89], s[0:1], 96
  v_lshrrev_b32 v1, 6, v0
  v_and_b32 v2, 63, v0
  v_readfirstlane_b32 s3, v1
  s_getpc_b64 s[4:5]
  v_lshlrev_b32 v3, 7, v0
  global_load_dword v0, v3, s[4:5]
  s_and_b32 s6, s2, 7
  s_lshl_b32 s6, s6, 2
  s_lshr_b32 s6, 0x37621540, s6
  s_and_b32 s6, s6, 7
  s_andn2_b32 s2, s2, 7
  s_or_b32 s2, s2, s6
  s_lshr_b32 s7, s2, 3
  s_lshr_b32 s32, s6, 2
  s_lshr_b32 s33, s7, 2
  s_and_b32 s93, s33, 1
  s_lshr_b32 s92, s33, 1
  s_and_b32 s34, s6, 3
  s_lshl_b32 s50, s34, 2
  s_lshr_b32 s50, 0x2470, s50
  s_and_b32 s50, s50, 15
  s_lshl_b32 s34, s34, 2
  s_and_b32 s35, s7, 3
  s_add_u32 s34, s34, s35
  s_mov_b32 s36, 0x3dd53b95
  s_mov_b32 s37, 0x46800000
  s_waitcnt lgkmcnt(0)
  s_cmp_eq_u32 s32, 0
  s_cselect_b32 s8, s64, s74
  s_cselect_b32 s9, s65, s75
  s_mov_b32 s10, 2293760
  s_mov_b32 s11, 0x20000
  s_cselect_b32 s12, s70, s80
  s_cselect_b32 s13, s71, s81
  s_mov_b32 s14, 7864320
  s_mov_b32 s15, 0x20000
  s_cselect_b32 s16, s66, s76
  s_cselect_b32 s17, s67, s77
  s_mov_b32 s18, 50331648
  s_mov_b32 s19, 0x20000
  s_cselect_b32 s20, s68, s78
  s_cselect_b32 s21, s69, s79
  s_mov_b32 s22, 50331648
  s_mov_b32 s23, 0x20000
  s_cselect_b32 s28, s72, s82
  s_cselect_b32 s29, s73, s83
  s_mov_b32 s30, 7864320
  s_mov_b32 s31, 0x20000
  s_mov_b32 s24, s88
  s_mov_b32 s25, s89
  s_mov_b32 s26, 268435456
  s_mov_b32 s27, 0x20000
  s_mov_b32 s56, s84
  s_mov_b32 s57, s85
  s_mov_b32 s58, 4587520
  s_mov_b32 s59, 0x20000
  s_mov_b32 s60, s86
  s_mov_b32 s61, s87
  s_mov_b32 s62, 256
  s_mov_b32 s63, 0x20000
  s_cmp_eq_u32 s3, 7
  s_cbranch_scc1 L_loader0
  v_lshlrev_b32 v3, 4, v2
  v_lshrrev_b32 v4, 3, v2
  v_mul_u32_u24 v4, 1152, v4
  v_and_b32 v8, 48, v2
  v_xor_b32 v8, v3, v8
  v_add_u32 v5, v4, v8
  v_xor_b32 v8, 64, v8
  v_add_u32 v8, v4, v8
  v_add_u32 v6, 9216, v8
  s_mul_i32 s48, s33, 286720
  s_mul_i32 s47, s3, 40960
  s_add_u32 s48, s48, s47
  s_lshl_b32 s49, s3, 12
  s_add_u32 s49, s49, 24576
  s_add_u32 m0, s49, 0
  s_add_u32 s47, s48, 20480
  buffer_load_dwordx4 v5, s[8:11], s48 offen  lds
  buffer_load_dwordx4 v6, s[8:11], s48 offen offset:1024  lds
  s_add_u32 m0, s49, 2048
  s_add_u32 s48, s48, 128
  buffer_load_dwordx4 v5, s[8:11], s47 offen  lds
  buffer_load_dwordx4 v6, s[8:11], s47 offen offset:1024  lds
  s_branch L_setup2
L_loader0:
  s_setprio 3
  v_mov_b32 v1, v2
  v_lshlrev_b32 v2, 4, v1
  s_movk_i32 s46, 2731
  s_mul_i32 s49, s34, 768
  s_mul_i32 s84, s93, 384
  s_add_u32 s49, s49, s84
  s_sub_u32 s49, s49, 98304
  s_mov_b32 s43, 0
  v_add_u32 v3, 0, v1
  v_mul_u32_u24 v4, s46, v3
  v_lshrrev_b32 v4, 16, v4
  v_bfe_u32 v5, v4, 1, 2
  v_lshlrev_b32 v5, 5, v5
  v_xor_b32 v16, v2, v5
  v_and_b32 v5, 32, v5
  v_xor_b32 v5, v2, v5
  v_mul_u32_u24 v6, 11904, v4
  v_add_u32 v20, v6, v5
  v_xor_b32 v23, 64, v20
  v_add_u32 v3, 64, v1
  v_mul_u32_u24 v4, s46, v3
  v_lshrrev_b32 v4, 16, v4
  v_bfe_u32 v5, v4, 1, 2
  v_lshlrev_b32 v5, 5, v5
  v_xor_b32 v17, v2, v5
  v_and_b32 v5, 32, v5
  v_xor_b32 v5, v2, v5
  v_mul_u32_u24 v6, 11904, v4
  v_add_u32 v21, v6, v5
  v_xor_b32 v24, 64, v21
  v_add_u32 v3, 128, v1
  v_mul_u32_u24 v4, s46, v3
  v_lshrrev_b32 v4, 16, v4
  v_bfe_u32 v5, v4, 1, 2
  v_lshlrev_b32 v5, 5, v5
  v_xor_b32 v18, v2, v5
  v_and_b32 v5, 32, v5
  v_xor_b32 v5, v2, v5
  v_mul_u32_u24 v6, 11904, v4
  v_add_u32 v22, v6, v5
  v_xor_b32 v25, 64, v22
  s_add_u32 m0, s43, 0
  s_add_u32 s49, s49, 98304
  buffer_load_dwordx4 v20, s[12:15], s49 offen offset:0  lds
  buffer_load_dwordx4 v21, s[12:15], s49 offen offset:1024  lds
  buffer_load_dwordx4 v22, s[12:15], s49 offen offset:2048  lds
  s_add_u32 m0, s43, 3072
  s_add_u32 s49, s49, 98304
  buffer_load_dwordx4 v23, s[12:15], s49 offen offset:0  lds
  buffer_load_dwordx4 v24, s[12:15], s49 offen offset:1024  lds
  buffer_load_dwordx4 v25, s[12:15], s49 offen offset:2048  lds
  s_add_u32 m0, s43, 6144
  s_add_u32 s49, s49, 98304
  buffer_load_dwordx4 v20, s[12:15], s49 offen offset:0  lds
  buffer_load_dwordx4 v21, s[12:15], s49 offen offset:1024  lds
  buffer_load_dwordx4 v22, s[12:15], s49 offen offset:2048  lds
  s_add_u32 m0, s43, 9216
  s_add_u32 s49, s49, 98304
  buffer_load_dwordx4 v23, s[12:15], s49 offen offset:0  lds
  buffer_load_dwordx4 v24, s[12:15], s49 offen offset:1024  lds
  buffer_load_dwordx4 v25, s[12:15], s49 offen offset:2048  lds
  s_add_u32 m0, s43, 12288
  s_add_u32 s49, s49, 98304
  buffer_load_dwordx4 v20, s[12:15], s49 offen offset:0  lds
  buffer_load_dwordx4 v21, s[12:15], s49 offen offset:1024  lds
  buffer_load_dwordx4 v22, s[12:15], s49 offen offset:2048  lds
  s_add_u32 m0, s43, 15360
  s_add_u32 s49, s49, 98304
  buffer_load_dwordx4 v23, s[12:15], s49 offen offset:0  lds
  buffer_load_dwordx4 v24, s[12:15], s49 offen offset:1024  lds
  buffer_load_dwordx4 v25, s[12:15], s49 offen offset:2048  lds
  s_add_u32 m0, s43, 18432
  s_add_u32 s49, s49, 98304
  buffer_load_dwordx4 v20, s[12:15], s49 offen offset:0  lds
  buffer_load_dwordx4 v21, s[12:15], s49 offen offset:1024  lds
  buffer_load_dwordx4 v22, s[12:15], s49 offen offset:2048  lds
  s_add_u32 m0, s43, 21504
  s_add_u32 s49, s49, 98304
  buffer_load_dwordx4 v23, s[12:15], s49 offen offset:0  lds
  buffer_load_dwordx4 v24, s[12:15], s49 offen offset:1024  lds
  buffer_load_dwordx4 v25, s[12:15], s49 offen offset:2048  lds
  s_add_u32 s43, s43, 53248
  s_cmp_ge_u32 s43, 159744
  s_cselect_b32 s53, 159744, 0
  s_sub_u32 s43, s43, s53
  s_branch L_loader
L_setup2:
  v_and_b32 v3, 15, v2
  v_lshrrev_b32 v4, 4, v2
  v_lshrrev_b32 v8, 1, v3
  v_xor_b32 v9, v4, v8
  v_lshlrev_b32 v9, 4, v9
  v_mul_u32_u24 v10, 384, v3
  v_add_u32 v9, v9, v10
  v_add_u32 v12, 53248, v9
  v_xor_b32 v13, 64, v12
  v_lshrrev_b32 v9, 2, v2
  v_mul_u32_u24 v9, 384, v9
  v_bfe_u32 v10, v2, 3, 2
  v_lshl_add_u32 v9, v10, 5, v9
  v_and_b32 v10, 3, v2
  v_lshl_add_u32 v9, v10, 3, v9
  v_add_u32 v20, 65536, v9
  v_bfe_u32 v9, v2, 2, 2
  v_lshl_add_u32 v11, v4, 3, v9
  v_mul_u32_u24 v11, 384, v11
  v_lshl_add_u32 v11, v10, 3, v11
  v_lshrrev_b32 v9, 1, v9
  v_lshl_add_u32 v11, v9, 5, v11
  v_and_b32 v9, 1, v4
  v_lshl_add_u32 v21, v9, 6, v11
  v_xor_b32 v14, 0, v21
  v_xor_b32 v15, 32, v21
  v_xor_b32 v16, 64, v21
  v_xor_b32 v17, 96, v21
  v_xor_b32 v9, v4, v8
  v_lshlrev_b32 v9, 4, v9
  v_lshl_add_u32 v9, v3, 7, v9
  v_add_u32 v18, s49, v9
  v_xor_b32 v19, 64, v18
  s_lshl_b32 s38, s3, 11
  v_lshlrev_b32 v9, 4, v2
  v_add_u32 v7, s38, v9
  s_lshl_b32 s38, s32, 3
  s_add_u32 s38, s38, s33
  s_lshl_b32 s38, s38, 4
  s_andn2_b32 s39, s34, 3
  s_add_u32 s38, s38, s39
  s_mul_i32 s46, s38, 172032
  s_mul_i32 s39, s35, 172032
  s_mul_i32 s38, s93, 86016
  s_add_u32 s64, s46, s38
  s_sub_u32 s65, s46, s38
  s_add_u32 s65, s65, 86016
  s_add_u32 s55, s64, s39
  s_add_u32 s66, s65, s39
  s_mov_b32 s51, s55
  s_mov_b32 s44, 0x10000000
  s_add_u32 m0, s49, 53248
  s_add_u32 s47, s48, 20480
  buffer_load_dwordx4 v5, s[8:11], s48 offen  lds
  buffer_load_dwordx4 v6, s[8:11], s48 offen offset:1024  lds
  s_add_u32 m0, s49, 55296
  s_add_u32 s48, s48, 128
  buffer_load_dwordx4 v5, s[8:11], s47 offen  lds
  buffer_load_dwordx4 v6, s[8:11], s47 offen offset:1024  lds
  s_mov_b32 s54, 1
  s_mov_b32 s52, 53248
  s_mov_b32 s53, 26624
  s_barrier
  ds_read_b64_tr_b16 v[32:33], v14 offset:0
  ds_read_b64_tr_b16 v[34:35], v14 offset:1536
  ds_read_b64_tr_b16 v[36:37], v15 offset:0
  ds_read_b64_tr_b16 v[38:39], v15 offset:1536
  ds_read_b64_tr_b16 v[40:41], v16 offset:0
  ds_read_b64_tr_b16 v[42:43], v16 offset:1536
  ds_read_b64_tr_b16 v[44:45], v17 offset:0
  ds_read_b64_tr_b16 v[46:47], v17 offset:1536
  s_waitcnt vmcnt(4)
  ds_read_b128 v[88:91], v18 offset:0
  ds_read_b128 v[92:95], v18 offset:2048
  ds_read_b64_tr_b16 v[48:49], v14 offset:128
  s_waitcnt lgkmcnt(7)
  s_waitcnt lgkmcnt(2)
  v_mfma_f32_16x16x32_bf16 v[160:163], v[32:35], v[88:91], 0
  ds_read_b64_tr_b16 v[50:51], v14 offset:1664
  ds_read_b128 v[72:75], v19 offset:0
  s_setprio 3
  s_waitcnt lgkmcnt(3)
  v_mfma_f32_16x16x32_bf16 v[164:167], v[32:35], v[92:95], 0
  ds_read_b64_tr_b16 v[52:53], v15 offset:128
  v_mfma_f32_16x16x32_bf16 v[168:171], v[36:39], v[88:91], 0
  ds_read_b64_tr_b16 v[54:55], v15 offset:1664
  ds_read_b128 v[76:79], v19 offset:2048
  s_add_u32 m0, s49, 106496
  v_mfma_f32_16x16x32_bf16 v[172:175], v[36:39], v[92:95], 0
  ds_read_b64_tr_b16 v[56:57], v16 offset:128
  s_add_u32 s47, s48, 20480
  v_mfma_f32_16x16x32_bf16 v[176:179], v[40:43], v[88:91], 0
  ds_read_b64_tr_b16 v[58:59], v16 offset:1664
  buffer_load_dwordx4 v5, s[8:11], s48 offen  lds
  v_mfma_f32_16x16x32_bf16 v[180:183], v[40:43], v[92:95], 0
  ds_read_b64_tr_b16 v[60:61], v17 offset:128
  v_mfma_f32_16x16x32_bf16 v[184:187], v[44:47], v[88:91], 0
  ds_read_b64_tr_b16 v[62:63], v17 offset:1664
  s_setprio 2
  v_mfma_f32_16x16x32_bf16 v[188:191], v[44:47], v[92:95], 0
  ds_read_b64_tr_b16 v[32:33], v14 offset:256
  s_waitcnt lgkmcnt(6)
  v_mfma_f32_16x16x32_bf16 v[192:195], v[48:51], v[88:91], 0
  ds_read_b64_tr_b16 v[34:35], v14 offset:1792
  buffer_load_dwordx4 v6, s[8:11], s48 offen offset:1024  lds
  v_mfma_f32_16x16x32_bf16 v[196:199], v[48:51], v[92:95], 0
  ds_read_b64_tr_b16 v[36:37], v15 offset:256
  v_mfma_f32_16x16x32_bf16 v[200:203], v[52:55], v[88:91], 0
  ds_read_b64_tr_b16 v[38:39], v15 offset:1792
  s_add_u32 m0, s49, 108544
  v_mfma_f32_16x16x32_bf16 v[204:207], v[52:55], v[92:95], 0
  ds_read_b64_tr_b16 v[40:41], v16 offset:256
  s_add_u32 s48, s48, 128
  s_waitcnt lgkmcnt(5)
  v_mfma_f32_16x16x32_bf16 v[208:211], v[56:59], v[88:91], 0
  ds_read_b64_tr_b16 v[42:43], v16 offset:1792
  s_setprio 1
  buffer_load_dwordx4 v5, s[8:11], s47 offen  lds
  v_mfma_f32_16x16x32_bf16 v[212:215], v[56:59], v[92:95], 0
  s_barrier
  ds_read_b64_tr_b16 v[44:45], v17 offset:256
  v_mfma_f32_16x16x32_bf16 v[216:219], v[60:63], v[88:91], 0
  ds_read_b64_tr_b16 v[46:47], v17 offset:1792
  v_mfma_f32_16x16x32_bf16 v[220:223], v[60:63], v[92:95], 0
  ds_read_b64_tr_b16 v[48:49], v14 offset:12288
  s_waitcnt lgkmcnt(5)
  v_mfma_f32_16x16x32_bf16 v[224:227], v[32:35], v[88:91], 0
  ds_read_b64_tr_b16 v[50:51], v14 offset:13824
  buffer_load_dwordx4 v6, s[8:11], s47 offen offset:1024  lds
  v_mfma_f32_16x16x32_bf16 v[228:231], v[32:35], v[92:95], 0
  ds_read_b64_tr_b16 v[52:53], v15 offset:12288
  v_mfma_f32_16x16x32_bf16 v[232:235], v[36:39], v[88:91], 0
  ds_read_b64_tr_b16 v[54:55], v15 offset:13824
  s_setprio 0
  v_mfma_f32_16x16x32_bf16 v[236:239], v[36:39], v[92:95], 0
  ds_read_b64_tr_b16 v[56:57], v16 offset:12288
  s_waitcnt lgkmcnt(5)
  v_mfma_f32_16x16x32_bf16 v[240:243], v[40:43], v[88:91], 0
  ds_read_b64_tr_b16 v[58:59], v16 offset:13824
  v_mfma_f32_16x16x32_bf16 v[244:247], v[40:43], v[92:95], 0
  ds_read_b64_tr_b16 v[60:61], v17 offset:12288
  v_mfma_f32_16x16x32_bf16 v[248:251], v[44:47], v[88:91], 0
  ds_read_b64_tr_b16 v[62:63], v17 offset:13824
  v_mfma_f32_16x16x32_bf16 v[252:255], v[44:47], v[92:95], 0
  s_barrier
  ds_read_b64_tr_b16 v[32:33], v14 offset:12416
  v_add_u32 v18, 53248, v18
  s_waitcnt lgkmcnt(5)
  v_mfma_f32_16x16x32_bf16 v[160:163], v[48:51], v[72:75], v[160:163]
  ds_read_b64_tr_b16 v[34:35], v14 offset:13952
  s_setprio 3
  v_add_u32 v19, 53248, v19
  v_mfma_f32_16x16x32_bf16 v[164:167], v[48:51], v[76:79], v[164:167]
  ds_read_b64_tr_b16 v[36:37], v15 offset:12416
  v_mfma_f32_16x16x32_bf16 v[168:171], v[52:55], v[72:75], v[168:171]
  ds_read_b64_tr_b16 v[38:39], v15 offset:13952
  s_add_u32 m0, s49, 0
  v_mfma_f32_16x16x32_bf16 v[172:175], v[52:55], v[76:79], v[172:175]
  ds_read_b64_tr_b16 v[40:41], v16 offset:12416
  s_waitcnt vmcnt(4)
  s_add_u32 s47, s48, 20480
  s_waitcnt lgkmcnt(5)
  v_mfma_f32_16x16x32_bf16 v[176:179], v[56:59], v[72:75], v[176:179]
  ds_read_b64_tr_b16 v[42:43], v16 offset:13952
  ds_read_b128 v[88:91], v18 offset:0
  buffer_load_dwordx4 v5, s[8:11], s48 offen  lds
  v_mfma_f32_16x16x32_bf16 v[180:183], v[56:59], v[76:79], v[180:183]
  ds_read_b64_tr_b16 v[44:45], v17 offset:12416
  v_mfma_f32_16x16x32_bf16 v[184:187], v[60:63], v[72:75], v[184:187]
  ds_read_b64_tr_b16 v[46:47], v17 offset:13952
  ds_read_b128 v[92:95], v18 offset:2048
  s_setprio 2
  v_mfma_f32_16x16x32_bf16 v[188:191], v[60:63], v[76:79], v[188:191]
  ds_read_b64_tr_b16 v[48:49], v14 offset:12544
  s_waitcnt lgkmcnt(7)
  v_mfma_f32_16x16x32_bf16 v[192:195], v[32:35], v[72:75], v[192:195]
  ds_read_b64_tr_b16 v[50:51], v14 offset:14080
  ds_read_b128 v[96:99], v19 offset:0
  v_add_u32 v14, 53248, v14
  buffer_load_dwordx4 v6, s[8:11], s48 offen offset:1024  lds
  v_mfma_f32_16x16x32_bf16 v[196:199], v[32:35], v[76:79], v[196:199]
  ds_read_b64_tr_b16 v[52:53], v15 offset:12544
  v_mfma_f32_16x16x32_bf16 v[200:203], v[36:39], v[72:75], v[200:203]
  ds_read_b64_tr_b16 v[54:55], v15 offset:14080
  ds_read_b128 v[100:103], v19 offset:2048
  v_add_u32 v15, 53248, v15
  s_add_u32 m0, s49, 2048
  v_mfma_f32_16x16x32_bf16 v[204:207], v[36:39], v[76:79], v[204:207]
  ds_read_b64_tr_b16 v[56:57], v16 offset:12544
  s_add_u32 s48, s48, 128
  s_waitcnt lgkmcnt(8)
  v_mfma_f32_16x16x32_bf16 v[208:211], v[40:43], v[72:75], v[208:211]
  ds_read_b64_tr_b16 v[58:59], v16 offset:14080
  s_setprio 1
  v_add_u32 v16, 53248, v16
  buffer_load_dwordx4 v5, s[8:11], s47 offen  lds
  v_mfma_f32_16x16x32_bf16 v[212:215], v[40:43], v[76:79], v[212:215]
  ds_read_b64_tr_b16 v[60:61], v17 offset:12544
  v_mfma_f32_16x16x32_bf16 v[216:219], v[44:47], v[72:75], v[216:219]
  ds_read_b64_tr_b16 v[62:63], v17 offset:14080
  v_add_u32 v17, 53248, v17
  v_mfma_f32_16x16x32_bf16 v[220:223], v[44:47], v[76:79], v[220:223]
  ds_read_b64_tr_b16 v[32:33], v14 offset:0
  s_waitcnt lgkmcnt(6)
  v_mfma_f32_16x16x32_bf16 v[224:227], v[48:51], v[72:75], v[224:227]
  ds_read_b64_tr_b16 v[34:35], v14 offset:1536
  buffer_load_dwordx4 v6, s[8:11], s47 offen offset:1024  lds
  v_mfma_f32_16x16x32_bf16 v[228:231], v[48:51], v[76:79], v[228:231]
  ds_read_b64_tr_b16 v[36:37], v15 offset:0
  v_mfma_f32_16x16x32_bf16 v[232:235], v[52:55], v[72:75], v[232:235]
  ds_read_b64_tr_b16 v[38:39], v15 offset:1536
  s_setprio 0
  v_mfma_f32_16x16x32_bf16 v[236:239], v[52:55], v[76:79], v[236:239]
  ds_read_b64_tr_b16 v[40:41], v16 offset:0
  s_waitcnt lgkmcnt(5)
  v_mfma_f32_16x16x32_bf16 v[240:243], v[56:59], v[72:75], v[240:243]
  ds_read_b64_tr_b16 v[42:43], v16 offset:1536
  v_mfma_f32_16x16x32_bf16 v[244:247], v[56:59], v[76:79], v[244:247]
  ds_read_b64_tr_b16 v[44:45], v17 offset:0
  v_mfma_f32_16x16x32_bf16 v[248:251], v[60:63], v[72:75], v[248:251]
  ds_read_b64_tr_b16 v[46:47], v17 offset:1536
  v_mfma_f32_16x16x32_bf16 v[252:255], v[60:63], v[76:79], v[252:255]
L_mid:
  s_barrier
  ds_read_b64_tr_b16 v[48:49], v14 offset:128
  s_waitcnt lgkmcnt(5)
  v_mfma_f32_16x16x32_bf16 v[160:163], v[32:35], v[88:91], v[160:163]
  ds_read_b64_tr_b16 v[50:51], v14 offset:1664
  s_setprio 3
  v_mfma_f32_16x16x32_bf16 v[164:167], v[32:35], v[92:95], v[164:167]
  ds_read_b64_tr_b16 v[52:53], v15 offset:128
  v_mfma_f32_16x16x32_bf16 v[168:171], v[36:39], v[88:91], v[168:171]
  ds_read_b64_tr_b16 v[54:55], v15 offset:1664
  s_add_u32 m0, s49, 53248
  v_mfma_f32_16x16x32_bf16 v[172:175], v[36:39], v[92:95], v[172:175]
  ds_read_b64_tr_b16 v[56:57], v16 offset:128
  s_add_u32 s47, s48, 20480
  s_waitcnt lgkmcnt(5)
  v_mfma_f32_16x16x32_bf16 v[176:179], v[40:43], v[88:91], v[176:179]
  ds_read_b64_tr_b16 v[58:59], v16 offset:1664
  buffer_load_dwordx4 v5, s[8:11], s48 offen  lds
  v_mfma_f32_16x16x32_bf16 v[180:183], v[40:43], v[92:95], v[180:183]
  ds_read_b64_tr_b16 v[60:61], v17 offset:128
  v_mfma_f32_16x16x32_bf16 v[184:187], v[44:47], v[88:91], v[184:187]
  ds_read_b64_tr_b16 v[62:63], v17 offset:1664
  s_setprio 2
  v_mfma_f32_16x16x32_bf16 v[188:191], v[44:47], v[92:95], v[188:191]
  ds_read_b64_tr_b16 v[32:33], v14 offset:256
  s_waitcnt lgkmcnt(5)
  v_mfma_f32_16x16x32_bf16 v[192:195], v[48:51], v[88:91], v[192:195]
  ds_read_b64_tr_b16 v[34:35], v14 offset:1792
  v_mfma_f32_16x16x32_bf16 v[196:199], v[48:51], v[92:95], v[196:199]
  ds_read_b64_tr_b16 v[36:37], v15 offset:256
  v_mfma_f32_16x16x32_bf16 v[200:203], v[52:55], v[88:91], v[200:203]
  ds_read_b64_tr_b16 v[38:39], v15 offset:1792
  v_mfma_f32_16x16x32_bf16 v[204:207], v[52:55], v[92:95], v[204:207]
  ds_read_b64_tr_b16 v[40:41], v16 offset:256
  s_waitcnt lgkmcnt(5)
  v_mfma_f32_16x16x32_bf16 v[208:211], v[56:59], v[88:91], v[208:211]
  ds_read_b64_tr_b16 v[42:43], v16 offset:1792
  s_setprio 1
  buffer_load_dwordx4 v6, s[8:11], s48 offen offset:1024  lds
  v_mfma_f32_16x16x32_bf16 v[212:215], v[56:59], v[92:95], v[212:215]
  ds_read_b64_tr_b16 v[44:45], v17 offset:256
  v_mfma_f32_16x16x32_bf16 v[216:219], v[60:63], v[88:91], v[216:219]
  ds_read_b64_tr_b16 v[46:47], v17 offset:1792
  v_mfma_f32_16x16x32_bf16 v[220:223], v[60:63], v[92:95], v[220:223]
  ds_read_b64_tr_b16 v[48:49], v14 offset:12288
  s_waitcnt lgkmcnt(5)
  v_mfma_f32_16x16x32_bf16 v[224:227], v[32:35], v[88:91], v[224:227]
  ds_read_b64_tr_b16 v[50:51], v14 offset:13824
  v_mfma_f32_16x16x32_bf16 v[228:231], v[32:35], v[92:95], v[228:231]
  ds_read_b64_tr_b16 v[52:53], v15 offset:12288
  v_mfma_f32_16x16x32_bf16 v[232:235], v[36:39], v[88:91], v[232:235]
  ds_read_b64_tr_b16 v[54:55], v15 offset:13824
  s_setprio 0
  v_mfma_f32_16x16x32_bf16 v[236:239], v[36:39], v[92:95], v[236:239]
  ds_read_b64_tr_b16 v[56:57], v16 offset:12288
  s_waitcnt lgkmcnt(5)
  v_mfma_f32_16x16x32_bf16 v[240:243], v[40:43], v[88:91], v[240:243]
  ds_read_b64_tr_b16 v[58:59], v16 offset:13824
  buffer_store_dwordx4 v[120:123], v7, s[24:27], s44 offen offset:0 sc1
  v_mfma_f32_16x16x32_bf16 v[244:247], v[40:43], v[92:95], v[244:247]
  ds_read_b64_tr_b16 v[60:61], v17 offset:12288
  v_mfma_f32_16x16x32_bf16 v[248:251], v[44:47], v[88:91], v[248:251]
  ds_read_b64_tr_b16 v[62:63], v17 offset:13824
  v_mfma_f32_16x16x32_bf16 v[252:255], v[44:47], v[92:95], v[252:255]
  s_barrier
  ds_read_b64_tr_b16 v[32:33], v14 offset:12416
  v_add_u32 v18, 53248, v18
  s_waitcnt lgkmcnt(5)
  v_mfma_f32_16x16x32_bf16 v[160:163], v[48:51], v[96:99], v[160:163]
  ds_read_b64_tr_b16 v[34:35], v14 offset:13952
  s_setprio 3
  v_add_u32 v19, 53248, v19
  v_mfma_f32_16x16x32_bf16 v[164:167], v[48:51], v[100:103], v[164:167]
  ds_read_b64_tr_b16 v[36:37], v15 offset:12416
  v_mfma_f32_16x16x32_bf16 v[168:171], v[52:55], v[96:99], v[168:171]
  ds_read_b64_tr_b16 v[38:39], v15 offset:13952
  v_mfma_f32_16x16x32_bf16 v[172:175], v[52:55], v[100:103], v[172:175]
  ds_read_b64_tr_b16 v[40:41], v16 offset:12416
  s_waitcnt vmcnt(7)
  s_waitcnt lgkmcnt(5)
  v_mfma_f32_16x16x32_bf16 v[176:179], v[56:59], v[96:99], v[176:179]
  ds_read_b64_tr_b16 v[42:43], v16 offset:13952
  ds_read_b128 v[88:91], v18 offset:0
  v_mfma_f32_16x16x32_bf16 v[180:183], v[56:59], v[100:103], v[180:183]
  ds_read_b64_tr_b16 v[44:45], v17 offset:12416
  v_mfma_f32_16x16x32_bf16 v[184:187], v[60:63], v[96:99], v[184:187]
  ds_read_b64_tr_b16 v[46:47], v17 offset:13952
  ds_read_b128 v[92:95], v18 offset:2048
  s_setprio 2
  v_mfma_f32_16x16x32_bf16 v[188:191], v[60:63], v[100:103], v[188:191]
  ds_read_b64_tr_b16 v[48:49], v14 offset:12544
  s_waitcnt lgkmcnt(7)
  v_mfma_f32_16x16x32_bf16 v[192:195], v[32:35], v[96:99], v[192:195]
  ds_read_b64_tr_b16 v[50:51], v14 offset:14080
  ds_read_b128 v[72:75], v19 offset:0
  v_add_u32 v14, 53248, v14
  v_mfma_f32_16x16x32_bf16 v[196:199], v[32:35], v[100:103], v[196:199]
  ds_read_b64_tr_b16 v[52:53], v15 offset:12544
  v_mfma_f32_16x16x32_bf16 v[200:203], v[36:39], v[96:99], v[200:203]
  ds_read_b64_tr_b16 v[54:55], v15 offset:14080
  ds_read_b128 v[76:79], v19 offset:2048
  v_add_u32 v15, 53248, v15
  v_mfma_f32_16x16x32_bf16 v[204:207], v[36:39], v[100:103], v[204:207]
  ds_read_b64_tr_b16 v[56:57], v16 offset:12544
  s_waitcnt lgkmcnt(8)
  v_mfma_f32_16x16x32_bf16 v[208:211], v[40:43], v[96:99], v[208:211]
  ds_read_b64_tr_b16 v[58:59], v16 offset:14080
  s_setprio 1
  v_add_u32 v16, 53248, v16
  v_mfma_f32_16x16x32_bf16 v[212:215], v[40:43], v[100:103], v[212:215]
  ds_read_b64_tr_b16 v[60:61], v17 offset:12544
  v_mfma_f32_16x16x32_bf16 v[216:219], v[44:47], v[96:99], v[216:219]
  ds_read_b64_tr_b16 v[62:63], v17 offset:14080
  v_add_u32 v17, 53248, v17
  s_add_u32 m0, s49, 55296
  v_mfma_f32_16x16x32_bf16 v[220:223], v[44:47], v[100:103], v[220:223]
  ds_read_b64_tr_b16 v[32:33], v14 offset:0
  s_add_u32 s48, s48, 128
  s_waitcnt lgkmcnt(6)
  v_mfma_f32_16x16x32_bf16 v[224:227], v[48:51], v[96:99], v[224:227]
  ds_read_b64_tr_b16 v[34:35], v14 offset:1536
  buffer_load_dwordx4 v5, s[8:11], s47 offen  lds
  v_mfma_f32_16x16x32_bf16 v[228:231], v[48:51], v[100:103], v[228:231]
  ds_read_b64_tr_b16 v[36:37], v15 offset:0
  v_mfma_f32_16x16x32_bf16 v[232:235], v[52:55], v[96:99], v[232:235]
  ds_read_b64_tr_b16 v[38:39], v15 offset:1536
  s_setprio 0
  buffer_load_dwordx4 v6, s[8:11], s47 offen offset:1024  lds
  v_mfma_f32_16x16x32_bf16 v[236:239], v[52:55], v[100:103], v[236:239]
  ds_read_b64_tr_b16 v[40:41], v16 offset:0
  s_waitcnt lgkmcnt(5)
  v_mfma_f32_16x16x32_bf16 v[240:243], v[56:59], v[96:99], v[240:243]
  ds_read_b64_tr_b16 v[42:43], v16 offset:1536
  buffer_store_dwordx4 v[124:127], v7, s[24:27], s44 offen offset:1024 sc1
  v_mfma_f32_16x16x32_bf16 v[244:247], v[56:59], v[100:103], v[244:247]
  ds_read_b64_tr_b16 v[44:45], v17 offset:0
  s_add_u32 s44, s44, 14336
  v_mfma_f32_16x16x32_bf16 v[248:251], v[60:63], v[96:99], v[248:251]
  ds_read_b64_tr_b16 v[46:47], v17 offset:1536
  v_mfma_f32_16x16x32_bf16 v[252:255], v[60:63], v[100:103], v[252:255]
  s_barrier
  ds_read_b64_tr_b16 v[48:49], v14 offset:128
  s_waitcnt lgkmcnt(5)
  v_mfma_f32_16x16x32_bf16 v[160:163], v[32:35], v[88:91], v[160:163]
  ds_read_b64_tr_b16 v[50:51], v14 offset:1664
  s_setprio 3
  v_mfma_f32_16x16x32_bf16 v[164:167], v[32:35], v[92:95], v[164:167]
  ds_read_b64_tr_b16 v[52:53], v15 offset:128
  v_mfma_f32_16x16x32_bf16 v[168:171], v[36:39], v[88:91], v[168:171]
  ds_read_b64_tr_b16 v[54:55], v15 offset:1664
  s_add_u32 m0, s49, 106496
  v_mfma_f32_16x16x32_bf16 v[172:175], v[36:39], v[92:95], v[172:175]
  ds_read_b64_tr_b16 v[56:57], v16 offset:128
  s_add_u32 s47, s48, 20480
  s_waitcnt lgkmcnt(5)
  v_mfma_f32_16x16x32_bf16 v[176:179], v[40:43], v[88:91], v[176:179]
  ds_read_b64_tr_b16 v[58:59], v16 offset:1664
  buffer_load_dwordx4 v5, s[8:11], s48 offen  lds
  v_mfma_f32_16x16x32_bf16 v[180:183], v[40:43], v[92:95], v[180:183]
  ds_read_b64_tr_b16 v[60:61], v17 offset:128
  v_mfma_f32_16x16x32_bf16 v[184:187], v[44:47], v[88:91], v[184:187]
  ds_read_b64_tr_b16 v[62:63], v17 offset:1664
  s_setprio 2
  v_mfma_f32_16x16x32_bf16 v[188:191], v[44:47], v[92:95], v[188:191]
  ds_read_b64_tr_b16 v[32:33], v14 offset:256
  s_waitcnt lgkmcnt(5)
  v_mfma_f32_16x16x32_bf16 v[192:195], v[48:51], v[88:91], v[192:195]
  ds_read_b64_tr_b16 v[34:35], v14 offset:1792
  v_mfma_f32_16x16x32_bf16 v[196:199], v[48:51], v[92:95], v[196:199]
  ds_read_b64_tr_b16 v[36:37], v15 offset:256
  v_mfma_f32_16x16x32_bf16 v[200:203], v[52:55], v[88:91], v[200:203]
  ds_read_b64_tr_b16 v[38:39], v15 offset:1792
  v_mfma_f32_16x16x32_bf16 v[204:207], v[52:55], v[92:95], v[204:207]
  ds_read_b64_tr_b16 v[40:41], v16 offset:256
  s_waitcnt lgkmcnt(5)
  v_mfma_f32_16x16x32_bf16 v[208:211], v[56:59], v[88:91], v[208:211]
  ds_read_b64_tr_b16 v[42:43], v16 offset:1792
  s_setprio 1
  buffer_load_dwordx4 v6, s[8:11], s48 offen offset:1024  lds
  v_mfma_f32_16x16x32_bf16 v[212:215], v[56:59], v[92:95], v[212:215]
  ds_read_b64_tr_b16 v[44:45], v17 offset:256
  v_mfma_f32_16x16x32_bf16 v[216:219], v[60:63], v[88:91], v[216:219]
  ds_read_b64_tr_b16 v[46:47], v17 offset:1792
  v_mfma_f32_16x16x32_bf16 v[220:223], v[60:63], v[92:95], v[220:223]
  ds_read_b64_tr_b16 v[48:49], v14 offset:12288
  s_waitcnt lgkmcnt(5)
  v_mfma_f32_16x16x32_bf16 v[224:227], v[32:35], v[88:91], v[224:227]
  ds_read_b64_tr_b16 v[50:51], v14 offset:13824
  v_mfma_f32_16x16x32_bf16 v[228:231], v[32:35], v[92:95], v[228:231]
  ds_read_b64_tr_b16 v[52:53], v15 offset:12288
  v_mfma_f32_16x16x32_bf16 v[232:235], v[36:39], v[88:91], v[232:235]
  ds_read_b64_tr_b16 v[54:55], v15 offset:13824
  s_setprio 0
  v_mfma_f32_16x16x32_bf16 v[236:239], v[36:39], v[92:95], v[236:239]
  ds_read_b64_tr_b16 v[56:57], v16 offset:12288
  s_waitcnt lgkmcnt(5)
  v_mfma_f32_16x16x32_bf16 v[240:243], v[40:43], v[88:91], v[240:243]
  ds_read_b64_tr_b16 v[58:59], v16 offset:13824
  buffer_store_dwordx4 v[128:131], v7, s[24:27], s44 offen offset:0 sc1
  v_mfma_f32_16x16x32_bf16 v[244:247], v[40:43], v[92:95], v[244:247]
  ds_read_b64_tr_b16 v[60:61], v17 offset:12288
  v_mfma_f32_16x16x32_bf16 v[248:251], v[44:47], v[88:91], v[248:251]
  ds_read_b64_tr_b16 v[62:63], v17 offset:13824
  v_mfma_f32_16x16x32_bf16 v[252:255], v[44:47], v[92:95], v[252:255]
  s_barrier
  ds_read_b64_tr_b16 v[32:33], v14 offset:12416
  v_add_u32 v18, 4294860800, v18
  s_waitcnt lgkmcnt(5)
  v_mfma_f32_16x16x32_bf16 v[160:163], v[48:51], v[72:75], v[160:163]
  ds_read_b64_tr_b16 v[34:35], v14 offset:13952
  s_setprio 3
  v_add_u32 v19, 4294860800, v19
  v_mfma_f32_16x16x32_bf16 v[164:167], v[48:51], v[76:79], v[164:167]
  ds_read_b64_tr_b16 v[36:37], v15 offset:12416
  v_mfma_f32_16x16x32_bf16 v[168:171], v[52:55], v[72:75], v[168:171]
  ds_read_b64_tr_b16 v[38:39], v15 offset:13952
  v_mfma_f32_16x16x32_bf16 v[172:175], v[52:55], v[76:79], v[172:175]
  ds_read_b64_tr_b16 v[40:41], v16 offset:12416
  s_waitcnt vmcnt(9)
  s_waitcnt lgkmcnt(5)
  v_mfma_f32_16x16x32_bf16 v[176:179], v[56:59], v[72:75], v[176:179]
  ds_read_b64_tr_b16 v[42:43], v16 offset:13952
  ds_read_b128 v[88:91], v18 offset:0
  v_mfma_f32_16x16x32_bf16 v[180:183], v[56:59], v[76:79], v[180:183]
  ds_read_b64_tr_b16 v[44:45], v17 offset:12416
  v_mfma_f32_16x16x32_bf16 v[184:187], v[60:63], v[72:75], v[184:187]
  ds_read_b64_tr_b16 v[46:47], v17 offset:13952
  ds_read_b128 v[92:95], v18 offset:2048
  s_setprio 2
  v_mfma_f32_16x16x32_bf16 v[188:191], v[60:63], v[76:79], v[188:191]
  ds_read_b64_tr_b16 v[48:49], v14 offset:12544
  s_waitcnt lgkmcnt(7)
  v_mfma_f32_16x16x32_bf16 v[192:195], v[32:35], v[72:75], v[192:195]
  ds_read_b64_tr_b16 v[50:51], v14 offset:14080
  ds_read_b128 v[96:99], v19 offset:0
  v_add_u32 v14, 4294860800, v14
  v_mfma_f32_16x16x32_bf16 v[196:199], v[32:35], v[76:79], v[196:199]
  ds_read_b64_tr_b16 v[52:53], v15 offset:12544
  v_mfma_f32_16x16x32_bf16 v[200:203], v[36:39], v[72:75], v[200:203]
  ds_read_b64_tr_b16 v[54:55], v15 offset:14080
  ds_read_b128 v[100:103], v19 offset:2048
  v_add_u32 v15, 4294860800, v15
  v_mfma_f32_16x16x32_bf16 v[204:207], v[36:39], v[76:79], v[204:207]
  ds_read_b64_tr_b16 v[56:57], v16 offset:12544
  s_waitcnt lgkmcnt(8)
  v_mfma_f32_16x16x32_bf16 v[208:211], v[40:43], v[72:75], v[208:211]
  ds_read_b64_tr_b16 v[58:59], v16 offset:14080
  s_setprio 1
  v_add_u32 v16, 4294860800, v16
  v_mfma_f32_16x16x32_bf16 v[212:215], v[40:43], v[76:79], v[212:215]
  ds_read_b64_tr_b16 v[60:61], v17 offset:12544
  v_mfma_f32_16x16x32_bf16 v[216:219], v[44:47], v[72:75], v[216:219]
  ds_read_b64_tr_b16 v[62:63], v17 offset:14080
  v_add_u32 v17, 4294860800, v17
  s_add_u32 m0, s49, 108544
  v_mfma_f32_16x16x32_bf16 v[220:223], v[44:47], v[76:79], v[220:223]
  ds_read_b64_tr_b16 v[32:33], v14 offset:0
  s_add_u32 s48, s48, 128
  s_waitcnt lgkmcnt(6)
  v_mfma_f32_16x16x32_bf16 v[224:227], v[48:51], v[72:75], v[224:227]
  ds_read_b64_tr_b16 v[34:35], v14 offset:1536
  buffer_load_dwordx4 v5, s[8:11], s47 offen  lds
  v_mfma_f32_16x16x32_bf16 v[228:231], v[48:51], v[76:79], v[228:231]
  ds_read_b64_tr_b16 v[36:37], v15 offset:0
  v_mfma_f32_16x16x32_bf16 v[232:235], v[52:55], v[72:75], v[232:235]
  ds_read_b64_tr_b16 v[38:39], v15 offset:1536
  s_setprio 0
  buffer_load_dwordx4 v6, s[8:11], s47 offen offset:1024  lds
  v_mfma_f32_16x16x32_bf16 v[236:239], v[52:55], v[76:79], v[236:239]
  ds_read_b64_tr_b16 v[40:41], v16 offset:0
  s_waitcnt lgkmcnt(5)
  v_mfma_f32_16x16x32_bf16 v[240:243], v[56:59], v[72:75], v[240:243]
  ds_read_b64_tr_b16 v[42:43], v16 offset:1536
  buffer_store_dwordx4 v[132:135], v7, s[24:27], s44 offen offset:1024 sc1
  v_mfma_f32_16x16x32_bf16 v[244:247], v[56:59], v[76:79], v[244:247]
  ds_read_b64_tr_b16 v[44:45], v17 offset:0
  s_add_u32 s44, s44, 14336
  v_mfma_f32_16x16x32_bf16 v[248:251], v[60:63], v[72:75], v[248:251]
  ds_read_b64_tr_b16 v[46:47], v17 offset:1536
  v_mfma_f32_16x16x32_bf16 v[252:255], v[60:63], v[76:79], v[252:255]
  s_barrier
  ds_read_b64_tr_b16 v[48:49], v14 offset:128
  s_waitcnt lgkmcnt(5)
  v_mfma_f32_16x16x32_bf16 v[160:163], v[32:35], v[88:91], v[160:163]
  ds_read_b64_tr_b16 v[50:51], v14 offset:1664
  s_setprio 3
  v_mfma_f32_16x16x32_bf16 v[164:167], v[32:35], v[92:95], v[164:167]
  ds_read_b64_tr_b16 v[52:53], v15 offset:128
  v_mfma_f32_16x16x32_bf16 v[168:171], v[36:39], v[88:91], v[168:171]
  ds_read_b64_tr_b16 v[54:55], v15 offset:1664
  s_add_u32 m0, s49, 0
  v_mfma_f32_16x16x32_bf16 v[172:175], v[36:39], v[92:95], v[172:175]
  ds_read_b64_tr_b16 v[56:57], v16 offset:128
  s_add_u32 s47, s48, 20480
  s_waitcnt lgkmcnt(5)
  v_mfma_f32_16x16x32_bf16 v[176:179], v[40:43], v[88:91], v[176:179]
  ds_read_b64_tr_b16 v[58:59], v16 offset:1664
  buffer_load_dwordx4 v5, s[8:11], s48 offen  lds
  v_mfma_f32_16x16x32_bf16 v[180:183], v[40:43], v[92:95], v[180:183]
  ds_read_b64_tr_b16 v[60:61], v17 offset:128
  v_mfma_f32_16x16x32_bf16 v[184:187], v[44:47], v[88:91], v[184:187]
  ds_read_b64_tr_b16 v[62:63], v17 offset:1664
  s_setprio 2
  v_mfma_f32_16x16x32_bf16 v[188:191], v[44:47], v[92:95], v[188:191]
  ds_read_b64_tr_b16 v[32:33], v14 offset:256
  s_waitcnt lgkmcnt(5)
  v_mfma_f32_16x16x32_bf16 v[192:195], v[48:51], v[88:91], v[192:195]
  ds_read_b64_tr_b16 v[34:35], v14 offset:1792
  v_mfma_f32_16x16x32_bf16 v[196:199], v[48:51], v[92:95], v[196:199]
  ds_read_b64_tr_b16 v[36:37], v15 offset:256
  v_mfma_f32_16x16x32_bf16 v[200:203], v[52:55], v[88:91], v[200:203]
  ds_read_b64_tr_b16 v[38:39], v15 offset:1792
  v_mfma_f32_16x16x32_bf16 v[204:207], v[52:55], v[92:95], v[204:207]
  ds_read_b64_tr_b16 v[40:41], v16 offset:256
  s_waitcnt lgkmcnt(5)
  v_mfma_f32_16x16x32_bf16 v[208:211], v[56:59], v[88:91], v[208:211]
  ds_read_b64_tr_b16 v[42:43], v16 offset:1792
  s_setprio 1
  buffer_load_dwordx4 v6, s[8:11], s48 offen offset:1024  lds
  v_mfma_f32_16x16x32_bf16 v[212:215], v[56:59], v[92:95], v[212:215]
  ds_read_b64_tr_b16 v[44:45], v17 offset:256
  v_mfma_f32_16x16x32_bf16 v[216:219], v[60:63], v[88:91], v[216:219]
  ds_read_b64_tr_b16 v[46:47], v17 offset:1792
  v_mfma_f32_16x16x32_bf16 v[220:223], v[60:63], v[92:95], v[220:223]
  ds_read_b64_tr_b16 v[48:49], v14 offset:12288
  s_waitcnt lgkmcnt(5)
  v_mfma_f32_16x16x32_bf16 v[224:227], v[32:35], v[88:91], v[224:227]
  ds_read_b64_tr_b16 v[50:51], v14 offset:13824
  v_mfma_f32_16x16x32_bf16 v[228:231], v[32:35], v[92:95], v[228:231]
  ds_read_b64_tr_b16 v[52:53], v15 offset:12288
  v_mfma_f32_16x16x32_bf16 v[232:235], v[36:39], v[88:91], v[232:235]
  ds_read_b64_tr_b16 v[54:55], v15 offset:13824
  s_setprio 0
  v_mfma_f32_16x16x32_bf16 v[236:239], v[36:39], v[92:95], v[236:239]
  ds_read_b64_tr_b16 v[56:57], v16 offset:12288
  s_waitcnt lgkmcnt(5)
  v_mfma_f32_16x16x32_bf16 v[240:243], v[40:43], v[88:91], v[240:243]
  ds_read_b64_tr_b16 v[58:59], v16 offset:13824
  buffer_store_dwordx4 v[136:139], v7, s[24:27], s44 offen offset:0 sc1
  v_mfma_f32_16x16x32_bf16 v[244:247], v[40:43], v[92:95], v[244:247]
  ds_read_b64_tr_b16 v[60:61], v17 offset:12288
  v_mfma_f32_16x16x32_bf16 v[248:251], v[44:47], v[88:91], v[248:251]
  ds_read_b64_tr_b16 v[62:63], v17 offset:13824
  v_mfma_f32_16x16x32_bf16 v[252:255], v[44:47], v[92:95], v[252:255]
  s_barrier
  ds_read_b64_tr_b16 v[32:33], v14 offset:12416
  v_add_u32 v18, 53248, v18
  s_waitcnt lgkmcnt(5)
  v_mfma_f32_16x16x32_bf16 v[160:163], v[48:51], v[96:99], v[160:163]
  ds_read_b64_tr_b16 v[34:35], v14 offset:13952
  s_setprio 3
  v_add_u32 v19, 53248, v19
  v_mfma_f32_16x16x32_bf16 v[164:167], v[48:51], v[100:103], v[164:167]
  ds_read_b64_tr_b16 v[36:37], v15 offset:12416
  v_mfma_f32_16x16x32_bf16 v[168:171], v[52:55], v[96:99], v[168:171]
  ds_read_b64_tr_b16 v[38:39], v15 offset:13952
  v_mfma_f32_16x16x32_bf16 v[172:175], v[52:55], v[100:103], v[172:175]
  ds_read_b64_tr_b16 v[40:41], v16 offset:12416
  s_waitcnt vmcnt(10)
  s_waitcnt lgkmcnt(5)
  v_mfma_f32_16x16x32_bf16 v[176:179], v[56:59], v[96:99], v[176:179]
  ds_read_b64_tr_b16 v[42:43], v16 offset:13952
  ds_read_b128 v[88:91], v18 offset:0
  v_mfma_f32_16x16x32_bf16 v[180:183], v[56:59], v[100:103], v[180:183]
  ds_read_b64_tr_b16 v[44:45], v17 offset:12416
  v_mfma_f32_16x16x32_bf16 v[184:187], v[60:63], v[96:99], v[184:187]
  ds_read_b64_tr_b16 v[46:47], v17 offset:13952
  ds_read_b128 v[92:95], v18 offset:2048
  s_setprio 2
  v_mfma_f32_16x16x32_bf16 v[188:191], v[60:63], v[100:103], v[188:191]
  ds_read_b64_tr_b16 v[48:49], v14 offset:12544
  s_waitcnt lgkmcnt(7)
  v_mfma_f32_16x16x32_bf16 v[192:195], v[32:35], v[96:99], v[192:195]
  ds_read_b64_tr_b16 v[50:51], v14 offset:14080
  ds_read_b128 v[72:75], v19 offset:0
  v_add_u32 v14, 53248, v14
  v_mfma_f32_16x16x32_bf16 v[196:199], v[32:35], v[100:103], v[196:199]
  ds_read_b64_tr_b16 v[52:53], v15 offset:12544
  v_mfma_f32_16x16x32_bf16 v[200:203], v[36:39], v[96:99], v[200:203]
  ds_read_b64_tr_b16 v[54:55], v15 offset:14080
  ds_read_b128 v[76:79], v19 offset:2048
  v_add_u32 v15, 53248, v15
  v_mfma_f32_16x16x32_bf16 v[204:207], v[36:39], v[100:103], v[204:207]
  ds_read_b64_tr_b16 v[56:57], v16 offset:12544
  s_waitcnt lgkmcnt(8)
  v_mfma_f32_16x16x32_bf16 v[208:211], v[40:43], v[96:99], v[208:211]
  ds_read_b64_tr_b16 v[58:59], v16 offset:14080
  s_setprio 1
  v_add_u32 v16, 53248, v16
  v_mfma_f32_16x16x32_bf16 v[212:215], v[40:43], v[100:103], v[212:215]
  ds_read_b64_tr_b16 v[60:61], v17 offset:12544
  v_mfma_f32_16x16x32_bf16 v[216:219], v[44:47], v[96:99], v[216:219]
  ds_read_b64_tr_b16 v[62:63], v17 offset:14080
  v_add_u32 v17, 53248, v17
  s_add_u32 m0, s49, 2048
  v_mfma_f32_16x16x32_bf16 v[220:223], v[44:47], v[100:103], v[220:223]
  ds_read_b64_tr_b16 v[32:33], v14 offset:0
  s_add_u32 s48, s48, 128
  s_waitcnt lgkmcnt(6)
  v_mfma_f32_16x16x32_bf16 v[224:227], v[48:51], v[96:99], v[224:227]
  ds_read_b64_tr_b16 v[34:35], v14 offset:1536
  buffer_load_dwordx4 v5, s[8:11], s47 offen  lds
  v_mfma_f32_16x16x32_bf16 v[228:231], v[48:51], v[100:103], v[228:231]
  ds_read_b64_tr_b16 v[36:37], v15 offset:0
  v_mfma_f32_16x16x32_bf16 v[232:235], v[52:55], v[96:99], v[232:235]
  ds_read_b64_tr_b16 v[38:39], v15 offset:1536
  s_setprio 0
  buffer_load_dwordx4 v6, s[8:11], s47 offen offset:1024  lds
  v_mfma_f32_16x16x32_bf16 v[236:239], v[52:55], v[100:103], v[236:239]
  ds_read_b64_tr_b16 v[40:41], v16 offset:0
  s_waitcnt lgkmcnt(5)
  v_mfma_f32_16x16x32_bf16 v[240:243], v[56:59], v[96:99], v[240:243]
  ds_read_b64_tr_b16 v[42:43], v16 offset:1536
  buffer_store_dwordx4 v[140:143], v7, s[24:27], s44 offen offset:1024 sc1
  v_mfma_f32_16x16x32_bf16 v[244:247], v[56:59], v[100:103], v[244:247]
  ds_read_b64_tr_b16 v[44:45], v17 offset:0
  s_add_u32 s44, s44, 14336
  v_mfma_f32_16x16x32_bf16 v[248:251], v[60:63], v[96:99], v[248:251]
  ds_read_b64_tr_b16 v[46:47], v17 offset:1536
  v_mfma_f32_16x16x32_bf16 v[252:255], v[60:63], v[100:103], v[252:255]
  s_barrier
  ds_read_b64_tr_b16 v[48:49], v14 offset:128
  s_waitcnt lgkmcnt(5)
  v_mfma_f32_16x16x32_bf16 v[160:163], v[32:35], v[88:91], v[160:163]
  ds_read_b64_tr_b16 v[50:51], v14 offset:1664
  s_setprio 3
  v_mfma_f32_16x16x32_bf16 v[164:167], v[32:35], v[92:95], v[164:167]
  ds_read_b64_tr_b16 v[52:53], v15 offset:128
  v_mfma_f32_16x16x32_bf16 v[168:171], v[36:39], v[88:91], v[168:171]
  ds_read_b64_tr_b16 v[54:55], v15 offset:1664
  s_add_u32 m0, s49, 53248
  v_mfma_f32_16x16x32_bf16 v[172:175], v[36:39], v[92:95], v[172:175]
  ds_read_b64_tr_b16 v[56:57], v16 offset:128
  s_add_u32 s47, s48, 20480
  s_waitcnt lgkmcnt(5)
  v_mfma_f32_16x16x32_bf16 v[176:179], v[40:43], v[88:91], v[176:179]
  ds_read_b64_tr_b16 v[58:59], v16 offset:1664
  buffer_load_dwordx4 v5, s[8:11], s48 offen  lds
  v_mfma_f32_16x16x32_bf16 v[180:183], v[40:43], v[92:95], v[180:183]
  ds_read_b64_tr_b16 v[60:61], v17 offset:128
  v_mfma_f32_16x16x32_bf16 v[184:187], v[44:47], v[88:91], v[184:187]
  ds_read_b64_tr_b16 v[62:63], v17 offset:1664
  s_setprio 2
  v_mfma_f32_16x16x32_bf16 v[188:191], v[44:47], v[92:95], v[188:191]
  ds_read_b64_tr_b16 v[32:33], v14 offset:256
  s_waitcnt lgkmcnt(5)
  v_mfma_f32_16x16x32_bf16 v[192:195], v[48:51], v[88:91], v[192:195]
  ds_read_b64_tr_b16 v[34:35], v14 offset:1792
  v_mfma_f32_16x16x32_bf16 v[196:199], v[48:51], v[92:95], v[196:199]
  ds_read_b64_tr_b16 v[36:37], v15 offset:256
  v_mfma_f32_16x16x32_bf16 v[200:203], v[52:55], v[88:91], v[200:203]
  ds_read_b64_tr_b16 v[38:39], v15 offset:1792
  v_mfma_f32_16x16x32_bf16 v[204:207], v[52:55], v[92:95], v[204:207]
  ds_read_b64_tr_b16 v[40:41], v16 offset:256
  s_waitcnt lgkmcnt(5)
  v_mfma_f32_16x16x32_bf16 v[208:211], v[56:59], v[88:91], v[208:211]
  ds_read_b64_tr_b16 v[42:43], v16 offset:1792
  s_setprio 1
  buffer_load_dwordx4 v6, s[8:11], s48 offen offset:1024  lds
  v_mfma_f32_16x16x32_bf16 v[212:215], v[56:59], v[92:95], v[212:215]
  ds_read_b64_tr_b16 v[44:45], v17 offset:256
  v_mfma_f32_16x16x32_bf16 v[216:219], v[60:63], v[88:91], v[216:219]
  ds_read_b64_tr_b16 v[46:47], v17 offset:1792
  v_mfma_f32_16x16x32_bf16 v[220:223], v[60:63], v[92:95], v[220:223]
  ds_read_b64_tr_b16 v[48:49], v14 offset:12288
  s_waitcnt lgkmcnt(5)
  v_mfma_f32_16x16x32_bf16 v[224:227], v[32:35], v[88:91], v[224:227]
  ds_read_b64_tr_b16 v[50:51], v14 offset:13824
  v_mfma_f32_16x16x32_bf16 v[228:231], v[32:35], v[92:95], v[228:231]
  ds_read_b64_tr_b16 v[52:53], v15 offset:12288
  v_mfma_f32_16x16x32_bf16 v[232:235], v[36:39], v[88:91], v[232:235]
  ds_read_b64_tr_b16 v[54:55], v15 offset:13824
  s_setprio 0
  v_mfma_f32_16x16x32_bf16 v[236:239], v[36:39], v[92:95], v[236:239]
  ds_read_b64_tr_b16 v[56:57], v16 offset:12288
  s_waitcnt lgkmcnt(5)
  v_mfma_f32_16x16x32_bf16 v[240:243], v[40:43], v[88:91], v[240:243]
  ds_read_b64_tr_b16 v[58:59], v16 offset:13824
  buffer_store_dwordx4 v[144:147], v7, s[24:27], s44 offen offset:0 sc1
  v_mfma_f32_16x16x32_bf16 v[244:247], v[40:43], v[92:95], v[244:247]
  ds_read_b64_tr_b16 v[60:61], v17 offset:12288
  v_mfma_f32_16x16x32_bf16 v[248:251], v[44:47], v[88:91], v[248:251]
  ds_read_b64_tr_b16 v[62:63], v17 offset:13824
  v_mfma_f32_16x16x32_bf16 v[252:255], v[44:47], v[92:95], v[252:255]
  s_barrier
  ds_read_b64_tr_b16 v[32:33], v14 offset:12416
  v_add_u32 v18, 53248, v18
  s_waitcnt lgkmcnt(5)
  v_mfma_f32_16x16x32_bf16 v[160:163], v[48:51], v[72:75], v[160:163]
  ds_read_b64_tr_b16 v[34:35], v14 offset:13952
  s_setprio 3
  v_add_u32 v19, 53248, v19
  v_mfma_f32_16x16x32_bf16 v[164:167], v[48:51], v[76:79], v[164:167]
  ds_read_b64_tr_b16 v[36:37], v15 offset:12416
  v_mfma_f32_16x16x32_bf16 v[168:171], v[52:55], v[72:75], v[168:171]
  ds_read_b64_tr_b16 v[38:39], v15 offset:13952
  v_mfma_f32_16x16x32_bf16 v[172:175], v[52:55], v[76:79], v[172:175]
  ds_read_b64_tr_b16 v[40:41], v16 offset:12416
  s_waitcnt vmcnt(10)
  s_waitcnt lgkmcnt(5)
  v_mfma_f32_16x16x32_bf16 v[176:179], v[56:59], v[72:75], v[176:179]
  ds_read_b64_tr_b16 v[42:43], v16 offset:13952
  ds_read_b128 v[88:91], v18 offset:0
  v_mfma_f32_16x16x32_bf16 v[180:183], v[56:59], v[76:79], v[180:183]
  ds_read_b64_tr_b16 v[44:45], v17 offset:12416
  v_mfma_f32_16x16x32_bf16 v[184:187], v[60:63], v[72:75], v[184:187]
  ds_read_b64_tr_b16 v[46:47], v17 offset:13952
  ds_read_b128 v[92:95], v18 offset:2048
  s_setprio 2
  v_mfma_f32_16x16x32_bf16 v[188:191], v[60:63], v[76:79], v[188:191]
  ds_read_b64_tr_b16 v[48:49], v14 offset:12544
  s_waitcnt lgkmcnt(7)
  v_mfma_f32_16x16x32_bf16 v[192:195], v[32:35], v[72:75], v[192:195]
  ds_read_b64_tr_b16 v[50:51], v14 offset:14080
  ds_read_b128 v[96:99], v19 offset:0
  v_add_u32 v14, 53248, v14
  v_mfma_f32_16x16x32_bf16 v[196:199], v[32:35], v[76:79], v[196:199]
  ds_read_b64_tr_b16 v[52:53], v15 offset:12544
  v_mfma_f32_16x16x32_bf16 v[200:203], v[36:39], v[72:75], v[200:203]
  ds_read_b64_tr_b16 v[54:55], v15 offset:14080
  ds_read_b128 v[100:103], v19 offset:2048
  v_add_u32 v15, 53248, v15
  v_mfma_f32_16x16x32_bf16 v[204:207], v[36:39], v[76:79], v[204:207]
  ds_read_b64_tr_b16 v[56:57], v16 offset:12544
  s_waitcnt lgkmcnt(8)
  v_mfma_f32_16x16x32_bf16 v[208:211], v[40:43], v[72:75], v[208:211]
  ds_read_b64_tr_b16 v[58:59], v16 offset:14080
  s_setprio 1
  v_add_u32 v16, 53248, v16
  v_mfma_f32_16x16x32_bf16 v[212:215], v[40:43], v[76:79], v[212:215]
  ds_read_b64_tr_b16 v[60:61], v17 offset:12544
  v_mfma_f32_16x16x32_bf16 v[216:219], v[44:47], v[72:75], v[216:219]
  ds_read_b64_tr_b16 v[62:63], v17 offset:14080
  v_add_u32 v17, 53248, v17
  s_add_u32 m0, s49, 55296
  v_mfma_f32_16x16x32_bf16 v[220:223], v[44:47], v[76:79], v[220:223]
  ds_read_b64_tr_b16 v[32:33], v14 offset:0
  s_add_u32 s48, s48, 128
  s_waitcnt lgkmcnt(6)
  v_mfma_f32_16x16x32_bf16 v[224:227], v[48:51], v[72:75], v[224:227]
  ds_read_b64_tr_b16 v[34:35], v14 offset:1536
  buffer_load_dwordx4 v5, s[8:11], s47 offen  lds
  v_mfma_f32_16x16x32_bf16 v[228:231], v[48:51], v[76:79], v[228:231]
  ds_read_b64_tr_b16 v[36:37], v15 offset:0
  v_mfma_f32_16x16x32_bf16 v[232:235], v[52:55], v[72:75], v[232:235]
  ds_read_b64_tr_b16 v[38:39], v15 offset:1536
  s_setprio 0
  buffer_load_dwordx4 v6, s[8:11], s47 offen offset:1024  lds
  v_mfma_f32_16x16x32_bf16 v[236:239], v[52:55], v[76:79], v[236:239]
  ds_read_b64_tr_b16 v[40:41], v16 offset:0
  s_waitcnt lgkmcnt(5)
  v_mfma_f32_16x16x32_bf16 v[240:243], v[56:59], v[72:75], v[240:243]
  ds_read_b64_tr_b16 v[42:43], v16 offset:1536
  buffer_store_dwordx4 v[148:151], v7, s[24:27], s44 offen offset:1024 sc1
  v_mfma_f32_16x16x32_bf16 v[244:247], v[56:59], v[76:79], v[244:247]
  ds_read_b64_tr_b16 v[44:45], v17 offset:0
  s_add_u32 s44, s44, 14336
  v_mfma_f32_16x16x32_bf16 v[248:251], v[60:63], v[72:75], v[248:251]
  ds_read_b64_tr_b16 v[46:47], v17 offset:1536
  v_mfma_f32_16x16x32_bf16 v[252:255], v[60:63], v[76:79], v[252:255]
  s_barrier
  ds_read_b64_tr_b16 v[48:49], v14 offset:128
  s_waitcnt lgkmcnt(5)
  v_mfma_f32_16x16x32_bf16 v[160:163], v[32:35], v[88:91], v[160:163]
  ds_read_b64_tr_b16 v[50:51], v14 offset:1664
  s_setprio 3
  v_mfma_f32_16x16x32_bf16 v[164:167], v[32:35], v[92:95], v[164:167]
  ds_read_b64_tr_b16 v[52:53], v15 offset:128
  v_mfma_f32_16x16x32_bf16 v[168:171], v[36:39], v[88:91], v[168:171]
  ds_read_b64_tr_b16 v[54:55], v15 offset:1664
  s_add_u32 m0, s49, 106496
  v_mfma_f32_16x16x32_bf16 v[172:175], v[36:39], v[92:95], v[172:175]
  ds_read_b64_tr_b16 v[56:57], v16 offset:128
  s_add_u32 s47, s48, 20480
  s_waitcnt lgkmcnt(5)
  v_mfma_f32_16x16x32_bf16 v[176:179], v[40:43], v[88:91], v[176:179]
  ds_read_b64_tr_b16 v[58:59], v16 offset:1664
  buffer_load_dwordx4 v5, s[8:11], s48 offen  lds
  v_mfma_f32_16x16x32_bf16 v[180:183], v[40:43], v[92:95], v[180:183]
  ds_read_b64_tr_b16 v[60:61], v17 offset:128
  v_mfma_f32_16x16x32_bf16 v[184:187], v[44:47], v[88:91], v[184:187]
  ds_read_b64_tr_b16 v[62:63], v17 offset:1664
  s_setprio 2
  v_mfma_f32_16x16x32_bf16 v[188:191], v[44:47], v[92:95], v[188:191]
  ds_read_b64_tr_b16 v[32:33], v14 offset:256
  s_waitcnt lgkmcnt(5)
  v_mfma_f32_16x16x32_bf16 v[192:195], v[48:51], v[88:91], v[192:195]
  ds_read_b64_tr_b16 v[34:35], v14 offset:1792
  v_mfma_f32_16x16x32_bf16 v[196:199], v[48:51], v[92:95], v[196:199]
  ds_read_b64_tr_b16 v[36:37], v15 offset:256
  v_mfma_f32_16x16x32_bf16 v[200:203], v[52:55], v[88:91], v[200:203]
  ds_read_b64_tr_b16 v[38:39], v15 offset:1792
  v_mfma_f32_16x16x32_bf16 v[204:207], v[52:55], v[92:95], v[204:207]
  ds_read_b64_tr_b16 v[40:41], v16 offset:256
  s_waitcnt lgkmcnt(5)
  v_mfma_f32_16x16x32_bf16 v[208:211], v[56:59], v[88:91], v[208:211]
  ds_read_b64_tr_b16 v[42:43], v16 offset:1792
  s_setprio 1
  buffer_load_dwordx4 v6, s[8:11], s48 offen offset:1024  lds
  v_mfma_f32_16x16x32_bf16 v[212:215], v[56:59], v[92:95], v[212:215]
  ds_read_b64_tr_b16 v[44:45], v17 offset:256
  v_mfma_f32_16x16x32_bf16 v[216:219], v[60:63], v[88:91], v[216:219]
  ds_read_b64_tr_b16 v[46:47], v17 offset:1792
  v_mfma_f32_16x16x32_bf16 v[220:223], v[60:63], v[92:95], v[220:223]
  ds_read_b64_tr_b16 v[48:49], v14 offset:12288
  s_waitcnt lgkmcnt(5)
  v_mfma_f32_16x16x32_bf16 v[224:227], v[32:35], v[88:91], v[224:227]
  ds_read_b64_tr_b16 v[50:51], v14 offset:13824
  v_mfma_f32_16x16x32_bf16 v[228:231], v[32:35], v[92:95], v[228:231]
  ds_read_b64_tr_b16 v[52:53], v15 offset:12288
  v_mfma_f32_16x16x32_bf16 v[232:235], v[36:39], v[88:91], v[232:235]
  ds_read_b64_tr_b16 v[54:55], v15 offset:13824
  s_setprio 0
  v_mfma_f32_16x16x32_bf16 v[236:239], v[36:39], v[92:95], v[236:239]
  ds_read_b64_tr_b16 v[56:57], v16 offset:12288
  s_waitcnt lgkmcnt(5)
  v_mfma_f32_16x16x32_bf16 v[240:243], v[40:43], v[88:91], v[240:243]
  ds_read_b64_tr_b16 v[58:59], v16 offset:13824
  buffer_store_dwordx4 v[152:155], v7, s[24:27], s44 offen offset:0 sc1
  v_mfma_f32_16x16x32_bf16 v[244:247], v[40:43], v[92:95], v[244:247]
  ds_read_b64_tr_b16 v[60:61], v17 offset:12288
  v_mfma_f32_16x16x32_bf16 v[248:251], v[44:47], v[88:91], v[248:251]
  ds_read_b64_tr_b16 v[62:63], v17 offset:13824
  v_mfma_f32_16x16x32_bf16 v[252:255], v[44:47], v[92:95], v[252:255]
  s_barrier
  ds_read_b64_tr_b16 v[32:33], v14 offset:12416
  v_add_u32 v18, 4294860800, v18
  s_waitcnt lgkmcnt(5)
  v_mfma_f32_16x16x32_bf16 v[160:163], v[48:51], v[96:99], v[160:163]
  ds_read_b64_tr_b16 v[34:35], v14 offset:13952
  s_setprio 3
  v_add_u32 v19, 4294860800, v19
  v_mfma_f32_16x16x32_bf16 v[164:167], v[48:51], v[100:103], v[164:167]
  ds_read_b64_tr_b16 v[36:37], v15 offset:12416
  v_mfma_f32_16x16x32_bf16 v[168:171], v[52:55], v[96:99], v[168:171]
  ds_read_b64_tr_b16 v[38:39], v15 offset:13952
  v_mfma_f32_16x16x32_bf16 v[172:175], v[52:55], v[100:103], v[172:175]
  ds_read_b64_tr_b16 v[40:41], v16 offset:12416
  s_waitcnt vmcnt(10)
  s_waitcnt lgkmcnt(5)
  v_mfma_f32_16x16x32_bf16 v[176:179], v[56:59], v[96:99], v[176:179]
  ds_read_b64_tr_b16 v[42:43], v16 offset:13952
  ds_read_b128 v[88:91], v18 offset:0
  v_mfma_f32_16x16x32_bf16 v[180:183], v[56:59], v[100:103], v[180:183]
  ds_read_b64_tr_b16 v[44:45], v17 offset:12416
  v_mfma_f32_16x16x32_bf16 v[184:187], v[60:63], v[96:99], v[184:187]
  ds_read_b64_tr_b16 v[46:47], v17 offset:13952
  ds_read_b128 v[92:95], v18 offset:2048
  s_setprio 2
  v_mfma_f32_16x16x32_bf16 v[188:191], v[60:63], v[100:103], v[188:191]
  ds_read_b64_tr_b16 v[48:49], v14 offset:12544
  s_waitcnt lgkmcnt(7)
  v_mfma_f32_16x16x32_bf16 v[192:195], v[32:35], v[96:99], v[192:195]
  ds_read_b64_tr_b16 v[50:51], v14 offset:14080
  ds_read_b128 v[72:75], v19 offset:0
  v_add_u32 v14, 4294860800, v14
  v_mfma_f32_16x16x32_bf16 v[196:199], v[32:35], v[100:103], v[196:199]
  ds_read_b64_tr_b16 v[52:53], v15 offset:12544
  v_mfma_f32_16x16x32_bf16 v[200:203], v[36:39], v[96:99], v[200:203]
  ds_read_b64_tr_b16 v[54:55], v15 offset:14080
  ds_read_b128 v[76:79], v19 offset:2048
  v_add_u32 v15, 4294860800, v15
  v_mfma_f32_16x16x32_bf16 v[204:207], v[36:39], v[100:103], v[204:207]
  ds_read_b64_tr_b16 v[56:57], v16 offset:12544
  s_waitcnt lgkmcnt(8)
  v_mfma_f32_16x16x32_bf16 v[208:211], v[40:43], v[96:99], v[208:211]
  ds_read_b64_tr_b16 v[58:59], v16 offset:14080
  s_setprio 1
  v_add_u32 v16, 4294860800, v16
  v_mfma_f32_16x16x32_bf16 v[212:215], v[40:43], v[100:103], v[212:215]
  ds_read_b64_tr_b16 v[60:61], v17 offset:12544
  v_mfma_f32_16x16x32_bf16 v[216:219], v[44:47], v[96:99], v[216:219]
  ds_read_b64_tr_b16 v[62:63], v17 offset:14080
  v_add_u32 v17, 4294860800, v17
  s_add_u32 m0, s49, 108544
  v_mfma_f32_16x16x32_bf16 v[220:223], v[44:47], v[100:103], v[220:223]
  ds_read_b64_tr_b16 v[32:33], v14 offset:0
  s_add_u32 s48, s48, 128
  s_waitcnt lgkmcnt(6)
  v_mfma_f32_16x16x32_bf16 v[224:227], v[48:51], v[96:99], v[224:227]
  ds_read_b64_tr_b16 v[34:35], v14 offset:1536
  buffer_load_dwordx4 v5, s[8:11], s47 offen  lds
  v_mfma_f32_16x16x32_bf16 v[228:231], v[48:51], v[100:103], v[228:231]
  ds_read_b64_tr_b16 v[36:37], v15 offset:0
  v_mfma_f32_16x16x32_bf16 v[232:235], v[52:55], v[96:99], v[232:235]
  ds_read_b64_tr_b16 v[38:39], v15 offset:1536
  s_setprio 0
  buffer_load_dwordx4 v6, s[8:11], s47 offen offset:1024  lds
  v_mfma_f32_16x16x32_bf16 v[236:239], v[52:55], v[100:103], v[236:239]
  ds_read_b64_tr_b16 v[40:41], v16 offset:0
  s_waitcnt lgkmcnt(5)
  v_mfma_f32_16x16x32_bf16 v[240:243], v[56:59], v[96:99], v[240:243]
  ds_read_b64_tr_b16 v[42:43], v16 offset:1536
  buffer_store_dwordx4 v[156:159], v7, s[24:27], s44 offen offset:1024 sc1
  v_mfma_f32_16x16x32_bf16 v[244:247], v[56:59], v[100:103], v[244:247]
  ds_read_b64_tr_b16 v[44:45], v17 offset:0
  s_add_u32 s44, s44, 14336
  v_mfma_f32_16x16x32_bf16 v[248:251], v[60:63], v[96:99], v[248:251]
  ds_read_b64_tr_b16 v[46:47], v17 offset:1536
  v_mfma_f32_16x16x32_bf16 v[252:255], v[60:63], v[100:103], v[252:255]
  s_barrier
  ds_read_b64_tr_b16 v[48:49], v14 offset:128
  s_waitcnt lgkmcnt(5)
  v_mfma_f32_16x16x32_bf16 v[160:163], v[32:35], v[88:91], v[160:163]
  ds_read_b64_tr_b16 v[50:51], v14 offset:1664
  s_setprio 3
  v_mfma_f32_16x16x32_bf16 v[164:167], v[32:35], v[92:95], v[164:167]
  ds_read_b64_tr_b16 v[52:53], v15 offset:128
  v_mfma_f32_16x16x32_bf16 v[168:171], v[36:39], v[88:91], v[168:171]
  ds_read_b64_tr_b16 v[54:55], v15 offset:1664
  s_add_u32 m0, s49, 0
  v_mfma_f32_16x16x32_bf16 v[172:175], v[36:39], v[92:95], v[172:175]
  ds_read_b64_tr_b16 v[56:57], v16 offset:128
  s_add_u32 s47, s48, 20480
  s_waitcnt lgkmcnt(5)
  v_mfma_f32_16x16x32_bf16 v[176:179], v[40:43], v[88:91], v[176:179]
  ds_read_b64_tr_b16 v[58:59], v16 offset:1664
  buffer_load_dwordx4 v5, s[8:11], s48 offen  lds
  v_mfma_f32_16x16x32_bf16 v[180:183], v[40:43], v[92:95], v[180:183]
  ds_read_b64_tr_b16 v[60:61], v17 offset:128
  v_mfma_f32_16x16x32_bf16 v[184:187], v[44:47], v[88:91], v[184:187]
  ds_read_b64_tr_b16 v[62:63], v17 offset:1664
  s_setprio 2
  v_mfma_f32_16x16x32_bf16 v[188:191], v[44:47], v[92:95], v[188:191]
  ds_read_b64_tr_b16 v[32:33], v14 offset:256
  s_waitcnt lgkmcnt(5)
  v_mfma_f32_16x16x32_bf16 v[192:195], v[48:51], v[88:91], v[192:195]
  ds_read_b64_tr_b16 v[34:35], v14 offset:1792
  v_mfma_f32_16x16x32_bf16 v[196:199], v[48:51], v[92:95], v[196:199]
  ds_read_b64_tr_b16 v[36:37], v15 offset:256
  v_mfma_f32_16x16x32_bf16 v[200:203], v[52:55], v[88:91], v[200:203]
  ds_read_b64_tr_b16 v[38:39], v15 offset:1792
  v_mfma_f32_16x16x32_bf16 v[204:207], v[52:55], v[92:95], v[204:207]
  ds_read_b64_tr_b16 v[40:41], v16 offset:256
  s_waitcnt lgkmcnt(5)
  v_mfma_f32_16x16x32_bf16 v[208:211], v[56:59], v[88:91], v[208:211]
  ds_read_b64_tr_b16 v[42:43], v16 offset:1792
  s_setprio 1
  buffer_load_dwordx4 v6, s[8:11], s48 offen offset:1024  lds
  v_mfma_f32_16x16x32_bf16 v[212:215], v[56:59], v[92:95], v[212:215]
  ds_read_b64_tr_b16 v[44:45], v17 offset:256
  v_mfma_f32_16x16x32_bf16 v[216:219], v[60:63], v[88:91], v[216:219]
  ds_read_b64_tr_b16 v[46:47], v17 offset:1792
  v_mfma_f32_16x16x32_bf16 v[220:223], v[60:63], v[92:95], v[220:223]
  ds_read_b64_tr_b16 v[48:49], v14 offset:12288
  s_waitcnt lgkmcnt(5)
  v_mfma_f32_16x16x32_bf16 v[224:227], v[32:35], v[88:91], v[224:227]
  ds_read_b64_tr_b16 v[50:51], v14 offset:13824
  v_mfma_f32_16x16x32_bf16 v[228:231], v[32:35], v[92:95], v[228:231]
  ds_read_b64_tr_b16 v[52:53], v15 offset:12288
  v_mfma_f32_16x16x32_bf16 v[232:235], v[36:39], v[88:91], v[232:235]
  ds_read_b64_tr_b16 v[54:55], v15 offset:13824
  s_setprio 0
  v_mfma_f32_16x16x32_bf16 v[236:239], v[36:39], v[92:95], v[236:239]
  ds_read_b64_tr_b16 v[56:57], v16 offset:12288
  s_waitcnt lgkmcnt(5)
  v_mfma_f32_16x16x32_bf16 v[240:243], v[40:43], v[88:91], v[240:243]
  ds_read_b64_tr_b16 v[58:59], v16 offset:13824
  v_mfma_f32_16x16x32_bf16 v[244:247], v[40:43], v[92:95], v[244:247]
  ds_read_b64_tr_b16 v[60:61], v17 offset:12288
  v_mfma_f32_16x16x32_bf16 v[248:251], v[44:47], v[88:91], v[248:251]
  ds_read_b64_tr_b16 v[62:63], v17 offset:13824
  v_mfma_f32_16x16x32_bf16 v[252:255], v[44:47], v[92:95], v[252:255]
  s_barrier
  ds_read_b64_tr_b16 v[32:33], v14 offset:12416
  v_add_u32 v18, 53248, v18
  s_waitcnt lgkmcnt(5)
  v_mfma_f32_16x16x32_bf16 v[160:163], v[48:51], v[72:75], v[160:163]
  ds_read_b64_tr_b16 v[34:35], v14 offset:13952
  s_setprio 3
  v_add_u32 v19, 53248, v19
  v_mfma_f32_16x16x32_bf16 v[164:167], v[48:51], v[76:79], v[164:167]
  ds_read_b64_tr_b16 v[36:37], v15 offset:12416
  v_mfma_f32_16x16x32_bf16 v[168:171], v[52:55], v[72:75], v[168:171]
  ds_read_b64_tr_b16 v[38:39], v15 offset:13952
  v_mfma_f32_16x16x32_bf16 v[172:175], v[52:55], v[76:79], v[172:175]
  ds_read_b64_tr_b16 v[40:41], v16 offset:12416
  s_waitcnt vmcnt(9)
  s_waitcnt lgkmcnt(5)
  v_mfma_f32_16x16x32_bf16 v[176:179], v[56:59], v[72:75], v[176:179]
  ds_read_b64_tr_b16 v[42:43], v16 offset:13952
  ds_read_b128 v[88:91], v18 offset:0
  v_mfma_f32_16x16x32_bf16 v[180:183], v[56:59], v[76:79], v[180:183]
  ds_read_b64_tr_b16 v[44:45], v17 offset:12416
  v_mfma_f32_16x16x32_bf16 v[184:187], v[60:63], v[72:75], v[184:187]
  ds_read_b64_tr_b16 v[46:47], v17 offset:13952
  ds_read_b128 v[92:95], v18 offset:2048
  s_setprio 2
  v_mfma_f32_16x16x32_bf16 v[188:191], v[60:63], v[76:79], v[188:191]
  ds_read_b64_tr_b16 v[48:49], v14 offset:12544
  s_waitcnt lgkmcnt(7)
  v_mfma_f32_16x16x32_bf16 v[192:195], v[32:35], v[72:75], v[192:195]
  ds_read_b64_tr_b16 v[50:51], v14 offset:14080
  ds_read_b128 v[96:99], v19 offset:0
  v_add_u32 v14, 53248, v14
  v_mfma_f32_16x16x32_bf16 v[196:199], v[32:35], v[76:79], v[196:199]
  ds_read_b64_tr_b16 v[52:53], v15 offset:12544
  v_mfma_f32_16x16x32_bf16 v[200:203], v[36:39], v[72:75], v[200:203]
  ds_read_b64_tr_b16 v[54:55], v15 offset:14080
  ds_read_b128 v[100:103], v19 offset:2048
  v_add_u32 v15, 53248, v15
  v_mfma_f32_16x16x32_bf16 v[204:207], v[36:39], v[76:79], v[204:207]
  ds_read_b64_tr_b16 v[56:57], v16 offset:12544
  s_waitcnt lgkmcnt(8)
  v_mfma_f32_16x16x32_bf16 v[208:211], v[40:43], v[72:75], v[208:211]
  ds_read_b64_tr_b16 v[58:59], v16 offset:14080
  s_setprio 1
  v_add_u32 v16, 53248, v16
  v_mfma_f32_16x16x32_bf16 v[212:215], v[40:43], v[76:79], v[212:215]
  ds_read_b64_tr_b16 v[60:61], v17 offset:12544
  v_mfma_f32_16x16x32_bf16 v[216:219], v[44:47], v[72:75], v[216:219]
  ds_read_b64_tr_b16 v[62:63], v17 offset:14080
  v_add_u32 v17, 53248, v17
  s_add_u32 m0, s49, 2048
  v_mfma_f32_16x16x32_bf16 v[220:223], v[44:47], v[76:79], v[220:223]
  ds_read_b64_tr_b16 v[32:33], v14 offset:0
  s_add_u32 s48, s48, 128
  s_waitcnt lgkmcnt(6)
  v_mfma_f32_16x16x32_bf16 v[224:227], v[48:51], v[72:75], v[224:227]
  ds_read_b64_tr_b16 v[34:35], v14 offset:1536
  buffer_load_dwordx4 v5, s[8:11], s47 offen  lds
  v_mfma_f32_16x16x32_bf16 v[228:231], v[48:51], v[76:79], v[228:231]
  ds_read_b64_tr_b16 v[36:37], v15 offset:0
  v_mfma_f32_16x16x32_bf16 v[232:235], v[52:55], v[72:75], v[232:235]
  ds_read_b64_tr_b16 v[38:39], v15 offset:1536
  s_setprio 0
  buffer_load_dwordx4 v6, s[8:11], s47 offen offset:1024  lds
  v_mfma_f32_16x16x32_bf16 v[236:239], v[52:55], v[76:79], v[236:239]
  ds_read_b64_tr_b16 v[40:41], v16 offset:0
  s_waitcnt lgkmcnt(5)
  v_mfma_f32_16x16x32_bf16 v[240:243], v[56:59], v[72:75], v[240:243]
  ds_read_b64_tr_b16 v[42:43], v16 offset:1536
  v_mfma_f32_16x16x32_bf16 v[244:247], v[56:59], v[76:79], v[244:247]
  ds_read_b64_tr_b16 v[44:45], v17 offset:0
  v_mfma_f32_16x16x32_bf16 v[248:251], v[60:63], v[72:75], v[248:251]
  ds_read_b64_tr_b16 v[46:47], v17 offset:1536
  v_mfma_f32_16x16x32_bf16 v[252:255], v[60:63], v[76:79], v[252:255]
  s_barrier
  ds_read_b64_tr_b16 v[48:49], v14 offset:128
  s_waitcnt lgkmcnt(5)
  v_mfma_f32_16x16x32_bf16 v[160:163], v[32:35], v[88:91], v[160:163]
  ds_read_b64_tr_b16 v[50:51], v14 offset:1664
  s_setprio 3
  v_mfma_f32_16x16x32_bf16 v[164:167], v[32:35], v[92:95], v[164:167]
  ds_read_b64_tr_b16 v[52:53], v15 offset:128
  v_mfma_f32_16x16x32_bf16 v[168:171], v[36:39], v[88:91], v[168:171]
  ds_read_b64_tr_b16 v[54:55], v15 offset:1664
  v_mfma_f32_16x16x32_bf16 v[172:175], v[36:39], v[92:95], v[172:175]
  ds_read_b64_tr_b16 v[56:57], v16 offset:128
  s_waitcnt lgkmcnt(5)
  v_mfma_f32_16x16x32_bf16 v[176:179], v[40:43], v[88:91], v[176:179]
  ds_read_b64_tr_b16 v[58:59], v16 offset:1664
  v_mfma_f32_16x16x32_bf16 v[180:183], v[40:43], v[92:95], v[180:183]
  ds_read_b64_tr_b16 v[60:61], v17 offset:128
  v_mfma_f32_16x16x32_bf16 v[184:187], v[44:47], v[88:91], v[184:187]
  ds_read_b64_tr_b16 v[62:63], v17 offset:1664
  s_setprio 2
  v_mfma_f32_16x16x32_bf16 v[188:191], v[44:47], v[92:95], v[188:191]
  ds_read_b64_tr_b16 v[32:33], v14 offset:256
  s_waitcnt lgkmcnt(5)
  v_mfma_f32_16x16x32_bf16 v[192:195], v[48:51], v[88:91], v[192:195]
  ds_read_b64_tr_b16 v[34:35], v14 offset:1792
  v_mfma_f32_16x16x32_bf16 v[196:199], v[48:51], v[92:95], v[196:199]
  ds_read_b64_tr_b16 v[36:37], v15 offset:256
  v_mfma_f32_16x16x32_bf16 v[200:203], v[52:55], v[88:91], v[200:203]
  ds_read_b64_tr_b16 v[38:39], v15 offset:1792
  v_mfma_f32_16x16x32_bf16 v[204:207], v[52:55], v[92:95], v[204:207]
  ds_read_b64_tr_b16 v[40:41], v16 offset:256
  s_waitcnt lgkmcnt(5)
  v_mfma_f32_16x16x32_bf16 v[208:211], v[56:59], v[88:91], v[208:211]
  ds_read_b64_tr_b16 v[42:43], v16 offset:1792
  s_setprio 1
  v_mfma_f32_16x16x32_bf16 v[212:215], v[56:59], v[92:95], v[212:215]
  ds_read_b64_tr_b16 v[44:45], v17 offset:256
  v_mfma_f32_16x16x32_bf16 v[216:219], v[60:63], v[88:91], v[216:219]
  ds_read_b64_tr_b16 v[46:47], v17 offset:1792
  v_mfma_f32_16x16x32_bf16 v[220:223], v[60:63], v[92:95], v[220:223]
  ds_read_b64_tr_b16 v[48:49], v14 offset:12288
  s_waitcnt lgkmcnt(5)
  v_mfma_f32_16x16x32_bf16 v[224:227], v[32:35], v[88:91], v[224:227]
  ds_read_b64_tr_b16 v[50:51], v14 offset:13824
  v_mfma_f32_16x16x32_bf16 v[228:231], v[32:35], v[92:95], v[228:231]
  ds_read_b64_tr_b16 v[52:53], v15 offset:12288
  v_mfma_f32_16x16x32_bf16 v[232:235], v[36:39], v[88:91], v[232:235]
  ds_read_b64_tr_b16 v[54:55], v15 offset:13824
  s_setprio 0
  v_mfma_f32_16x16x32_bf16 v[236:239], v[36:39], v[92:95], v[236:239]
  ds_read_b64_tr_b16 v[56:57], v16 offset:12288
  s_waitcnt lgkmcnt(5)
  v_mfma_f32_16x16x32_bf16 v[240:243], v[40:43], v[88:91], v[240:243]
  ds_read_b64_tr_b16 v[58:59], v16 offset:13824
  v_mfma_f32_16x16x32_bf16 v[244:247], v[40:43], v[92:95], v[244:247]
  ds_read_b64_tr_b16 v[60:61], v17 offset:12288
  v_mfma_f32_16x16x32_bf16 v[248:251], v[44:47], v[88:91], v[248:251]
  ds_read_b64_tr_b16 v[62:63], v17 offset:13824
  v_mfma_f32_16x16x32_bf16 v[252:255], v[44:47], v[92:95], v[252:255]
  s_barrier
  ds_read_b64_tr_b16 v[32:33], v14 offset:12416
  v_add_u32 v18, 53248, v18
  s_waitcnt lgkmcnt(5)
  v_mfma_f32_16x16x32_bf16 v[160:163], v[48:51], v[96:99], v[160:163]
  ds_read_b64_tr_b16 v[34:35], v14 offset:13952
  s_setprio 3
  v_add_u32 v19, 53248, v19
  v_mfma_f32_16x16x32_bf16 v[164:167], v[48:51], v[100:103], v[164:167]
  ds_read_b64_tr_b16 v[36:37], v15 offset:12416
  v_mfma_f32_16x16x32_bf16 v[168:171], v[52:55], v[96:99], v[168:171]
  ds_read_b64_tr_b16 v[38:39], v15 offset:13952
  v_mfma_f32_16x16x32_bf16 v[172:175], v[52:55], v[100:103], v[172:175]
  ds_read_b64_tr_b16 v[40:41], v16 offset:12416
  s_waitcnt vmcnt(5)
  s_waitcnt lgkmcnt(5)
  v_mfma_f32_16x16x32_bf16 v[176:179], v[56:59], v[96:99], v[176:179]
  ds_read_b64_tr_b16 v[42:43], v16 offset:13952
  ds_read_b128 v[88:91], v18 offset:0
  v_xor_b32 v64, 0, v21
  v_mfma_f32_16x16x32_bf16 v[180:183], v[56:59], v[100:103], v[180:183]
  ds_read_b64_tr_b16 v[44:45], v17 offset:12416
  v_xor_b32 v65, 32, v21
  v_mfma_f32_16x16x32_bf16 v[184:187], v[60:63], v[96:99], v[184:187]
  ds_read_b64_tr_b16 v[46:47], v17 offset:13952
  ds_read_b128 v[92:95], v18 offset:2048
  s_setprio 2
  v_xor_b32 v66, 64, v21
  v_mfma_f32_16x16x32_bf16 v[188:191], v[60:63], v[100:103], v[188:191]
  ds_read_b64_tr_b16 v[48:49], v14 offset:12544
  v_xor_b32 v67, 96, v21
  s_waitcnt lgkmcnt(7)
  v_mfma_f32_16x16x32_bf16 v[192:195], v[32:35], v[96:99], v[192:195]
  ds_read_b64_tr_b16 v[50:51], v14 offset:14080
  ds_read_b128 v[72:75], v19 offset:0
  v_add_u32 v14, 53248, v14
  v_mfma_f32_16x16x32_bf16 v[196:199], v[32:35], v[100:103], v[196:199]
  ds_read_b64_tr_b16 v[52:53], v15 offset:12544
  v_mfma_f32_16x16x32_bf16 v[200:203], v[36:39], v[96:99], v[200:203]
  ds_read_b64_tr_b16 v[54:55], v15 offset:14080
  ds_read_b128 v[76:79], v19 offset:2048
  v_add_u32 v15, 53248, v15
  v_mfma_f32_16x16x32_bf16 v[204:207], v[36:39], v[100:103], v[204:207]
  ds_read_b64_tr_b16 v[56:57], v16 offset:12544
  s_waitcnt lgkmcnt(8)
  v_mfma_f32_16x16x32_bf16 v[208:211], v[40:43], v[96:99], v[208:211]
  ds_read_b64_tr_b16 v[58:59], v16 offset:14080
  s_setprio 1
  v_add_u32 v16, 53248, v16
  v_mfma_f32_16x16x32_bf16 v[212:215], v[40:43], v[100:103], v[212:215]
  ds_read_b64_tr_b16 v[60:61], v17 offset:12544
  v_mfma_f32_16x16x32_bf16 v[216:219], v[44:47], v[96:99], v[216:219]
  ds_read_b64_tr_b16 v[62:63], v17 offset:14080
  v_add_u32 v17, 53248, v17
  v_mfma_f32_16x16x32_bf16 v[220:223], v[44:47], v[100:103], v[220:223]
  ds_read_b64_tr_b16 v[32:33], v14 offset:0
  s_waitcnt lgkmcnt(6)
  v_mfma_f32_16x16x32_bf16 v[224:227], v[48:51], v[96:99], v[224:227]
  ds_read_b64_tr_b16 v[34:35], v14 offset:1536
  v_mfma_f32_16x16x32_bf16 v[228:231], v[48:51], v[100:103], v[228:231]
  ds_read_b64_tr_b16 v[36:37], v14 offset:12288
  v_mfma_f32_16x16x32_bf16 v[232:235], v[52:55], v[96:99], v[232:235]
  ds_read_b64_tr_b16 v[38:39], v14 offset:13824
  s_setprio 0
  v_mfma_f32_16x16x32_bf16 v[236:239], v[52:55], v[100:103], v[236:239]
  ds_read_b64_tr_b16 v[40:41], v15 offset:0
  v_add_u32 v18, 4294860800, v18
  s_waitcnt lgkmcnt(5)
  v_mfma_f32_16x16x32_bf16 v[240:243], v[56:59], v[96:99], v[240:243]
  ds_read_b64_tr_b16 v[42:43], v15 offset:1536
  v_add_u32 v19, 4294860800, v19
  v_mfma_f32_16x16x32_bf16 v[244:247], v[56:59], v[100:103], v[244:247]
  ds_read_b64_tr_b16 v[44:45], v15 offset:12288
  v_mfma_f32_16x16x32_bf16 v[248:251], v[60:63], v[96:99], v[248:251]
  ds_read_b64_tr_b16 v[46:47], v15 offset:13824
  v_mfma_f32_16x16x32_bf16 v[252:255], v[60:63], v[100:103], v[252:255]
  s_sub_u32 s48, s48, 1280
  s_barrier
  s_waitcnt vmcnt(0)
  ds_read_b64_tr_b16 v[48:49], v64 offset:0
  ds_read_b128 v[80:83], v18 offset:0
  s_waitcnt lgkmcnt(6)
  v_mfma_f32_16x16x32_bf16 v[160:163], v[32:35], v[88:91], v[160:163]
  ds_read_b64_tr_b16 v[50:51], v64 offset:1536
  ds_read_b128 v[84:87], v18 offset:2048
  s_setprio 3
  v_mfma_f32_16x16x32_bf16 v[164:167], v[32:35], v[92:95], v[164:167]
  ds_read_b64_tr_b16 v[52:53], v64 offset:12288
  ds_read_b128 v[104:107], v19 offset:0
  v_mfma_f32_16x16x32_bf16 v[160:163], v[36:39], v[72:75], v[160:163]
  ds_read_b64_tr_b16 v[54:55], v64 offset:13824
  ds_read_b128 v[108:111], v19 offset:2048
  v_mfma_f32_16x16x32_bf16 v[164:167], v[36:39], v[76:79], v[164:167]
  ds_read_b64_tr_b16 v[56:57], v65 offset:0
  s_waitcnt lgkmcnt(9)
  v_mfma_f32_16x16x32_bf16 v[168:171], v[40:43], v[88:91], v[168:171]
  ds_read_b64_tr_b16 v[58:59], v65 offset:1536
  v_mfma_f32_16x16x32_bf16 v[172:175], v[40:43], v[92:95], v[172:175]
  ds_read_b64_tr_b16 v[60:61], v65 offset:12288
  v_mfma_f32_16x16x32_bf16 v[168:171], v[44:47], v[72:75], v[168:171]
  ds_read_b64_tr_b16 v[62:63], v65 offset:13824
  v_mfma_f32_16x16x32_bf16 v[172:175], v[44:47], v[76:79], v[172:175]
  ds_read_b64_tr_b16 v[32:33], v16 offset:0
  s_waitcnt lgkmcnt(6)
  v_mfma_f32_16x16x32_bf16 v[160:163], v[48:51], v[80:83], v[160:163]
  ds_read_b64_tr_b16 v[34:35], v16 offset:1536
  v_mfma_f32_16x16x32_bf16 v[164:167], v[48:51], v[84:87], v[164:167]
  ds_read_b64_tr_b16 v[36:37], v16 offset:12288
  v_mfma_f32_16x16x32_bf16 v[160:163], v[52:55], v[104:107], v[160:163]
  ds_read_b64_tr_b16 v[38:39], v16 offset:13824
  s_waitcnt lgkmcnt(8)
  v_mfma_f32_16x16x32_bf16 v[164:167], v[52:55], v[108:111], v[164:167]
  ds_read_b64_tr_b16 v[40:41], v66 offset:0
  s_waitcnt lgkmcnt(5)
  v_mfma_f32_16x16x32_bf16 v[168:171], v[56:59], v[80:83], v[168:171]
  ds_read_b64_tr_b16 v[42:43], v66 offset:1536
  v_mfma_f32_16x16x32_bf16 v[172:175], v[56:59], v[84:87], v[172:175]
  ds_read_b64_tr_b16 v[44:45], v66 offset:12288
  v_mfma_f32_16x16x32_bf16 v[168:171], v[60:63], v[104:107], v[168:171]
  ds_read_b64_tr_b16 v[46:47], v66 offset:13824
  v_mfma_f32_16x16x32_bf16 v[172:175], v[60:63], v[108:111], v[172:175]
  ds_read_b64_tr_b16 v[48:49], v17 offset:0
  s_setprio 2
  s_waitcnt lgkmcnt(5)
  v_mfma_f32_16x16x32_bf16 v[176:179], v[32:35], v[88:91], v[176:179]
  ds_read_b64_tr_b16 v[50:51], v17 offset:1536
  v_mul_f32 v160, s36, v160
  v_mul_f32 v161, s36, v161
  v_mfma_f32_16x16x32_bf16 v[180:183], v[32:35], v[92:95], v[180:183]
  ds_read_b64_tr_b16 v[52:53], v17 offset:12288
  v_mul_f32 v162, s36, v162
  v_mul_f32 v163, s36, v163
  v_mfma_f32_16x16x32_bf16 v[176:179], v[36:39], v[72:75], v[176:179]
  ds_read_b64_tr_b16 v[54:55], v17 offset:13824
  v_mul_f32 v168, s36, v168
  v_mul_f32 v169, s36, v169
  v_mfma_f32_16x16x32_bf16 v[180:183], v[36:39], v[76:79], v[180:183]
  ds_read_b64_tr_b16 v[56:57], v67 offset:0
  v_mul_f32 v170, s36, v170
  v_mul_f32 v171, s36, v171
  s_waitcnt lgkmcnt(5)
  v_mfma_f32_16x16x32_bf16 v[176:179], v[40:43], v[80:83], v[176:179]
  ds_read_b64_tr_b16 v[58:59], v67 offset:1536
  v_cvt_pk_bf16_f32 v112, v160, v161
  v_cvt_pk_bf16_f32 v114, v168, v169
  v_mfma_f32_16x16x32_bf16 v[180:183], v[40:43], v[84:87], v[180:183]
  ds_read_b64_tr_b16 v[60:61], v67 offset:12288
  v_cvt_pk_bf16_f32 v113, v162, v163
  v_cvt_pk_bf16_f32 v115, v170, v171
  v_mfma_f32_16x16x32_bf16 v[176:179], v[44:47], v[104:107], v[176:179]
  ds_read_b64_tr_b16 v[62:63], v67 offset:13824
  v_mul_f32 v164, s36, v164
  v_mul_f32 v165, s36, v165
  v_mfma_f32_16x16x32_bf16 v[180:183], v[44:47], v[108:111], v[180:183]
  ds_read_b64_tr_b16 v[32:33], v14 offset:128
  v_mul_f32 v166, s36, v166
  v_mul_f32 v167, s36, v167
  s_waitcnt lgkmcnt(5)
  v_mfma_f32_16x16x32_bf16 v[184:187], v[48:51], v[88:91], v[184:187]
  ds_read_b64_tr_b16 v[34:35], v14 offset:1664
  v_mul_f32 v172, s36, v172
  v_mul_f32 v173, s36, v173
  v_mfma_f32_16x16x32_bf16 v[188:191], v[48:51], v[92:95], v[188:191]
  ds_read_b64_tr_b16 v[36:37], v14 offset:12416
  v_mul_f32 v174, s36, v174
  v_mul_f32 v175, s36, v175
  v_mfma_f32_16x16x32_bf16 v[184:187], v[52:55], v[72:75], v[184:187]
  ds_read_b64_tr_b16 v[38:39], v14 offset:13952
  v_cvt_pk_bf16_f32 v116, v164, v165
  v_cvt_pk_bf16_f32 v118, v172, v173
  v_mfma_f32_16x16x32_bf16 v[188:191], v[52:55], v[76:79], v[188:191]
  ds_read_b64_tr_b16 v[40:41], v64 offset:128
  v_cvt_pk_bf16_f32 v117, v166, v167
  v_cvt_pk_bf16_f32 v119, v174, v175
  s_waitcnt lgkmcnt(5)
  v_mfma_f32_16x16x32_bf16 v[184:187], v[56:59], v[80:83], v[184:187]
  ds_read_b64_tr_b16 v[42:43], v64 offset:1664
  v_permlane32_swap_b32 v112, v114
  v_permlane32_swap_b32 v113, v115
  v_mfma_f32_16x16x32_bf16 v[188:191], v[56:59], v[84:87], v[188:191]
  ds_read_b64_tr_b16 v[44:45], v64 offset:12416
  v_permlane32_swap_b32 v116, v118
  v_permlane32_swap_b32 v117, v119
  v_mfma_f32_16x16x32_bf16 v[184:187], v[60:63], v[104:107], v[184:187]
  ds_read_b64_tr_b16 v[46:47], v64 offset:13952
  s_setprio 1
  v_permlane16_swap_b32 v112, v114
  v_permlane16_swap_b32 v113, v115
  v_mfma_f32_16x16x32_bf16 v[188:191], v[60:63], v[108:111], v[188:191]
  ds_read_b64_tr_b16 v[48:49], v15 offset:128
  v_permlane16_swap_b32 v116, v118
  v_permlane16_swap_b32 v117, v119
  s_waitcnt lgkmcnt(5)
  v_mfma_f32_16x16x32_bf16 v[192:195], v[32:35], v[88:91], v[192:195]
  ds_read_b64_tr_b16 v[50:51], v15 offset:1664
  v_mul_f32 v176, s36, v176
  v_mul_f32 v177, s36, v177
  v_mfma_f32_16x16x32_bf16 v[196:199], v[32:35], v[92:95], v[196:199]
  ds_read_b64_tr_b16 v[52:53], v15 offset:12416
  v_mul_f32 v178, s36, v178
  v_mul_f32 v179, s36, v179
  v_mfma_f32_16x16x32_bf16 v[192:195], v[36:39], v[72:75], v[192:195]
  ds_read_b64_tr_b16 v[54:55], v15 offset:13952
  v_mul_f32 v184, s36, v184
  v_mul_f32 v185, s36, v185
  v_mfma_f32_16x16x32_bf16 v[196:199], v[36:39], v[76:79], v[196:199]
  ds_read_b64_tr_b16 v[56:57], v65 offset:128
  v_mul_f32 v186, s36, v186
  v_mul_f32 v187, s36, v187
  s_waitcnt lgkmcnt(5)
  v_mfma_f32_16x16x32_bf16 v[192:195], v[40:43], v[80:83], v[192:195]
  ds_read_b64_tr_b16 v[58:59], v65 offset:1664
  v_cvt_pk_bf16_f32 v120, v176, v177
  v_cvt_pk_bf16_f32 v122, v184, v185
  v_mfma_f32_16x16x32_bf16 v[196:199], v[40:43], v[84:87], v[196:199]
  ds_read_b64_tr_b16 v[60:61], v65 offset:12416
  v_cvt_pk_bf16_f32 v121, v178, v179
  v_cvt_pk_bf16_f32 v123, v186, v187
  v_mfma_f32_16x16x32_bf16 v[192:195], v[44:47], v[104:107], v[192:195]
  ds_read_b64_tr_b16 v[62:63], v65 offset:13952
  v_mul_f32 v180, s36, v180
  v_mul_f32 v181, s36, v181
  v_mfma_f32_16x16x32_bf16 v[196:199], v[44:47], v[108:111], v[196:199]
  ds_read_b64_tr_b16 v[32:33], v16 offset:128
  v_mul_f32 v182, s36, v182
  v_mul_f32 v183, s36, v183
  s_waitcnt lgkmcnt(5)
  v_mfma_f32_16x16x32_bf16 v[200:203], v[48:51], v[88:91], v[200:203]
  ds_read_b64_tr_b16 v[34:35], v16 offset:1664
  v_mul_f32 v188, s36, v188
  v_mul_f32 v189, s36, v189
  v_mfma_f32_16x16x32_bf16 v[204:207], v[48:51], v[92:95], v[204:207]
  ds_read_b64_tr_b16 v[36:37], v16 offset:12416
  v_mul_f32 v190, s36, v190
  v_mul_f32 v191, s36, v191
  v_mfma_f32_16x16x32_bf16 v[200:203], v[52:55], v[72:75], v[200:203]
  ds_read_b64_tr_b16 v[38:39], v16 offset:13952
  v_cvt_pk_bf16_f32 v124, v180, v181
  v_cvt_pk_bf16_f32 v126, v188, v189
  v_mfma_f32_16x16x32_bf16 v[204:207], v[52:55], v[76:79], v[204:207]
  ds_read_b64_tr_b16 v[40:41], v66 offset:128
  v_cvt_pk_bf16_f32 v125, v182, v183
  v_cvt_pk_bf16_f32 v127, v190, v191
  s_waitcnt lgkmcnt(5)
  v_mfma_f32_16x16x32_bf16 v[200:203], v[56:59], v[80:83], v[200:203]
  ds_read_b64_tr_b16 v[42:43], v66 offset:1664
  v_permlane32_swap_b32 v120, v122
  v_permlane32_swap_b32 v121, v123
  v_mfma_f32_16x16x32_bf16 v[204:207], v[56:59], v[84:87], v[204:207]
  ds_read_b64_tr_b16 v[44:45], v66 offset:12416
  s_setprio 0
  v_permlane32_swap_b32 v124, v126
  v_permlane32_swap_b32 v125, v127
  v_mfma_f32_16x16x32_bf16 v[200:203], v[60:63], v[104:107], v[200:203]
  ds_read_b64_tr_b16 v[46:47], v66 offset:13952
  v_permlane16_swap_b32 v120, v122
  v_permlane16_swap_b32 v121, v123
  v_mfma_f32_16x16x32_bf16 v[204:207], v[60:63], v[108:111], v[204:207]
  ds_read_b64_tr_b16 v[48:49], v17 offset:128
  v_permlane16_swap_b32 v124, v126
  v_permlane16_swap_b32 v125, v127
  s_waitcnt lgkmcnt(5)
  v_mfma_f32_16x16x32_bf16 v[208:211], v[32:35], v[88:91], v[208:211]
  ds_read_b64_tr_b16 v[50:51], v17 offset:1664
  v_mul_f32 v192, s36, v192
  v_mul_f32 v193, s36, v193
  v_mfma_f32_16x16x32_bf16 v[212:215], v[32:35], v[92:95], v[212:215]
  ds_read_b64_tr_b16 v[52:53], v17 offset:12416
  v_mul_f32 v194, s36, v194
  v_mul_f32 v195, s36, v195
  v_mfma_f32_16x16x32_bf16 v[208:211], v[36:39], v[72:75], v[208:211]
  ds_read_b64_tr_b16 v[54:55], v17 offset:13952
  v_mul_f32 v200, s36, v200
  v_mul_f32 v201, s36, v201
  v_mfma_f32_16x16x32_bf16 v[212:215], v[36:39], v[76:79], v[212:215]
  ds_read_b64_tr_b16 v[56:57], v67 offset:128
  v_mul_f32 v202, s36, v202
  v_mul_f32 v203, s36, v203
  s_waitcnt lgkmcnt(5)
  v_mfma_f32_16x16x32_bf16 v[208:211], v[40:43], v[80:83], v[208:211]
  ds_read_b64_tr_b16 v[58:59], v67 offset:1664
  v_cvt_pk_bf16_f32 v128, v192, v193
  v_cvt_pk_bf16_f32 v130, v200, v201
  v_mfma_f32_16x16x32_bf16 v[212:215], v[40:43], v[84:87], v[212:215]
  ds_read_b64_tr_b16 v[60:61], v67 offset:12416
  v_cvt_pk_bf16_f32 v129, v194, v195
  v_cvt_pk_bf16_f32 v131, v202, v203
  v_mfma_f32_16x16x32_bf16 v[208:211], v[44:47], v[104:107], v[208:211]
  ds_read_b64_tr_b16 v[62:63], v67 offset:13952
  v_mul_f32 v196, s36, v196
  v_mul_f32 v197, s36, v197
  v_mfma_f32_16x16x32_bf16 v[212:215], v[44:47], v[108:111], v[212:215]
  ds_read_b64_tr_b16 v[32:33], v14 offset:256
  v_mul_f32 v198, s36, v198
  v_mul_f32 v199, s36, v199
  s_waitcnt lgkmcnt(5)
  v_mfma_f32_16x16x32_bf16 v[216:219], v[48:51], v[88:91], v[216:219]
  ds_read_b64_tr_b16 v[34:35], v14 offset:1792
  v_mul_f32 v204, s36, v204
  v_mul_f32 v205, s36, v205
  v_mfma_f32_16x16x32_bf16 v[220:223], v[48:51], v[92:95], v[220:223]
  ds_read_b64_tr_b16 v[36:37], v14 offset:12544
  v_mul_f32 v206, s36, v206
  v_mul_f32 v207, s36, v207
  v_mfma_f32_16x16x32_bf16 v[216:219], v[52:55], v[72:75], v[216:219]
  ds_read_b64_tr_b16 v[38:39], v14 offset:14080
  v_xor_b32 v14, 0, v20
  v_cvt_pk_bf16_f32 v132, v196, v197
  v_mfma_f32_16x16x32_bf16 v[220:223], v[52:55], v[76:79], v[220:223]
  s_barrier
  ds_read_b64_tr_b16 v[40:41], v64 offset:256
  v_cvt_pk_bf16_f32 v134, v204, v205
  v_cvt_pk_bf16_f32 v133, v198, v199
  s_waitcnt lgkmcnt(5)
  v_mfma_f32_16x16x32_bf16 v[216:219], v[56:59], v[80:83], v[216:219]
  ds_read_b64_tr_b16 v[42:43], v64 offset:1792
  s_setprio 3
  v_cvt_pk_bf16_f32 v135, v206, v207
  v_permlane32_swap_b32 v128, v130
  v_mfma_f32_16x16x32_bf16 v[220:223], v[56:59], v[84:87], v[220:223]
  ds_read_b64_tr_b16 v[44:45], v64 offset:12544
  v_permlane32_swap_b32 v129, v131
  v_permlane32_swap_b32 v132, v134
  v_mfma_f32_16x16x32_bf16 v[216:219], v[60:63], v[104:107], v[216:219]
  ds_read_b64_tr_b16 v[46:47], v64 offset:14080
  v_permlane32_swap_b32 v133, v135
  v_permlane16_swap_b32 v128, v130
  v_mfma_f32_16x16x32_bf16 v[220:223], v[60:63], v[108:111], v[220:223]
  ds_read_b64_tr_b16 v[48:49], v15 offset:256
  v_permlane16_swap_b32 v129, v131
  v_permlane16_swap_b32 v132, v134
  s_waitcnt lgkmcnt(5)
  v_mfma_f32_16x16x32_bf16 v[224:227], v[32:35], v[88:91], v[224:227]
  ds_read_b64_tr_b16 v[50:51], v15 offset:1792
  v_permlane16_swap_b32 v133, v135
  v_mul_f32 v208, s36, v208
  v_mfma_f32_16x16x32_bf16 v[228:231], v[32:35], v[92:95], v[228:231]
  ds_read_b64_tr_b16 v[52:53], v15 offset:12544
  v_mul_f32 v209, s36, v209
  v_mul_f32 v210, s36, v210
  v_mfma_f32_16x16x32_bf16 v[224:227], v[36:39], v[72:75], v[224:227]
  ds_read_b64_tr_b16 v[54:55], v15 offset:14080
  v_xor_b32 v15, 32, v20
  v_mul_f32 v211, s36, v211
  v_mfma_f32_16x16x32_bf16 v[228:231], v[36:39], v[76:79], v[228:231]
  ds_read_b64_tr_b16 v[56:57], v65 offset:256
  v_mul_f32 v216, s36, v216
  v_mul_f32 v217, s36, v217
  s_waitcnt lgkmcnt(5)
  v_mfma_f32_16x16x32_bf16 v[224:227], v[40:43], v[80:83], v[224:227]
  ds_read_b64_tr_b16 v[58:59], v65 offset:1792
  v_mul_f32 v218, s36, v218
  v_mul_f32 v219, s36, v219
  v_mfma_f32_16x16x32_bf16 v[228:231], v[40:43], v[84:87], v[228:231]
  ds_read_b64_tr_b16 v[60:61], v65 offset:12544
  s_setprio 2
  v_cvt_pk_bf16_f32 v136, v208, v209
  v_cvt_pk_bf16_f32 v138, v216, v217
  v_mfma_f32_16x16x32_bf16 v[224:227], v[44:47], v[104:107], v[224:227]
  ds_read_b64_tr_b16 v[62:63], v65 offset:14080
  v_cvt_pk_bf16_f32 v137, v210, v211
  v_cvt_pk_bf16_f32 v139, v218, v219
  v_mfma_f32_16x16x32_bf16 v[228:231], v[44:47], v[108:111], v[228:231]
  ds_read_b64_tr_b16 v[32:33], v16 offset:256
  v_mul_f32 v212, s36, v212
  v_mul_f32 v213, s36, v213
  s_waitcnt lgkmcnt(5)
  v_mfma_f32_16x16x32_bf16 v[232:235], v[48:51], v[88:91], v[232:235]
  ds_read_b64_tr_b16 v[34:35], v16 offset:1792
  v_mul_f32 v214, s36, v214
  v_mul_f32 v215, s36, v215
  v_mfma_f32_16x16x32_bf16 v[236:239], v[48:51], v[92:95], v[236:239]
  ds_read_b64_tr_b16 v[36:37], v16 offset:12544
  v_mul_f32 v220, s36, v220
  v_mul_f32 v221, s36, v221
  v_mfma_f32_16x16x32_bf16 v[232:235], v[52:55], v[72:75], v[232:235]
  ds_read_b64_tr_b16 v[38:39], v16 offset:14080
  v_xor_b32 v16, 64, v20
  v_mul_f32 v222, s36, v222
  v_mfma_f32_16x16x32_bf16 v[236:239], v[52:55], v[76:79], v[236:239]
  ds_read_b64_tr_b16 v[40:41], v66 offset:256
  v_mul_f32 v223, s36, v223
  v_cvt_pk_bf16_f32 v140, v212, v213
  s_waitcnt lgkmcnt(5)
  v_mfma_f32_16x16x32_bf16 v[232:235], v[56:59], v[80:83], v[232:235]
  ds_read_b64_tr_b16 v[42:43], v66 offset:1792
  v_cvt_pk_bf16_f32 v142, v220, v221
  v_cvt_pk_bf16_f32 v141, v214, v215
  v_mfma_f32_16x16x32_bf16 v[236:239], v[56:59], v[84:87], v[236:239]
  ds_read_b64_tr_b16 v[44:45], v66 offset:12544
  v_cvt_pk_bf16_f32 v143, v222, v223
  v_permlane32_swap_b32 v136, v138
  v_mfma_f32_16x16x32_bf16 v[232:235], v[60:63], v[104:107], v[232:235]
  ds_read_b64_tr_b16 v[46:47], v66 offset:14080
  s_setprio 1
  v_permlane32_swap_b32 v137, v139
  v_permlane32_swap_b32 v140, v142
  v_mfma_f32_16x16x32_bf16 v[236:239], v[60:63], v[108:111], v[236:239]
  ds_read_b64_tr_b16 v[48:49], v17 offset:256
  v_permlane32_swap_b32 v141, v143
  v_permlane16_swap_b32 v136, v138
  s_waitcnt lgkmcnt(5)
  v_mfma_f32_16x16x32_bf16 v[240:243], v[32:35], v[88:91], v[240:243]
  ds_read_b64_tr_b16 v[50:51], v17 offset:1792
  v_permlane16_swap_b32 v137, v139
  v_permlane16_swap_b32 v140, v142
  v_mfma_f32_16x16x32_bf16 v[244:247], v[32:35], v[92:95], v[244:247]
  ds_read_b64_tr_b16 v[52:53], v17 offset:12544
  v_permlane16_swap_b32 v141, v143
  v_mul_f32 v224, s36, v224
  v_mfma_f32_16x16x32_bf16 v[240:243], v[36:39], v[72:75], v[240:243]
  ds_read_b64_tr_b16 v[54:55], v17 offset:14080
  v_xor_b32 v17, 96, v20
  v_mul_f32 v225, s36, v225
  v_mfma_f32_16x16x32_bf16 v[244:247], v[36:39], v[76:79], v[244:247]
  ds_read_b64_tr_b16 v[56:57], v67 offset:256
  v_mul_f32 v226, s36, v226
  v_mul_f32 v227, s36, v227
  s_waitcnt lgkmcnt(5)
  v_mfma_f32_16x16x32_bf16 v[240:243], v[40:43], v[80:83], v[240:243]
  ds_read_b64_tr_b16 v[58:59], v67 offset:1792
  v_mul_f32 v232, s36, v232
  v_mul_f32 v233, s36, v233
  v_mfma_f32_16x16x32_bf16 v[244:247], v[40:43], v[84:87], v[244:247]
  ds_read_b64_tr_b16 v[60:61], v67 offset:12544
  v_mul_f32 v234, s36, v234
  v_mul_f32 v235, s36, v235
  v_mfma_f32_16x16x32_bf16 v[240:243], v[44:47], v[104:107], v[240:243]
  ds_read_b64_tr_b16 v[62:63], v67 offset:14080
  v_cvt_pk_bf16_f32 v144, v224, v225
  v_cvt_pk_bf16_f32 v146, v232, v233
  v_mfma_f32_16x16x32_bf16 v[244:247], v[44:47], v[108:111], v[244:247]
  ds_read_b128 v[32:35], v12 offset:26624
  s_setprio 0
  v_cvt_pk_bf16_f32 v145, v226, v227
  v_cvt_pk_bf16_f32 v147, v234, v235
  s_waitcnt lgkmcnt(5)
  v_mfma_f32_16x16x32_bf16 v[248:251], v[48:51], v[88:91], v[248:251]
  v_mul_f32 v228, s36, v228
  v_mul_f32 v229, s36, v229
  v_mfma_f32_16x16x32_bf16 v[252:255], v[48:51], v[92:95], v[252:255]
  ds_read_b128 v[36:39], v12 offset:32768
  v_mul_f32 v230, s36, v230
  v_mul_f32 v231, s36, v231
  v_mfma_f32_16x16x32_bf16 v[248:251], v[52:55], v[72:75], v[248:251]
  v_mul_f32 v236, s36, v236
  v_mul_f32 v237, s36, v237
  v_mfma_f32_16x16x32_bf16 v[252:255], v[52:55], v[76:79], v[252:255]
  ds_read_b128 v[40:43], v13 offset:26624
  v_mul_f32 v238, s36, v238
  v_mul_f32 v239, s36, v239
  s_waitcnt lgkmcnt(3)
  v_mfma_f32_16x16x32_bf16 v[248:251], v[56:59], v[80:83], v[248:251]
  v_cvt_pk_bf16_f32 v148, v228, v229
  v_cvt_pk_bf16_f32 v150, v236, v237
  v_mfma_f32_16x16x32_bf16 v[252:255], v[56:59], v[84:87], v[252:255]
  ds_read_b128 v[44:47], v13 offset:32768
  v_cvt_pk_bf16_f32 v149, v230, v231
  v_cvt_pk_bf16_f32 v151, v238, v239
  v_mfma_f32_16x16x32_bf16 v[248:251], v[60:63], v[104:107], v[248:251]
  v_permlane32_swap_b32 v144, v146
  v_permlane32_swap_b32 v145, v147
  v_mfma_f32_16x16x32_bf16 v[252:255], v[60:63], v[108:111], v[252:255]
  s_barrier
  ds_read_b128 v[48:51], v12 offset:26752
  v_permlane32_swap_b32 v148, v150
  v_permlane32_swap_b32 v149, v151
  s_waitcnt lgkmcnt(3)
  v_mfma_f32_16x16x32_bf16 v[88:91], v[32:35], v[112:115], 0
  s_setprio 3
  v_permlane16_swap_b32 v144, v146
  v_permlane16_swap_b32 v145, v147
  v_mfma_f32_16x16x32_bf16 v[92:95], v[32:35], v[116:119], 0
  ds_read_b128 v[52:55], v12 offset:32896
  v_permlane16_swap_b32 v148, v150
  v_permlane16_swap_b32 v149, v151
  v_mfma_f32_16x16x32_bf16 v[104:107], v[36:39], v[112:115], 0
  v_mul_f32 v240, s36, v240
  v_mul_f32 v241, s36, v241
  v_mfma_f32_16x16x32_bf16 v[108:111], v[36:39], v[116:119], 0
  ds_read_b128 v[56:59], v13 offset:26752
  v_mul_f32 v242, s36, v242
  v_mul_f32 v243, s36, v243
  s_waitcnt lgkmcnt(3)
  v_mfma_f32_16x16x32_bf16 v[88:91], v[40:43], v[120:123], v[88:91]
  v_mul_f32 v248, s36, v248
  v_mul_f32 v249, s36, v249
  v_mfma_f32_16x16x32_bf16 v[92:95], v[40:43], v[124:127], v[92:95]
  ds_read_b128 v[60:63], v13 offset:32896
  s_setprio 2
  v_mul_f32 v250, s36, v250
  v_mul_f32 v251, s36, v251
  v_mfma_f32_16x16x32_bf16 v[104:107], v[44:47], v[120:123], v[104:107]
  v_cvt_pk_bf16_f32 v152, v240, v241
  v_cvt_pk_bf16_f32 v154, v248, v249
  v_mfma_f32_16x16x32_bf16 v[108:111], v[44:47], v[124:127], v[108:111]
  ds_read_b128 v[32:35], v12 offset:26880
  v_cvt_pk_bf16_f32 v153, v242, v243
  v_cvt_pk_bf16_f32 v155, v250, v251
  s_waitcnt lgkmcnt(3)
  v_mfma_f32_16x16x32_bf16 v[88:91], v[48:51], v[128:131], v[88:91]
  v_mul_f32 v244, s36, v244
  v_mul_f32 v245, s36, v245
  v_mfma_f32_16x16x32_bf16 v[92:95], v[48:51], v[132:135], v[92:95]
  ds_read_b128 v[36:39], v12 offset:33024
  v_mul_f32 v246, s36, v246
  v_mul_f32 v247, s36, v247
  v_mfma_f32_16x16x32_bf16 v[104:107], v[52:55], v[128:131], v[104:107]
  v_mul_f32 v252, s36, v252
  v_mul_f32 v253, s36, v253
  v_mfma_f32_16x16x32_bf16 v[108:111], v[52:55], v[132:135], v[108:111]
  ds_read_b128 v[40:43], v13 offset:26880
  s_setprio 1
  v_mul_f32 v254, s36, v254
  v_mul_f32 v255, s36, v255
  s_waitcnt lgkmcnt(3)
  v_mfma_f32_16x16x32_bf16 v[88:91], v[56:59], v[136:139], v[88:91]
  v_cvt_pk_bf16_f32 v156, v244, v245
  v_cvt_pk_bf16_f32 v158, v252, v253
  v_mfma_f32_16x16x32_bf16 v[92:95], v[56:59], v[140:143], v[92:95]
  ds_read_b128 v[44:47], v13 offset:33024
  v_cvt_pk_bf16_f32 v157, v246, v247
  v_cvt_pk_bf16_f32 v159, v254, v255
  v_mfma_f32_16x16x32_bf16 v[104:107], v[60:63], v[136:139], v[104:107]
  v_permlane32_swap_b32 v152, v154
  v_permlane32_swap_b32 v153, v155
  v_mfma_f32_16x16x32_bf16 v[108:111], v[60:63], v[140:143], v[108:111]
  ds_read_b128 v[48:51], v12 offset:0
  v_permlane32_swap_b32 v156, v158
  v_permlane32_swap_b32 v157, v159
  s_waitcnt lgkmcnt(3)
  v_mfma_f32_16x16x32_bf16 v[88:91], v[32:35], v[144:147], v[88:91]
  v_permlane16_swap_b32 v152, v154
  v_permlane16_swap_b32 v153, v155
  v_mfma_f32_16x16x32_bf16 v[92:95], v[32:35], v[148:151], v[92:95]
  ds_read_b128 v[52:55], v13 offset:0
  s_setprio 0
  v_permlane16_swap_b32 v156, v158
  v_permlane16_swap_b32 v157, v159
  v_mfma_f32_16x16x32_bf16 v[104:107], v[36:39], v[144:147], v[104:107]
  v_mfma_f32_16x16x32_bf16 v[108:111], v[36:39], v[148:151], v[108:111]
  ds_read_b128 v[56:59], v12 offset:128
  s_waitcnt lgkmcnt(3)
  v_mfma_f32_16x16x32_bf16 v[88:91], v[40:43], v[152:155], v[88:91]
  v_mfma_f32_16x16x32_bf16 v[92:95], v[40:43], v[156:159], v[92:95]
  ds_read_b128 v[60:63], v13 offset:128
  v_mfma_f32_16x16x32_bf16 v[104:107], v[44:47], v[152:155], v[104:107]
  v_mfma_f32_16x16x32_bf16 v[108:111], v[44:47], v[156:159], v[108:111]
  s_barrier
  ds_read_b128 v[32:35], v12 offset:256
  s_waitcnt lgkmcnt(3)
  v_mfma_f32_16x16x32_bf16 v[96:99], v[48:51], v[112:115], 0
  s_setprio 3
  v_max3_f32 v1, v88, v89, v90
  v_max3_f32 v3, v92, v93, v94
  v_max3_f32 v2, v91, v104, v105
  v_max3_f32 v4, v95, v108, v109
  v_max3_f32 v1, v1, v106, v107
  v_mfma_f32_16x16x32_bf16 v[100:103], v[48:51], v[116:119], 0
  ds_read_b128 v[36:39], v13 offset:256
  v_max3_f32 v3, v3, v110, v111
  v_max_f32 v1, v1, v2
  v_max_f32 v3, v3, v4
  v_mov_b32 v2, v1
  v_mov_b32 v4, v3
  v_mfma_f32_16x16x32_bf16 v[96:99], v[52:55], v[120:123], v[96:99]
  v_permlane32_swap_b32 v1, v2
  v_permlane32_swap_b32 v3, v4
  v_max_f32 v1, v1, v2
  v_max_f32 v3, v3, v4
  v_mov_b32 v2, v1
  v_mfma_f32_16x16x32_bf16 v[100:103], v[52:55], v[124:127], v[100:103]
  ds_read_b128 v[40:43], v12 offset:6144
  v_mov_b32 v4, v3
  v_permlane16_swap_b32 v1, v2
  s_nop 0
  v_permlane16_swap_b32 v3, v4
  v_max_f32 v1, v1, v2
  v_max_f32 v3, v3, v4
  s_waitcnt lgkmcnt(3)
  v_mfma_f32_16x16x32_bf16 v[96:99], v[56:59], v[128:131], v[96:99]
  v_sub_f32 v104, v104, v1
  v_sub_f32 v108, v108, v3
  v_sub_f32 v105, v105, v1
  v_sub_f32 v109, v109, v3
  v_sub_f32 v106, v106, v1
  v_mfma_f32_16x16x32_bf16 v[100:103], v[56:59], v[132:135], v[100:103]
  ds_read_b128 v[44:47], v13 offset:6144
  v_sub_f32 v110, v110, v3
  v_sub_f32 v107, v107, v1
  v_sub_f32 v111, v111, v3
  v_exp_f32 v24, v104
  v_mfma_f32_16x16x32_bf16 v[96:99], v[60:63], v[136:139], v[96:99]
  v_exp_f32 v28, v108
  v_exp_f32 v25, v105
  v_mfma_f32_16x16x32_bf16 v[100:103], v[60:63], v[140:143], v[100:103]
  ds_read_b128 v[48:51], v12 offset:6272
  v_exp_f32 v29, v109
  v_exp_f32 v26, v106
  s_waitcnt lgkmcnt(3)
  v_mfma_f32_16x16x32_bf16 v[96:99], v[32:35], v[144:147], v[96:99]
  v_exp_f32 v30, v110
  v_cvt_pk_bf16_f32 v74, v24, v25
  v_cvt_pk_bf16_f32 v78, v28, v29
  v_add_f32 v24, v24, v25
  v_mfma_f32_16x16x32_bf16 v[100:103], v[32:35], v[148:151], v[100:103]
  ds_read_b128 v[52:55], v13 offset:6272
  v_add_f32 v28, v28, v29
  v_exp_f32 v27, v107
  v_exp_f32 v31, v111
  v_mfma_f32_16x16x32_bf16 v[96:99], v[36:39], v[152:155], v[96:99]
  v_cvt_pk_bf16_f32 v75, v26, v27
  v_cvt_pk_bf16_f32 v79, v30, v31
  v_add_f32 v26, v26, v27
  v_add_f32 v30, v30, v31
  v_add_f32 v10, v24, v26
  v_mfma_f32_16x16x32_bf16 v[100:103], v[36:39], v[156:159], v[100:103]
  ds_read_b128 v[56:59], v12 offset:6400
  s_setprio 2
  v_add_u32 v12, 53248, v12
  v_add_f32 v11, v28, v30
  v_sub_f32 v88, v88, v1
  v_sub_f32 v92, v92, v3
  v_sub_f32 v89, v89, v1
  s_waitcnt lgkmcnt(3)
  v_mfma_f32_16x16x32_bf16 v[104:107], v[40:43], v[112:115], 0
  v_sub_f32 v93, v93, v3
  v_sub_f32 v90, v90, v1
  v_sub_f32 v94, v94, v3
  v_sub_f32 v91, v91, v1
  v_sub_f32 v95, v95, v3
  v_mfma_f32_16x16x32_bf16 v[108:111], v[40:43], v[116:119], 0
  ds_read_b128 v[60:63], v13 offset:6400
  v_add_u32 v13, 53248, v13
  v_exp_f32 v24, v88
  v_exp_f32 v28, v92
  v_mfma_f32_16x16x32_bf16 v[104:107], v[44:47], v[120:123], v[104:107]
  v_exp_f32 v25, v89
  v_exp_f32 v29, v93
  v_mfma_f32_16x16x32_bf16 v[108:111], v[44:47], v[124:127], v[108:111]
  ds_read_b64_tr_b16 v[32:33], v14 offset:26624
  v_exp_f32 v26, v90
  v_exp_f32 v30, v94
  v_cvt_pk_bf16_f32 v72, v24, v25
  s_waitcnt lgkmcnt(3)
  v_mfma_f32_16x16x32_bf16 v[104:107], v[48:51], v[128:131], v[104:107]
  ds_read_b64_tr_b16 v[34:35], v14 offset:32768
  v_cvt_pk_bf16_f32 v76, v28, v29
  v_add_f32 v24, v24, v25
  v_add_f32 v28, v28, v29
  v_exp_f32 v27, v91
  v_mfma_f32_16x16x32_bf16 v[108:111], v[48:51], v[132:135], v[108:111]
  ds_read_b64_tr_b16 v[36:37], v15 offset:26624
  v_exp_f32 v31, v95
  v_add_f32 v10, v10, v24
  v_add_f32 v11, v11, v28
  v_cvt_pk_bf16_f32 v73, v26, v27
  v_mfma_f32_16x16x32_bf16 v[104:107], v[52:55], v[136:139], v[104:107]
  ds_read_b64_tr_b16 v[38:39], v15 offset:32768
  v_cvt_pk_bf16_f32 v77, v30, v31
  v_add_f32 v26, v26, v27
  v_add_f32 v30, v30, v31
  v_add_f32 v10, v10, v26
  v_add_f32 v11, v11, v30
  v_mfma_f32_16x16x32_bf16 v[108:111], v[52:55], v[140:143], v[108:111]
  ds_read_b64_tr_b16 v[40:41], v16 offset:26624
  s_waitcnt lgkmcnt(5)
  v_mfma_f32_16x16x32_bf16 v[104:107], v[56:59], v[144:147], v[104:107]
  ds_read_b64_tr_b16 v[42:43], v16 offset:32768
  v_mfma_f32_16x16x32_bf16 v[108:111], v[56:59], v[148:151], v[108:111]
  ds_read_b64_tr_b16 v[44:45], v17 offset:26624
  v_mov_b32 v8, v10
  v_mov_b32 v9, v11
  v_sub_f32 v96, v96, v1
  v_mfma_f32_16x16x32_bf16 v[104:107], v[60:63], v[152:155], v[104:107]
  ds_read_b64_tr_b16 v[46:47], v17 offset:32768
  v_sub_f32 v97, v97, v1
  v_sub_f32 v98, v98, v1
  v_sub_f32 v99, v99, v1
  v_mfma_f32_16x16x32_bf16 v[108:111], v[60:63], v[156:159], v[108:111]
  ds_read_b64_tr_b16 v[48:49], v14 offset:26752
  s_setprio 1
  v_exp_f32 v24, v96
  s_waitcnt lgkmcnt(5)
  v_mfma_f32_16x16x32_bf16 v[160:163], v[32:35], v[72:75], 0
  ds_read_b64_tr_b16 v[50:51], v14 offset:32896
  v_exp_f32 v25, v97
  v_mfma_f32_16x16x32_bf16 v[164:167], v[32:35], v[76:79], 0
  ds_read_b64_tr_b16 v[52:53], v15 offset:26752
  v_exp_f32 v26, v98
  v_cvt_pk_bf16_f32 v80, v24, v25
  v_mfma_f32_16x16x32_bf16 v[168:171], v[36:39], v[72:75], 0
  ds_read_b64_tr_b16 v[54:55], v15 offset:32896
  v_add_f32 v24, v24, v25
  v_exp_f32 v27, v99
  v_mfma_f32_16x16x32_bf16 v[172:175], v[36:39], v[76:79], 0
  ds_read_b64_tr_b16 v[56:57], v16 offset:26752
  v_cvt_pk_bf16_f32 v81, v26, v27
  v_add_f32 v26, v26, v27
  v_add_f32 v10, v24, v26
  s_waitcnt lgkmcnt(5)
  v_mfma_f32_16x16x32_bf16 v[176:179], v[40:43], v[72:75], 0
  ds_read_b64_tr_b16 v[58:59], v16 offset:32896
  v_sub_f32 v100, v100, v3
  v_sub_f32 v101, v101, v3
  v_sub_f32 v102, v102, v3
  v_mfma_f32_16x16x32_bf16 v[180:183], v[40:43], v[76:79], 0
  ds_read_b64_tr_b16 v[60:61], v17 offset:26752
  v_sub_f32 v103, v103, v3
  v_exp_f32 v28, v100
  v_mfma_f32_16x16x32_bf16 v[184:187], v[44:47], v[72:75], 0
  ds_read_b64_tr_b16 v[62:63], v17 offset:32896
  v_exp_f32 v29, v101
  v_mfma_f32_16x16x32_bf16 v[188:191], v[44:47], v[76:79], 0
  ds_read_b64_tr_b16 v[32:33], v14 offset:26880
  v_exp_f32 v30, v102
  v_cvt_pk_bf16_f32 v84, v28, v29
  s_waitcnt lgkmcnt(5)
  v_mfma_f32_16x16x32_bf16 v[192:195], v[48:51], v[72:75], 0
  ds_read_b64_tr_b16 v[34:35], v14 offset:33024
  v_add_f32 v28, v28, v29
  v_exp_f32 v31, v103
  v_mfma_f32_16x16x32_bf16 v[196:199], v[48:51], v[76:79], 0
  ds_read_b64_tr_b16 v[36:37], v15 offset:26880
  v_cvt_pk_bf16_f32 v85, v30, v31
  v_add_f32 v30, v30, v31
  v_add_f32 v11, v28, v30
  v_mfma_f32_16x16x32_bf16 v[200:203], v[52:55], v[72:75], 0
  ds_read_b64_tr_b16 v[38:39], v15 offset:33024
  v_sub_f32 v104, v104, v1
  v_sub_f32 v105, v105, v1
  v_sub_f32 v106, v106, v1
  v_mfma_f32_16x16x32_bf16 v[204:207], v[52:55], v[76:79], 0
  ds_read_b64_tr_b16 v[40:41], v16 offset:26880
  s_setprio 0
  v_sub_f32 v107, v107, v1
  v_sub_f32 v108, v108, v3
  v_sub_f32 v109, v109, v3
  s_waitcnt lgkmcnt(5)
  v_mfma_f32_16x16x32_bf16 v[208:211], v[56:59], v[72:75], 0
  ds_read_b64_tr_b16 v[42:43], v16 offset:33024
  v_sub_f32 v110, v110, v3
  v_sub_f32 v111, v111, v3
  v_mfma_f32_16x16x32_bf16 v[212:215], v[56:59], v[76:79], 0
  ds_read_b64_tr_b16 v[44:45], v17 offset:26880
  v_exp_f32 v24, v104
  v_mfma_f32_16x16x32_bf16 v[216:219], v[60:63], v[72:75], 0
  ds_read_b64_tr_b16 v[46:47], v17 offset:33024
  v_exp_f32 v25, v105
  v_mfma_f32_16x16x32_bf16 v[220:223], v[60:63], v[76:79], 0
  ds_read_b128 v[48:51], v12 offset:26624
  v_exp_f32 v26, v106
  v_cvt_pk_bf16_f32 v82, v24, v25
  s_waitcnt lgkmcnt(5)
  v_mfma_f32_16x16x32_bf16 v[224:227], v[32:35], v[72:75], 0
  v_add_f32 v24, v24, v25
  v_exp_f32 v27, v107
  v_mfma_f32_16x16x32_bf16 v[228:231], v[32:35], v[76:79], 0
  ds_read_b128 v[52:55], v13 offset:26624
  v_add_f32 v10, v10, v24
  v_cvt_pk_bf16_f32 v83, v26, v27
  v_add_f32 v26, v26, v27
  v_mfma_f32_16x16x32_bf16 v[232:235], v[36:39], v[72:75], 0
  v_add_f32 v10, v10, v26
  v_sub_f32 v64, 0, v1
  v_sub_f32 v65, 0, v1
  v_mfma_f32_16x16x32_bf16 v[236:239], v[36:39], v[76:79], 0
  ds_read_b128 v[56:59], v12 offset:26752
  v_sub_f32 v66, 0, v1
  v_sub_f32 v67, 0, v1
  v_sub_f32 v68, 0, v3
  s_waitcnt lgkmcnt(3)
  v_mfma_f32_16x16x32_bf16 v[240:243], v[40:43], v[72:75], 0
  v_sub_f32 v69, 0, v3
  v_sub_f32 v70, 0, v3
  v_sub_f32 v71, 0, v3
  v_mfma_f32_16x16x32_bf16 v[244:247], v[40:43], v[76:79], 0
  ds_read_b128 v[60:63], v13 offset:26752
  v_mfma_f32_16x16x32_bf16 v[248:251], v[44:47], v[72:75], 0
  v_mfma_f32_16x16x32_bf16 v[252:255], v[44:47], v[76:79], 0
  s_mov_b32 s39, 2
L_aloop:
  s_barrier
  ds_read_b128 v[32:35], v12 offset:26880
  s_waitcnt lgkmcnt(3)
  v_mfma_f32_16x16x32_bf16 v[88:91], v[48:51], v[112:115], v[64:67]
  s_setprio 3
  v_exp_f32 v28, v108
  v_mfma_f32_16x16x32_bf16 v[92:95], v[48:51], v[116:119], v[68:71]
  ds_read_b128 v[36:39], v13 offset:26880
  v_exp_f32 v29, v109
  v_mfma_f32_16x16x32_bf16 v[88:91], v[52:55], v[120:123], v[88:91]
  v_exp_f32 v30, v110
  v_mfma_f32_16x16x32_bf16 v[92:95], v[52:55], v[124:127], v[92:95]
  ds_read_b128 v[40:43], v12 offset:32768
  s_waitcnt lgkmcnt(3)
  v_mfma_f32_16x16x32_bf16 v[88:91], v[56:59], v[128:131], v[88:91]
  v_cvt_pk_bf16_f32 v86, v28, v29
  v_add_f32 v28, v28, v29
  v_mfma_f32_16x16x32_bf16 v[92:95], v[56:59], v[132:135], v[92:95]
  ds_read_b128 v[44:47], v13 offset:32768
  v_exp_f32 v31, v111
  v_mfma_f32_16x16x32_bf16 v[88:91], v[60:63], v[136:139], v[88:91]
  v_add_f32 v11, v11, v28
  v_cvt_pk_bf16_f32 v87, v30, v31
  v_mfma_f32_16x16x32_bf16 v[92:95], v[60:63], v[140:143], v[92:95]
  ds_read_b128 v[48:51], v12 offset:32896
  v_add_f32 v30, v30, v31
  s_waitcnt lgkmcnt(3)
  v_mfma_f32_16x16x32_bf16 v[88:91], v[32:35], v[144:147], v[88:91]
  v_add_f32 v11, v11, v30
  v_max_f32 v2, v10, v11
  v_mfma_f32_16x16x32_bf16 v[92:95], v[32:35], v[148:151], v[92:95]
  ds_read_b128 v[52:55], v13 offset:32896
  v_cmp_lt_f32 vcc, s37, v2
  v_mfma_f32_16x16x32_bf16 v[88:91], v[36:39], v[152:155], v[88:91]
  v_mfma_f32_16x16x32_bf16 v[92:95], v[36:39], v[156:159], v[92:95]
  ds_read_b128 v[56:59], v12 offset:33024
  s_cbranch_vccnz L_rare_a2
L_ret_a2:
  v_add_f32 v8, v8, v10
  s_waitcnt lgkmcnt(3)
  v_mfma_f32_16x16x32_bf16 v[104:107], v[40:43], v[112:115], v[64:67]
  s_setprio 2
  v_add_f32 v9, v9, v11
  v_mfma_f32_16x16x32_bf16 v[108:111], v[40:43], v[116:119], v[68:71]
  ds_read_b128 v[60:63], v13 offset:33024
  v_mfma_f32_16x16x32_bf16 v[104:107], v[44:47], v[120:123], v[104:107]
  v_exp_f32 v24, v88
  v_mfma_f32_16x16x32_bf16 v[108:111], v[44:47], v[124:127], v[108:111]
  ds_read_b64_tr_b16 v[32:33], v14 offset:0
  s_waitcnt lgkmcnt(3)
  v_mfma_f32_16x16x32_bf16 v[104:107], v[48:51], v[128:131], v[104:107]
  ds_read_b64_tr_b16 v[34:35], v14 offset:6144
  v_exp_f32 v25, v89
  v_mfma_f32_16x16x32_bf16 v[108:111], v[48:51], v[132:135], v[108:111]
  ds_read_b64_tr_b16 v[36:37], v15 offset:0
  v_exp_f32 v26, v90
  v_mfma_f32_16x16x32_bf16 v[104:107], v[52:55], v[136:139], v[104:107]
  ds_read_b64_tr_b16 v[38:39], v15 offset:6144
  v_cvt_pk_bf16_f32 v72, v24, v25
  v_mfma_f32_16x16x32_bf16 v[108:111], v[52:55], v[140:143], v[108:111]
  ds_read_b64_tr_b16 v[40:41], v16 offset:0
  v_add_f32 v24, v24, v25
  s_waitcnt lgkmcnt(5)
  v_mfma_f32_16x16x32_bf16 v[104:107], v[56:59], v[144:147], v[104:107]
  ds_read_b64_tr_b16 v[42:43], v16 offset:6144
  v_exp_f32 v27, v91
  v_mfma_f32_16x16x32_bf16 v[108:111], v[56:59], v[148:151], v[108:111]
  ds_read_b64_tr_b16 v[44:45], v17 offset:0
  v_cvt_pk_bf16_f32 v73, v26, v27
  v_mfma_f32_16x16x32_bf16 v[104:107], v[60:63], v[152:155], v[104:107]
  ds_read_b64_tr_b16 v[46:47], v17 offset:6144
  v_add_f32 v26, v26, v27
  v_mfma_f32_16x16x32_bf16 v[108:111], v[60:63], v[156:159], v[108:111]
  ds_read_b64_tr_b16 v[48:49], v14 offset:128
  v_add_f32 v10, v24, v26
  s_waitcnt lgkmcnt(5)
  v_mfma_f32_16x16x32_bf16 v[160:163], v[32:35], v[80:83], v[160:163]
  ds_read_b64_tr_b16 v[50:51], v14 offset:6272
  s_setprio 1
  v_mfma_f32_16x16x32_bf16 v[164:167], v[32:35], v[84:87], v[164:167]
  ds_read_b64_tr_b16 v[52:53], v15 offset:128
  v_exp_f32 v28, v92
  v_mfma_f32_16x16x32_bf16 v[168:171], v[36:39], v[80:83], v[168:171]
  ds_read_b64_tr_b16 v[54:55], v15 offset:6272
  v_mfma_f32_16x16x32_bf16 v[172:175], v[36:39], v[84:87], v[172:175]
  ds_read_b64_tr_b16 v[56:57], v16 offset:128
  v_exp_f32 v29, v93
  s_waitcnt lgkmcnt(5)
  v_mfma_f32_16x16x32_bf16 v[176:179], v[40:43], v[80:83], v[176:179]
  ds_read_b64_tr_b16 v[58:59], v16 offset:6272
  v_mfma_f32_16x16x32_bf16 v[180:183], v[40:43], v[84:87], v[180:183]
  ds_read_b64_tr_b16 v[60:61], v17 offset:128
  v_exp_f32 v30, v94
  v_mfma_f32_16x16x32_bf16 v[184:187], v[44:47], v[80:83], v[184:187]
  ds_read_b64_tr_b16 v[62:63], v17 offset:6272
  v_cvt_pk_bf16_f32 v76, v28, v29
  v_add_f32 v28, v28, v29
  v_mfma_f32_16x16x32_bf16 v[188:191], v[44:47], v[84:87], v[188:191]
  ds_read_b64_tr_b16 v[32:33], v14 offset:256
  s_waitcnt lgkmcnt(5)
  v_mfma_f32_16x16x32_bf16 v[192:195], v[48:51], v[80:83], v[192:195]
  ds_read_b64_tr_b16 v[34:35], v14 offset:6400
  v_add_u32 v14, 53248, v14
  v_mfma_f32_16x16x32_bf16 v[196:199], v[48:51], v[84:87], v[196:199]
  ds_read_b64_tr_b16 v[36:37], v15 offset:256
  v_exp_f32 v31, v95
  v_mfma_f32_16x16x32_bf16 v[200:203], v[52:55], v[80:83], v[200:203]
  ds_read_b64_tr_b16 v[38:39], v15 offset:6400
  v_add_u32 v15, 53248, v15
  v_cvt_pk_bf16_f32 v77, v30, v31
  v_mfma_f32_16x16x32_bf16 v[204:207], v[52:55], v[84:87], v[204:207]
  ds_read_b64_tr_b16 v[40:41], v16 offset:256
  s_waitcnt lgkmcnt(5)
  v_mfma_f32_16x16x32_bf16 v[208:211], v[56:59], v[80:83], v[208:211]
  ds_read_b64_tr_b16 v[42:43], v16 offset:6400
  s_setprio 0
  v_add_u32 v16, 53248, v16
  v_add_f32 v30, v30, v31
  v_mfma_f32_16x16x32_bf16 v[212:215], v[56:59], v[84:87], v[212:215]
  ds_read_b64_tr_b16 v[44:45], v17 offset:256
  v_add_f32 v11, v28, v30
  v_mfma_f32_16x16x32_bf16 v[216:219], v[60:63], v[80:83], v[216:219]
  ds_read_b64_tr_b16 v[46:47], v17 offset:6400
  v_add_u32 v17, 53248, v17
  v_mfma_f32_16x16x32_bf16 v[220:223], v[60:63], v[84:87], v[220:223]
  ds_read_b128 v[48:51], v12 offset:0
  v_exp_f32 v24, v104
  s_waitcnt lgkmcnt(5)
  v_mfma_f32_16x16x32_bf16 v[224:227], v[32:35], v[80:83], v[224:227]
  v_exp_f32 v25, v105
  v_mfma_f32_16x16x32_bf16 v[228:231], v[32:35], v[84:87], v[228:231]
  ds_read_b128 v[52:55], v13 offset:0
  v_exp_f32 v26, v106
  v_mfma_f32_16x16x32_bf16 v[232:235], v[36:39], v[80:83], v[232:235]
  v_cvt_pk_bf16_f32 v74, v24, v25
  v_add_f32 v24, v24, v25
  v_mfma_f32_16x16x32_bf16 v[236:239], v[36:39], v[84:87], v[236:239]
  ds_read_b128 v[56:59], v12 offset:128
  s_waitcnt lgkmcnt(3)
  v_mfma_f32_16x16x32_bf16 v[240:243], v[40:43], v[80:83], v[240:243]
  v_exp_f32 v27, v107
  v_mfma_f32_16x16x32_bf16 v[244:247], v[40:43], v[84:87], v[244:247]
  ds_read_b128 v[60:63], v13 offset:128
  v_add_f32 v10, v10, v24
  v_cvt_pk_bf16_f32 v75, v26, v27
  v_mfma_f32_16x16x32_bf16 v[248:251], v[44:47], v[80:83], v[248:251]
  v_add_f32 v26, v26, v27
  v_add_f32 v10, v10, v26
  v_mfma_f32_16x16x32_bf16 v[252:255], v[44:47], v[84:87], v[252:255]
  s_barrier
  ds_read_b128 v[32:35], v12 offset:256
  s_waitcnt lgkmcnt(3)
  v_mfma_f32_16x16x32_bf16 v[96:99], v[48:51], v[112:115], v[64:67]
  s_setprio 3
  v_exp_f32 v28, v108
  v_mfma_f32_16x16x32_bf16 v[100:103], v[48:51], v[116:119], v[68:71]
  ds_read_b128 v[36:39], v13 offset:256
  v_exp_f32 v29, v109
  v_mfma_f32_16x16x32_bf16 v[96:99], v[52:55], v[120:123], v[96:99]
  v_exp_f32 v30, v110
  v_mfma_f32_16x16x32_bf16 v[100:103], v[52:55], v[124:127], v[100:103]
  ds_read_b128 v[40:43], v12 offset:6144
  s_waitcnt lgkmcnt(3)
  v_mfma_f32_16x16x32_bf16 v[96:99], v[56:59], v[128:131], v[96:99]
  v_cvt_pk_bf16_f32 v78, v28, v29
  v_add_f32 v28, v28, v29
  v_mfma_f32_16x16x32_bf16 v[100:103], v[56:59], v[132:135], v[100:103]
  ds_read_b128 v[44:47], v13 offset:6144
  v_exp_f32 v31, v111
  v_mfma_f32_16x16x32_bf16 v[96:99], v[60:63], v[136:139], v[96:99]
  v_add_f32 v11, v11, v28
  v_cvt_pk_bf16_f32 v79, v30, v31
  v_mfma_f32_16x16x32_bf16 v[100:103], v[60:63], v[140:143], v[100:103]
  ds_read_b128 v[48:51], v12 offset:6272
  v_add_f32 v30, v30, v31
  s_waitcnt lgkmcnt(3)
  v_mfma_f32_16x16x32_bf16 v[96:99], v[32:35], v[144:147], v[96:99]
  v_add_f32 v11, v11, v30
  v_max_f32 v2, v10, v11
  v_mfma_f32_16x16x32_bf16 v[100:103], v[32:35], v[148:151], v[100:103]
  ds_read_b128 v[52:55], v13 offset:6272
  v_cmp_lt_f32 vcc, s37, v2
  v_mfma_f32_16x16x32_bf16 v[96:99], v[36:39], v[152:155], v[96:99]
  v_mfma_f32_16x16x32_bf16 v[100:103], v[36:39], v[156:159], v[100:103]
  ds_read_b128 v[56:59], v12 offset:6400
  s_cbranch_vccnz L_rare_a3
L_ret_a3:
  v_add_f32 v8, v8, v10
  s_waitcnt lgkmcnt(3)
  v_mfma_f32_16x16x32_bf16 v[104:107], v[40:43], v[112:115], v[64:67]
  s_setprio 2
  v_add_f32 v9, v9, v11
  v_mfma_f32_16x16x32_bf16 v[108:111], v[40:43], v[116:119], v[68:71]
  ds_read_b128 v[60:63], v13 offset:6400
  v_add_u32 v12, 4294860800, v12
  v_mfma_f32_16x16x32_bf16 v[104:107], v[44:47], v[120:123], v[104:107]
  v_add_u32 v13, 4294860800, v13
  v_mfma_f32_16x16x32_bf16 v[108:111], v[44:47], v[124:127], v[108:111]
  ds_read_b64_tr_b16 v[32:33], v14 offset:26624
  v_exp_f32 v24, v96
  s_waitcnt lgkmcnt(3)
  v_mfma_f32_16x16x32_bf16 v[104:107], v[48:51], v[128:131], v[104:107]
  ds_read_b64_tr_b16 v[34:35], v14 offset:32768
  v_exp_f32 v25, v97
  v_mfma_f32_16x16x32_bf16 v[108:111], v[48:51], v[132:135], v[108:111]
  ds_read_b64_tr_b16 v[36:37], v15 offset:26624
  v_mfma_f32_16x16x32_bf16 v[104:107], v[52:55], v[136:139], v[104:107]
  ds_read_b64_tr_b16 v[38:39], v15 offset:32768
  v_exp_f32 v26, v98
  v_mfma_f32_16x16x32_bf16 v[108:111], v[52:55], v[140:143], v[108:111]
  ds_read_b64_tr_b16 v[40:41], v16 offset:26624
  s_waitcnt lgkmcnt(5)
  v_mfma_f32_16x16x32_bf16 v[104:107], v[56:59], v[144:147], v[104:107]
  ds_read_b64_tr_b16 v[42:43], v16 offset:32768
  v_cvt_pk_bf16_f32 v80, v24, v25
  v_add_f32 v24, v24, v25
  v_mfma_f32_16x16x32_bf16 v[108:111], v[56:59], v[148:151], v[108:111]
  ds_read_b64_tr_b16 v[44:45], v17 offset:26624
  v_exp_f32 v27, v99
  v_mfma_f32_16x16x32_bf16 v[104:107], v[60:63], v[152:155], v[104:107]
  ds_read_b64_tr_b16 v[46:47], v17 offset:32768
  v_cvt_pk_bf16_f32 v81, v26, v27
  v_mfma_f32_16x16x32_bf16 v[108:111], v[60:63], v[156:159], v[108:111]
  ds_read_b64_tr_b16 v[48:49], v14 offset:26752
  s_waitcnt lgkmcnt(5)
  v_mfma_f32_16x16x32_bf16 v[160:163], v[32:35], v[72:75], v[160:163]
  ds_read_b64_tr_b16 v[50:51], v14 offset:32896
  s_setprio 1
  v_add_f32 v26, v26, v27
  v_mfma_f32_16x16x32_bf16 v[164:167], v[32:35], v[76:79], v[164:167]
  ds_read_b64_tr_b16 v[52:53], v15 offset:26752
  v_add_f32 v10, v24, v26
  v_mfma_f32_16x16x32_bf16 v[168:171], v[36:39], v[72:75], v[168:171]
  ds_read_b64_tr_b16 v[54:55], v15 offset:32896
  v_exp_f32 v28, v100
  v_mfma_f32_16x16x32_bf16 v[172:175], v[36:39], v[76:79], v[172:175]
  ds_read_b64_tr_b16 v[56:57], v16 offset:26752
  s_waitcnt lgkmcnt(5)
  v_mfma_f32_16x16x32_bf16 v[176:179], v[40:43], v[72:75], v[176:179]
  ds_read_b64_tr_b16 v[58:59], v16 offset:32896
  v_exp_f32 v29, v101
  v_mfma_f32_16x16x32_bf16 v[180:183], v[40:43], v[76:79], v[180:183]
  ds_read_b64_tr_b16 v[60:61], v17 offset:26752
  v_mfma_f32_16x16x32_bf16 v[184:187], v[44:47], v[72:75], v[184:187]
  ds_read_b64_tr_b16 v[62:63], v17 offset:32896
  v_exp_f32 v30, v102
  v_mfma_f32_16x16x32_bf16 v[188:191], v[44:47], v[76:79], v[188:191]
  ds_read_b64_tr_b16 v[32:33], v14 offset:26880
  v_cvt_pk_bf16_f32 v84, v28, v29
  s_waitcnt lgkmcnt(5)
  v_mfma_f32_16x16x32_bf16 v[192:195], v[48:51], v[72:75], v[192:195]
  ds_read_b64_tr_b16 v[34:35], v14 offset:33024
  v_add_f32 v28, v28, v29
  v_mfma_f32_16x16x32_bf16 v[196:199], v[48:51], v[76:79], v[196:199]
  ds_read_b64_tr_b16 v[36:37], v15 offset:26880
  v_exp_f32 v31, v103
  v_mfma_f32_16x16x32_bf16 v[200:203], v[52:55], v[72:75], v[200:203]
  ds_read_b64_tr_b16 v[38:39], v15 offset:33024
  v_cvt_pk_bf16_f32 v85, v30, v31
  v_mfma_f32_16x16x32_bf16 v[204:207], v[52:55], v[76:79], v[204:207]
  ds_read_b64_tr_b16 v[40:41], v16 offset:26880
  s_waitcnt lgkmcnt(5)
  v_mfma_f32_16x16x32_bf16 v[208:211], v[56:59], v[72:75], v[208:211]
  ds_read_b64_tr_b16 v[42:43], v16 offset:33024
  s_setprio 0
  v_add_f32 v30, v30, v31
  v_mfma_f32_16x16x32_bf16 v[212:215], v[56:59], v[76:79], v[212:215]
  ds_read_b64_tr_b16 v[44:45], v17 offset:26880
  v_add_f32 v11, v28, v30
  v_mfma_f32_16x16x32_bf16 v[216:219], v[60:63], v[72:75], v[216:219]
  ds_read_b64_tr_b16 v[46:47], v17 offset:33024
  v_exp_f32 v24, v104
  v_mfma_f32_16x16x32_bf16 v[220:223], v[60:63], v[76:79], v[220:223]
  ds_read_b128 v[48:51], v12 offset:26624
  s_waitcnt lgkmcnt(5)
  v_mfma_f32_16x16x32_bf16 v[224:227], v[32:35], v[72:75], v[224:227]
  v_exp_f32 v25, v105
  v_mfma_f32_16x16x32_bf16 v[228:231], v[32:35], v[76:79], v[228:231]
  ds_read_b128 v[52:55], v13 offset:26624
  v_exp_f32 v26, v106
  v_mfma_f32_16x16x32_bf16 v[232:235], v[36:39], v[72:75], v[232:235]
  v_cvt_pk_bf16_f32 v82, v24, v25
  v_add_f32 v24, v24, v25
  v_mfma_f32_16x16x32_bf16 v[236:239], v[36:39], v[76:79], v[236:239]
  ds_read_b128 v[56:59], v12 offset:26752
  s_waitcnt lgkmcnt(3)
  v_mfma_f32_16x16x32_bf16 v[240:243], v[40:43], v[72:75], v[240:243]
  v_exp_f32 v27, v107
  v_mfma_f32_16x16x32_bf16 v[244:247], v[40:43], v[76:79], v[244:247]
  ds_read_b128 v[60:63], v13 offset:26752
  v_add_f32 v10, v10, v24
  v_cvt_pk_bf16_f32 v83, v26, v27
  v_mfma_f32_16x16x32_bf16 v[248:251], v[44:47], v[72:75], v[248:251]
  v_add_f32 v26, v26, v27
  v_add_f32 v10, v10, v26
  v_mfma_f32_16x16x32_bf16 v[252:255], v[44:47], v[76:79], v[252:255]
  s_barrier
  ds_read_b128 v[32:35], v12 offset:26880
  s_waitcnt lgkmcnt(3)
  v_mfma_f32_16x16x32_bf16 v[88:91], v[48:51], v[112:115], v[64:67]
  s_setprio 3
  v_exp_f32 v28, v108
  v_mfma_f32_16x16x32_bf16 v[92:95], v[48:51], v[116:119], v[68:71]
  ds_read_b128 v[36:39], v13 offset:26880
  v_exp_f32 v29, v109
  v_mfma_f32_16x16x32_bf16 v[88:91], v[52:55], v[120:123], v[88:91]
  v_exp_f32 v30, v110
  v_mfma_f32_16x16x32_bf16 v[92:95], v[52:55], v[124:127], v[92:95]
  ds_read_b128 v[40:43], v12 offset:32768
  s_waitcnt lgkmcnt(3)
  v_mfma_f32_16x16x32_bf16 v[88:91], v[56:59], v[128:131], v[88:91]
  v_cvt_pk_bf16_f32 v86, v28, v29
  v_add_f32 v28, v28, v29
  v_mfma_f32_16x16x32_bf16 v[92:95], v[56:59], v[132:135], v[92:95]
  ds_read_b128 v[44:47], v13 offset:32768
  v_exp_f32 v31, v111
  v_mfma_f32_16x16x32_bf16 v[88:91], v[60:63], v[136:139], v[88:91]
  v_add_f32 v11, v11, v28
  v_cvt_pk_bf16_f32 v87, v30, v31
  v_mfma_f32_16x16x32_bf16 v[92:95], v[60:63], v[140:143], v[92:95]
  ds_read_b128 v[48:51], v12 offset:32896
  v_add_f32 v30, v30, v31
  s_waitcnt lgkmcnt(3)
  v_mfma_f32_16x16x32_bf16 v[88:91], v[32:35], v[144:147], v[88:91]
  v_add_f32 v11, v11, v30
  v_max_f32 v2, v10, v11
  v_mfma_f32_16x16x32_bf16 v[92:95], v[32:35], v[148:151], v[92:95]
  ds_read_b128 v[52:55], v13 offset:32896
  v_cmp_lt_f32 vcc, s37, v2
  v_mfma_f32_16x16x32_bf16 v[88:91], v[36:39], v[152:155], v[88:91]
  v_mfma_f32_16x16x32_bf16 v[92:95], v[36:39], v[156:159], v[92:95]
  ds_read_b128 v[56:59], v12 offset:33024
  s_cbranch_vccnz L_rare_a4
L_ret_a4:
  v_add_f32 v8, v8, v10
  s_waitcnt lgkmcnt(3)
  v_mfma_f32_16x16x32_bf16 v[104:107], v[40:43], v[112:115], v[64:67]
  s_setprio 2
  v_add_f32 v9, v9, v11
  v_mfma_f32_16x16x32_bf16 v[108:111], v[40:43], v[116:119], v[68:71]
  ds_read_b128 v[60:63], v13 offset:33024
  v_mfma_f32_16x16x32_bf16 v[104:107], v[44:47], v[120:123], v[104:107]
  v_exp_f32 v24, v88
  v_mfma_f32_16x16x32_bf16 v[108:111], v[44:47], v[124:127], v[108:111]
  ds_read_b64_tr_b16 v[32:33], v14 offset:0
  s_waitcnt lgkmcnt(3)
  v_mfma_f32_16x16x32_bf16 v[104:107], v[48:51], v[128:131], v[104:107]
  ds_read_b64_tr_b16 v[34:35], v14 offset:6144
  v_exp_f32 v25, v89
  v_mfma_f32_16x16x32_bf16 v[108:111], v[48:51], v[132:135], v[108:111]
  ds_read_b64_tr_b16 v[36:37], v15 offset:0
  v_exp_f32 v26, v90
  v_mfma_f32_16x16x32_bf16 v[104:107], v[52:55], v[136:139], v[104:107]
  ds_read_b64_tr_b16 v[38:39], v15 offset:6144
  v_cvt_pk_bf16_f32 v72, v24, v25
  v_mfma_f32_16x16x32_bf16 v[108:111], v[52:55], v[140:143], v[108:111]
  ds_read_b64_tr_b16 v[40:41], v16 offset:0
  v_add_f32 v24, v24, v25
  s_waitcnt lgkmcnt(5)
  v_mfma_f32_16x16x32_bf16 v[104:107], v[56:59], v[144:147], v[104:107]
  ds_read_b64_tr_b16 v[42:43], v16 offset:6144
  v_exp_f32 v27, v91
  v_mfma_f32_16x16x32_bf16 v[108:111], v[56:59], v[148:151], v[108:111]
  ds_read_b64_tr_b16 v[44:45], v17 offset:0
  v_cvt_pk_bf16_f32 v73, v26, v27
  v_mfma_f32_16x16x32_bf16 v[104:107], v[60:63], v[152:155], v[104:107]
  ds_read_b64_tr_b16 v[46:47], v17 offset:6144
  v_add_f32 v26, v26, v27
  v_mfma_f32_16x16x32_bf16 v[108:111], v[60:63], v[156:159], v[108:111]
  ds_read_b64_tr_b16 v[48:49], v14 offset:128
  v_add_f32 v10, v24, v26
  s_waitcnt lgkmcnt(5)
  v_mfma_f32_16x16x32_bf16 v[160:163], v[32:35], v[80:83], v[160:163]
  ds_read_b64_tr_b16 v[50:51], v14 offset:6272
  s_setprio 1
  v_mfma_f32_16x16x32_bf16 v[164:167], v[32:35], v[84:87], v[164:167]
  ds_read_b64_tr_b16 v[52:53], v15 offset:128
  v_exp_f32 v28, v92
  v_mfma_f32_16x16x32_bf16 v[168:171], v[36:39], v[80:83], v[168:171]
  ds_read_b64_tr_b16 v[54:55], v15 offset:6272
  v_mfma_f32_16x16x32_bf16 v[172:175], v[36:39], v[84:87], v[172:175]
  ds_read_b64_tr_b16 v[56:57], v16 offset:128
  v_exp_f32 v29, v93
  s_waitcnt lgkmcnt(5)
  v_mfma_f32_16x16x32_bf16 v[176:179], v[40:43], v[80:83], v[176:179]
  ds_read_b64_tr_b16 v[58:59], v16 offset:6272
  v_mfma_f32_16x16x32_bf16 v[180:183], v[40:43], v[84:87], v[180:183]
  ds_read_b64_tr_b16 v[60:61], v17 offset:128
  v_exp_f32 v30, v94
  v_mfma_f32_16x16x32_bf16 v[184:187], v[44:47], v[80:83], v[184:187]
  ds_read_b64_tr_b16 v[62:63], v17 offset:6272
  v_cvt_pk_bf16_f32 v76, v28, v29
  v_add_f32 v28, v28, v29
  v_mfma_f32_16x16x32_bf16 v[188:191], v[44:47], v[84:87], v[188:191]
  ds_read_b64_tr_b16 v[32:33], v14 offset:256
  s_waitcnt lgkmcnt(5)
  v_mfma_f32_16x16x32_bf16 v[192:195], v[48:51], v[80:83], v[192:195]
  ds_read_b64_tr_b16 v[34:35], v14 offset:6400
  v_add_u32 v14, 4294860800, v14
  v_mfma_f32_16x16x32_bf16 v[196:199], v[48:51], v[84:87], v[196:199]
  ds_read_b64_tr_b16 v[36:37], v15 offset:256
  v_exp_f32 v31, v95
  v_mfma_f32_16x16x32_bf16 v[200:203], v[52:55], v[80:83], v[200:203]
  ds_read_b64_tr_b16 v[38:39], v15 offset:6400
  v_add_u32 v15, 4294860800, v15
  v_cvt_pk_bf16_f32 v77, v30, v31
  v_mfma_f32_16x16x32_bf16 v[204:207], v[52:55], v[84:87], v[204:207]
  ds_read_b64_tr_b16 v[40:41], v16 offset:256
  s_waitcnt lgkmcnt(5)
  v_mfma_f32_16x16x32_bf16 v[208:211], v[56:59], v[80:83], v[208:211]
  ds_read_b64_tr_b16 v[42:43], v16 offset:6400
  s_setprio 0
  v_add_u32 v16, 4294860800, v16
  v_add_f32 v30, v30, v31
  v_mfma_f32_16x16x32_bf16 v[212:215], v[56:59], v[84:87], v[212:215]
  ds_read_b64_tr_b16 v[44:45], v17 offset:256
  v_add_f32 v11, v28, v30
  v_mfma_f32_16x16x32_bf16 v[216:219], v[60:63], v[80:83], v[216:219]
  ds_read_b64_tr_b16 v[46:47], v17 offset:6400
  v_add_u32 v17, 4294860800, v17
  v_mfma_f32_16x16x32_bf16 v[220:223], v[60:63], v[84:87], v[220:223]
  ds_read_b128 v[48:51], v12 offset:0
  v_exp_f32 v24, v104
  s_waitcnt lgkmcnt(5)
  v_mfma_f32_16x16x32_bf16 v[224:227], v[32:35], v[80:83], v[224:227]
  v_exp_f32 v25, v105
  v_mfma_f32_16x16x32_bf16 v[228:231], v[32:35], v[84:87], v[228:231]
  ds_read_b128 v[52:55], v13 offset:0
  v_exp_f32 v26, v106
  v_mfma_f32_16x16x32_bf16 v[232:235], v[36:39], v[80:83], v[232:235]
  v_cvt_pk_bf16_f32 v74, v24, v25
  v_add_f32 v24, v24, v25
  v_mfma_f32_16x16x32_bf16 v[236:239], v[36:39], v[84:87], v[236:239]
  ds_read_b128 v[56:59], v12 offset:128
  s_waitcnt lgkmcnt(3)
  v_mfma_f32_16x16x32_bf16 v[240:243], v[40:43], v[80:83], v[240:243]
  v_exp_f32 v27, v107
  v_mfma_f32_16x16x32_bf16 v[244:247], v[40:43], v[84:87], v[244:247]
  ds_read_b128 v[60:63], v13 offset:128
  v_add_f32 v10, v10, v24
  v_cvt_pk_bf16_f32 v75, v26, v27
  v_mfma_f32_16x16x32_bf16 v[248:251], v[44:47], v[80:83], v[248:251]
  v_add_f32 v26, v26, v27
  v_add_f32 v10, v10, v26
  v_mfma_f32_16x16x32_bf16 v[252:255], v[44:47], v[84:87], v[252:255]
  s_barrier
  ds_read_b128 v[32:35], v12 offset:256
  s_waitcnt lgkmcnt(3)
  v_mfma_f32_16x16x32_bf16 v[96:99], v[48:51], v[112:115], v[64:67]
  s_setprio 3
  v_exp_f32 v28, v108
  v_mfma_f32_16x16x32_bf16 v[100:103], v[48:51], v[116:119], v[68:71]
  ds_read_b128 v[36:39], v13 offset:256
  v_exp_f32 v29, v109
  v_mfma_f32_16x16x32_bf16 v[96:99], v[52:55], v[120:123], v[96:99]
  v_exp_f32 v30, v110
  v_mfma_f32_16x16x32_bf16 v[100:103], v[52:55], v[124:127], v[100:103]
  ds_read_b128 v[40:43], v12 offset:6144
  s_waitcnt lgkmcnt(3)
  v_mfma_f32_16x16x32_bf16 v[96:99], v[56:59], v[128:131], v[96:99]
  v_cvt_pk_bf16_f32 v78, v28, v29
  v_add_f32 v28, v28, v29
  v_mfma_f32_16x16x32_bf16 v[100:103], v[56:59], v[132:135], v[100:103]
  ds_read_b128 v[44:47], v13 offset:6144
  v_exp_f32 v31, v111
  v_mfma_f32_16x16x32_bf16 v[96:99], v[60:63], v[136:139], v[96:99]
  v_add_f32 v11, v11, v28
  v_cvt_pk_bf16_f32 v79, v30, v31
  v_mfma_f32_16x16x32_bf16 v[100:103], v[60:63], v[140:143], v[100:103]
  ds_read_b128 v[48:51], v12 offset:6272
  v_add_f32 v30, v30, v31
  s_waitcnt lgkmcnt(3)
  v_mfma_f32_16x16x32_bf16 v[96:99], v[32:35], v[144:147], v[96:99]
  v_add_f32 v11, v11, v30
  v_max_f32 v2, v10, v11
  v_mfma_f32_16x16x32_bf16 v[100:103], v[32:35], v[148:151], v[100:103]
  ds_read_b128 v[52:55], v13 offset:6272
  v_cmp_lt_f32 vcc, s37, v2
  v_mfma_f32_16x16x32_bf16 v[96:99], v[36:39], v[152:155], v[96:99]
  v_mfma_f32_16x16x32_bf16 v[100:103], v[36:39], v[156:159], v[100:103]
  ds_read_b128 v[56:59], v12 offset:6400
  s_cbranch_vccnz L_rare_a5
L_ret_a5:
  v_add_f32 v8, v8, v10
  s_waitcnt lgkmcnt(3)
  v_mfma_f32_16x16x32_bf16 v[104:107], v[40:43], v[112:115], v[64:67]
  s_setprio 2
  v_add_f32 v9, v9, v11
  v_mfma_f32_16x16x32_bf16 v[108:111], v[40:43], v[116:119], v[68:71]
  ds_read_b128 v[60:63], v13 offset:6400
  v_add_u32 v12, 53248, v12
  v_mfma_f32_16x16x32_bf16 v[104:107], v[44:47], v[120:123], v[104:107]
  v_add_u32 v13, 53248, v13
  v_mfma_f32_16x16x32_bf16 v[108:111], v[44:47], v[124:127], v[108:111]
  ds_read_b64_tr_b16 v[32:33], v14 offset:26624
  v_exp_f32 v24, v96
  s_waitcnt lgkmcnt(3)
  v_mfma_f32_16x16x32_bf16 v[104:107], v[48:51], v[128:131], v[104:107]
  ds_read_b64_tr_b16 v[34:35], v14 offset:32768
  v_exp_f32 v25, v97
  v_mfma_f32_16x16x32_bf16 v[108:111], v[48:51], v[132:135], v[108:111]
  ds_read_b64_tr_b16 v[36:37], v15 offset:26624
  v_mfma_f32_16x16x32_bf16 v[104:107], v[52:55], v[136:139], v[104:107]
  ds_read_b64_tr_b16 v[38:39], v15 offset:32768
  v_exp_f32 v26, v98
  v_mfma_f32_16x16x32_bf16 v[108:111], v[52:55], v[140:143], v[108:111]
  ds_read_b64_tr_b16 v[40:41], v16 offset:26624
  s_waitcnt lgkmcnt(5)
  v_mfma_f32_16x16x32_bf16 v[104:107], v[56:59], v[144:147], v[104:107]
  ds_read_b64_tr_b16 v[42:43], v16 offset:32768
  v_cvt_pk_bf16_f32 v80, v24, v25
  v_add_f32 v24, v24, v25
  v_mfma_f32_16x16x32_bf16 v[108:111], v[56:59], v[148:151], v[108:111]
  ds_read_b64_tr_b16 v[44:45], v17 offset:26624
  v_exp_f32 v27, v99
  v_mfma_f32_16x16x32_bf16 v[104:107], v[60:63], v[152:155], v[104:107]
  ds_read_b64_tr_b16 v[46:47], v17 offset:32768
  v_cvt_pk_bf16_f32 v81, v26, v27
  v_mfma_f32_16x16x32_bf16 v[108:111], v[60:63], v[156:159], v[108:111]
  ds_read_b64_tr_b16 v[48:49], v14 offset:26752
  s_waitcnt lgkmcnt(5)
  v_mfma_f32_16x16x32_bf16 v[160:163], v[32:35], v[72:75], v[160:163]
  ds_read_b64_tr_b16 v[50:51], v14 offset:32896
  s_setprio 1
  v_add_f32 v26, v26, v27
  v_mfma_f32_16x16x32_bf16 v[164:167], v[32:35], v[76:79], v[164:167]
  ds_read_b64_tr_b16 v[52:53], v15 offset:26752
  v_add_f32 v10, v24, v26
  v_mfma_f32_16x16x32_bf16 v[168:171], v[36:39], v[72:75], v[168:171]
  ds_read_b64_tr_b16 v[54:55], v15 offset:32896
  v_exp_f32 v28, v100
  v_mfma_f32_16x16x32_bf16 v[172:175], v[36:39], v[76:79], v[172:175]
  ds_read_b64_tr_b16 v[56:57], v16 offset:26752
  s_waitcnt lgkmcnt(5)
  v_mfma_f32_16x16x32_bf16 v[176:179], v[40:43], v[72:75], v[176:179]
  ds_read_b64_tr_b16 v[58:59], v16 offset:32896
  v_exp_f32 v29, v101
  v_mfma_f32_16x16x32_bf16 v[180:183], v[40:43], v[76:79], v[180:183]
  ds_read_b64_tr_b16 v[60:61], v17 offset:26752
  v_mfma_f32_16x16x32_bf16 v[184:187], v[44:47], v[72:75], v[184:187]
  ds_read_b64_tr_b16 v[62:63], v17 offset:32896
  v_exp_f32 v30, v102
  v_mfma_f32_16x16x32_bf16 v[188:191], v[44:47], v[76:79], v[188:191]
  ds_read_b64_tr_b16 v[32:33], v14 offset:26880
  v_cvt_pk_bf16_f32 v84, v28, v29
  s_waitcnt lgkmcnt(5)
  v_mfma_f32_16x16x32_bf16 v[192:195], v[48:51], v[72:75], v[192:195]
  ds_read_b64_tr_b16 v[34:35], v14 offset:33024
  v_add_f32 v28, v28, v29
  v_mfma_f32_16x16x32_bf16 v[196:199], v[48:51], v[76:79], v[196:199]
  ds_read_b64_tr_b16 v[36:37], v15 offset:26880
  v_exp_f32 v31, v103
  v_mfma_f32_16x16x32_bf16 v[200:203], v[52:55], v[72:75], v[200:203]
  ds_read_b64_tr_b16 v[38:39], v15 offset:33024
  v_cvt_pk_bf16_f32 v85, v30, v31
  v_mfma_f32_16x16x32_bf16 v[204:207], v[52:55], v[76:79], v[204:207]
  ds_read_b64_tr_b16 v[40:41], v16 offset:26880
  s_waitcnt lgkmcnt(5)
  v_mfma_f32_16x16x32_bf16 v[208:211], v[56:59], v[72:75], v[208:211]
  ds_read_b64_tr_b16 v[42:43], v16 offset:33024
  s_setprio 0
  v_add_f32 v30, v30, v31
  v_mfma_f32_16x16x32_bf16 v[212:215], v[56:59], v[76:79], v[212:215]
  ds_read_b64_tr_b16 v[44:45], v17 offset:26880
  v_add_f32 v11, v28, v30
  v_mfma_f32_16x16x32_bf16 v[216:219], v[60:63], v[72:75], v[216:219]
  ds_read_b64_tr_b16 v[46:47], v17 offset:33024
  v_exp_f32 v24, v104
  v_mfma_f32_16x16x32_bf16 v[220:223], v[60:63], v[76:79], v[220:223]
  ds_read_b128 v[48:51], v12 offset:26624
  s_waitcnt lgkmcnt(5)
  v_mfma_f32_16x16x32_bf16 v[224:227], v[32:35], v[72:75], v[224:227]
  v_exp_f32 v25, v105
  v_mfma_f32_16x16x32_bf16 v[228:231], v[32:35], v[76:79], v[228:231]
  ds_read_b128 v[52:55], v13 offset:26624
  v_exp_f32 v26, v106
  v_mfma_f32_16x16x32_bf16 v[232:235], v[36:39], v[72:75], v[232:235]
  v_cvt_pk_bf16_f32 v82, v24, v25
  v_add_f32 v24, v24, v25
  v_mfma_f32_16x16x32_bf16 v[236:239], v[36:39], v[76:79], v[236:239]
  ds_read_b128 v[56:59], v12 offset:26752
  s_waitcnt lgkmcnt(3)
  v_mfma_f32_16x16x32_bf16 v[240:243], v[40:43], v[72:75], v[240:243]
  v_exp_f32 v27, v107
  v_mfma_f32_16x16x32_bf16 v[244:247], v[40:43], v[76:79], v[244:247]
  ds_read_b128 v[60:63], v13 offset:26752
  v_add_f32 v10, v10, v24
  v_cvt_pk_bf16_f32 v83, v26, v27
  v_mfma_f32_16x16x32_bf16 v[248:251], v[44:47], v[72:75], v[248:251]
  v_add_f32 v26, v26, v27
  v_add_f32 v10, v10, v26
  v_mfma_f32_16x16x32_bf16 v[252:255], v[44:47], v[76:79], v[252:255]
  s_barrier
  ds_read_b128 v[32:35], v12 offset:26880
  s_waitcnt lgkmcnt(3)
  v_mfma_f32_16x16x32_bf16 v[88:91], v[48:51], v[112:115], v[64:67]
  s_setprio 3
  v_exp_f32 v28, v108
  v_mfma_f32_16x16x32_bf16 v[92:95], v[48:51], v[116:119], v[68:71]
  ds_read_b128 v[36:39], v13 offset:26880
  v_exp_f32 v29, v109
  v_mfma_f32_16x16x32_bf16 v[88:91], v[52:55], v[120:123], v[88:91]
  v_exp_f32 v30, v110
  v_mfma_f32_16x16x32_bf16 v[92:95], v[52:55], v[124:127], v[92:95]
  ds_read_b128 v[40:43], v12 offset:32768
  s_waitcnt lgkmcnt(3)
  v_mfma_f32_16x16x32_bf16 v[88:91], v[56:59], v[128:131], v[88:91]
  v_cvt_pk_bf16_f32 v86, v28, v29
  v_add_f32 v28, v28, v29
  v_mfma_f32_16x16x32_bf16 v[92:95], v[56:59], v[132:135], v[92:95]
  ds_read_b128 v[44:47], v13 offset:32768
  v_exp_f32 v31, v111
  v_mfma_f32_16x16x32_bf16 v[88:91], v[60:63], v[136:139], v[88:91]
  v_add_f32 v11, v11, v28
  v_cvt_pk_bf16_f32 v87, v30, v31
  v_mfma_f32_16x16x32_bf16 v[92:95], v[60:63], v[140:143], v[92:95]
  ds_read_b128 v[48:51], v12 offset:32896
  v_add_f32 v30, v30, v31
  s_waitcnt lgkmcnt(3)
  v_mfma_f32_16x16x32_bf16 v[88:91], v[32:35], v[144:147], v[88:91]
  v_add_f32 v11, v11, v30
  v_max_f32 v2, v10, v11
  v_mfma_f32_16x16x32_bf16 v[92:95], v[32:35], v[148:151], v[92:95]
  ds_read_b128 v[52:55], v13 offset:32896
  v_cmp_lt_f32 vcc, s37, v2
  v_mfma_f32_16x16x32_bf16 v[88:91], v[36:39], v[152:155], v[88:91]
  v_mfma_f32_16x16x32_bf16 v[92:95], v[36:39], v[156:159], v[92:95]
  ds_read_b128 v[56:59], v12 offset:33024
  s_cbranch_vccnz L_rare_a6
L_ret_a6:
  v_add_f32 v8, v8, v10
  s_waitcnt lgkmcnt(3)
  v_mfma_f32_16x16x32_bf16 v[104:107], v[40:43], v[112:115], v[64:67]
  s_setprio 2
  v_add_f32 v9, v9, v11
  v_mfma_f32_16x16x32_bf16 v[108:111], v[40:43], v[116:119], v[68:71]
  ds_read_b128 v[60:63], v13 offset:33024
  v_mfma_f32_16x16x32_bf16 v[104:107], v[44:47], v[120:123], v[104:107]
  v_exp_f32 v24, v88
  v_mfma_f32_16x16x32_bf16 v[108:111], v[44:47], v[124:127], v[108:111]
  ds_read_b64_tr_b16 v[32:33], v14 offset:0
  s_waitcnt lgkmcnt(3)
  v_mfma_f32_16x16x32_bf16 v[104:107], v[48:51], v[128:131], v[104:107]
  ds_read_b64_tr_b16 v[34:35], v14 offset:6144
  v_exp_f32 v25, v89
  v_mfma_f32_16x16x32_bf16 v[108:111], v[48:51], v[132:135], v[108:111]
  ds_read_b64_tr_b16 v[36:37], v15 offset:0
  v_exp_f32 v26, v90
  v_mfma_f32_16x16x32_bf16 v[104:107], v[52:55], v[136:139], v[104:107]
  ds_read_b64_tr_b16 v[38:39], v15 offset:6144
  v_cvt_pk_bf16_f32 v72, v24, v25
  v_mfma_f32_16x16x32_bf16 v[108:111], v[52:55], v[140:143], v[108:111]
  ds_read_b64_tr_b16 v[40:41], v16 offset:0
  v_add_f32 v24, v24, v25
  s_waitcnt lgkmcnt(5)
  v_mfma_f32_16x16x32_bf16 v[104:107], v[56:59], v[144:147], v[104:107]
  ds_read_b64_tr_b16 v[42:43], v16 offset:6144
  v_exp_f32 v27, v91
  v_mfma_f32_16x16x32_bf16 v[108:111], v[56:59], v[148:151], v[108:111]
  ds_read_b64_tr_b16 v[44:45], v17 offset:0
  v_cvt_pk_bf16_f32 v73, v26, v27
  v_mfma_f32_16x16x32_bf16 v[104:107], v[60:63], v[152:155], v[104:107]
  ds_read_b64_tr_b16 v[46:47], v17 offset:6144
  v_add_f32 v26, v26, v27
  v_mfma_f32_16x16x32_bf16 v[108:111], v[60:63], v[156:159], v[108:111]
  ds_read_b64_tr_b16 v[48:49], v14 offset:128
  v_add_f32 v10, v24, v26
  s_waitcnt lgkmcnt(5)
  v_mfma_f32_16x16x32_bf16 v[160:163], v[32:35], v[80:83], v[160:163]
  ds_read_b64_tr_b16 v[50:51], v14 offset:6272
  s_setprio 1
  v_mfma_f32_16x16x32_bf16 v[164:167], v[32:35], v[84:87], v[164:167]
  ds_read_b64_tr_b16 v[52:53], v15 offset:128
  v_exp_f32 v28, v92
  v_mfma_f32_16x16x32_bf16 v[168:171], v[36:39], v[80:83], v[168:171]
  ds_read_b64_tr_b16 v[54:55], v15 offset:6272
  v_mfma_f32_16x16x32_bf16 v[172:175], v[36:39], v[84:87], v[172:175]
  ds_read_b64_tr_b16 v[56:57], v16 offset:128
  v_exp_f32 v29, v93
  s_waitcnt lgkmcnt(5)
  v_mfma_f32_16x16x32_bf16 v[176:179], v[40:43], v[80:83], v[176:179]
  ds_read_b64_tr_b16 v[58:59], v16 offset:6272
  v_mfma_f32_16x16x32_bf16 v[180:183], v[40:43], v[84:87], v[180:183]
  ds_read_b64_tr_b16 v[60:61], v17 offset:128
  v_exp_f32 v30, v94
  v_mfma_f32_16x16x32_bf16 v[184:187], v[44:47], v[80:83], v[184:187]
  ds_read_b64_tr_b16 v[62:63], v17 offset:6272
  v_cvt_pk_bf16_f32 v76, v28, v29
  v_add_f32 v28, v28, v29
  v_mfma_f32_16x16x32_bf16 v[188:191], v[44:47], v[84:87], v[188:191]
  ds_read_b64_tr_b16 v[32:33], v14 offset:256
  s_waitcnt lgkmcnt(5)
  v_mfma_f32_16x16x32_bf16 v[192:195], v[48:51], v[80:83], v[192:195]
  ds_read_b64_tr_b16 v[34:35], v14 offset:6400
  v_add_u32 v14, 53248, v14
  v_mfma_f32_16x16x32_bf16 v[196:199], v[48:51], v[84:87], v[196:199]
  ds_read_b64_tr_b16 v[36:37], v15 offset:256
  v_exp_f32 v31, v95
  v_mfma_f32_16x16x32_bf16 v[200:203], v[52:55], v[80:83], v[200:203]
  ds_read_b64_tr_b16 v[38:39], v15 offset:6400
  v_add_u32 v15, 53248, v15
  v_cvt_pk_bf16_f32 v77, v30, v31
  v_mfma_f32_16x16x32_bf16 v[204:207], v[52:55], v[84:87], v[204:207]
  ds_read_b64_tr_b16 v[40:41], v16 offset:256
  s_waitcnt lgkmcnt(5)
  v_mfma_f32_16x16x32_bf16 v[208:211], v[56:59], v[80:83], v[208:211]
  ds_read_b64_tr_b16 v[42:43], v16 offset:6400
  s_setprio 0
  v_add_u32 v16, 53248, v16
  v_add_f32 v30, v30, v31
  v_mfma_f32_16x16x32_bf16 v[212:215], v[56:59], v[84:87], v[212:215]
  ds_read_b64_tr_b16 v[44:45], v17 offset:256
  v_add_f32 v11, v28, v30
  v_mfma_f32_16x16x32_bf16 v[216:219], v[60:63], v[80:83], v[216:219]
  ds_read_b64_tr_b16 v[46:47], v17 offset:6400
  v_add_u32 v17, 53248, v17
  v_mfma_f32_16x16x32_bf16 v[220:223], v[60:63], v[84:87], v[220:223]
  ds_read_b128 v[48:51], v12 offset:0
  v_exp_f32 v24, v104
  s_waitcnt lgkmcnt(5)
  v_mfma_f32_16x16x32_bf16 v[224:227], v[32:35], v[80:83], v[224:227]
  v_exp_f32 v25, v105
  v_mfma_f32_16x16x32_bf16 v[228:231], v[32:35], v[84:87], v[228:231]
  ds_read_b128 v[52:55], v13 offset:0
  v_exp_f32 v26, v106
  v_mfma_f32_16x16x32_bf16 v[232:235], v[36:39], v[80:83], v[232:235]
  v_cvt_pk_bf16_f32 v74, v24, v25
  v_add_f32 v24, v24, v25
  v_mfma_f32_16x16x32_bf16 v[236:239], v[36:39], v[84:87], v[236:239]
  ds_read_b128 v[56:59], v12 offset:128
  s_waitcnt lgkmcnt(3)
  v_mfma_f32_16x16x32_bf16 v[240:243], v[40:43], v[80:83], v[240:243]
  v_exp_f32 v27, v107
  v_mfma_f32_16x16x32_bf16 v[244:247], v[40:43], v[84:87], v[244:247]
  ds_read_b128 v[60:63], v13 offset:128
  v_add_f32 v10, v10, v24
  v_cvt_pk_bf16_f32 v75, v26, v27
  v_mfma_f32_16x16x32_bf16 v[248:251], v[44:47], v[80:83], v[248:251]
  v_add_f32 v26, v26, v27
  v_add_f32 v10, v10, v26
  v_mfma_f32_16x16x32_bf16 v[252:255], v[44:47], v[84:87], v[252:255]
  s_barrier
  ds_read_b128 v[32:35], v12 offset:256
  s_waitcnt lgkmcnt(3)
  v_mfma_f32_16x16x32_bf16 v[96:99], v[48:51], v[112:115], v[64:67]
  s_setprio 3
  v_exp_f32 v28, v108
  v_mfma_f32_16x16x32_bf16 v[100:103], v[48:51], v[116:119], v[68:71]
  ds_read_b128 v[36:39], v13 offset:256
  v_exp_f32 v29, v109
  v_mfma_f32_16x16x32_bf16 v[96:99], v[52:55], v[120:123], v[96:99]
  v_exp_f32 v30, v110
  v_mfma_f32_16x16x32_bf16 v[100:103], v[52:55], v[124:127], v[100:103]
  ds_read_b128 v[40:43], v12 offset:6144
  s_waitcnt lgkmcnt(3)
  v_mfma_f32_16x16x32_bf16 v[96:99], v[56:59], v[128:131], v[96:99]
  v_cvt_pk_bf16_f32 v78, v28, v29
  v_add_f32 v28, v28, v29
  v_mfma_f32_16x16x32_bf16 v[100:103], v[56:59], v[132:135], v[100:103]
  ds_read_b128 v[44:47], v13 offset:6144
  v_exp_f32 v31, v111
  v_mfma_f32_16x16x32_bf16 v[96:99], v[60:63], v[136:139], v[96:99]
  v_add_f32 v11, v11, v28
  v_cvt_pk_bf16_f32 v79, v30, v31
  v_mfma_f32_16x16x32_bf16 v[100:103], v[60:63], v[140:143], v[100:103]
  ds_read_b128 v[48:51], v12 offset:6272
  v_add_f32 v30, v30, v31
  s_waitcnt lgkmcnt(3)
  v_mfma_f32_16x16x32_bf16 v[96:99], v[32:35], v[144:147], v[96:99]
  v_add_f32 v11, v11, v30
  v_max_f32 v2, v10, v11
  v_mfma_f32_16x16x32_bf16 v[100:103], v[32:35], v[148:151], v[100:103]
  ds_read_b128 v[52:55], v13 offset:6272
  v_cmp_lt_f32 vcc, s37, v2
  v_mfma_f32_16x16x32_bf16 v[96:99], v[36:39], v[152:155], v[96:99]
  v_mfma_f32_16x16x32_bf16 v[100:103], v[36:39], v[156:159], v[100:103]
  ds_read_b128 v[56:59], v12 offset:6400
  s_cbranch_vccnz L_rare_a7
L_ret_a7:
  v_add_f32 v8, v8, v10
  s_waitcnt lgkmcnt(3)
  v_mfma_f32_16x16x32_bf16 v[104:107], v[40:43], v[112:115], v[64:67]
  s_setprio 2
  v_add_f32 v9, v9, v11
  v_mfma_f32_16x16x32_bf16 v[108:111], v[40:43], v[116:119], v[68:71]
  ds_read_b128 v[60:63], v13 offset:6400
  v_add_u32 v12, 53248, v12
  v_mfma_f32_16x16x32_bf16 v[104:107], v[44:47], v[120:123], v[104:107]
  v_add_u32 v13, 53248, v13
  v_mfma_f32_16x16x32_bf16 v[108:111], v[44:47], v[124:127], v[108:111]
  ds_read_b64_tr_b16 v[32:33], v14 offset:26624
  v_exp_f32 v24, v96
  s_waitcnt lgkmcnt(3)
  v_mfma_f32_16x16x32_bf16 v[104:107], v[48:51], v[128:131], v[104:107]
  ds_read_b64_tr_b16 v[34:35], v14 offset:32768
  v_exp_f32 v25, v97
  v_mfma_f32_16x16x32_bf16 v[108:111], v[48:51], v[132:135], v[108:111]
  ds_read_b64_tr_b16 v[36:37], v15 offset:26624
  v_mfma_f32_16x16x32_bf16 v[104:107], v[52:55], v[136:139], v[104:107]
  ds_read_b64_tr_b16 v[38:39], v15 offset:32768
  v_exp_f32 v26, v98
  v_mfma_f32_16x16x32_bf16 v[108:111], v[52:55], v[140:143], v[108:111]
  ds_read_b64_tr_b16 v[40:41], v16 offset:26624
  s_waitcnt lgkmcnt(5)
  v_mfma_f32_16x16x32_bf16 v[104:107], v[56:59], v[144:147], v[104:107]
  ds_read_b64_tr_b16 v[42:43], v16 offset:32768
  v_cvt_pk_bf16_f32 v80, v24, v25
  v_add_f32 v24, v24, v25
  v_mfma_f32_16x16x32_bf16 v[108:111], v[56:59], v[148:151], v[108:111]
  ds_read_b64_tr_b16 v[44:45], v17 offset:26624
  v_exp_f32 v27, v99
  v_mfma_f32_16x16x32_bf16 v[104:107], v[60:63], v[152:155], v[104:107]
  ds_read_b64_tr_b16 v[46:47], v17 offset:32768
  v_cvt_pk_bf16_f32 v81, v26, v27
  v_mfma_f32_16x16x32_bf16 v[108:111], v[60:63], v[156:159], v[108:111]
  ds_read_b64_tr_b16 v[48:49], v14 offset:26752
  s_waitcnt lgkmcnt(5)
  v_mfma_f32_16x16x32_bf16 v[160:163], v[32:35], v[72:75], v[160:163]
  ds_read_b64_tr_b16 v[50:51], v14 offset:32896
  s_setprio 1
  v_add_f32 v26, v26, v27
  v_mfma_f32_16x16x32_bf16 v[164:167], v[32:35], v[76:79], v[164:167]
  ds_read_b64_tr_b16 v[52:53], v15 offset:26752
  v_add_f32 v10, v24, v26
  v_mfma_f32_16x16x32_bf16 v[168:171], v[36:39], v[72:75], v[168:171]
  ds_read_b64_tr_b16 v[54:55], v15 offset:32896
  v_exp_f32 v28, v100
  v_mfma_f32_16x16x32_bf16 v[172:175], v[36:39], v[76:79], v[172:175]
  ds_read_b64_tr_b16 v[56:57], v16 offset:26752
  s_waitcnt lgkmcnt(5)
  v_mfma_f32_16x16x32_bf16 v[176:179], v[40:43], v[72:75], v[176:179]
  ds_read_b64_tr_b16 v[58:59], v16 offset:32896
  v_exp_f32 v29, v101
  v_mfma_f32_16x16x32_bf16 v[180:183], v[40:43], v[76:79], v[180:183]
  ds_read_b64_tr_b16 v[60:61], v17 offset:26752
  v_mfma_f32_16x16x32_bf16 v[184:187], v[44:47], v[72:75], v[184:187]
  ds_read_b64_tr_b16 v[62:63], v17 offset:32896
  v_exp_f32 v30, v102
  v_mfma_f32_16x16x32_bf16 v[188:191], v[44:47], v[76:79], v[188:191]
  ds_read_b64_tr_b16 v[32:33], v14 offset:26880
  v_cvt_pk_bf16_f32 v84, v28, v29
  s_waitcnt lgkmcnt(5)
  v_mfma_f32_16x16x32_bf16 v[192:195], v[48:51], v[72:75], v[192:195]
  ds_read_b64_tr_b16 v[34:35], v14 offset:33024
  v_add_f32 v28, v28, v29
  v_mfma_f32_16x16x32_bf16 v[196:199], v[48:51], v[76:79], v[196:199]
  ds_read_b64_tr_b16 v[36:37], v15 offset:26880
  v_exp_f32 v31, v103
  v_mfma_f32_16x16x32_bf16 v[200:203], v[52:55], v[72:75], v[200:203]
  ds_read_b64_tr_b16 v[38:39], v15 offset:33024
  v_cvt_pk_bf16_f32 v85, v30, v31
  v_mfma_f32_16x16x32_bf16 v[204:207], v[52:55], v[76:79], v[204:207]
  ds_read_b64_tr_b16 v[40:41], v16 offset:26880
  s_waitcnt lgkmcnt(5)
  v_mfma_f32_16x16x32_bf16 v[208:211], v[56:59], v[72:75], v[208:211]
  ds_read_b64_tr_b16 v[42:43], v16 offset:33024
  s_setprio 0
  v_add_f32 v30, v30, v31
  v_mfma_f32_16x16x32_bf16 v[212:215], v[56:59], v[76:79], v[212:215]
  ds_read_b64_tr_b16 v[44:45], v17 offset:26880
  v_add_f32 v11, v28, v30
  v_mfma_f32_16x16x32_bf16 v[216:219], v[60:63], v[72:75], v[216:219]
  ds_read_b64_tr_b16 v[46:47], v17 offset:33024
  v_exp_f32 v24, v104
  v_mfma_f32_16x16x32_bf16 v[220:223], v[60:63], v[76:79], v[220:223]
  ds_read_b128 v[48:51], v12 offset:26624
  s_waitcnt lgkmcnt(5)
  v_mfma_f32_16x16x32_bf16 v[224:227], v[32:35], v[72:75], v[224:227]
  v_exp_f32 v25, v105
  v_mfma_f32_16x16x32_bf16 v[228:231], v[32:35], v[76:79], v[228:231]
  ds_read_b128 v[52:55], v13 offset:26624
  v_exp_f32 v26, v106
  v_mfma_f32_16x16x32_bf16 v[232:235], v[36:39], v[72:75], v[232:235]
  v_cvt_pk_bf16_f32 v82, v24, v25
  v_add_f32 v24, v24, v25
  v_mfma_f32_16x16x32_bf16 v[236:239], v[36:39], v[76:79], v[236:239]
  ds_read_b128 v[56:59], v12 offset:26752
  s_waitcnt lgkmcnt(3)
  v_mfma_f32_16x16x32_bf16 v[240:243], v[40:43], v[72:75], v[240:243]
  v_exp_f32 v27, v107
  s_sub_u32 s39, s39, 1
  v_mfma_f32_16x16x32_bf16 v[244:247], v[40:43], v[76:79], v[244:247]
  ds_read_b128 v[60:63], v13 offset:26752
  v_add_f32 v10, v10, v24
  v_cvt_pk_bf16_f32 v83, v26, v27
  v_mfma_f32_16x16x32_bf16 v[248:251], v[44:47], v[72:75], v[248:251]
  v_add_f32 v26, v26, v27
  v_add_f32 v10, v10, v26
  s_cmp_lg_u32 s39, 0
  v_mfma_f32_16x16x32_bf16 v[252:255], v[44:47], v[76:79], v[252:255]
  s_cbranch_scc1 L_aloop
  s_barrier
  ds_read_b128 v[32:35], v12 offset:26880
  s_waitcnt lgkmcnt(3)
  v_mfma_f32_16x16x32_bf16 v[88:91], v[48:51], v[112:115], v[64:67]
  s_setprio 3
  v_exp_f32 v28, v108
  s_cmp_eq_u32 s54, 1
  s_cbranch_scc0 L_nox_a14_0
  s_add_u32 m0, s49, 0
  s_add_u32 s47, s48, 20480
  buffer_load_dwordx4 v5, s[8:11], s48 offen  lds
L_nox_a14_0:
  v_mfma_f32_16x16x32_bf16 v[92:95], v[48:51], v[116:119], v[68:71]
  ds_read_b128 v[36:39], v13 offset:26880
  v_exp_f32 v29, v109
  v_mfma_f32_16x16x32_bf16 v[88:91], v[52:55], v[120:123], v[88:91]
  v_exp_f32 v30, v110
  s_cmp_eq_u32 s54, 1
  s_cbranch_scc0 L_nox_a14_1
  buffer_load_dwordx4 v6, s[8:11], s48 offen offset:1024  lds
L_nox_a14_1:
  v_mfma_f32_16x16x32_bf16 v[92:95], v[52:55], v[124:127], v[92:95]
  ds_read_b128 v[40:43], v12 offset:32768
  s_waitcnt lgkmcnt(3)
  v_mfma_f32_16x16x32_bf16 v[88:91], v[56:59], v[128:131], v[88:91]
  v_cvt_pk_bf16_f32 v86, v28, v29
  v_add_f32 v28, v28, v29
  s_cmp_eq_u32 s54, 1
  s_cbranch_scc0 L_nox_a14_2
  s_add_u32 m0, s49, 2048
  s_add_u32 s48, s48, 128
  buffer_load_dwordx4 v5, s[8:11], s47 offen  lds
L_nox_a14_2:
  v_mfma_f32_16x16x32_bf16 v[92:95], v[56:59], v[132:135], v[92:95]
  ds_read_b128 v[44:47], v13 offset:32768
  v_exp_f32 v31, v111
  v_mfma_f32_16x16x32_bf16 v[88:91], v[60:63], v[136:139], v[88:91]
  v_add_f32 v11, v11, v28
  v_cvt_pk_bf16_f32 v87, v30, v31
  s_cmp_eq_u32 s54, 1
  s_cbranch_scc0 L_nox_a14_3
  buffer_load_dwordx4 v6, s[8:11], s47 offen offset:1024  lds
L_nox_a14_3:
  v_mfma_f32_16x16x32_bf16 v[92:95], v[60:63], v[140:143], v[92:95]
  ds_read_b128 v[48:51], v12 offset:32896
  v_add_f32 v30, v30, v31
  s_waitcnt lgkmcnt(3)
  v_mfma_f32_16x16x32_bf16 v[88:91], v[32:35], v[144:147], v[88:91]
  v_add_f32 v11, v11, v30
  v_max_f32 v2, v10, v11
  v_mfma_f32_16x16x32_bf16 v[92:95], v[32:35], v[148:151], v[92:95]
  ds_read_b128 v[52:55], v13 offset:32896
  v_cmp_lt_f32 vcc, s37, v2
  v_mfma_f32_16x16x32_bf16 v[88:91], v[36:39], v[152:155], v[88:91]
  v_mfma_f32_16x16x32_bf16 v[92:95], v[36:39], v[156:159], v[92:95]
  ds_read_b128 v[56:59], v12 offset:33024
  s_cbranch_vccnz L_rare_a14
L_ret_a14:
  v_add_f32 v8, v8, v10
  s_waitcnt lgkmcnt(3)
  v_mfma_f32_16x16x32_bf16 v[104:107], v[40:43], v[112:115], v[64:67]
  s_setprio 2
  v_add_f32 v9, v9, v11
  v_mfma_f32_16x16x32_bf16 v[108:111], v[40:43], v[116:119], v[68:71]
  ds_read_b128 v[60:63], v13 offset:33024
  v_mfma_f32_16x16x32_bf16 v[104:107], v[44:47], v[120:123], v[104:107]
  v_exp_f32 v24, v88
  v_mfma_f32_16x16x32_bf16 v[108:111], v[44:47], v[124:127], v[108:111]
  ds_read_b64_tr_b16 v[32:33], v14 offset:0
  s_waitcnt lgkmcnt(3)
  v_mfma_f32_16x16x32_bf16 v[104:107], v[48:51], v[128:131], v[104:107]
  ds_read_b64_tr_b16 v[34:35], v14 offset:6144
  v_exp_f32 v25, v89
  v_mfma_f32_16x16x32_bf16 v[108:111], v[48:51], v[132:135], v[108:111]
  ds_read_b64_tr_b16 v[36:37], v15 offset:0
  v_exp_f32 v26, v90
  v_mfma_f32_16x16x32_bf16 v[104:107], v[52:55], v[136:139], v[104:107]
  ds_read_b64_tr_b16 v[38:39], v15 offset:6144
  v_cvt_pk_bf16_f32 v72, v24, v25
  v_mfma_f32_16x16x32_bf16 v[108:111], v[52:55], v[140:143], v[108:111]
  ds_read_b64_tr_b16 v[40:41], v16 offset:0
  v_add_f32 v24, v24, v25
  s_waitcnt lgkmcnt(5)
  v_mfma_f32_16x16x32_bf16 v[104:107], v[56:59], v[144:147], v[104:107]
  ds_read_b64_tr_b16 v[42:43], v16 offset:6144
  v_exp_f32 v27, v91
  v_mfma_f32_16x16x32_bf16 v[108:111], v[56:59], v[148:151], v[108:111]
  ds_read_b64_tr_b16 v[44:45], v17 offset:0
  v_cvt_pk_bf16_f32 v73, v26, v27
  v_mfma_f32_16x16x32_bf16 v[104:107], v[60:63], v[152:155], v[104:107]
  ds_read_b64_tr_b16 v[46:47], v17 offset:6144
  v_add_f32 v26, v26, v27
  v_mfma_f32_16x16x32_bf16 v[108:111], v[60:63], v[156:159], v[108:111]
  ds_read_b64_tr_b16 v[48:49], v14 offset:128
  v_add_f32 v10, v24, v26
  s_waitcnt lgkmcnt(5)
  v_mfma_f32_16x16x32_bf16 v[160:163], v[32:35], v[80:83], v[160:163]
  ds_read_b64_tr_b16 v[50:51], v14 offset:6272
  s_setprio 1
  v_mfma_f32_16x16x32_bf16 v[164:167], v[32:35], v[84:87], v[164:167]
  ds_read_b64_tr_b16 v[52:53], v15 offset:128
  v_exp_f32 v28, v92
  v_mfma_f32_16x16x32_bf16 v[168:171], v[36:39], v[80:83], v[168:171]
  ds_read_b64_tr_b16 v[54:55], v15 offset:6272
  v_mfma_f32_16x16x32_bf16 v[172:175], v[36:39], v[84:87], v[172:175]
  ds_read_b64_tr_b16 v[56:57], v16 offset:128
  v_exp_f32 v29, v93
  s_waitcnt lgkmcnt(5)
  v_mfma_f32_16x16x32_bf16 v[176:179], v[40:43], v[80:83], v[176:179]
  ds_read_b64_tr_b16 v[58:59], v16 offset:6272
  v_mfma_f32_16x16x32_bf16 v[180:183], v[40:43], v[84:87], v[180:183]
  ds_read_b64_tr_b16 v[60:61], v17 offset:128
  v_exp_f32 v30, v94
  v_mfma_f32_16x16x32_bf16 v[184:187], v[44:47], v[80:83], v[184:187]
  ds_read_b64_tr_b16 v[62:63], v17 offset:6272
  v_cvt_pk_bf16_f32 v76, v28, v29
  v_add_f32 v28, v28, v29
  v_mfma_f32_16x16x32_bf16 v[188:191], v[44:47], v[84:87], v[188:191]
  ds_read_b64_tr_b16 v[32:33], v14 offset:256
  s_waitcnt lgkmcnt(5)
  v_mfma_f32_16x16x32_bf16 v[192:195], v[48:51], v[80:83], v[192:195]
  ds_read_b64_tr_b16 v[34:35], v14 offset:6400
  v_add_u32 v14, 53248, v14
  v_mfma_f32_16x16x32_bf16 v[196:199], v[48:51], v[84:87], v[196:199]
  ds_read_b64_tr_b16 v[36:37], v15 offset:256
  v_exp_f32 v31, v95
  v_mfma_f32_16x16x32_bf16 v[200:203], v[52:55], v[80:83], v[200:203]
  ds_read_b64_tr_b16 v[38:39], v15 offset:6400
  v_add_u32 v15, 53248, v15
  v_cvt_pk_bf16_f32 v77, v30, v31
  v_mfma_f32_16x16x32_bf16 v[204:207], v[52:55], v[84:87], v[204:207]
  ds_read_b64_tr_b16 v[40:41], v16 offset:256
  s_waitcnt lgkmcnt(5)
  v_mfma_f32_16x16x32_bf16 v[208:211], v[56:59], v[80:83], v[208:211]
  ds_read_b64_tr_b16 v[42:43], v16 offset:6400
  s_setprio 0
  v_add_u32 v16, 53248, v16
  v_add_f32 v30, v30, v31
  v_mfma_f32_16x16x32_bf16 v[212:215], v[56:59], v[84:87], v[212:215]
  ds_read_b64_tr_b16 v[44:45], v17 offset:256
  v_add_f32 v11, v28, v30
  v_mfma_f32_16x16x32_bf16 v[216:219], v[60:63], v[80:83], v[216:219]
  ds_read_b64_tr_b16 v[46:47], v17 offset:6400
  v_add_u32 v17, 53248, v17
  v_mfma_f32_16x16x32_bf16 v[220:223], v[60:63], v[84:87], v[220:223]
  ds_read_b128 v[48:51], v12 offset:0
  v_exp_f32 v24, v104
  s_waitcnt lgkmcnt(5)
  v_mfma_f32_16x16x32_bf16 v[224:227], v[32:35], v[80:83], v[224:227]
  v_exp_f32 v25, v105
  v_mfma_f32_16x16x32_bf16 v[228:231], v[32:35], v[84:87], v[228:231]
  ds_read_b128 v[52:55], v13 offset:0
  v_exp_f32 v26, v106
  v_mfma_f32_16x16x32_bf16 v[232:235], v[36:39], v[80:83], v[232:235]
  v_cvt_pk_bf16_f32 v74, v24, v25
  v_add_f32 v24, v24, v25
  v_mfma_f32_16x16x32_bf16 v[236:239], v[36:39], v[84:87], v[236:239]
  ds_read_b128 v[56:59], v12 offset:128
  s_waitcnt lgkmcnt(3)
  v_mfma_f32_16x16x32_bf16 v[240:243], v[40:43], v[80:83], v[240:243]
  v_exp_f32 v27, v107
  v_mfma_f32_16x16x32_bf16 v[244:247], v[40:43], v[84:87], v[244:247]
  ds_read_b128 v[60:63], v13 offset:128
  v_add_f32 v10, v10, v24
  v_cvt_pk_bf16_f32 v75, v26, v27
  v_mfma_f32_16x16x32_bf16 v[248:251], v[44:47], v[80:83], v[248:251]
  v_add_f32 v26, v26, v27
  v_add_f32 v10, v10, v26
  v_mfma_f32_16x16x32_bf16 v[252:255], v[44:47], v[84:87], v[252:255]
  s_barrier
  ds_read_b128 v[32:35], v12 offset:256
  s_waitcnt lgkmcnt(3)
  v_mfma_f32_16x16x32_bf16 v[96:99], v[48:51], v[112:115], v[64:67]
  s_setprio 3
  v_exp_f32 v28, v108
  s_cmp_eq_u32 s54, 1
  s_cbranch_scc0 L_nox_a15_0
  s_add_u32 m0, s49, 53248
  s_add_u32 s47, s48, 20480
  buffer_load_dwordx4 v5, s[8:11], s48 offen  lds
L_nox_a15_0:
  v_mfma_f32_16x16x32_bf16 v[100:103], v[48:51], v[116:119], v[68:71]
  ds_read_b128 v[36:39], v13 offset:256
  v_exp_f32 v29, v109
  v_mfma_f32_16x16x32_bf16 v[96:99], v[52:55], v[120:123], v[96:99]
  v_exp_f32 v30, v110
  s_cmp_eq_u32 s54, 1
  s_cbranch_scc0 L_nox_a15_1
  buffer_load_dwordx4 v6, s[8:11], s48 offen offset:1024  lds
L_nox_a15_1:
  v_mfma_f32_16x16x32_bf16 v[100:103], v[52:55], v[124:127], v[100:103]
  ds_read_b128 v[40:43], v12 offset:6144
  s_waitcnt lgkmcnt(3)
  v_mfma_f32_16x16x32_bf16 v[96:99], v[56:59], v[128:131], v[96:99]
  v_cvt_pk_bf16_f32 v78, v28, v29
  v_add_f32 v28, v28, v29
  s_cmp_eq_u32 s54, 1
  s_cbranch_scc0 L_nox_a15_2
  s_add_u32 m0, s49, 55296
  s_add_u32 s48, s48, 128
  buffer_load_dwordx4 v5, s[8:11], s47 offen  lds
L_nox_a15_2:
  v_mfma_f32_16x16x32_bf16 v[100:103], v[56:59], v[132:135], v[100:103]
  ds_read_b128 v[44:47], v13 offset:6144
  v_exp_f32 v31, v111
  v_mfma_f32_16x16x32_bf16 v[96:99], v[60:63], v[136:139], v[96:99]
  v_add_f32 v11, v11, v28
  v_cvt_pk_bf16_f32 v79, v30, v31
  s_cmp_eq_u32 s54, 1
  s_cbranch_scc0 L_nox_a15_3
  buffer_load_dwordx4 v6, s[8:11], s47 offen offset:1024  lds
L_nox_a15_3:
  v_mfma_f32_16x16x32_bf16 v[100:103], v[60:63], v[140:143], v[100:103]
  ds_read_b128 v[48:51], v12 offset:6272
  v_add_f32 v30, v30, v31
  s_waitcnt lgkmcnt(3)
  v_mfma_f32_16x16x32_bf16 v[96:99], v[32:35], v[144:147], v[96:99]
  v_add_f32 v11, v11, v30
  v_max_f32 v2, v10, v11
  v_mfma_f32_16x16x32_bf16 v[100:103], v[32:35], v[148:151], v[100:103]
  ds_read_b128 v[52:55], v13 offset:6272
  v_cmp_lt_f32 vcc, s37, v2
  v_mfma_f32_16x16x32_bf16 v[96:99], v[36:39], v[152:155], v[96:99]
  v_mfma_f32_16x16x32_bf16 v[100:103], v[36:39], v[156:159], v[100:103]
  ds_read_b128 v[56:59], v12 offset:6400
  s_cbranch_vccnz L_rare_a15
L_ret_a15:
  v_add_f32 v8, v8, v10
  s_waitcnt lgkmcnt(3)
  v_mfma_f32_16x16x32_bf16 v[104:107], v[40:43], v[112:115], v[64:67]
  s_setprio 2
  v_add_f32 v9, v9, v11
  v_mfma_f32_16x16x32_bf16 v[108:111], v[40:43], v[116:119], v[68:71]
  ds_read_b128 v[60:63], v13 offset:6400
  v_mfma_f32_16x16x32_bf16 v[104:107], v[44:47], v[120:123], v[104:107]
  v_exp_f32 v24, v96
  v_mfma_f32_16x16x32_bf16 v[108:111], v[44:47], v[124:127], v[108:111]
  ds_read_b64_tr_b16 v[32:33], v14 offset:26624
  v_exp_f32 v25, v97
  s_waitcnt lgkmcnt(3)
  v_mfma_f32_16x16x32_bf16 v[104:107], v[48:51], v[128:131], v[104:107]
  ds_read_b64_tr_b16 v[34:35], v14 offset:32768
  v_exp_f32 v26, v98
  v_mfma_f32_16x16x32_bf16 v[108:111], v[48:51], v[132:135], v[108:111]
  ds_read_b64_tr_b16 v[36:37], v15 offset:26624
  v_cvt_pk_bf16_f32 v80, v24, v25
  v_add_f32 v24, v24, v25
  v_mfma_f32_16x16x32_bf16 v[104:107], v[52:55], v[136:139], v[104:107]
  ds_read_b64_tr_b16 v[38:39], v15 offset:32768
  v_exp_f32 v27, v99
  v_mfma_f32_16x16x32_bf16 v[108:111], v[52:55], v[140:143], v[108:111]
  ds_read_b64_tr_b16 v[40:41], v16 offset:26624
  v_cvt_pk_bf16_f32 v81, v26, v27
  v_add_f32 v26, v26, v27
  s_waitcnt lgkmcnt(5)
  v_mfma_f32_16x16x32_bf16 v[104:107], v[56:59], v[144:147], v[104:107]
  ds_read_b64_tr_b16 v[42:43], v16 offset:32768
  v_add_f32 v10, v24, v26
  v_mfma_f32_16x16x32_bf16 v[108:111], v[56:59], v[148:151], v[108:111]
  ds_read_b64_tr_b16 v[44:45], v17 offset:26624
  v_exp_f32 v28, v100
  v_mfma_f32_16x16x32_bf16 v[104:107], v[60:63], v[152:155], v[104:107]
  ds_read_b64_tr_b16 v[46:47], v17 offset:32768
  v_exp_f32 v29, v101
  v_mfma_f32_16x16x32_bf16 v[108:111], v[60:63], v[156:159], v[108:111]
  ds_read_b64_tr_b16 v[48:49], v14 offset:26752
  v_exp_f32 v30, v102
  s_waitcnt lgkmcnt(5)
  v_mfma_f32_16x16x32_bf16 v[160:163], v[32:35], v[72:75], v[160:163]
  ds_read_b64_tr_b16 v[50:51], v14 offset:32896
  s_setprio 1
  v_cvt_pk_bf16_f32 v84, v28, v29
  v_add_f32 v28, v28, v29
  v_mfma_f32_16x16x32_bf16 v[164:167], v[32:35], v[76:79], v[164:167]
  ds_read_b64_tr_b16 v[52:53], v15 offset:26752
  v_exp_f32 v31, v103
  v_mfma_f32_16x16x32_bf16 v[168:171], v[36:39], v[72:75], v[168:171]
  ds_read_b64_tr_b16 v[54:55], v15 offset:32896
  v_cvt_pk_bf16_f32 v85, v30, v31
  v_add_f32 v30, v30, v31
  v_mfma_f32_16x16x32_bf16 v[172:175], v[36:39], v[76:79], v[172:175]
  ds_read_b64_tr_b16 v[56:57], v16 offset:26752
  v_add_f32 v11, v28, v30
  s_waitcnt lgkmcnt(5)
  v_mfma_f32_16x16x32_bf16 v[176:179], v[40:43], v[72:75], v[176:179]
  ds_read_b64_tr_b16 v[58:59], v16 offset:32896
  v_exp_f32 v24, v104
  v_mfma_f32_16x16x32_bf16 v[180:183], v[40:43], v[76:79], v[180:183]
  ds_read_b64_tr_b16 v[60:61], v17 offset:26752
  v_exp_f32 v25, v105
  v_mfma_f32_16x16x32_bf16 v[184:187], v[44:47], v[72:75], v[184:187]
  ds_read_b64_tr_b16 v[62:63], v17 offset:32896
  v_exp_f32 v26, v106
  v_mfma_f32_16x16x32_bf16 v[188:191], v[44:47], v[76:79], v[188:191]
  ds_read_b64_tr_b16 v[32:33], v14 offset:26880
  v_cvt_pk_bf16_f32 v82, v24, v25
  v_add_f32 v24, v24, v25
  s_waitcnt lgkmcnt(5)
  v_mfma_f32_16x16x32_bf16 v[192:195], v[48:51], v[72:75], v[192:195]
  ds_read_b64_tr_b16 v[34:35], v14 offset:33024
  v_exp_f32 v27, v107
  v_mfma_f32_16x16x32_bf16 v[196:199], v[48:51], v[76:79], v[196:199]
  ds_read_b64_tr_b16 v[36:37], v15 offset:26880
  v_add_f32 v10, v10, v24
  v_cvt_pk_bf16_f32 v83, v26, v27
  v_mfma_f32_16x16x32_bf16 v[200:203], v[52:55], v[72:75], v[200:203]
  ds_read_b64_tr_b16 v[38:39], v15 offset:33024
  v_add_f32 v26, v26, v27
  v_add_f32 v10, v10, v26
  v_mfma_f32_16x16x32_bf16 v[204:207], v[52:55], v[76:79], v[204:207]
  ds_read_b64_tr_b16 v[40:41], v16 offset:26880
  v_exp_f32 v28, v108
  s_waitcnt lgkmcnt(5)
  v_mfma_f32_16x16x32_bf16 v[208:211], v[56:59], v[72:75], v[208:211]
  ds_read_b64_tr_b16 v[42:43], v16 offset:33024
  s_setprio 0
  v_exp_f32 v29, v109
  v_mfma_f32_16x16x32_bf16 v[212:215], v[56:59], v[76:79], v[212:215]
  ds_read_b64_tr_b16 v[44:45], v17 offset:26880
  v_exp_f32 v30, v110
  v_mfma_f32_16x16x32_bf16 v[216:219], v[60:63], v[72:75], v[216:219]
  ds_read_b64_tr_b16 v[46:47], v17 offset:33024
  v_cvt_pk_bf16_f32 v86, v28, v29
  v_add_f32 v28, v28, v29
  v_mfma_f32_16x16x32_bf16 v[220:223], v[60:63], v[76:79], v[220:223]
  ds_read_b64_tr_b16 v[48:49], v14 offset:0
  v_exp_f32 v31, v111
  s_waitcnt lgkmcnt(5)
  v_mfma_f32_16x16x32_bf16 v[224:227], v[32:35], v[72:75], v[224:227]
  ds_read_b64_tr_b16 v[50:51], v14 offset:6144
  v_add_f32 v11, v11, v28
  v_cvt_pk_bf16_f32 v87, v30, v31
  v_mfma_f32_16x16x32_bf16 v[228:231], v[32:35], v[76:79], v[228:231]
  ds_read_b64_tr_b16 v[52:53], v15 offset:0
  v_add_f32 v30, v30, v31
  v_add_f32 v11, v11, v30
  v_mfma_f32_16x16x32_bf16 v[232:235], v[36:39], v[72:75], v[232:235]
  ds_read_b64_tr_b16 v[54:55], v15 offset:6144
  v_max_f32 v2, v10, v11
  v_cmp_lt_f32 vcc, s37, v2
  v_mfma_f32_16x16x32_bf16 v[236:239], v[36:39], v[76:79], v[236:239]
  ds_read_b64_tr_b16 v[56:57], v16 offset:0
  s_waitcnt lgkmcnt(5)
  v_mfma_f32_16x16x32_bf16 v[240:243], v[40:43], v[72:75], v[240:243]
  ds_read_b64_tr_b16 v[58:59], v16 offset:6144
  v_mfma_f32_16x16x32_bf16 v[244:247], v[40:43], v[76:79], v[244:247]
  ds_read_b64_tr_b16 v[60:61], v17 offset:0
  v_mfma_f32_16x16x32_bf16 v[248:251], v[44:47], v[72:75], v[248:251]
  ds_read_b64_tr_b16 v[62:63], v17 offset:6144
  s_cmp_eq_u32 s54, 1
  v_mfma_f32_16x16x32_bf16 v[252:255], v[44:47], v[76:79], v[252:255]
  s_cbranch_scc0 L_ophase
  s_mov_b32 s54, 99
  s_mov_b32 s44, s55
  s_barrier
  s_cbranch_vccnz L_rare_af0
L_ret_af0:
  ds_read_b64_tr_b16 v[32:33], v14 offset:128
  v_add_f32 v8, v8, v10
  v_add_f32 v9, v9, v11
  v_mov_b32 v1, v8
  s_waitcnt lgkmcnt(5)
  v_mfma_f32_16x16x32_bf16 v[160:163], v[48:51], v[80:83], v[160:163]
  ds_read_b64_tr_b16 v[34:35], v14 offset:6272
  s_setprio 3
  s_waitcnt vmcnt(4)
  v_mov_b32 v2, v9
  v_permlane32_swap_b32 v8, v1
  s_nop 0
  v_permlane32_swap_b32 v9, v2
  v_mfma_f32_16x16x32_bf16 v[164:167], v[48:51], v[84:87], v[164:167]
  ds_read_b64_tr_b16 v[36:37], v15 offset:128
  v_add_f32 v8, v8, v1
  v_add_f32 v9, v9, v2
  v_mov_b32 v1, v8
  v_mfma_f32_16x16x32_bf16 v[168:171], v[52:55], v[80:83], v[168:171]
  ds_read_b64_tr_b16 v[38:39], v15 offset:6272
  ds_read_b128 v[72:75], v18 offset:0
  v_mov_b32 v2, v9
  v_permlane16_swap_b32 v8, v1
  s_nop 0
  v_permlane16_swap_b32 v9, v2
  v_mfma_f32_16x16x32_bf16 v[172:175], v[52:55], v[84:87], v[172:175]
  ds_read_b64_tr_b16 v[40:41], v16 offset:128
  v_add_f32 v8, v8, v1
  v_add_f32 v9, v9, v2
  s_waitcnt lgkmcnt(6)
  v_mfma_f32_16x16x32_bf16 v[176:179], v[56:59], v[80:83], v[176:179]
  ds_read_b64_tr_b16 v[42:43], v16 offset:6272
  v_rcp_f32 v8, v8
  v_mfma_f32_16x16x32_bf16 v[180:183], v[56:59], v[84:87], v[180:183]
  ds_read_b64_tr_b16 v[44:45], v17 offset:128
  s_setprio 2
  v_rcp_f32 v9, v9
  v_mul_f32 v160, v8, v160
  v_mfma_f32_16x16x32_bf16 v[184:187], v[60:63], v[80:83], v[184:187]
  ds_read_b64_tr_b16 v[46:47], v17 offset:6272
  ds_read_b128 v[76:79], v18 offset:2048
  v_mul_f32 v161, v8, v161
  v_mul_f32 v162, v8, v162
  v_mul_f32 v163, v8, v163
  v_mfma_f32_16x16x32_bf16 v[188:191], v[60:63], v[84:87], v[188:191]
  ds_read_b64_tr_b16 v[48:49], v14 offset:256
  v_mul_f32 v168, v8, v168
  v_mul_f32 v169, v8, v169
  v_mul_f32 v170, v8, v170
  s_waitcnt lgkmcnt(7)
  v_mfma_f32_16x16x32_bf16 v[192:195], v[32:35], v[80:83], v[192:195]
  ds_read_b64_tr_b16 v[50:51], v14 offset:6400
  v_xor_b32 v14, 0, v21
  v_mul_f32 v171, v8, v171
  v_cvt_pk_bf16_f32 v112, v160, v161
  v_mfma_f32_16x16x32_bf16 v[196:199], v[32:35], v[84:87], v[196:199]
  ds_read_b64_tr_b16 v[52:53], v15 offset:256
  v_cvt_pk_bf16_f32 v114, v168, v169
  v_cvt_pk_bf16_f32 v113, v162, v163
  v_cvt_pk_bf16_f32 v115, v170, v171
  v_mfma_f32_16x16x32_bf16 v[200:203], v[36:39], v[80:83], v[200:203]
  ds_read_b64_tr_b16 v[54:55], v15 offset:6400
  ds_read_b128 v[104:107], v19 offset:0
  v_xor_b32 v15, 32, v21
  v_mul_f32 v164, v9, v164
  v_mul_f32 v165, v9, v165
  v_mfma_f32_16x16x32_bf16 v[204:207], v[36:39], v[84:87], v[204:207]
  ds_read_b64_tr_b16 v[56:57], v16 offset:256
  s_setprio 1
  v_mul_f32 v166, v9, v166
  v_mul_f32 v167, v9, v167
  v_mul_f32 v172, v9, v172
  s_waitcnt lgkmcnt(7)
  v_mfma_f32_16x16x32_bf16 v[208:211], v[40:43], v[80:83], v[208:211]
  ds_read_b64_tr_b16 v[58:59], v16 offset:6400
  v_xor_b32 v16, 64, v21
  v_mul_f32 v173, v9, v173
  v_mul_f32 v174, v9, v174
  v_mfma_f32_16x16x32_bf16 v[212:215], v[40:43], v[84:87], v[212:215]
  ds_read_b64_tr_b16 v[60:61], v17 offset:256
  v_mul_f32 v175, v9, v175
  v_cvt_pk_bf16_f32 v116, v164, v165
  v_cvt_pk_bf16_f32 v118, v172, v173
  v_mfma_f32_16x16x32_bf16 v[216:219], v[44:47], v[80:83], v[216:219]
  ds_read_b64_tr_b16 v[62:63], v17 offset:6400
  ds_read_b128 v[108:111], v19 offset:2048
  v_xor_b32 v17, 96, v21
  v_cvt_pk_bf16_f32 v117, v166, v167
  v_cvt_pk_bf16_f32 v119, v174, v175
  v_mfma_f32_16x16x32_bf16 v[220:223], v[44:47], v[84:87], v[220:223]
  ds_read_b64_tr_b16 v[32:33], v14 offset:0
  v_mul_f32 v176, v8, v176
  v_mul_f32 v177, v8, v177
  v_mul_f32 v178, v8, v178
  s_waitcnt lgkmcnt(7)
  v_mfma_f32_16x16x32_bf16 v[224:227], v[48:51], v[80:83], v[224:227]
  ds_read_b64_tr_b16 v[34:35], v14 offset:1536
  v_mul_f32 v179, v8, v179
  v_mul_f32 v184, v8, v184
  v_mul_f32 v185, v8, v185
  v_mfma_f32_16x16x32_bf16 v[228:231], v[48:51], v[84:87], v[228:231]
  ds_read_b64_tr_b16 v[36:37], v14 offset:12288
  s_setprio 0
  v_mul_f32 v186, v8, v186
  v_mul_f32 v187, v8, v187
  v_cvt_pk_bf16_f32 v120, v176, v177
  v_mfma_f32_16x16x32_bf16 v[232:235], v[52:55], v[80:83], v[232:235]
  ds_read_b64_tr_b16 v[38:39], v14 offset:13824
  v_cvt_pk_bf16_f32 v122, v184, v185
  v_cvt_pk_bf16_f32 v121, v178, v179
  v_cvt_pk_bf16_f32 v123, v186, v187
  v_mfma_f32_16x16x32_bf16 v[236:239], v[52:55], v[84:87], v[236:239]
  ds_read_b64_tr_b16 v[40:41], v15 offset:0
  v_mul_f32 v180, v9, v180
  v_mul_f32 v181, v9, v181
  v_mul_f32 v182, v9, v182
  s_waitcnt lgkmcnt(6)
  v_mfma_f32_16x16x32_bf16 v[240:243], v[56:59], v[80:83], v[240:243]
  ds_read_b64_tr_b16 v[42:43], v15 offset:1536
  v_mul_f32 v183, v9, v183
  v_mul_f32 v188, v9, v188
  v_mul_f32 v189, v9, v189
  v_mfma_f32_16x16x32_bf16 v[244:247], v[56:59], v[84:87], v[244:247]
  ds_read_b64_tr_b16 v[44:45], v15 offset:12288
  v_mul_f32 v190, v9, v190
  v_mul_f32 v191, v9, v191
  v_cvt_pk_bf16_f32 v124, v180, v181
  v_mfma_f32_16x16x32_bf16 v[248:251], v[60:63], v[80:83], v[248:251]
  ds_read_b64_tr_b16 v[46:47], v15 offset:13824
  v_cvt_pk_bf16_f32 v126, v188, v189
  v_cvt_pk_bf16_f32 v125, v182, v183
  v_cvt_pk_bf16_f32 v127, v190, v191
  v_mfma_f32_16x16x32_bf16 v[252:255], v[60:63], v[84:87], v[252:255]
  s_barrier
  ds_read_b64_tr_b16 v[48:49], v16 offset:0
  v_mul_f32 v192, v8, v192
  v_mul_f32 v193, v8, v193
  v_mul_f32 v194, v8, v194
  s_waitcnt lgkmcnt(5)
  v_mfma_f32_16x16x32_bf16 v[160:163], v[32:35], v[72:75], 0
  ds_read_b64_tr_b16 v[50:51], v16 offset:1536
  s_setprio 3
  v_mul_f32 v195, v8, v195
  v_mul_f32 v200, v8, v200
  v_mul_f32 v201, v8, v201
  v_mfma_f32_16x16x32_bf16 v[164:167], v[32:35], v[76:79], 0
  ds_read_b64_tr_b16 v[52:53], v16 offset:12288
  v_mul_f32 v202, v8, v202
  v_mul_f32 v203, v8, v203
  v_cvt_pk_bf16_f32 v128, v192, v193
  s_add_u32 m0, s49, 106496
  s_add_u32 s47, s48, 20480
  buffer_load_dwordx4 v5, s[8:11], s48 offen  lds
  v_mfma_f32_16x16x32_bf16 v[160:163], v[36:39], v[104:107], v[160:163]
  ds_read_b64_tr_b16 v[54:55], v16 offset:13824
  v_cvt_pk_bf16_f32 v130, v200, v201
  v_cvt_pk_bf16_f32 v129, v194, v195
  v_cvt_pk_bf16_f32 v131, v202, v203
  v_mfma_f32_16x16x32_bf16 v[164:167], v[36:39], v[108:111], v[164:167]
  ds_read_b64_tr_b16 v[56:57], v17 offset:0
  v_mul_f32 v196, v9, v196
  v_mul_f32 v197, v9, v197
  v_mul_f32 v198, v9, v198
  s_waitcnt lgkmcnt(5)
  v_mfma_f32_16x16x32_bf16 v[168:171], v[40:43], v[72:75], 0
  ds_read_b64_tr_b16 v[58:59], v17 offset:1536
  v_mul_f32 v199, v9, v199
  v_mul_f32 v204, v9, v204
  v_mul_f32 v205, v9, v205
  buffer_load_dwordx4 v6, s[8:11], s48 offen offset:1024  lds
  v_mfma_f32_16x16x32_bf16 v[172:175], v[40:43], v[76:79], 0
  ds_read_b64_tr_b16 v[60:61], v17 offset:12288
  v_mul_f32 v206, v9, v206
  v_mul_f32 v207, v9, v207
  v_cvt_pk_bf16_f32 v132, v196, v197
  v_mfma_f32_16x16x32_bf16 v[168:171], v[44:47], v[104:107], v[168:171]
  ds_read_b64_tr_b16 v[62:63], v17 offset:13824
  v_cvt_pk_bf16_f32 v134, v204, v205
  v_cvt_pk_bf16_f32 v133, v198, v199
  v_cvt_pk_bf16_f32 v135, v206, v207
  v_mfma_f32_16x16x32_bf16 v[172:175], v[44:47], v[108:111], v[172:175]
  ds_read_b64_tr_b16 v[32:33], v14 offset:128
  v_mul_f32 v208, v8, v208
  v_mul_f32 v209, v8, v209
  v_mul_f32 v210, v8, v210
  s_add_u32 m0, s49, 108544
  s_add_u32 s48, s48, 128
  buffer_load_dwordx4 v5, s[8:11], s47 offen  lds
  s_waitcnt lgkmcnt(5)
  v_mfma_f32_16x16x32_bf16 v[176:179], v[48:51], v[72:75], 0
  ds_read_b64_tr_b16 v[34:35], v14 offset:1664
  v_mul_f32 v211, v8, v211
  v_mul_f32 v216, v8, v216
  v_mul_f32 v217, v8, v217
  v_mfma_f32_16x16x32_bf16 v[180:183], v[48:51], v[76:79], 0
  ds_read_b64_tr_b16 v[36:37], v14 offset:12416
  v_mul_f32 v218, v8, v218
  v_mul_f32 v219, v8, v219
  v_cvt_pk_bf16_f32 v136, v208, v209
  v_mfma_f32_16x16x32_bf16 v[176:179], v[52:55], v[104:107], v[176:179]
  ds_read_b64_tr_b16 v[38:39], v14 offset:13952
  v_cvt_pk_bf16_f32 v138, v216, v217
  v_cvt_pk_bf16_f32 v137, v210, v211
  v_cvt_pk_bf16_f32 v139, v218, v219
  buffer_load_dwordx4 v6, s[8:11], s47 offen offset:1024  lds
  v_mfma_f32_16x16x32_bf16 v[180:183], v[52:55], v[108:111], v[180:183]
  ds_read_b64_tr_b16 v[40:41], v15 offset:128
  s_setprio 2
  v_mul_f32 v212, v9, v212
  v_mul_f32 v213, v9, v213
  v_mul_f32 v214, v9, v214
  s_waitcnt lgkmcnt(5)
  v_mfma_f32_16x16x32_bf16 v[184:187], v[56:59], v[72:75], 0
  ds_read_b64_tr_b16 v[42:43], v15 offset:1664
  v_mul_f32 v215, v9, v215
  v_mul_f32 v220, v9, v220
  v_mul_f32 v221, v9, v221
  v_mfma_f32_16x16x32_bf16 v[188:191], v[56:59], v[76:79], 0
  ds_read_b64_tr_b16 v[44:45], v15 offset:12416
  v_mul_f32 v222, v9, v222
  v_mul_f32 v223, v9, v223
  v_cvt_pk_bf16_f32 v140, v212, v213
  v_mfma_f32_16x16x32_bf16 v[184:187], v[60:63], v[104:107], v[184:187]
  ds_read_b64_tr_b16 v[46:47], v15 offset:13952
  v_cvt_pk_bf16_f32 v142, v220, v221
  v_cvt_pk_bf16_f32 v141, v214, v215
  v_cvt_pk_bf16_f32 v143, v222, v223
  v_mfma_f32_16x16x32_bf16 v[188:191], v[60:63], v[108:111], v[188:191]
  ds_read_b64_tr_b16 v[48:49], v16 offset:128
  v_mul_f32 v224, v8, v224
  v_mul_f32 v225, v8, v225
  v_mul_f32 v226, v8, v226
  s_add_u32 m0, s49, 0
  s_add_u32 s47, s48, 20480
  buffer_load_dwordx4 v5, s[8:11], s48 offen  lds
  s_waitcnt lgkmcnt(5)
  v_mfma_f32_16x16x32_bf16 v[192:195], v[32:35], v[72:75], 0
  ds_read_b64_tr_b16 v[50:51], v16 offset:1664
  v_mul_f32 v227, v8, v227
  v_mul_f32 v232, v8, v232
  v_mul_f32 v233, v8, v233
  v_mfma_f32_16x16x32_bf16 v[196:199], v[32:35], v[76:79], 0
  ds_read_b64_tr_b16 v[52:53], v16 offset:12416
  v_mul_f32 v234, v8, v234
  v_mul_f32 v235, v8, v235
  v_cvt_pk_bf16_f32 v144, v224, v225
  v_mfma_f32_16x16x32_bf16 v[192:195], v[36:39], v[104:107], v[192:195]
  ds_read_b64_tr_b16 v[54:55], v16 offset:13952
  v_cvt_pk_bf16_f32 v146, v232, v233
  v_cvt_pk_bf16_f32 v145, v226, v227
  v_cvt_pk_bf16_f32 v147, v234, v235
  buffer_load_dwordx4 v6, s[8:11], s48 offen offset:1024  lds
  v_mfma_f32_16x16x32_bf16 v[196:199], v[36:39], v[108:111], v[196:199]
  ds_read_b64_tr_b16 v[56:57], v17 offset:128
  v_mul_f32 v228, v9, v228
  v_mul_f32 v229, v9, v229
  v_mul_f32 v230, v9, v230
  s_waitcnt lgkmcnt(5)
  v_mfma_f32_16x16x32_bf16 v[200:203], v[40:43], v[72:75], 0
  ds_read_b64_tr_b16 v[58:59], v17 offset:1664
  v_mul_f32 v231, v9, v231
  v_mul_f32 v236, v9, v236
  v_mul_f32 v237, v9, v237
  v_mfma_f32_16x16x32_bf16 v[204:207], v[40:43], v[76:79], 0
  ds_read_b64_tr_b16 v[60:61], v17 offset:12416
  v_mul_f32 v238, v9, v238
  v_mul_f32 v239, v9, v239
  v_cvt_pk_bf16_f32 v148, v228, v229
  s_add_u32 m0, s49, 2048
  s_add_u32 s48, s48, 128
  buffer_load_dwordx4 v5, s[8:11], s47 offen  lds
  v_add_u32 v18, 53248, v18
  v_mfma_f32_16x16x32_bf16 v[200:203], v[44:47], v[104:107], v[200:203]
  ds_read_b64_tr_b16 v[62:63], v17 offset:13952
  v_cvt_pk_bf16_f32 v150, v236, v237
  v_cvt_pk_bf16_f32 v149, v230, v231
  v_cvt_pk_bf16_f32 v151, v238, v239
  v_add_u32 v19, 53248, v19
  v_mfma_f32_16x16x32_bf16 v[204:207], v[44:47], v[108:111], v[204:207]
  ds_read_b64_tr_b16 v[32:33], v14 offset:256
  s_setprio 1
  v_mul_f32 v240, v8, v240
  v_mul_f32 v241, v8, v241
  v_mul_f32 v242, v8, v242
  s_waitcnt lgkmcnt(5)
  v_mfma_f32_16x16x32_bf16 v[208:211], v[48:51], v[72:75], 0
  ds_read_b64_tr_b16 v[34:35], v14 offset:1792
  v_mul_f32 v243, v8, v243
  v_mul_f32 v248, v8, v248
  v_mul_f32 v249, v8, v249
  buffer_load_dwordx4 v6, s[8:11], s47 offen offset:1024  lds
  v_mfma_f32_16x16x32_bf16 v[212:215], v[48:51], v[76:79], 0
  ds_read_b64_tr_b16 v[36:37], v14 offset:12544
  v_mul_f32 v250, v8, v250
  v_mul_f32 v251, v8, v251
  v_cvt_pk_bf16_f32 v152, v240, v241
  s_waitcnt vmcnt(8)
  v_mfma_f32_16x16x32_bf16 v[208:211], v[52:55], v[104:107], v[208:211]
  ds_read_b64_tr_b16 v[38:39], v14 offset:14080
  ds_read_b128 v[88:91], v18 offset:0
  v_add_u32 v14, 53248, v14
  v_cvt_pk_bf16_f32 v154, v248, v249
  v_cvt_pk_bf16_f32 v153, v242, v243
  v_mfma_f32_16x16x32_bf16 v[212:215], v[52:55], v[108:111], v[212:215]
  ds_read_b64_tr_b16 v[40:41], v15 offset:256
  v_cvt_pk_bf16_f32 v155, v250, v251
  v_mul_f32 v244, v9, v244
  v_mul_f32 v245, v9, v245
  s_waitcnt lgkmcnt(6)
  v_mfma_f32_16x16x32_bf16 v[216:219], v[56:59], v[72:75], 0
  ds_read_b64_tr_b16 v[42:43], v15 offset:1792
  ds_read_b128 v[92:95], v18 offset:2048
  v_mul_f32 v246, v9, v246
  v_mul_f32 v247, v9, v247
  v_mul_f32 v252, v9, v252
  v_mfma_f32_16x16x32_bf16 v[220:223], v[56:59], v[76:79], 0
  ds_read_b64_tr_b16 v[44:45], v15 offset:12544
  v_mul_f32 v253, v9, v253
  v_mul_f32 v254, v9, v254
  v_mul_f32 v255, v9, v255
  v_mfma_f32_16x16x32_bf16 v[216:219], v[60:63], v[104:107], v[216:219]
  ds_read_b64_tr_b16 v[46:47], v15 offset:14080
  ds_read_b128 v[96:99], v19 offset:0
  v_add_u32 v15, 53248, v15
  v_cvt_pk_bf16_f32 v156, v244, v245
  v_cvt_pk_bf16_f32 v158, v252, v253
  v_mfma_f32_16x16x32_bf16 v[220:223], v[60:63], v[108:111], v[220:223]
  ds_read_b64_tr_b16 v[48:49], v16 offset:256
  v_cvt_pk_bf16_f32 v157, v246, v247
  v_cvt_pk_bf16_f32 v159, v254, v255
  s_waitcnt lgkmcnt(8)
  v_mfma_f32_16x16x32_bf16 v[224:227], v[32:35], v[72:75], 0
  ds_read_b64_tr_b16 v[50:51], v16 offset:1792
  ds_read_b128 v[100:103], v19 offset:2048
  v_mfma_f32_16x16x32_bf16 v[228:231], v[32:35], v[76:79], 0
  ds_read_b64_tr_b16 v[52:53], v16 offset:12544
  buffer_store_dwordx4 v[112:115], v7, s[24:27], s44 offen offset:0 sc1
  v_mfma_f32_16x16x32_bf16 v[224:227], v[36:39], v[104:107], v[224:227]
  ds_read_b64_tr_b16 v[54:55], v16 offset:14080
  v_add_u32 v16, 53248, v16
  v_mfma_f32_16x16x32_bf16 v[228:231], v[36:39], v[108:111], v[228:231]
  ds_read_b64_tr_b16 v[56:57], v17 offset:256
  s_setprio 0
  v_add_u32 v12, 4294914048, v12
  s_waitcnt lgkmcnt(7)
  v_mfma_f32_16x16x32_bf16 v[232:235], v[40:43], v[72:75], 0
  ds_read_b64_tr_b16 v[58:59], v17 offset:1792
  v_add_u32 v13, 4294914048, v13
  v_mfma_f32_16x16x32_bf16 v[236:239], v[40:43], v[76:79], 0
  ds_read_b64_tr_b16 v[60:61], v17 offset:12544
  v_mfma_f32_16x16x32_bf16 v[232:235], v[44:47], v[104:107], v[232:235]
  ds_read_b64_tr_b16 v[62:63], v17 offset:14080
  v_add_u32 v17, 53248, v17
  v_mfma_f32_16x16x32_bf16 v[236:239], v[44:47], v[108:111], v[236:239]
  ds_read_b64_tr_b16 v[32:33], v14 offset:0
  s_waitcnt lgkmcnt(5)
  v_mfma_f32_16x16x32_bf16 v[240:243], v[48:51], v[72:75], 0
  ds_read_b64_tr_b16 v[34:35], v14 offset:1536
  v_mfma_f32_16x16x32_bf16 v[244:247], v[48:51], v[76:79], 0
  ds_read_b64_tr_b16 v[36:37], v15 offset:0
  buffer_store_dwordx4 v[116:119], v7, s[24:27], s44 offen offset:1024 sc1
  s_add_u32 s44, s44, 14336
  v_mfma_f32_16x16x32_bf16 v[240:243], v[52:55], v[104:107], v[240:243]
  ds_read_b64_tr_b16 v[38:39], v15 offset:1536
  v_mfma_f32_16x16x32_bf16 v[244:247], v[52:55], v[108:111], v[244:247]
  ds_read_b64_tr_b16 v[40:41], v16 offset:0
  s_waitcnt lgkmcnt(5)
  v_mfma_f32_16x16x32_bf16 v[248:251], v[56:59], v[72:75], 0
  ds_read_b64_tr_b16 v[42:43], v16 offset:1536
  v_mfma_f32_16x16x32_bf16 v[252:255], v[56:59], v[76:79], 0
  ds_read_b64_tr_b16 v[44:45], v17 offset:0
  v_mfma_f32_16x16x32_bf16 v[248:251], v[60:63], v[104:107], v[248:251]
  ds_read_b64_tr_b16 v[46:47], v17 offset:1536
  v_mfma_f32_16x16x32_bf16 v[252:255], v[60:63], v[108:111], v[252:255]
  s_branch L_mid
L_ophase:
  s_mov_b32 s44, s66
  s_barrier
  s_cbranch_vccnz L_rare_af1
L_ret_af1:
  ds_read_b64_tr_b16 v[32:33], v14 offset:128
  v_add_f32 v8, v8, v10
  v_add_f32 v9, v9, v11
  v_mov_b32 v1, v8
  s_waitcnt lgkmcnt(5)
  v_mfma_f32_16x16x32_bf16 v[160:163], v[48:51], v[80:83], v[160:163]
  ds_read_b64_tr_b16 v[34:35], v14 offset:6272
  s_setprio 3
  v_mov_b32 v2, v9
  v_permlane32_swap_b32 v8, v1
  s_nop 0
  v_permlane32_swap_b32 v9, v2
  v_mfma_f32_16x16x32_bf16 v[164:167], v[48:51], v[84:87], v[164:167]
  ds_read_b64_tr_b16 v[36:37], v15 offset:128
  v_add_f32 v8, v8, v1
  v_add_f32 v9, v9, v2
  v_mov_b32 v1, v8
  v_mfma_f32_16x16x32_bf16 v[168:171], v[52:55], v[80:83], v[168:171]
  ds_read_b64_tr_b16 v[38:39], v15 offset:6272
  v_mov_b32 v2, v9
  v_permlane16_swap_b32 v8, v1
  s_nop 0
  v_permlane16_swap_b32 v9, v2
  v_mfma_f32_16x16x32_bf16 v[172:175], v[52:55], v[84:87], v[172:175]
  ds_read_b64_tr_b16 v[40:41], v16 offset:128
  v_add_f32 v8, v8, v1
  v_add_f32 v9, v9, v2
  s_waitcnt lgkmcnt(5)
  v_mfma_f32_16x16x32_bf16 v[176:179], v[56:59], v[80:83], v[176:179]
  ds_read_b64_tr_b16 v[42:43], v16 offset:6272
  v_rcp_f32 v8, v8
  v_mfma_f32_16x16x32_bf16 v[180:183], v[56:59], v[84:87], v[180:183]
  ds_read_b64_tr_b16 v[44:45], v17 offset:128
  s_setprio 2
  v_rcp_f32 v9, v9
  v_lshrrev_b32 v3, 6, v7
  v_mfma_f32_16x16x32_bf16 v[184:187], v[60:63], v[80:83], v[184:187]
  ds_read_b64_tr_b16 v[46:47], v17 offset:6272
  v_and_b32 v3, 15, v3
  v_mul_u32_u24 v4, 320, v3
  v_lshrrev_b32 v5, 1, v7
  v_mfma_f32_16x16x32_bf16 v[188:191], v[60:63], v[84:87], v[188:191]
  ds_read_b64_tr_b16 v[48:49], v14 offset:256
  v_and_b32 v5, 24, v5
  v_add_u32 v4, v4, v5
  v_lshlrev_b32 v5, 3, v3
  s_waitcnt lgkmcnt(5)
  v_mfma_f32_16x16x32_bf16 v[192:195], v[32:35], v[80:83], v[192:195]
  ds_read_b64_tr_b16 v[50:51], v14 offset:6400
  v_and_b32 v5, 32, v5
  v_add_u32 v22, v4, v5
  v_xor_b32 v5, 32, v5
  v_mfma_f32_16x16x32_bf16 v[196:199], v[32:35], v[84:87], v[196:199]
  ds_read_b64_tr_b16 v[52:53], v15 offset:256
  v_add_u32 v23, v4, v5
  v_mul_f32 v160, v8, v160
  v_mul_f32 v161, v8, v161
  v_mfma_f32_16x16x32_bf16 v[200:203], v[36:39], v[80:83], v[200:203]
  ds_read_b64_tr_b16 v[54:55], v15 offset:6400
  v_mul_f32 v162, v8, v162
  v_mul_f32 v163, v8, v163
  v_mul_f32 v168, v8, v168
  v_mfma_f32_16x16x32_bf16 v[204:207], v[36:39], v[84:87], v[204:207]
  ds_read_b64_tr_b16 v[56:57], v16 offset:256
  s_setprio 1
  v_mul_f32 v169, v8, v169
  v_mul_f32 v170, v8, v170
  v_mul_f32 v171, v8, v171
  s_waitcnt lgkmcnt(5)
  v_mfma_f32_16x16x32_bf16 v[208:211], v[40:43], v[80:83], v[208:211]
  ds_read_b64_tr_b16 v[58:59], v16 offset:6400
  v_cvt_pk_bf16_f32 v112, v160, v161
  v_cvt_pk_bf16_f32 v114, v168, v169
  v_cvt_pk_bf16_f32 v113, v162, v163
  v_mfma_f32_16x16x32_bf16 v[212:215], v[40:43], v[84:87], v[212:215]
  ds_read_b64_tr_b16 v[60:61], v17 offset:256
  v_cvt_pk_bf16_f32 v115, v170, v171
  v_mul_f32 v164, v9, v164
  v_mul_f32 v165, v9, v165
  v_mfma_f32_16x16x32_bf16 v[216:219], v[44:47], v[80:83], v[216:219]
  ds_read_b64_tr_b16 v[62:63], v17 offset:6400
  v_mul_f32 v166, v9, v166
  v_mul_f32 v167, v9, v167
  v_mul_f32 v172, v9, v172
  v_mfma_f32_16x16x32_bf16 v[220:223], v[44:47], v[84:87], v[220:223]
  ds_read_b64_tr_b16 v[32:33], v22 offset:0
  v_mul_f32 v173, v9, v173
  v_mul_f32 v174, v9, v174
  v_mul_f32 v175, v9, v175
  s_waitcnt lgkmcnt(5)
  v_mfma_f32_16x16x32_bf16 v[224:227], v[48:51], v[80:83], v[224:227]
  ds_read_b64_tr_b16 v[34:35], v22 offset:5120
  v_cvt_pk_bf16_f32 v116, v164, v165
  v_cvt_pk_bf16_f32 v118, v172, v173
  v_cvt_pk_bf16_f32 v117, v166, v167
  v_mfma_f32_16x16x32_bf16 v[228:231], v[48:51], v[84:87], v[228:231]
  ds_read_b64_tr_b16 v[36:37], v23 offset:0
  s_setprio 0
  v_cvt_pk_bf16_f32 v119, v174, v175
  v_mul_f32 v176, v8, v176
  v_mul_f32 v177, v8, v177
  v_mfma_f32_16x16x32_bf16 v[232:235], v[52:55], v[80:83], v[232:235]
  ds_read_b64_tr_b16 v[38:39], v23 offset:5120
  v_mul_f32 v178, v8, v178
  v_mul_f32 v179, v8, v179
  v_mul_f32 v184, v8, v184
  v_mfma_f32_16x16x32_bf16 v[236:239], v[52:55], v[84:87], v[236:239]
  ds_read_b64_tr_b16 v[40:41], v22 offset:64
  v_mul_f32 v185, v8, v185
  v_mul_f32 v186, v8, v186
  v_mul_f32 v187, v8, v187
  s_waitcnt lgkmcnt(5)
  v_mfma_f32_16x16x32_bf16 v[240:243], v[56:59], v[80:83], v[240:243]
  ds_read_b64_tr_b16 v[42:43], v22 offset:5184
  v_cvt_pk_bf16_f32 v120, v176, v177
  v_cvt_pk_bf16_f32 v122, v184, v185
  v_cvt_pk_bf16_f32 v121, v178, v179
  v_mfma_f32_16x16x32_bf16 v[244:247], v[56:59], v[84:87], v[244:247]
  ds_read_b64_tr_b16 v[44:45], v23 offset:64
  v_cvt_pk_bf16_f32 v123, v186, v187
  v_mul_f32 v180, v9, v180
  v_mul_f32 v181, v9, v181
  v_mfma_f32_16x16x32_bf16 v[248:251], v[60:63], v[80:83], v[248:251]
  ds_read_b64_tr_b16 v[46:47], v23 offset:5184
  v_mul_f32 v182, v9, v182
  v_mul_f32 v183, v9, v183
  v_mul_f32 v188, v9, v188
  v_mfma_f32_16x16x32_bf16 v[252:255], v[60:63], v[84:87], v[252:255]
  s_barrier
  ds_read_b64_tr_b16 v[48:49], v22 offset:10240
  v_mul_f32 v189, v9, v189
  v_mul_f32 v190, v9, v190
  v_mul_f32 v191, v9, v191
  s_add_u32 s38, s92, 0
  s_and_b32 s38, s38, 3
  s_waitcnt lgkmcnt(5)
  v_mfma_f32_16x16x32_bf16 v[160:163], v[32:35], v[112:115], 0
  ds_read_b64_tr_b16 v[50:51], v22 offset:15360
  s_setprio 3
  v_cvt_pk_bf16_f32 v124, v180, v181
  v_cvt_pk_bf16_f32 v126, v188, v189
  v_cvt_pk_bf16_f32 v125, v182, v183
  s_mul_i32 s38, s38, 172032
  s_add_u32 s45, s64, s38
  v_mfma_f32_16x16x32_bf16 v[164:167], v[32:35], v[116:119], 0
  ds_read_b64_tr_b16 v[52:53], v23 offset:10240
  v_cvt_pk_bf16_f32 v127, v190, v191
  v_mfma_f32_16x16x32_bf16 v[168:171], v[36:39], v[112:115], 0
  ds_read_b64_tr_b16 v[54:55], v23 offset:15360
  v_mul_f32 v192, v8, v192
  v_mul_f32 v193, v8, v193
  buffer_load_dwordx4 v[64:67], v7, s[24:27], s45 offen sc1
  v_mfma_f32_16x16x32_bf16 v[172:175], v[36:39], v[116:119], 0
  ds_read_b64_tr_b16 v[32:33], v22 offset:10304
  v_mul_f32 v194, v8, v194
  v_mul_f32 v195, v8, v195
  s_waitcnt lgkmcnt(5)
  v_mfma_f32_16x16x32_bf16 v[176:179], v[40:43], v[112:115], 0
  ds_read_b64_tr_b16 v[34:35], v22 offset:15424
  v_mul_f32 v200, v8, v200
  v_mul_f32 v201, v8, v201
  v_mfma_f32_16x16x32_bf16 v[180:183], v[40:43], v[116:119], 0
  ds_read_b64_tr_b16 v[36:37], v23 offset:10304
  v_mul_f32 v202, v8, v202
  v_mul_f32 v203, v8, v203
  v_mfma_f32_16x16x32_bf16 v[184:187], v[44:47], v[112:115], 0
  ds_read_b64_tr_b16 v[38:39], v23 offset:15424
  v_cvt_pk_bf16_f32 v128, v192, v193
  v_cvt_pk_bf16_f32 v130, v200, v201
  v_mfma_f32_16x16x32_bf16 v[188:191], v[44:47], v[116:119], 0
  ds_read_b64_tr_b16 v[40:41], v22 offset:128
  v_cvt_pk_bf16_f32 v129, v194, v195
  v_cvt_pk_bf16_f32 v131, v202, v203
  s_waitcnt lgkmcnt(5)
  v_mfma_f32_16x16x32_bf16 v[160:163], v[48:51], v[120:123], v[160:163]
  ds_read_b64_tr_b16 v[42:43], v22 offset:5248
  v_mul_f32 v196, v9, v196
  v_mul_f32 v197, v9, v197
  buffer_load_dwordx4 v[68:71], v7, s[24:27], s45 offen offset:1024 sc1
  v_mfma_f32_16x16x32_bf16 v[164:167], v[48:51], v[124:127], v[164:167]
  ds_read_b64_tr_b16 v[44:45], v22 offset:10368
  s_setprio 2
  v_mul_f32 v198, v9, v198
  v_mul_f32 v199, v9, v199
  s_add_u32 s45, s45, 14336
  v_mfma_f32_16x16x32_bf16 v[168:171], v[52:55], v[120:123], v[168:171]
  ds_read_b64_tr_b16 v[46:47], v22 offset:15488
  v_mul_f32 v204, v9, v204
  v_mul_f32 v205, v9, v205
  v_mfma_f32_16x16x32_bf16 v[172:175], v[52:55], v[124:127], v[172:175]
  ds_read_b64_tr_b16 v[48:49], v23 offset:128
  v_mul_f32 v206, v9, v206
  v_mul_f32 v207, v9, v207
  s_waitcnt lgkmcnt(5)
  v_mfma_f32_16x16x32_bf16 v[176:179], v[32:35], v[120:123], v[176:179]
  ds_read_b64_tr_b16 v[50:51], v23 offset:5248
  v_cvt_pk_bf16_f32 v132, v196, v197
  v_cvt_pk_bf16_f32 v134, v204, v205
  v_mfma_f32_16x16x32_bf16 v[180:183], v[32:35], v[124:127], v[180:183]
  ds_read_b64_tr_b16 v[52:53], v23 offset:10368
  v_cvt_pk_bf16_f32 v133, v198, v199
  v_cvt_pk_bf16_f32 v135, v206, v207
  v_mfma_f32_16x16x32_bf16 v[184:187], v[36:39], v[120:123], v[184:187]
  ds_read_b64_tr_b16 v[54:55], v23 offset:15488
  v_mul_f32 v208, v8, v208
  v_mul_f32 v209, v8, v209
  buffer_load_dwordx4 v[72:75], v7, s[24:27], s45 offen sc1
  v_mfma_f32_16x16x32_bf16 v[188:191], v[36:39], v[124:127], v[188:191]
  ds_read_b64_tr_b16 v[32:33], v22 offset:26624
  v_mul_f32 v210, v8, v210
  v_mul_f32 v211, v8, v211
  s_waitcnt lgkmcnt(5)
  v_mfma_f32_16x16x32_bf16 v[192:195], v[40:43], v[112:115], 0
  ds_read_b64_tr_b16 v[34:35], v22 offset:31744
  v_mul_f32 v216, v8, v216
  v_mul_f32 v217, v8, v217
  v_mfma_f32_16x16x32_bf16 v[196:199], v[40:43], v[116:119], 0
  ds_read_b64_tr_b16 v[36:37], v23 offset:26624
  v_mul_f32 v218, v8, v218
  v_mul_f32 v219, v8, v219
  v_mfma_f32_16x16x32_bf16 v[192:195], v[44:47], v[120:123], v[192:195]
  ds_read_b64_tr_b16 v[38:39], v23 offset:31744
  v_cvt_pk_bf16_f32 v136, v208, v209
  v_cvt_pk_bf16_f32 v138, v216, v217
  v_mfma_f32_16x16x32_bf16 v[196:199], v[44:47], v[124:127], v[196:199]
  ds_read_b64_tr_b16 v[40:41], v22 offset:26688
  s_setprio 1
  v_cvt_pk_bf16_f32 v137, v210, v211
  v_cvt_pk_bf16_f32 v139, v218, v219
  s_waitcnt lgkmcnt(5)
  v_mfma_f32_16x16x32_bf16 v[200:203], v[48:51], v[112:115], 0
  ds_read_b64_tr_b16 v[42:43], v22 offset:31808
  v_mul_f32 v212, v9, v212
  v_mul_f32 v213, v9, v213
  buffer_load_dwordx4 v[76:79], v7, s[24:27], s45 offen offset:1024 sc1
  v_mfma_f32_16x16x32_bf16 v[204:207], v[48:51], v[116:119], 0
  ds_read_b64_tr_b16 v[44:45], v23 offset:26688
  v_mul_f32 v214, v9, v214
  v_mul_f32 v215, v9, v215
  s_add_u32 s45, s45, 14336
  v_mfma_f32_16x16x32_bf16 v[200:203], v[52:55], v[120:123], v[200:203]
  ds_read_b64_tr_b16 v[46:47], v23 offset:31808
  v_mul_f32 v220, v9, v220
  v_mul_f32 v221, v9, v221
  v_mfma_f32_16x16x32_bf16 v[204:207], v[52:55], v[124:127], v[204:207]
  ds_read_b64_tr_b16 v[48:49], v22 offset:26752
  v_mul_f32 v222, v9, v222
  v_mul_f32 v223, v9, v223
  s_waitcnt lgkmcnt(5)
  v_mfma_f32_16x16x32_bf16 v[160:163], v[32:35], v[128:131], v[160:163]
  ds_read_b64_tr_b16 v[50:51], v22 offset:31872
  v_cvt_pk_bf16_f32 v140, v212, v213
  v_cvt_pk_bf16_f32 v142, v220, v221
  v_mfma_f32_16x16x32_bf16 v[164:167], v[32:35], v[132:135], v[164:167]
  ds_read_b64_tr_b16 v[52:53], v23 offset:26752
  v_cvt_pk_bf16_f32 v141, v214, v215
  v_cvt_pk_bf16_f32 v143, v222, v223
  v_mfma_f32_16x16x32_bf16 v[168:171], v[36:39], v[128:131], v[168:171]
  ds_read_b64_tr_b16 v[54:55], v23 offset:31872
  buffer_store_dwordx4 v[112:115], v7, s[24:27], s44 offen offset:0 sc1
  v_mfma_f32_16x16x32_bf16 v[172:175], v[36:39], v[132:135], v[172:175]
  ds_read_b64_tr_b16 v[32:33], v22 offset:192
  s_waitcnt lgkmcnt(5)
  v_mfma_f32_16x16x32_bf16 v[176:179], v[40:43], v[128:131], v[176:179]
  ds_read_b64_tr_b16 v[34:35], v22 offset:5312
  v_mfma_f32_16x16x32_bf16 v[180:183], v[40:43], v[132:135], v[180:183]
  ds_read_b64_tr_b16 v[36:37], v22 offset:10432
  s_setprio 0
  v_mfma_f32_16x16x32_bf16 v[184:187], v[44:47], v[128:131], v[184:187]
  ds_read_b64_tr_b16 v[38:39], v22 offset:15552
  v_mfma_f32_16x16x32_bf16 v[188:191], v[44:47], v[132:135], v[188:191]
  ds_read_b64_tr_b16 v[40:41], v22 offset:26816
  s_waitcnt lgkmcnt(5)
  v_mfma_f32_16x16x32_bf16 v[192:195], v[48:51], v[128:131], v[192:195]
  ds_read_b64_tr_b16 v[42:43], v22 offset:31936
  v_mfma_f32_16x16x32_bf16 v[196:199], v[48:51], v[132:135], v[196:199]
  ds_read_b64_tr_b16 v[44:45], v23 offset:192
  v_mfma_f32_16x16x32_bf16 v[200:203], v[52:55], v[128:131], v[200:203]
  ds_read_b64_tr_b16 v[46:47], v23 offset:5312
  v_mul_f32 v224, v8, v224
  v_mul_f32 v225, v8, v225
  v_mfma_f32_16x16x32_bf16 v[204:207], v[52:55], v[132:135], v[204:207]
  ds_read_b64_tr_b16 v[48:49], v23 offset:10432
  v_mul_f32 v226, v8, v226
  v_mul_f32 v227, v8, v227
  s_waitcnt lgkmcnt(5)
  v_mfma_f32_16x16x32_bf16 v[208:211], v[32:35], v[112:115], 0
  ds_read_b64_tr_b16 v[50:51], v23 offset:15552
  v_mul_f32 v232, v8, v232
  v_mul_f32 v233, v8, v233
  v_mfma_f32_16x16x32_bf16 v[212:215], v[32:35], v[116:119], 0
  ds_read_b64_tr_b16 v[52:53], v23 offset:26816
  v_mul_f32 v234, v8, v234
  v_mul_f32 v235, v8, v235
  v_mfma_f32_16x16x32_bf16 v[208:211], v[36:39], v[120:123], v[208:211]
  ds_read_b64_tr_b16 v[54:55], v23 offset:31936
  v_cvt_pk_bf16_f32 v144, v224, v225
  v_cvt_pk_bf16_f32 v146, v232, v233
  v_mfma_f32_16x16x32_bf16 v[212:215], v[36:39], v[124:127], v[212:215]
  s_barrier
  ds_read_b64_tr_b16 v[32:33], v22 offset:36864
  v_cvt_pk_bf16_f32 v145, v226, v227
  v_cvt_pk_bf16_f32 v147, v234, v235
  s_waitcnt lgkmcnt(5)
  v_mfma_f32_16x16x32_bf16 v[208:211], v[40:43], v[128:131], v[208:211]
  ds_read_b64_tr_b16 v[34:35], v22 offset:41984
  v_mul_f32 v228, v9, v228
  v_mul_f32 v229, v9, v229
  s_setprio 3
  v_mfma_f32_16x16x32_bf16 v[212:215], v[40:43], v[132:135], v[212:215]
  ds_read_b64_tr_b16 v[36:37], v23 offset:36864
  v_mul_f32 v230, v9, v230
  v_mul_f32 v231, v9, v231
  v_mfma_f32_16x16x32_bf16 v[216:219], v[44:47], v[112:115], 0
  ds_read_b64_tr_b16 v[38:39], v23 offset:41984
  v_mul_f32 v236, v9, v236
  v_mul_f32 v237, v9, v237
  buffer_load_dwordx4 v[80:83], v7, s[24:27], s45 offen sc1
  v_mfma_f32_16x16x32_bf16 v[220:223], v[44:47], v[116:119], 0
  ds_read_b64_tr_b16 v[40:41], v22 offset:36928
  v_mul_f32 v238, v9, v238
  v_mul_f32 v239, v9, v239
  s_waitcnt lgkmcnt(5)
  v_mfma_f32_16x16x32_bf16 v[216:219], v[48:51], v[120:123], v[216:219]
  ds_read_b64_tr_b16 v[42:43], v22 offset:42048
  v_cvt_pk_bf16_f32 v148, v228, v229
  v_cvt_pk_bf16_f32 v150, v236, v237
  v_mfma_f32_16x16x32_bf16 v[220:223], v[48:51], v[124:127], v[220:223]
  ds_read_b64_tr_b16 v[44:45], v23 offset:36928
  v_cvt_pk_bf16_f32 v149, v230, v231
  v_cvt_pk_bf16_f32 v151, v238, v239
  v_mfma_f32_16x16x32_bf16 v[216:219], v[52:55], v[128:131], v[216:219]
  ds_read_b64_tr_b16 v[46:47], v23 offset:42048
  v_mfma_f32_16x16x32_bf16 v[220:223], v[52:55], v[132:135], v[220:223]
  ds_read_b64_tr_b16 v[48:49], v22 offset:36992
  s_waitcnt lgkmcnt(5)
  v_mfma_f32_16x16x32_bf16 v[160:163], v[32:35], v[136:139], v[160:163]
  ds_read_b64_tr_b16 v[50:51], v22 offset:42112
  buffer_load_dwordx4 v[84:87], v7, s[24:27], s45 offen offset:1024 sc1
  v_mfma_f32_16x16x32_bf16 v[164:167], v[32:35], v[140:143], v[164:167]
  ds_read_b64_tr_b16 v[52:53], v23 offset:36992
  s_add_u32 s45, s45, 14336
  v_mfma_f32_16x16x32_bf16 v[168:171], v[36:39], v[136:139], v[168:171]
  ds_read_b64_tr_b16 v[54:55], v23 offset:42112
  s_setprio 2
  v_mfma_f32_16x16x32_bf16 v[172:175], v[36:39], v[140:143], v[172:175]
  ds_read_b64_tr_b16 v[32:33], v22 offset:37056
  s_waitcnt lgkmcnt(5)
  v_mfma_f32_16x16x32_bf16 v[176:179], v[40:43], v[136:139], v[176:179]
  ds_read_b64_tr_b16 v[34:35], v22 offset:42176
  v_mfma_f32_16x16x32_bf16 v[180:183], v[40:43], v[140:143], v[180:183]
  ds_read_b64_tr_b16 v[36:37], v23 offset:37056
  v_mfma_f32_16x16x32_bf16 v[184:187], v[44:47], v[136:139], v[184:187]
  ds_read_b64_tr_b16 v[38:39], v23 offset:42176
  buffer_load_dwordx4 v[88:91], v7, s[24:27], s45 offen sc1
  v_mfma_f32_16x16x32_bf16 v[188:191], v[44:47], v[140:143], v[188:191]
  ds_read_b64_tr_b16 v[40:41], v22 offset:256
  s_waitcnt lgkmcnt(5)
  v_mfma_f32_16x16x32_bf16 v[192:195], v[48:51], v[136:139], v[192:195]
  ds_read_b64_tr_b16 v[42:43], v22 offset:5376
  v_mfma_f32_16x16x32_bf16 v[196:199], v[48:51], v[140:143], v[196:199]
  ds_read_b64_tr_b16 v[44:45], v22 offset:10496
  v_mfma_f32_16x16x32_bf16 v[200:203], v[52:55], v[136:139], v[200:203]
  ds_read_b64_tr_b16 v[46:47], v22 offset:15616
  v_mfma_f32_16x16x32_bf16 v[204:207], v[52:55], v[140:143], v[204:207]
  ds_read_b64_tr_b16 v[48:49], v22 offset:26880
  s_waitcnt lgkmcnt(5)
  v_mfma_f32_16x16x32_bf16 v[208:211], v[32:35], v[136:139], v[208:211]
  ds_read_b64_tr_b16 v[50:51], v22 offset:32000
  s_setprio 1
  buffer_load_dwordx4 v[92:95], v7, s[24:27], s45 offen offset:1024 sc1
  v_mfma_f32_16x16x32_bf16 v[212:215], v[32:35], v[140:143], v[212:215]
  ds_read_b64_tr_b16 v[52:53], v22 offset:37120
  s_add_u32 s45, s45, 14336
  v_mfma_f32_16x16x32_bf16 v[216:219], v[36:39], v[136:139], v[216:219]
  ds_read_b64_tr_b16 v[54:55], v22 offset:42240
  v_mul_f32 v240, v8, v240
  v_mul_f32 v241, v8, v241
  v_add_u32 v22, 53248, v22
  v_mfma_f32_16x16x32_bf16 v[220:223], v[36:39], v[140:143], v[220:223]
  ds_read_b64_tr_b16 v[32:33], v23 offset:256
  v_mul_f32 v242, v8, v242
  v_mul_f32 v243, v8, v243
  s_waitcnt lgkmcnt(5)
  v_mfma_f32_16x16x32_bf16 v[224:227], v[40:43], v[112:115], 0
  ds_read_b64_tr_b16 v[34:35], v23 offset:5376
  v_mul_f32 v248, v8, v248
  v_mul_f32 v249, v8, v249
  v_mfma_f32_16x16x32_bf16 v[228:231], v[40:43], v[116:119], 0
  ds_read_b64_tr_b16 v[36:37], v23 offset:10496
  v_mul_f32 v250, v8, v250
  v_mul_f32 v251, v8, v251
  v_mfma_f32_16x16x32_bf16 v[224:227], v[44:47], v[120:123], v[224:227]
  ds_read_b64_tr_b16 v[38:39], v23 offset:15616
  v_cvt_pk_bf16_f32 v152, v240, v241
  v_cvt_pk_bf16_f32 v154, v248, v249
  buffer_store_dwordx4 v[116:119], v7, s[24:27], s44 offen offset:1024 sc1
  v_mfma_f32_16x16x32_bf16 v[228:231], v[44:47], v[124:127], v[228:231]
  ds_read_b64_tr_b16 v[40:41], v23 offset:26880
  v_cvt_pk_bf16_f32 v153, v242, v243
  v_cvt_pk_bf16_f32 v155, v250, v251
  s_add_u32 s44, s44, 14336
  s_waitcnt lgkmcnt(5)
  v_mfma_f32_16x16x32_bf16 v[224:227], v[48:51], v[128:131], v[224:227]
  ds_read_b64_tr_b16 v[42:43], v23 offset:32000
  v_mul_f32 v244, v9, v244
  v_mul_f32 v245, v9, v245
  v_mfma_f32_16x16x32_bf16 v[228:231], v[48:51], v[132:135], v[228:231]
  ds_read_b64_tr_b16 v[44:45], v23 offset:37120
  v_mul_f32 v246, v9, v246
  v_mul_f32 v247, v9, v247
  v_mfma_f32_16x16x32_bf16 v[224:227], v[52:55], v[136:139], v[224:227]
  ds_read_b64_tr_b16 v[46:47], v23 offset:42240
  v_mul_f32 v252, v9, v252
  v_mul_f32 v253, v9, v253
  s_setprio 0
  v_add_u32 v23, 53248, v23
  v_mfma_f32_16x16x32_bf16 v[228:231], v[52:55], v[140:143], v[228:231]
  ds_read_b64_tr_b16 v[48:49], v22 offset:0
  v_mul_f32 v254, v9, v254
  v_mul_f32 v255, v9, v255
  s_waitcnt lgkmcnt(5)
  v_mfma_f32_16x16x32_bf16 v[232:235], v[32:35], v[112:115], 0
  ds_read_b64_tr_b16 v[50:51], v22 offset:5120
  v_cvt_pk_bf16_f32 v156, v244, v245
  v_cvt_pk_bf16_f32 v158, v252, v253
  v_mfma_f32_16x16x32_bf16 v[236:239], v[32:35], v[116:119], 0
  ds_read_b64_tr_b16 v[52:53], v23 offset:0
  v_cvt_pk_bf16_f32 v157, v246, v247
  v_cvt_pk_bf16_f32 v159, v254, v255
  v_mfma_f32_16x16x32_bf16 v[232:235], v[36:39], v[120:123], v[232:235]
  ds_read_b64_tr_b16 v[54:55], v23 offset:5120
  v_mfma_f32_16x16x32_bf16 v[236:239], v[36:39], v[124:127], v[236:239]
  ds_read_b64_tr_b16 v[32:33], v22 offset:64
  s_waitcnt lgkmcnt(5)
  v_mfma_f32_16x16x32_bf16 v[232:235], v[40:43], v[128:131], v[232:235]
  ds_read_b64_tr_b16 v[34:35], v22 offset:5184
  buffer_store_dwordx4 v[120:123], v7, s[24:27], s44 offen offset:0 sc1
  v_mfma_f32_16x16x32_bf16 v[236:239], v[40:43], v[132:135], v[236:239]
  ds_read_b64_tr_b16 v[36:37], v23 offset:64
  v_mfma_f32_16x16x32_bf16 v[232:235], v[44:47], v[136:139], v[232:235]
  ds_read_b64_tr_b16 v[38:39], v23 offset:5184
  v_mfma_f32_16x16x32_bf16 v[236:239], v[44:47], v[140:143], v[236:239]
  s_barrier
  ds_read_b64_tr_b16 v[40:41], v22 offset:128
  s_waitcnt lgkmcnt(5)
  v_mfma_f32_16x16x32_bf16 v[160:163], v[48:51], v[144:147], v[160:163]
  ds_read_b64_tr_b16 v[42:43], v22 offset:5248
  s_setprio 3
  v_mfma_f32_16x16x32_bf16 v[164:167], v[48:51], v[148:151], v[164:167]
  ds_read_b64_tr_b16 v[44:45], v23 offset:128
  v_mfma_f32_16x16x32_bf16 v[168:171], v[52:55], v[144:147], v[168:171]
  ds_read_b64_tr_b16 v[46:47], v23 offset:5248
  buffer_load_dwordx4 v[96:99], v7, s[24:27], s45 offen sc1
  v_mfma_f32_16x16x32_bf16 v[172:175], v[52:55], v[148:151], v[172:175]
  ds_read_b64_tr_b16 v[48:49], v22 offset:192
  s_waitcnt lgkmcnt(5)
  v_mfma_f32_16x16x32_bf16 v[176:179], v[32:35], v[144:147], v[176:179]
  ds_read_b64_tr_b16 v[50:51], v22 offset:5312
  v_mfma_f32_16x16x32_bf16 v[180:183], v[32:35], v[148:151], v[180:183]
  ds_read_b64_tr_b16 v[52:53], v23 offset:192
  v_mfma_f32_16x16x32_bf16 v[184:187], v[36:39], v[144:147], v[184:187]
  ds_read_b64_tr_b16 v[54:55], v23 offset:5312
  v_mfma_f32_16x16x32_bf16 v[188:191], v[36:39], v[148:151], v[188:191]
  ds_read_b64_tr_b16 v[32:33], v22 offset:256
  s_waitcnt lgkmcnt(5)
  v_mfma_f32_16x16x32_bf16 v[192:195], v[40:43], v[144:147], v[192:195]
  ds_read_b64_tr_b16 v[34:35], v22 offset:5376
  buffer_load_dwordx4 v[100:103], v7, s[24:27], s45 offen offset:1024 sc1
  v_mfma_f32_16x16x32_bf16 v[196:199], v[40:43], v[148:151], v[196:199]
  ds_read_b64_tr_b16 v[36:37], v23 offset:256
  s_add_u32 s45, s45, 14336
  v_mfma_f32_16x16x32_bf16 v[200:203], v[44:47], v[144:147], v[200:203]
  ds_read_b64_tr_b16 v[38:39], v23 offset:5376
  s_setprio 2
  v_mfma_f32_16x16x32_bf16 v[204:207], v[44:47], v[148:151], v[204:207]
  ds_read_b64_tr_b16 v[40:41], v22 offset:10240
  s_waitcnt lgkmcnt(5)
  v_mfma_f32_16x16x32_bf16 v[208:211], v[48:51], v[144:147], v[208:211]
  ds_read_b64_tr_b16 v[42:43], v22 offset:15360
  v_mfma_f32_16x16x32_bf16 v[212:215], v[48:51], v[148:151], v[212:215]
  ds_read_b64_tr_b16 v[44:45], v23 offset:10240
  v_mfma_f32_16x16x32_bf16 v[216:219], v[52:55], v[144:147], v[216:219]
  ds_read_b64_tr_b16 v[46:47], v23 offset:15360
  buffer_load_dwordx4 v[104:107], v7, s[24:27], s45 offen sc1
  v_mfma_f32_16x16x32_bf16 v[220:223], v[52:55], v[148:151], v[220:223]
  ds_read_b64_tr_b16 v[48:49], v22 offset:10304
  s_waitcnt lgkmcnt(5)
  v_mfma_f32_16x16x32_bf16 v[224:227], v[32:35], v[144:147], v[224:227]
  ds_read_b64_tr_b16 v[50:51], v22 offset:15424
  v_mfma_f32_16x16x32_bf16 v[228:231], v[32:35], v[148:151], v[228:231]
  ds_read_b64_tr_b16 v[52:53], v23 offset:10304
  v_mfma_f32_16x16x32_bf16 v[232:235], v[36:39], v[144:147], v[232:235]
  ds_read_b64_tr_b16 v[54:55], v23 offset:15424
  v_mfma_f32_16x16x32_bf16 v[236:239], v[36:39], v[148:151], v[236:239]
  ds_read_b64_tr_b16 v[32:33], v22 offset:10368
  s_waitcnt lgkmcnt(5)
  v_mfma_f32_16x16x32_bf16 v[160:163], v[40:43], v[152:155], v[160:163]
  ds_read_b64_tr_b16 v[34:35], v22 offset:15488
  s_setprio 1
  buffer_load_dwordx4 v[108:111], v7, s[24:27], s45 offen offset:1024 sc1
  v_mfma_f32_16x16x32_bf16 v[164:167], v[40:43], v[156:159], v[164:167]
  ds_read_b64_tr_b16 v[36:37], v23 offset:10368
  s_add_u32 s45, s45, 14336
  v_mfma_f32_16x16x32_bf16 v[168:171], v[44:47], v[152:155], v[168:171]
  ds_read_b64_tr_b16 v[38:39], v23 offset:15488
  v_mfma_f32_16x16x32_bf16 v[172:175], v[44:47], v[156:159], v[172:175]
  ds_read_b64_tr_b16 v[40:41], v22 offset:10432
  s_waitcnt lgkmcnt(5)
  v_mfma_f32_16x16x32_bf16 v[176:179], v[48:51], v[152:155], v[176:179]
  ds_read_b64_tr_b16 v[42:43], v22 offset:15552
  v_mfma_f32_16x16x32_bf16 v[180:183], v[48:51], v[156:159], v[180:183]
  ds_read_b64_tr_b16 v[44:45], v23 offset:10432
  v_mfma_f32_16x16x32_bf16 v[184:187], v[52:55], v[152:155], v[184:187]
  ds_read_b64_tr_b16 v[46:47], v23 offset:15552
  buffer_store_dwordx4 v[124:127], v7, s[24:27], s44 offen offset:1024 sc1
  v_mfma_f32_16x16x32_bf16 v[188:191], v[52:55], v[156:159], v[188:191]
  ds_read_b64_tr_b16 v[48:49], v22 offset:10496
  s_add_u32 s44, s44, 14336
  s_waitcnt lgkmcnt(5)
  v_mfma_f32_16x16x32_bf16 v[192:195], v[32:35], v[152:155], v[192:195]
  ds_read_b64_tr_b16 v[50:51], v22 offset:15616
  v_add_u32 v22, 26624, v22
  v_mfma_f32_16x16x32_bf16 v[196:199], v[32:35], v[156:159], v[196:199]
  ds_read_b64_tr_b16 v[52:53], v23 offset:10496
  v_mfma_f32_16x16x32_bf16 v[200:203], v[36:39], v[152:155], v[200:203]
  ds_read_b64_tr_b16 v[54:55], v23 offset:15616
  s_setprio 0
  v_add_u32 v23, 26624, v23
  v_mfma_f32_16x16x32_bf16 v[204:207], v[36:39], v[156:159], v[204:207]
  ds_read_b64_tr_b16 v[32:33], v22 offset:0
  s_waitcnt lgkmcnt(5)
  v_mfma_f32_16x16x32_bf16 v[208:211], v[40:43], v[152:155], v[208:211]
  ds_read_b64_tr_b16 v[34:35], v22 offset:5120
  v_mfma_f32_16x16x32_bf16 v[212:215], v[40:43], v[156:159], v[212:215]
  ds_read_b64_tr_b16 v[36:37], v23 offset:0
  v_mfma_f32_16x16x32_bf16 v[216:219], v[44:47], v[152:155], v[216:219]
  ds_read_b64_tr_b16 v[38:39], v23 offset:5120
  v_mfma_f32_16x16x32_bf16 v[220:223], v[44:47], v[156:159], v[220:223]
  ds_read_b64_tr_b16 v[40:41], v22 offset:64
  s_waitcnt lgkmcnt(5)
  v_mfma_f32_16x16x32_bf16 v[224:227], v[48:51], v[152:155], v[224:227]
  ds_read_b64_tr_b16 v[42:43], v22 offset:5184
  buffer_store_dwordx4 v[128:131], v7, s[24:27], s44 offen offset:0 sc1
  v_mfma_f32_16x16x32_bf16 v[228:231], v[48:51], v[156:159], v[228:231]
  ds_read_b64_tr_b16 v[44:45], v23 offset:64
  v_mfma_f32_16x16x32_bf16 v[232:235], v[52:55], v[152:155], v[232:235]
  ds_read_b64_tr_b16 v[46:47], v23 offset:5184
  v_mfma_f32_16x16x32_bf16 v[236:239], v[52:55], v[156:159], v[236:239]
  s_barrier
  ds_read_b64_tr_b16 v[48:49], v22 offset:128
  s_waitcnt lgkmcnt(5)
  s_waitcnt vmcnt(16)
  v_mfma_f32_16x16x32_bf16 v[160:163], v[32:35], v[64:67], v[160:163]
  ds_read_b64_tr_b16 v[50:51], v22 offset:5248
  s_setprio 3
  s_waitcnt vmcnt(15)
  v_mfma_f32_16x16x32_bf16 v[164:167], v[32:35], v[68:71], v[164:167]
  ds_read_b64_tr_b16 v[52:53], v23 offset:128
  v_mfma_f32_16x16x32_bf16 v[168:171], v[36:39], v[64:67], v[168:171]
  ds_read_b64_tr_b16 v[54:55], v23 offset:5248
  v_mfma_f32_16x16x32_bf16 v[172:175], v[36:39], v[68:71], v[172:175]
  ds_read_b64_tr_b16 v[32:33], v22 offset:192
  s_waitcnt lgkmcnt(5)
  v_mfma_f32_16x16x32_bf16 v[176:179], v[40:43], v[64:67], v[176:179]
  ds_read_b64_tr_b16 v[34:35], v22 offset:5312
  v_mfma_f32_16x16x32_bf16 v[180:183], v[40:43], v[68:71], v[180:183]
  ds_read_b64_tr_b16 v[36:37], v23 offset:192
  v_mfma_f32_16x16x32_bf16 v[184:187], v[44:47], v[64:67], v[184:187]
  ds_read_b64_tr_b16 v[38:39], v23 offset:5312
  v_mfma_f32_16x16x32_bf16 v[188:191], v[44:47], v[68:71], v[188:191]
  ds_read_b64_tr_b16 v[40:41], v22 offset:256
  s_waitcnt lgkmcnt(5)
  v_mfma_f32_16x16x32_bf16 v[192:195], v[48:51], v[64:67], v[192:195]
  ds_read_b64_tr_b16 v[42:43], v22 offset:5376
  v_mfma_f32_16x16x32_bf16 v[196:199], v[48:51], v[68:71], v[196:199]
  ds_read_b64_tr_b16 v[44:45], v23 offset:256
  v_mfma_f32_16x16x32_bf16 v[200:203], v[52:55], v[64:67], v[200:203]
  ds_read_b64_tr_b16 v[46:47], v23 offset:5376
  s_setprio 2
  v_mfma_f32_16x16x32_bf16 v[204:207], v[52:55], v[68:71], v[204:207]
  ds_read_b64_tr_b16 v[48:49], v22 offset:10240
  s_waitcnt lgkmcnt(5)
  v_mfma_f32_16x16x32_bf16 v[208:211], v[32:35], v[64:67], v[208:211]
  ds_read_b64_tr_b16 v[50:51], v22 offset:15360
  v_mfma_f32_16x16x32_bf16 v[212:215], v[32:35], v[68:71], v[212:215]
  ds_read_b64_tr_b16 v[52:53], v23 offset:10240
  v_mfma_f32_16x16x32_bf16 v[216:219], v[36:39], v[64:67], v[216:219]
  ds_read_b64_tr_b16 v[54:55], v23 offset:15360
  v_mfma_f32_16x16x32_bf16 v[220:223], v[36:39], v[68:71], v[220:223]
  ds_read_b64_tr_b16 v[32:33], v22 offset:10304
  s_waitcnt lgkmcnt(5)
  v_mfma_f32_16x16x32_bf16 v[224:227], v[40:43], v[64:67], v[224:227]
  ds_read_b64_tr_b16 v[34:35], v22 offset:15424
  v_mfma_f32_16x16x32_bf16 v[228:231], v[40:43], v[68:71], v[228:231]
  ds_read_b64_tr_b16 v[36:37], v23 offset:10304
  v_mfma_f32_16x16x32_bf16 v[232:235], v[44:47], v[64:67], v[232:235]
  ds_read_b64_tr_b16 v[38:39], v23 offset:15424
  v_mfma_f32_16x16x32_bf16 v[236:239], v[44:47], v[68:71], v[236:239]
  ds_read_b64_tr_b16 v[40:41], v22 offset:10368
  s_waitcnt lgkmcnt(5)
  s_waitcnt vmcnt(14)
  v_mfma_f32_16x16x32_bf16 v[160:163], v[48:51], v[72:75], v[160:163]
  ds_read_b64_tr_b16 v[42:43], v22 offset:15488
  s_setprio 1
  s_waitcnt vmcnt(13)
  v_mfma_f32_16x16x32_bf16 v[164:167], v[48:51], v[76:79], v[164:167]
  ds_read_b64_tr_b16 v[44:45], v23 offset:10368
  v_mfma_f32_16x16x32_bf16 v[168:171], v[52:55], v[72:75], v[168:171]
  ds_read_b64_tr_b16 v[46:47], v23 offset:15488
  v_mfma_f32_16x16x32_bf16 v[172:175], v[52:55], v[76:79], v[172:175]
  ds_read_b64_tr_b16 v[48:49], v22 offset:10432
  s_waitcnt lgkmcnt(5)
  v_mfma_f32_16x16x32_bf16 v[176:179], v[32:35], v[72:75], v[176:179]
  ds_read_b64_tr_b16 v[50:51], v22 offset:15552
  v_mfma_f32_16x16x32_bf16 v[180:183], v[32:35], v[76:79], v[180:183]
  ds_read_b64_tr_b16 v[52:53], v23 offset:10432
  v_mfma_f32_16x16x32_bf16 v[184:187], v[36:39], v[72:75], v[184:187]
  ds_read_b64_tr_b16 v[54:55], v23 offset:15552
  buffer_store_dwordx4 v[132:135], v7, s[24:27], s44 offen offset:1024 sc1
  v_mfma_f32_16x16x32_bf16 v[188:191], v[36:39], v[76:79], v[188:191]
  ds_read_b64_tr_b16 v[32:33], v22 offset:10496
  s_add_u32 s44, s44, 14336
  s_waitcnt lgkmcnt(5)
  v_mfma_f32_16x16x32_bf16 v[192:195], v[40:43], v[72:75], v[192:195]
  ds_read_b64_tr_b16 v[34:35], v22 offset:15616
  v_add_u32 v22, 26624, v22
  v_mfma_f32_16x16x32_bf16 v[196:199], v[40:43], v[76:79], v[196:199]
  ds_read_b64_tr_b16 v[36:37], v23 offset:10496
  v_mfma_f32_16x16x32_bf16 v[200:203], v[44:47], v[72:75], v[200:203]
  ds_read_b64_tr_b16 v[38:39], v23 offset:15616
  s_setprio 0
  v_add_u32 v23, 26624, v23
  v_mfma_f32_16x16x32_bf16 v[204:207], v[44:47], v[76:79], v[204:207]
  ds_read_b64_tr_b16 v[40:41], v22 offset:0
  s_waitcnt lgkmcnt(5)
  v_mfma_f32_16x16x32_bf16 v[208:211], v[48:51], v[72:75], v[208:211]
  ds_read_b64_tr_b16 v[42:43], v22 offset:5120
  v_mfma_f32_16x16x32_bf16 v[212:215], v[48:51], v[76:79], v[212:215]
  ds_read_b64_tr_b16 v[44:45], v23 offset:0
  v_mfma_f32_16x16x32_bf16 v[216:219], v[52:55], v[72:75], v[216:219]
  ds_read_b64_tr_b16 v[46:47], v23 offset:5120
  v_mfma_f32_16x16x32_bf16 v[220:223], v[52:55], v[76:79], v[220:223]
  ds_read_b64_tr_b16 v[48:49], v22 offset:64
  s_waitcnt lgkmcnt(5)
  v_mfma_f32_16x16x32_bf16 v[224:227], v[32:35], v[72:75], v[224:227]
  ds_read_b64_tr_b16 v[50:51], v22 offset:5184
  buffer_store_dwordx4 v[136:139], v7, s[24:27], s44 offen offset:0 sc1
  v_mfma_f32_16x16x32_bf16 v[228:231], v[32:35], v[76:79], v[228:231]
  ds_read_b64_tr_b16 v[52:53], v23 offset:64
  v_mfma_f32_16x16x32_bf16 v[232:235], v[36:39], v[72:75], v[232:235]
  ds_read_b64_tr_b16 v[54:55], v23 offset:5184
  v_mfma_f32_16x16x32_bf16 v[236:239], v[36:39], v[76:79], v[236:239]
  s_barrier
  ds_read_b64_tr_b16 v[32:33], v22 offset:128
  s_add_u32 s38, s92, 1
  s_and_b32 s38, s38, 3
  s_waitcnt lgkmcnt(5)
  s_waitcnt vmcnt(13)
  v_mfma_f32_16x16x32_bf16 v[160:163], v[40:43], v[80:83], v[160:163]
  ds_read_b64_tr_b16 v[34:35], v22 offset:5248
  s_setprio 3
  s_mul_i32 s38, s38, 172032
  s_add_u32 s45, s64, s38
  s_waitcnt vmcnt(12)
  v_mfma_f32_16x16x32_bf16 v[164:167], v[40:43], v[84:87], v[164:167]
  ds_read_b64_tr_b16 v[36:37], v23 offset:128
  v_mfma_f32_16x16x32_bf16 v[168:171], v[44:47], v[80:83], v[168:171]
  ds_read_b64_tr_b16 v[38:39], v23 offset:5248
  buffer_load_dwordx4 v[64:67], v7, s[24:27], s45 offen sc1
  v_mfma_f32_16x16x32_bf16 v[172:175], v[44:47], v[84:87], v[172:175]
  ds_read_b64_tr_b16 v[40:41], v22 offset:192
  s_waitcnt lgkmcnt(5)
  v_mfma_f32_16x16x32_bf16 v[176:179], v[48:51], v[80:83], v[176:179]
  ds_read_b64_tr_b16 v[42:43], v22 offset:5312
  v_mfma_f32_16x16x32_bf16 v[180:183], v[48:51], v[84:87], v[180:183]
  ds_read_b64_tr_b16 v[44:45], v23 offset:192
  v_mfma_f32_16x16x32_bf16 v[184:187], v[52:55], v[80:83], v[184:187]
  ds_read_b64_tr_b16 v[46:47], v23 offset:5312
  v_mfma_f32_16x16x32_bf16 v[188:191], v[52:55], v[84:87], v[188:191]
  ds_read_b64_tr_b16 v[48:49], v22 offset:256
  s_waitcnt lgkmcnt(5)
  v_mfma_f32_16x16x32_bf16 v[192:195], v[32:35], v[80:83], v[192:195]
  ds_read_b64_tr_b16 v[50:51], v22 offset:5376
  buffer_load_dwordx4 v[68:71], v7, s[24:27], s45 offen offset:1024 sc1
  v_mfma_f32_16x16x32_bf16 v[196:199], v[32:35], v[84:87], v[196:199]
  ds_read_b64_tr_b16 v[52:53], v23 offset:256
  s_add_u32 s45, s45, 14336
  v_mfma_f32_16x16x32_bf16 v[200:203], v[36:39], v[80:83], v[200:203]
  ds_read_b64_tr_b16 v[54:55], v23 offset:5376
  s_setprio 2
  v_mfma_f32_16x16x32_bf16 v[204:207], v[36:39], v[84:87], v[204:207]
  ds_read_b64_tr_b16 v[32:33], v22 offset:10240
  s_waitcnt lgkmcnt(5)
  v_mfma_f32_16x16x32_bf16 v[208:211], v[40:43], v[80:83], v[208:211]
  ds_read_b64_tr_b16 v[34:35], v22 offset:15360
  v_mfma_f32_16x16x32_bf16 v[212:215], v[40:43], v[84:87], v[212:215]
  ds_read_b64_tr_b16 v[36:37], v23 offset:10240
  v_mfma_f32_16x16x32_bf16 v[216:219], v[44:47], v[80:83], v[216:219]
  ds_read_b64_tr_b16 v[38:39], v23 offset:15360
  buffer_load_dwordx4 v[72:75], v7, s[24:27], s45 offen sc1
  v_mfma_f32_16x16x32_bf16 v[220:223], v[44:47], v[84:87], v[220:223]
  ds_read_b64_tr_b16 v[40:41], v22 offset:10304
  s_waitcnt lgkmcnt(5)
  v_mfma_f32_16x16x32_bf16 v[224:227], v[48:51], v[80:83], v[224:227]
  ds_read_b64_tr_b16 v[42:43], v22 offset:15424
  v_mfma_f32_16x16x32_bf16 v[228:231], v[48:51], v[84:87], v[228:231]
  ds_read_b64_tr_b16 v[44:45], v23 offset:10304
  v_mfma_f32_16x16x32_bf16 v[232:235], v[52:55], v[80:83], v[232:235]
  ds_read_b64_tr_b16 v[46:47], v23 offset:15424
  v_mfma_f32_16x16x32_bf16 v[236:239], v[52:55], v[84:87], v[236:239]
  ds_read_b64_tr_b16 v[48:49], v22 offset:10368
  s_waitcnt lgkmcnt(5)
  s_waitcnt vmcnt(14)
  v_mfma_f32_16x16x32_bf16 v[160:163], v[32:35], v[88:91], v[160:163]
  ds_read_b64_tr_b16 v[50:51], v22 offset:15488
  s_setprio 1
  buffer_load_dwordx4 v[76:79], v7, s[24:27], s45 offen offset:1024 sc1
  s_waitcnt vmcnt(14)
  v_mfma_f32_16x16x32_bf16 v[164:167], v[32:35], v[92:95], v[164:167]
  ds_read_b64_tr_b16 v[52:53], v23 offset:10368
  s_add_u32 s45, s45, 14336
  v_mfma_f32_16x16x32_bf16 v[168:171], v[36:39], v[88:91], v[168:171]
  ds_read_b64_tr_b16 v[54:55], v23 offset:15488
  v_mfma_f32_16x16x32_bf16 v[172:175], v[36:39], v[92:95], v[172:175]
  ds_read_b64_tr_b16 v[32:33], v22 offset:10432
  s_waitcnt lgkmcnt(5)
  v_mfma_f32_16x16x32_bf16 v[176:179], v[40:43], v[88:91], v[176:179]
  ds_read_b64_tr_b16 v[34:35], v22 offset:15552
  v_mfma_f32_16x16x32_bf16 v[180:183], v[40:43], v[92:95], v[180:183]
  ds_read_b64_tr_b16 v[36:37], v23 offset:10432
  v_mfma_f32_16x16x32_bf16 v[184:187], v[44:47], v[88:91], v[184:187]
  ds_read_b64_tr_b16 v[38:39], v23 offset:15552
  buffer_store_dwordx4 v[140:143], v7, s[24:27], s44 offen offset:1024 sc1
  v_mfma_f32_16x16x32_bf16 v[188:191], v[44:47], v[92:95], v[188:191]
  ds_read_b64_tr_b16 v[40:41], v22 offset:10496
  s_add_u32 s44, s44, 14336
  s_waitcnt lgkmcnt(5)
  v_mfma_f32_16x16x32_bf16 v[192:195], v[48:51], v[88:91], v[192:195]
  ds_read_b64_tr_b16 v[42:43], v22 offset:15616
  v_add_u32 v22, 26624, v22
  v_mfma_f32_16x16x32_bf16 v[196:199], v[48:51], v[92:95], v[196:199]
  ds_read_b64_tr_b16 v[44:45], v23 offset:10496
  v_mfma_f32_16x16x32_bf16 v[200:203], v[52:55], v[88:91], v[200:203]
  ds_read_b64_tr_b16 v[46:47], v23 offset:15616
  s_setprio 0
  v_add_u32 v23, 26624, v23
  v_mfma_f32_16x16x32_bf16 v[204:207], v[52:55], v[92:95], v[204:207]
  ds_read_b64_tr_b16 v[48:49], v22 offset:0
  s_waitcnt lgkmcnt(5)
  v_mfma_f32_16x16x32_bf16 v[208:211], v[32:35], v[88:91], v[208:211]
  ds_read_b64_tr_b16 v[50:51], v22 offset:5120
  v_mfma_f32_16x16x32_bf16 v[212:215], v[32:35], v[92:95], v[212:215]
  ds_read_b64_tr_b16 v[52:53], v23 offset:0
  v_mfma_f32_16x16x32_bf16 v[216:219], v[36:39], v[88:91], v[216:219]
  ds_read_b64_tr_b16 v[54:55], v23 offset:5120
  v_mfma_f32_16x16x32_bf16 v[220:223], v[36:39], v[92:95], v[220:223]
  ds_read_b64_tr_b16 v[32:33], v22 offset:64
  s_waitcnt lgkmcnt(5)
  v_mfma_f32_16x16x32_bf16 v[224:227], v[40:43], v[88:91], v[224:227]
  ds_read_b64_tr_b16 v[34:35], v22 offset:5184
  v_mfma_f32_16x16x32_bf16 v[228:231], v[40:43], v[92:95], v[228:231]
  ds_read_b64_tr_b16 v[36:37], v23 offset:64
  v_mfma_f32_16x16x32_bf16 v[232:235], v[44:47], v[88:91], v[232:235]
  ds_read_b64_tr_b16 v[38:39], v23 offset:5184
  v_mfma_f32_16x16x32_bf16 v[236:239], v[44:47], v[92:95], v[236:239]
  s_barrier
  ds_read_b64_tr_b16 v[40:41], v22 offset:128
  s_waitcnt lgkmcnt(5)
  s_waitcnt vmcnt(12)
  v_mfma_f32_16x16x32_bf16 v[160:163], v[48:51], v[96:99], v[160:163]
  ds_read_b64_tr_b16 v[42:43], v22 offset:5248
  s_setprio 3
  s_waitcnt vmcnt(11)
  v_mfma_f32_16x16x32_bf16 v[164:167], v[48:51], v[100:103], v[164:167]
  ds_read_b64_tr_b16 v[44:45], v23 offset:128
  v_mfma_f32_16x16x32_bf16 v[168:171], v[52:55], v[96:99], v[168:171]
  ds_read_b64_tr_b16 v[46:47], v23 offset:5248
  buffer_load_dwordx4 v[80:83], v7, s[24:27], s45 offen sc1
  v_mfma_f32_16x16x32_bf16 v[172:175], v[52:55], v[100:103], v[172:175]
  ds_read_b64_tr_b16 v[48:49], v22 offset:192
  s_waitcnt lgkmcnt(5)
  v_mfma_f32_16x16x32_bf16 v[176:179], v[32:35], v[96:99], v[176:179]
  ds_read_b64_tr_b16 v[50:51], v22 offset:5312
  v_mfma_f32_16x16x32_bf16 v[180:183], v[32:35], v[100:103], v[180:183]
  ds_read_b64_tr_b16 v[52:53], v23 offset:192
  v_mfma_f32_16x16x32_bf16 v[184:187], v[36:39], v[96:99], v[184:187]
  ds_read_b64_tr_b16 v[54:55], v23 offset:5312
  v_mfma_f32_16x16x32_bf16 v[188:191], v[36:39], v[100:103], v[188:191]
  ds_read_b64_tr_b16 v[32:33], v22 offset:256
  s_waitcnt lgkmcnt(5)
  v_mfma_f32_16x16x32_bf16 v[192:195], v[40:43], v[96:99], v[192:195]
  ds_read_b64_tr_b16 v[34:35], v22 offset:5376
  buffer_load_dwordx4 v[84:87], v7, s[24:27], s45 offen offset:1024 sc1
  v_mfma_f32_16x16x32_bf16 v[196:199], v[40:43], v[100:103], v[196:199]
  ds_read_b64_tr_b16 v[36:37], v23 offset:256
  s_add_u32 s45, s45, 14336
  v_mfma_f32_16x16x32_bf16 v[200:203], v[44:47], v[96:99], v[200:203]
  ds_read_b64_tr_b16 v[38:39], v23 offset:5376
  s_setprio 2
  v_mfma_f32_16x16x32_bf16 v[204:207], v[44:47], v[100:103], v[204:207]
  ds_read_b64_tr_b16 v[40:41], v22 offset:10240
  s_waitcnt lgkmcnt(5)
  v_mfma_f32_16x16x32_bf16 v[208:211], v[48:51], v[96:99], v[208:211]
  ds_read_b64_tr_b16 v[42:43], v22 offset:15360
  v_mfma_f32_16x16x32_bf16 v[212:215], v[48:51], v[100:103], v[212:215]
  ds_read_b64_tr_b16 v[44:45], v23 offset:10240
  v_mfma_f32_16x16x32_bf16 v[216:219], v[52:55], v[96:99], v[216:219]
  ds_read_b64_tr_b16 v[46:47], v23 offset:15360
  buffer_load_dwordx4 v[88:91], v7, s[24:27], s45 offen sc1
  v_mfma_f32_16x16x32_bf16 v[220:223], v[52:55], v[100:103], v[220:223]
  ds_read_b64_tr_b16 v[48:49], v22 offset:10304
  s_waitcnt lgkmcnt(5)
  v_mfma_f32_16x16x32_bf16 v[224:227], v[32:35], v[96:99], v[224:227]
  ds_read_b64_tr_b16 v[50:51], v22 offset:15424
  v_mfma_f32_16x16x32_bf16 v[228:231], v[32:35], v[100:103], v[228:231]
  ds_read_b64_tr_b16 v[52:53], v23 offset:10304
  v_mfma_f32_16x16x32_bf16 v[232:235], v[36:39], v[96:99], v[232:235]
  ds_read_b64_tr_b16 v[54:55], v23 offset:15424
  v_mfma_f32_16x16x32_bf16 v[236:239], v[36:39], v[100:103], v[236:239]
  ds_read_b64_tr_b16 v[32:33], v22 offset:10368
  s_waitcnt lgkmcnt(5)
  s_waitcnt vmcnt(13)
  v_mfma_f32_16x16x32_bf16 v[160:163], v[40:43], v[104:107], v[160:163]
  ds_read_b64_tr_b16 v[34:35], v22 offset:15488
  s_setprio 1
  buffer_load_dwordx4 v[92:95], v7, s[24:27], s45 offen offset:1024 sc1
  s_waitcnt vmcnt(13)
  v_mfma_f32_16x16x32_bf16 v[164:167], v[40:43], v[108:111], v[164:167]
  ds_read_b64_tr_b16 v[36:37], v23 offset:10368
  s_add_u32 s45, s45, 14336
  v_mfma_f32_16x16x32_bf16 v[168:171], v[44:47], v[104:107], v[168:171]
  ds_read_b64_tr_b16 v[38:39], v23 offset:15488
  v_mfma_f32_16x16x32_bf16 v[172:175], v[44:47], v[108:111], v[172:175]
  ds_read_b64_tr_b16 v[40:41], v22 offset:10432
  s_waitcnt lgkmcnt(5)
  v_mfma_f32_16x16x32_bf16 v[176:179], v[48:51], v[104:107], v[176:179]
  ds_read_b64_tr_b16 v[42:43], v22 offset:15552
  v_mfma_f32_16x16x32_bf16 v[180:183], v[48:51], v[108:111], v[180:183]
  ds_read_b64_tr_b16 v[44:45], v23 offset:10432
  v_mfma_f32_16x16x32_bf16 v[184:187], v[52:55], v[104:107], v[184:187]
  ds_read_b64_tr_b16 v[46:47], v23 offset:15552
  buffer_store_dwordx4 v[144:147], v7, s[24:27], s44 offen offset:0 sc1
  v_mfma_f32_16x16x32_bf16 v[188:191], v[52:55], v[108:111], v[188:191]
  ds_read_b64_tr_b16 v[48:49], v22 offset:10496
  s_waitcnt lgkmcnt(5)
  v_mfma_f32_16x16x32_bf16 v[192:195], v[32:35], v[104:107], v[192:195]
  ds_read_b64_tr_b16 v[50:51], v22 offset:15616
  v_add_u32 v22, 4294834176, v22
  v_mfma_f32_16x16x32_bf16 v[196:199], v[32:35], v[108:111], v[196:199]
  ds_read_b64_tr_b16 v[52:53], v23 offset:10496
  v_mfma_f32_16x16x32_bf16 v[200:203], v[36:39], v[104:107], v[200:203]
  ds_read_b64_tr_b16 v[54:55], v23 offset:15616
  s_setprio 0
  v_add_u32 v23, 4294834176, v23
  v_mfma_f32_16x16x32_bf16 v[204:207], v[36:39], v[108:111], v[204:207]
  ds_read_b64_tr_b16 v[32:33], v22 offset:0
  s_waitcnt lgkmcnt(5)
  v_mfma_f32_16x16x32_bf16 v[208:211], v[40:43], v[104:107], v[208:211]
  ds_read_b64_tr_b16 v[34:35], v22 offset:5120
  v_mfma_f32_16x16x32_bf16 v[212:215], v[40:43], v[108:111], v[212:215]
  ds_read_b64_tr_b16 v[36:37], v23 offset:0
  v_mfma_f32_16x16x32_bf16 v[216:219], v[44:47], v[104:107], v[216:219]
  ds_read_b64_tr_b16 v[38:39], v23 offset:5120
  v_mfma_f32_16x16x32_bf16 v[220:223], v[44:47], v[108:111], v[220:223]
  ds_read_b64_tr_b16 v[40:41], v22 offset:64
  s_waitcnt lgkmcnt(5)
  v_mfma_f32_16x16x32_bf16 v[224:227], v[48:51], v[104:107], v[224:227]
  ds_read_b64_tr_b16 v[42:43], v22 offset:5184
  v_mfma_f32_16x16x32_bf16 v[228:231], v[48:51], v[108:111], v[228:231]
  ds_read_b64_tr_b16 v[44:45], v23 offset:64
  v_mfma_f32_16x16x32_bf16 v[232:235], v[52:55], v[104:107], v[232:235]
  ds_read_b64_tr_b16 v[46:47], v23 offset:5184
  v_mfma_f32_16x16x32_bf16 v[236:239], v[52:55], v[108:111], v[236:239]
  s_barrier
  ds_read_b64_tr_b16 v[48:49], v22 offset:128
  s_waitcnt lgkmcnt(5)
  s_waitcnt vmcnt(9)
  v_mfma_f32_16x16x32_bf16 v[160:163], v[32:35], v[64:67], v[160:163]
  ds_read_b64_tr_b16 v[50:51], v22 offset:5248
  s_setprio 3
  s_waitcnt vmcnt(8)
  v_mfma_f32_16x16x32_bf16 v[164:167], v[32:35], v[68:71], v[164:167]
  ds_read_b64_tr_b16 v[52:53], v23 offset:128
  v_mfma_f32_16x16x32_bf16 v[168:171], v[36:39], v[64:67], v[168:171]
  ds_read_b64_tr_b16 v[54:55], v23 offset:5248
  buffer_load_dwordx4 v[96:99], v7, s[24:27], s45 offen sc1
  v_mfma_f32_16x16x32_bf16 v[172:175], v[36:39], v[68:71], v[172:175]
  ds_read_b64_tr_b16 v[32:33], v22 offset:192
  s_waitcnt lgkmcnt(5)
  v_mfma_f32_16x16x32_bf16 v[176:179], v[40:43], v[64:67], v[176:179]
  ds_read_b64_tr_b16 v[34:35], v22 offset:5312
  v_mfma_f32_16x16x32_bf16 v[180:183], v[40:43], v[68:71], v[180:183]
  ds_read_b64_tr_b16 v[36:37], v23 offset:192
  v_mfma_f32_16x16x32_bf16 v[184:187], v[44:47], v[64:67], v[184:187]
  ds_read_b64_tr_b16 v[38:39], v23 offset:5312
  v_mfma_f32_16x16x32_bf16 v[188:191], v[44:47], v[68:71], v[188:191]
  ds_read_b64_tr_b16 v[40:41], v22 offset:256
  s_waitcnt lgkmcnt(5)
  v_mfma_f32_16x16x32_bf16 v[192:195], v[48:51], v[64:67], v[192:195]
  ds_read_b64_tr_b16 v[42:43], v22 offset:5376
  buffer_load_dwordx4 v[100:103], v7, s[24:27], s45 offen offset:1024 sc1
  v_mfma_f32_16x16x32_bf16 v[196:199], v[48:51], v[68:71], v[196:199]
  ds_read_b64_tr_b16 v[44:45], v23 offset:256
  s_add_u32 s45, s45, 14336
  v_mfma_f32_16x16x32_bf16 v[200:203], v[52:55], v[64:67], v[200:203]
  ds_read_b64_tr_b16 v[46:47], v23 offset:5376
  s_setprio 2
  v_mfma_f32_16x16x32_bf16 v[204:207], v[52:55], v[68:71], v[204:207]
  ds_read_b64_tr_b16 v[48:49], v22 offset:10240
  s_waitcnt lgkmcnt(5)
  v_mfma_f32_16x16x32_bf16 v[208:211], v[32:35], v[64:67], v[208:211]
  ds_read_b64_tr_b16 v[50:51], v22 offset:15360
  v_mfma_f32_16x16x32_bf16 v[212:215], v[32:35], v[68:71], v[212:215]
  ds_read_b64_tr_b16 v[52:53], v23 offset:10240
  v_mfma_f32_16x16x32_bf16 v[216:219], v[36:39], v[64:67], v[216:219]
  ds_read_b64_tr_b16 v[54:55], v23 offset:15360
  buffer_load_dwordx4 v[104:107], v7, s[24:27], s45 offen sc1
  v_mfma_f32_16x16x32_bf16 v[220:223], v[36:39], v[68:71], v[220:223]
  ds_read_b64_tr_b16 v[32:33], v22 offset:10304
  s_waitcnt lgkmcnt(5)
  v_mfma_f32_16x16x32_bf16 v[224:227], v[40:43], v[64:67], v[224:227]
  ds_read_b64_tr_b16 v[34:35], v22 offset:15424
  v_mfma_f32_16x16x32_bf16 v[228:231], v[40:43], v[68:71], v[228:231]
  ds_read_b64_tr_b16 v[36:37], v23 offset:10304
  v_mfma_f32_16x16x32_bf16 v[232:235], v[44:47], v[64:67], v[232:235]
  ds_read_b64_tr_b16 v[38:39], v23 offset:15424
  v_mfma_f32_16x16x32_bf16 v[236:239], v[44:47], v[68:71], v[236:239]
  ds_read_b64_tr_b16 v[40:41], v22 offset:10368
  s_waitcnt lgkmcnt(5)
  s_waitcnt vmcnt(10)
  v_mfma_f32_16x16x32_bf16 v[160:163], v[48:51], v[72:75], v[160:163]
  ds_read_b64_tr_b16 v[42:43], v22 offset:15488
  s_setprio 1
  buffer_load_dwordx4 v[108:111], v7, s[24:27], s45 offen offset:1024 sc1
  s_waitcnt vmcnt(10)
  v_mfma_f32_16x16x32_bf16 v[164:167], v[48:51], v[76:79], v[164:167]
  ds_read_b64_tr_b16 v[44:45], v23 offset:10368
  s_add_u32 s45, s45, 14336
  v_mfma_f32_16x16x32_bf16 v[168:171], v[52:55], v[72:75], v[168:171]
  ds_read_b64_tr_b16 v[46:47], v23 offset:15488
  v_mfma_f32_16x16x32_bf16 v[172:175], v[52:55], v[76:79], v[172:175]
  ds_read_b64_tr_b16 v[48:49], v22 offset:10432
  s_waitcnt lgkmcnt(5)
  v_mfma_f32_16x16x32_bf16 v[176:179], v[32:35], v[72:75], v[176:179]
  ds_read_b64_tr_b16 v[50:51], v22 offset:15552
  v_mfma_f32_16x16x32_bf16 v[180:183], v[32:35], v[76:79], v[180:183]
  ds_read_b64_tr_b16 v[52:53], v23 offset:10432
  v_mfma_f32_16x16x32_bf16 v[184:187], v[36:39], v[72:75], v[184:187]
  ds_read_b64_tr_b16 v[54:55], v23 offset:15552
  buffer_store_dwordx4 v[148:151], v7, s[24:27], s44 offen offset:1024 sc1
  v_mfma_f32_16x16x32_bf16 v[188:191], v[36:39], v[76:79], v[188:191]
  ds_read_b64_tr_b16 v[32:33], v22 offset:10496
  s_add_u32 s44, s44, 14336
  s_waitcnt lgkmcnt(5)
  v_mfma_f32_16x16x32_bf16 v[192:195], v[40:43], v[72:75], v[192:195]
  ds_read_b64_tr_b16 v[34:35], v22 offset:15616
  v_add_u32 v22, 26624, v22
  v_mfma_f32_16x16x32_bf16 v[196:199], v[40:43], v[76:79], v[196:199]
  ds_read_b64_tr_b16 v[36:37], v23 offset:10496
  v_mfma_f32_16x16x32_bf16 v[200:203], v[44:47], v[72:75], v[200:203]
  ds_read_b64_tr_b16 v[38:39], v23 offset:15616
  s_setprio 0
  v_add_u32 v23, 26624, v23
  v_mfma_f32_16x16x32_bf16 v[204:207], v[44:47], v[76:79], v[204:207]
  ds_read_b64_tr_b16 v[40:41], v22 offset:0
  s_waitcnt lgkmcnt(5)
  v_mfma_f32_16x16x32_bf16 v[208:211], v[48:51], v[72:75], v[208:211]
  ds_read_b64_tr_b16 v[42:43], v22 offset:5120
  v_mfma_f32_16x16x32_bf16 v[212:215], v[48:51], v[76:79], v[212:215]
  ds_read_b64_tr_b16 v[44:45], v23 offset:0
  v_mfma_f32_16x16x32_bf16 v[216:219], v[52:55], v[72:75], v[216:219]
  ds_read_b64_tr_b16 v[46:47], v23 offset:5120
  v_mfma_f32_16x16x32_bf16 v[220:223], v[52:55], v[76:79], v[220:223]
  ds_read_b64_tr_b16 v[48:49], v22 offset:64
  s_waitcnt lgkmcnt(5)
  v_mfma_f32_16x16x32_bf16 v[224:227], v[32:35], v[72:75], v[224:227]
  ds_read_b64_tr_b16 v[50:51], v22 offset:5184
  buffer_store_dwordx4 v[152:155], v7, s[24:27], s44 offen offset:0 sc1
  v_mfma_f32_16x16x32_bf16 v[228:231], v[32:35], v[76:79], v[228:231]
  ds_read_b64_tr_b16 v[52:53], v23 offset:64
  v_mfma_f32_16x16x32_bf16 v[232:235], v[36:39], v[72:75], v[232:235]
  ds_read_b64_tr_b16 v[54:55], v23 offset:5184
  v_mfma_f32_16x16x32_bf16 v[236:239], v[36:39], v[76:79], v[236:239]
  s_barrier
  ds_read_b64_tr_b16 v[32:33], v22 offset:128
  s_add_u32 s38, s92, 2
  s_and_b32 s38, s38, 3
  s_waitcnt lgkmcnt(5)
  s_waitcnt vmcnt(10)
  v_mfma_f32_16x16x32_bf16 v[160:163], v[40:43], v[80:83], v[160:163]
  ds_read_b64_tr_b16 v[34:35], v22 offset:5248
  s_setprio 3
  s_mul_i32 s38, s38, 172032
  s_add_u32 s45, s64, s38
  s_waitcnt vmcnt(9)
  v_mfma_f32_16x16x32_bf16 v[164:167], v[40:43], v[84:87], v[164:167]
  ds_read_b64_tr_b16 v[36:37], v23 offset:128
  v_mfma_f32_16x16x32_bf16 v[168:171], v[44:47], v[80:83], v[168:171]
  ds_read_b64_tr_b16 v[38:39], v23 offset:5248
  buffer_load_dwordx4 v[64:67], v7, s[24:27], s45 offen sc1
  v_mfma_f32_16x16x32_bf16 v[172:175], v[44:47], v[84:87], v[172:175]
  ds_read_b64_tr_b16 v[40:41], v22 offset:192
  s_waitcnt lgkmcnt(5)
  v_mfma_f32_16x16x32_bf16 v[176:179], v[48:51], v[80:83], v[176:179]
  ds_read_b64_tr_b16 v[42:43], v22 offset:5312
  v_mfma_f32_16x16x32_bf16 v[180:183], v[48:51], v[84:87], v[180:183]
  ds_read_b64_tr_b16 v[44:45], v23 offset:192
  v_mfma_f32_16x16x32_bf16 v[184:187], v[52:55], v[80:83], v[184:187]
  ds_read_b64_tr_b16 v[46:47], v23 offset:5312
  v_mfma_f32_16x16x32_bf16 v[188:191], v[52:55], v[84:87], v[188:191]
  ds_read_b64_tr_b16 v[48:49], v22 offset:256
  s_waitcnt lgkmcnt(5)
  v_mfma_f32_16x16x32_bf16 v[192:195], v[32:35], v[80:83], v[192:195]
  ds_read_b64_tr_b16 v[50:51], v22 offset:5376
  buffer_load_dwordx4 v[68:71], v7, s[24:27], s45 offen offset:1024 sc1
  v_mfma_f32_16x16x32_bf16 v[196:199], v[32:35], v[84:87], v[196:199]
  ds_read_b64_tr_b16 v[52:53], v23 offset:256
  s_add_u32 s45, s45, 14336
  v_mfma_f32_16x16x32_bf16 v[200:203], v[36:39], v[80:83], v[200:203]
  ds_read_b64_tr_b16 v[54:55], v23 offset:5376
  s_setprio 2
  v_mfma_f32_16x16x32_bf16 v[204:207], v[36:39], v[84:87], v[204:207]
  ds_read_b64_tr_b16 v[32:33], v22 offset:10240
  s_waitcnt lgkmcnt(5)
  v_mfma_f32_16x16x32_bf16 v[208:211], v[40:43], v[80:83], v[208:211]
  ds_read_b64_tr_b16 v[34:35], v22 offset:15360
  v_mfma_f32_16x16x32_bf16 v[212:215], v[40:43], v[84:87], v[212:215]
  ds_read_b64_tr_b16 v[36:37], v23 offset:10240
  v_mfma_f32_16x16x32_bf16 v[216:219], v[44:47], v[80:83], v[216:219]
  ds_read_b64_tr_b16 v[38:39], v23 offset:15360
  buffer_load_dwordx4 v[72:75], v7, s[24:27], s45 offen sc1
  v_mfma_f32_16x16x32_bf16 v[220:223], v[44:47], v[84:87], v[220:223]
  ds_read_b64_tr_b16 v[40:41], v22 offset:10304
  s_waitcnt lgkmcnt(5)
  v_mfma_f32_16x16x32_bf16 v[224:227], v[48:51], v[80:83], v[224:227]
  ds_read_b64_tr_b16 v[42:43], v22 offset:15424
  v_mfma_f32_16x16x32_bf16 v[228:231], v[48:51], v[84:87], v[228:231]
  ds_read_b64_tr_b16 v[44:45], v23 offset:10304
  v_mfma_f32_16x16x32_bf16 v[232:235], v[52:55], v[80:83], v[232:235]
  ds_read_b64_tr_b16 v[46:47], v23 offset:15424
  v_mfma_f32_16x16x32_bf16 v[236:239], v[52:55], v[84:87], v[236:239]
  ds_read_b64_tr_b16 v[48:49], v22 offset:10368
  s_waitcnt lgkmcnt(5)
  s_waitcnt vmcnt(11)
  v_mfma_f32_16x16x32_bf16 v[160:163], v[32:35], v[88:91], v[160:163]
  ds_read_b64_tr_b16 v[50:51], v22 offset:15488
  s_setprio 1
  buffer_load_dwordx4 v[76:79], v7, s[24:27], s45 offen offset:1024 sc1
  s_waitcnt vmcnt(11)
  v_mfma_f32_16x16x32_bf16 v[164:167], v[32:35], v[92:95], v[164:167]
  ds_read_b64_tr_b16 v[52:53], v23 offset:10368
  s_add_u32 s45, s45, 14336
  v_mfma_f32_16x16x32_bf16 v[168:171], v[36:39], v[88:91], v[168:171]
  ds_read_b64_tr_b16 v[54:55], v23 offset:15488
  v_mfma_f32_16x16x32_bf16 v[172:175], v[36:39], v[92:95], v[172:175]
  ds_read_b64_tr_b16 v[32:33], v22 offset:10432
  s_waitcnt lgkmcnt(5)
  v_mfma_f32_16x16x32_bf16 v[176:179], v[40:43], v[88:91], v[176:179]
  ds_read_b64_tr_b16 v[34:35], v22 offset:15552
  v_mfma_f32_16x16x32_bf16 v[180:183], v[40:43], v[92:95], v[180:183]
  ds_read_b64_tr_b16 v[36:37], v23 offset:10432
  v_mfma_f32_16x16x32_bf16 v[184:187], v[44:47], v[88:91], v[184:187]
  ds_read_b64_tr_b16 v[38:39], v23 offset:15552
  buffer_store_dwordx4 v[156:159], v7, s[24:27], s44 offen offset:1024 sc1
  v_mfma_f32_16x16x32_bf16 v[188:191], v[44:47], v[92:95], v[188:191]
  ds_read_b64_tr_b16 v[40:41], v22 offset:10496
  s_add_u32 s44, s44, 14336
  s_waitcnt lgkmcnt(5)
  v_mfma_f32_16x16x32_bf16 v[192:195], v[48:51], v[88:91], v[192:195]
  ds_read_b64_tr_b16 v[42:43], v22 offset:15616
  v_add_u32 v22, 26624, v22
  v_mfma_f32_16x16x32_bf16 v[196:199], v[48:51], v[92:95], v[196:199]
  ds_read_b64_tr_b16 v[44:45], v23 offset:10496
  v_mfma_f32_16x16x32_bf16 v[200:203], v[52:55], v[88:91], v[200:203]
  ds_read_b64_tr_b16 v[46:47], v23 offset:15616
  s_setprio 0
  v_add_u32 v23, 26624, v23
  v_mfma_f32_16x16x32_bf16 v[204:207], v[52:55], v[92:95], v[204:207]
  ds_read_b64_tr_b16 v[48:49], v22 offset:0
  s_waitcnt lgkmcnt(5)
  v_mfma_f32_16x16x32_bf16 v[208:211], v[32:35], v[88:91], v[208:211]
  ds_read_b64_tr_b16 v[50:51], v22 offset:5120
  v_mfma_f32_16x16x32_bf16 v[212:215], v[32:35], v[92:95], v[212:215]
  ds_read_b64_tr_b16 v[52:53], v23 offset:0
  v_mfma_f32_16x16x32_bf16 v[216:219], v[36:39], v[88:91], v[216:219]
  ds_read_b64_tr_b16 v[54:55], v23 offset:5120
  v_mfma_f32_16x16x32_bf16 v[220:223], v[36:39], v[92:95], v[220:223]
  ds_read_b64_tr_b16 v[32:33], v22 offset:64
  s_waitcnt lgkmcnt(5)
  v_mfma_f32_16x16x32_bf16 v[224:227], v[40:43], v[88:91], v[224:227]
  ds_read_b64_tr_b16 v[34:35], v22 offset:5184
  v_mfma_f32_16x16x32_bf16 v[228:231], v[40:43], v[92:95], v[228:231]
  ds_read_b64_tr_b16 v[36:37], v23 offset:64
  v_mfma_f32_16x16x32_bf16 v[232:235], v[44:47], v[88:91], v[232:235]
  ds_read_b64_tr_b16 v[38:39], v23 offset:5184
  v_mfma_f32_16x16x32_bf16 v[236:239], v[44:47], v[92:95], v[236:239]
  s_barrier
  ds_read_b64_tr_b16 v[40:41], v22 offset:128
  s_waitcnt lgkmcnt(5)
  s_waitcnt vmcnt(10)
  v_mfma_f32_16x16x32_bf16 v[160:163], v[48:51], v[96:99], v[160:163]
  ds_read_b64_tr_b16 v[42:43], v22 offset:5248
  s_setprio 3
  s_waitcnt vmcnt(9)
  v_mfma_f32_16x16x32_bf16 v[164:167], v[48:51], v[100:103], v[164:167]
  ds_read_b64_tr_b16 v[44:45], v23 offset:128
  v_mfma_f32_16x16x32_bf16 v[168:171], v[52:55], v[96:99], v[168:171]
  ds_read_b64_tr_b16 v[46:47], v23 offset:5248
  buffer_load_dwordx4 v[80:83], v7, s[24:27], s45 offen sc1
  v_mfma_f32_16x16x32_bf16 v[172:175], v[52:55], v[100:103], v[172:175]
  ds_read_b64_tr_b16 v[48:49], v22 offset:192
  s_waitcnt lgkmcnt(5)
  v_mfma_f32_16x16x32_bf16 v[176:179], v[32:35], v[96:99], v[176:179]
  ds_read_b64_tr_b16 v[50:51], v22 offset:5312
  v_mfma_f32_16x16x32_bf16 v[180:183], v[32:35], v[100:103], v[180:183]
  ds_read_b64_tr_b16 v[52:53], v23 offset:192
  v_mfma_f32_16x16x32_bf16 v[184:187], v[36:39], v[96:99], v[184:187]
  ds_read_b64_tr_b16 v[54:55], v23 offset:5312
  v_mfma_f32_16x16x32_bf16 v[188:191], v[36:39], v[100:103], v[188:191]
  ds_read_b64_tr_b16 v[32:33], v22 offset:256
  s_waitcnt lgkmcnt(5)
  v_mfma_f32_16x16x32_bf16 v[192:195], v[40:43], v[96:99], v[192:195]
  ds_read_b64_tr_b16 v[34:35], v22 offset:5376
  buffer_load_dwordx4 v[84:87], v7, s[24:27], s45 offen offset:1024 sc1
  v_mfma_f32_16x16x32_bf16 v[196:199], v[40:43], v[100:103], v[196:199]
  ds_read_b64_tr_b16 v[36:37], v23 offset:256
  s_add_u32 s45, s45, 14336
  v_mfma_f32_16x16x32_bf16 v[200:203], v[44:47], v[96:99], v[200:203]
  ds_read_b64_tr_b16 v[38:39], v23 offset:5376
  s_setprio 2
  v_mfma_f32_16x16x32_bf16 v[204:207], v[44:47], v[100:103], v[204:207]
  ds_read_b64_tr_b16 v[40:41], v22 offset:10240
  s_waitcnt lgkmcnt(5)
  v_mfma_f32_16x16x32_bf16 v[208:211], v[48:51], v[96:99], v[208:211]
  ds_read_b64_tr_b16 v[42:43], v22 offset:15360
  v_mfma_f32_16x16x32_bf16 v[212:215], v[48:51], v[100:103], v[212:215]
  ds_read_b64_tr_b16 v[44:45], v23 offset:10240
  v_mfma_f32_16x16x32_bf16 v[216:219], v[52:55], v[96:99], v[216:219]
  ds_read_b64_tr_b16 v[46:47], v23 offset:15360
  buffer_load_dwordx4 v[88:91], v7, s[24:27], s45 offen sc1
  v_mfma_f32_16x16x32_bf16 v[220:223], v[52:55], v[100:103], v[220:223]
  ds_read_b64_tr_b16 v[48:49], v22 offset:10304
  s_waitcnt lgkmcnt(5)
  v_mfma_f32_16x16x32_bf16 v[224:227], v[32:35], v[96:99], v[224:227]
  ds_read_b64_tr_b16 v[50:51], v22 offset:15424
  v_mfma_f32_16x16x32_bf16 v[228:231], v[32:35], v[100:103], v[228:231]
  ds_read_b64_tr_b16 v[52:53], v23 offset:10304
  v_mfma_f32_16x16x32_bf16 v[232:235], v[36:39], v[96:99], v[232:235]
  ds_read_b64_tr_b16 v[54:55], v23 offset:15424
  v_mfma_f32_16x16x32_bf16 v[236:239], v[36:39], v[100:103], v[236:239]
  ds_read_b64_tr_b16 v[32:33], v22 offset:10368
  s_waitcnt lgkmcnt(5)
  s_waitcnt vmcnt(11)
  v_mfma_f32_16x16x32_bf16 v[160:163], v[40:43], v[104:107], v[160:163]
  ds_read_b64_tr_b16 v[34:35], v22 offset:15488
  s_setprio 1
  buffer_load_dwordx4 v[92:95], v7, s[24:27], s45 offen offset:1024 sc1
  s_waitcnt vmcnt(11)
  v_mfma_f32_16x16x32_bf16 v[164:167], v[40:43], v[108:111], v[164:167]
  ds_read_b64_tr_b16 v[36:37], v23 offset:10368
  s_add_u32 s45, s45, 14336
  v_mfma_f32_16x16x32_bf16 v[168:171], v[44:47], v[104:107], v[168:171]
  ds_read_b64_tr_b16 v[38:39], v23 offset:15488
  v_mfma_f32_16x16x32_bf16 v[172:175], v[44:47], v[108:111], v[172:175]
  ds_read_b64_tr_b16 v[40:41], v22 offset:10432
  s_waitcnt lgkmcnt(5)
  v_mfma_f32_16x16x32_bf16 v[176:179], v[48:51], v[104:107], v[176:179]
  ds_read_b64_tr_b16 v[42:43], v22 offset:15552
  v_mfma_f32_16x16x32_bf16 v[180:183], v[48:51], v[108:111], v[180:183]
  ds_read_b64_tr_b16 v[44:45], v23 offset:10432
  v_mfma_f32_16x16x32_bf16 v[184:187], v[52:55], v[104:107], v[184:187]
  ds_read_b64_tr_b16 v[46:47], v23 offset:15552
  v_mfma_f32_16x16x32_bf16 v[188:191], v[52:55], v[108:111], v[188:191]
  ds_read_b64_tr_b16 v[48:49], v22 offset:10496
  s_waitcnt lgkmcnt(5)
  v_mfma_f32_16x16x32_bf16 v[192:195], v[32:35], v[104:107], v[192:195]
  ds_read_b64_tr_b16 v[50:51], v22 offset:15616
  v_add_u32 v22, 26624, v22
  v_mfma_f32_16x16x32_bf16 v[196:199], v[32:35], v[108:111], v[196:199]
  ds_read_b64_tr_b16 v[52:53], v23 offset:10496
  v_mfma_f32_16x16x32_bf16 v[200:203], v[36:39], v[104:107], v[200:203]
  ds_read_b64_tr_b16 v[54:55], v23 offset:15616
  s_setprio 0
  v_add_u32 v23, 26624, v23
  v_mfma_f32_16x16x32_bf16 v[204:207], v[36:39], v[108:111], v[204:207]
  ds_read_b64_tr_b16 v[32:33], v22 offset:0
  s_waitcnt lgkmcnt(5)
  v_mfma_f32_16x16x32_bf16 v[208:211], v[40:43], v[104:107], v[208:211]
  ds_read_b64_tr_b16 v[34:35], v22 offset:5120
  v_mfma_f32_16x16x32_bf16 v[212:215], v[40:43], v[108:111], v[212:215]
  ds_read_b64_tr_b16 v[36:37], v23 offset:0
  v_mfma_f32_16x16x32_bf16 v[216:219], v[44:47], v[104:107], v[216:219]
  ds_read_b64_tr_b16 v[38:39], v23 offset:5120
  v_mfma_f32_16x16x32_bf16 v[220:223], v[44:47], v[108:111], v[220:223]
  ds_read_b64_tr_b16 v[40:41], v22 offset:64
  s_waitcnt lgkmcnt(5)
  v_mfma_f32_16x16x32_bf16 v[224:227], v[48:51], v[104:107], v[224:227]
  ds_read_b64_tr_b16 v[42:43], v22 offset:5184
  v_mfma_f32_16x16x32_bf16 v[228:231], v[48:51], v[108:111], v[228:231]
  ds_read_b64_tr_b16 v[44:45], v23 offset:64
  v_mfma_f32_16x16x32_bf16 v[232:235], v[52:55], v[104:107], v[232:235]
  ds_read_b64_tr_b16 v[46:47], v23 offset:5184
  v_mfma_f32_16x16x32_bf16 v[236:239], v[52:55], v[108:111], v[236:239]
  s_barrier
  ds_read_b64_tr_b16 v[48:49], v22 offset:128
  s_waitcnt lgkmcnt(5)
  s_waitcnt vmcnt(8)
  v_mfma_f32_16x16x32_bf16 v[160:163], v[32:35], v[64:67], v[160:163]
  ds_read_b64_tr_b16 v[50:51], v22 offset:5248
  s_setprio 3
  s_waitcnt vmcnt(0)
  v_mfma_f32_16x16x32_bf16 v[164:167], v[32:35], v[68:71], v[164:167]
  ds_read_b64_tr_b16 v[52:53], v23 offset:128
  v_mfma_f32_16x16x32_bf16 v[168:171], v[36:39], v[64:67], v[168:171]
  ds_read_b64_tr_b16 v[54:55], v23 offset:5248
  buffer_load_dwordx4 v[96:99], v7, s[24:27], s45 offen sc1
  v_mfma_f32_16x16x32_bf16 v[172:175], v[36:39], v[68:71], v[172:175]
  ds_read_b64_tr_b16 v[32:33], v22 offset:192
  s_waitcnt lgkmcnt(5)
  v_mfma_f32_16x16x32_bf16 v[176:179], v[40:43], v[64:67], v[176:179]
  ds_read_b64_tr_b16 v[34:35], v22 offset:5312
  v_mfma_f32_16x16x32_bf16 v[180:183], v[40:43], v[68:71], v[180:183]
  ds_read_b64_tr_b16 v[36:37], v23 offset:192
  v_mfma_f32_16x16x32_bf16 v[184:187], v[44:47], v[64:67], v[184:187]
  ds_read_b64_tr_b16 v[38:39], v23 offset:5312
  v_mfma_f32_16x16x32_bf16 v[188:191], v[44:47], v[68:71], v[188:191]
  ds_read_b64_tr_b16 v[40:41], v22 offset:256
  s_waitcnt lgkmcnt(5)
  v_mfma_f32_16x16x32_bf16 v[192:195], v[48:51], v[64:67], v[192:195]
  ds_read_b64_tr_b16 v[42:43], v22 offset:5376
  buffer_load_dwordx4 v[100:103], v7, s[24:27], s45 offen offset:1024 sc1
  v_mfma_f32_16x16x32_bf16 v[196:199], v[48:51], v[68:71], v[196:199]
  ds_read_b64_tr_b16 v[44:45], v23 offset:256
  s_add_u32 s45, s45, 14336
  v_mfma_f32_16x16x32_bf16 v[200:203], v[52:55], v[64:67], v[200:203]
  ds_read_b64_tr_b16 v[46:47], v23 offset:5376
  s_setprio 2
  v_mfma_f32_16x16x32_bf16 v[204:207], v[52:55], v[68:71], v[204:207]
  ds_read_b64_tr_b16 v[48:49], v22 offset:10240
  s_waitcnt lgkmcnt(5)
  v_mfma_f32_16x16x32_bf16 v[208:211], v[32:35], v[64:67], v[208:211]
  ds_read_b64_tr_b16 v[50:51], v22 offset:15360
  v_mfma_f32_16x16x32_bf16 v[212:215], v[32:35], v[68:71], v[212:215]
  ds_read_b64_tr_b16 v[52:53], v23 offset:10240
  v_mfma_f32_16x16x32_bf16 v[216:219], v[36:39], v[64:67], v[216:219]
  ds_read_b64_tr_b16 v[54:55], v23 offset:15360
  buffer_load_dwordx4 v[104:107], v7, s[24:27], s45 offen sc1
  v_mfma_f32_16x16x32_bf16 v[220:223], v[36:39], v[68:71], v[220:223]
  ds_read_b64_tr_b16 v[32:33], v22 offset:10304
  s_waitcnt lgkmcnt(5)
  v_mfma_f32_16x16x32_bf16 v[224:227], v[40:43], v[64:67], v[224:227]
  ds_read_b64_tr_b16 v[34:35], v22 offset:15424
  v_mfma_f32_16x16x32_bf16 v[228:231], v[40:43], v[68:71], v[228:231]
  ds_read_b64_tr_b16 v[36:37], v23 offset:10304
  v_mfma_f32_16x16x32_bf16 v[232:235], v[44:47], v[64:67], v[232:235]
  ds_read_b64_tr_b16 v[38:39], v23 offset:15424
  v_mfma_f32_16x16x32_bf16 v[236:239], v[44:47], v[68:71], v[236:239]
  ds_read_b64_tr_b16 v[40:41], v22 offset:10368
  s_waitcnt lgkmcnt(5)
  v_mfma_f32_16x16x32_bf16 v[160:163], v[48:51], v[72:75], v[160:163]
  ds_read_b64_tr_b16 v[42:43], v22 offset:15488
  s_setprio 1
  buffer_load_dwordx4 v[108:111], v7, s[24:27], s45 offen offset:1024 sc1
  v_mfma_f32_16x16x32_bf16 v[164:167], v[48:51], v[76:79], v[164:167]
  ds_read_b64_tr_b16 v[44:45], v23 offset:10368
  s_add_u32 s45, s45, 14336
  v_mfma_f32_16x16x32_bf16 v[168:171], v[52:55], v[72:75], v[168:171]
  ds_read_b64_tr_b16 v[46:47], v23 offset:15488
  v_mfma_f32_16x16x32_bf16 v[172:175], v[52:55], v[76:79], v[172:175]
  ds_read_b64_tr_b16 v[48:49], v22 offset:10432
  s_waitcnt lgkmcnt(5)
  v_mfma_f32_16x16x32_bf16 v[176:179], v[32:35], v[72:75], v[176:179]
  ds_read_b64_tr_b16 v[50:51], v22 offset:15552
  v_mfma_f32_16x16x32_bf16 v[180:183], v[32:35], v[76:79], v[180:183]
  ds_read_b64_tr_b16 v[52:53], v23 offset:10432
  v_mfma_f32_16x16x32_bf16 v[184:187], v[36:39], v[72:75], v[184:187]
  ds_read_b64_tr_b16 v[54:55], v23 offset:15552
  v_mfma_f32_16x16x32_bf16 v[188:191], v[36:39], v[76:79], v[188:191]
  ds_read_b64_tr_b16 v[32:33], v22 offset:10496
  s_waitcnt lgkmcnt(5)
  v_mfma_f32_16x16x32_bf16 v[192:195], v[40:43], v[72:75], v[192:195]
  ds_read_b64_tr_b16 v[34:35], v22 offset:15616
  v_add_u32 v22, 26624, v22
  v_mfma_f32_16x16x32_bf16 v[196:199], v[40:43], v[76:79], v[196:199]
  ds_read_b64_tr_b16 v[36:37], v23 offset:10496
  v_mfma_f32_16x16x32_bf16 v[200:203], v[44:47], v[72:75], v[200:203]
  ds_read_b64_tr_b16 v[38:39], v23 offset:15616
  s_setprio 0
  v_add_u32 v23, 26624, v23
  v_mfma_f32_16x16x32_bf16 v[204:207], v[44:47], v[76:79], v[204:207]
  ds_read_b64_tr_b16 v[40:41], v22 offset:0
  s_waitcnt lgkmcnt(5)
  v_mfma_f32_16x16x32_bf16 v[208:211], v[48:51], v[72:75], v[208:211]
  ds_read_b64_tr_b16 v[42:43], v22 offset:5120
  v_mfma_f32_16x16x32_bf16 v[212:215], v[48:51], v[76:79], v[212:215]
  ds_read_b64_tr_b16 v[44:45], v23 offset:0
  v_mfma_f32_16x16x32_bf16 v[216:219], v[52:55], v[72:75], v[216:219]
  ds_read_b64_tr_b16 v[46:47], v23 offset:5120
  v_mfma_f32_16x16x32_bf16 v[220:223], v[52:55], v[76:79], v[220:223]
  ds_read_b64_tr_b16 v[48:49], v22 offset:64
  s_waitcnt lgkmcnt(5)
  v_mfma_f32_16x16x32_bf16 v[224:227], v[32:35], v[72:75], v[224:227]
  ds_read_b64_tr_b16 v[50:51], v22 offset:5184
  v_mfma_f32_16x16x32_bf16 v[228:231], v[32:35], v[76:79], v[228:231]
  ds_read_b64_tr_b16 v[52:53], v23 offset:64
  v_mfma_f32_16x16x32_bf16 v[232:235], v[36:39], v[72:75], v[232:235]
  ds_read_b64_tr_b16 v[54:55], v23 offset:5184
  v_mfma_f32_16x16x32_bf16 v[236:239], v[36:39], v[76:79], v[236:239]
  s_barrier
  ds_read_b64_tr_b16 v[32:33], v22 offset:128
  s_add_u32 s38, s92, 3
  s_and_b32 s38, s38, 3
  s_waitcnt lgkmcnt(5)
  v_mfma_f32_16x16x32_bf16 v[160:163], v[40:43], v[80:83], v[160:163]
  ds_read_b64_tr_b16 v[34:35], v22 offset:5248
  s_setprio 3
  s_mul_i32 s38, s38, 172032
  s_add_u32 s45, s64, s38
  v_mfma_f32_16x16x32_bf16 v[164:167], v[40:43], v[84:87], v[164:167]
  ds_read_b64_tr_b16 v[36:37], v23 offset:128
  v_mfma_f32_16x16x32_bf16 v[168:171], v[44:47], v[80:83], v[168:171]
  ds_read_b64_tr_b16 v[38:39], v23 offset:5248
  buffer_load_dwordx4 v[64:67], v7, s[24:27], s45 offen sc1
  v_mfma_f32_16x16x32_bf16 v[172:175], v[44:47], v[84:87], v[172:175]
  ds_read_b64_tr_b16 v[40:41], v22 offset:192
  s_waitcnt lgkmcnt(5)
  v_mfma_f32_16x16x32_bf16 v[176:179], v[48:51], v[80:83], v[176:179]
  ds_read_b64_tr_b16 v[42:43], v22 offset:5312
  v_mfma_f32_16x16x32_bf16 v[180:183], v[48:51], v[84:87], v[180:183]
  ds_read_b64_tr_b16 v[44:45], v23 offset:192
  v_mfma_f32_16x16x32_bf16 v[184:187], v[52:55], v[80:83], v[184:187]
  ds_read_b64_tr_b16 v[46:47], v23 offset:5312
  v_mfma_f32_16x16x32_bf16 v[188:191], v[52:55], v[84:87], v[188:191]
  ds_read_b64_tr_b16 v[48:49], v22 offset:256
  s_waitcnt lgkmcnt(5)
  v_mfma_f32_16x16x32_bf16 v[192:195], v[32:35], v[80:83], v[192:195]
  ds_read_b64_tr_b16 v[50:51], v22 offset:5376
  buffer_load_dwordx4 v[68:71], v7, s[24:27], s45 offen offset:1024 sc1
  v_mfma_f32_16x16x32_bf16 v[196:199], v[32:35], v[84:87], v[196:199]
  ds_read_b64_tr_b16 v[52:53], v23 offset:256
  s_add_u32 s45, s45, 14336
  v_mfma_f32_16x16x32_bf16 v[200:203], v[36:39], v[80:83], v[200:203]
  ds_read_b64_tr_b16 v[54:55], v23 offset:5376
  s_setprio 2
  v_mfma_f32_16x16x32_bf16 v[204:207], v[36:39], v[84:87], v[204:207]
  ds_read_b64_tr_b16 v[32:33], v22 offset:10240
  s_waitcnt lgkmcnt(5)
  v_mfma_f32_16x16x32_bf16 v[208:211], v[40:43], v[80:83], v[208:211]
  ds_read_b64_tr_b16 v[34:35], v22 offset:15360
  v_mfma_f32_16x16x32_bf16 v[212:215], v[40:43], v[84:87], v[212:215]
  ds_read_b64_tr_b16 v[36:37], v23 offset:10240
  v_mfma_f32_16x16x32_bf16 v[216:219], v[44:47], v[80:83], v[216:219]
  ds_read_b64_tr_b16 v[38:39], v23 offset:15360
  buffer_load_dwordx4 v[72:75], v7, s[24:27], s45 offen sc1
  v_mfma_f32_16x16x32_bf16 v[220:223], v[44:47], v[84:87], v[220:223]
  ds_read_b64_tr_b16 v[40:41], v22 offset:10304
  s_waitcnt lgkmcnt(5)
  v_mfma_f32_16x16x32_bf16 v[224:227], v[48:51], v[80:83], v[224:227]
  ds_read_b64_tr_b16 v[42:43], v22 offset:15424
  v_mfma_f32_16x16x32_bf16 v[228:231], v[48:51], v[84:87], v[228:231]
  ds_read_b64_tr_b16 v[44:45], v23 offset:10304
  v_mfma_f32_16x16x32_bf16 v[232:235], v[52:55], v[80:83], v[232:235]
  ds_read_b64_tr_b16 v[46:47], v23 offset:15424
  v_mfma_f32_16x16x32_bf16 v[236:239], v[52:55], v[84:87], v[236:239]
  ds_read_b64_tr_b16 v[48:49], v22 offset:10368
  s_waitcnt lgkmcnt(5)
  v_mfma_f32_16x16x32_bf16 v[160:163], v[32:35], v[88:91], v[160:163]
  ds_read_b64_tr_b16 v[50:51], v22 offset:15488
  s_setprio 1
  buffer_load_dwordx4 v[76:79], v7, s[24:27], s45 offen offset:1024 sc1
  v_mfma_f32_16x16x32_bf16 v[164:167], v[32:35], v[92:95], v[164:167]
  ds_read_b64_tr_b16 v[52:53], v23 offset:10368
  s_add_u32 s45, s45, 14336
  v_mfma_f32_16x16x32_bf16 v[168:171], v[36:39], v[88:91], v[168:171]
  ds_read_b64_tr_b16 v[54:55], v23 offset:15488
  v_mfma_f32_16x16x32_bf16 v[172:175], v[36:39], v[92:95], v[172:175]
  ds_read_b64_tr_b16 v[32:33], v22 offset:10432
  s_waitcnt lgkmcnt(5)
  v_mfma_f32_16x16x32_bf16 v[176:179], v[40:43], v[88:91], v[176:179]
  ds_read_b64_tr_b16 v[34:35], v22 offset:15552
  v_mfma_f32_16x16x32_bf16 v[180:183], v[40:43], v[92:95], v[180:183]
  ds_read_b64_tr_b16 v[36:37], v23 offset:10432
  v_mfma_f32_16x16x32_bf16 v[184:187], v[44:47], v[88:91], v[184:187]
  ds_read_b64_tr_b16 v[38:39], v23 offset:15552
  v_mfma_f32_16x16x32_bf16 v[188:191], v[44:47], v[92:95], v[188:191]
  ds_read_b64_tr_b16 v[40:41], v22 offset:10496
  s_waitcnt lgkmcnt(5)
  v_mfma_f32_16x16x32_bf16 v[192:195], v[48:51], v[88:91], v[192:195]
  ds_read_b64_tr_b16 v[42:43], v22 offset:15616
  v_add_u32 v22, 26624, v22
  v_mfma_f32_16x16x32_bf16 v[196:199], v[48:51], v[92:95], v[196:199]
  ds_read_b64_tr_b16 v[44:45], v23 offset:10496
  v_mfma_f32_16x16x32_bf16 v[200:203], v[52:55], v[88:91], v[200:203]
  ds_read_b64_tr_b16 v[46:47], v23 offset:15616
  s_setprio 0
  v_add_u32 v23, 26624, v23
  v_mfma_f32_16x16x32_bf16 v[204:207], v[52:55], v[92:95], v[204:207]
  ds_read_b64_tr_b16 v[48:49], v22 offset:0
  s_waitcnt lgkmcnt(5)
  v_mfma_f32_16x16x32_bf16 v[208:211], v[32:35], v[88:91], v[208:211]
  ds_read_b64_tr_b16 v[50:51], v22 offset:5120
  v_mfma_f32_16x16x32_bf16 v[212:215], v[32:35], v[92:95], v[212:215]
  ds_read_b64_tr_b16 v[52:53], v23 offset:0
  v_mfma_f32_16x16x32_bf16 v[216:219], v[36:39], v[88:91], v[216:219]
  ds_read_b64_tr_b16 v[54:55], v23 offset:5120
  v_mfma_f32_16x16x32_bf16 v[220:223], v[36:39], v[92:95], v[220:223]
  ds_read_b64_tr_b16 v[32:33], v22 offset:64
  s_waitcnt lgkmcnt(5)
  v_mfma_f32_16x16x32_bf16 v[224:227], v[40:43], v[88:91], v[224:227]
  ds_read_b64_tr_b16 v[34:35], v22 offset:5184
  v_mfma_f32_16x16x32_bf16 v[228:231], v[40:43], v[92:95], v[228:231]
  ds_read_b64_tr_b16 v[36:37], v23 offset:64
  v_mfma_f32_16x16x32_bf16 v[232:235], v[44:47], v[88:91], v[232:235]
  ds_read_b64_tr_b16 v[38:39], v23 offset:5184
  v_mfma_f32_16x16x32_bf16 v[236:239], v[44:47], v[92:95], v[236:239]
  s_barrier
  ds_read_b64_tr_b16 v[40:41], v22 offset:128
  s_waitcnt lgkmcnt(5)
  s_waitcnt vmcnt(7)
  v_mfma_f32_16x16x32_bf16 v[160:163], v[48:51], v[96:99], v[160:163]
  ds_read_b64_tr_b16 v[42:43], v22 offset:5248
  s_setprio 3
  v_mov_b32 v1, 159744
  s_waitcnt vmcnt(6)
  v_mfma_f32_16x16x32_bf16 v[164:167], v[48:51], v[100:103], v[164:167]
  ds_read_b64_tr_b16 v[44:45], v23 offset:128
  v_mfma_f32_16x16x32_bf16 v[168:171], v[52:55], v[96:99], v[168:171]
  ds_read_b64_tr_b16 v[46:47], v23 offset:5248
  buffer_load_dwordx4 v[80:83], v7, s[24:27], s45 offen sc1
  v_mfma_f32_16x16x32_bf16 v[172:175], v[52:55], v[100:103], v[172:175]
  ds_read_b64_tr_b16 v[48:49], v22 offset:192
  s_waitcnt lgkmcnt(5)
  v_mfma_f32_16x16x32_bf16 v[176:179], v[32:35], v[96:99], v[176:179]
  ds_read_b64_tr_b16 v[50:51], v22 offset:5312
  ds_read_b32 v2, v1
  v_mfma_f32_16x16x32_bf16 v[180:183], v[32:35], v[100:103], v[180:183]
  ds_read_b64_tr_b16 v[52:53], v23 offset:192
  v_mfma_f32_16x16x32_bf16 v[184:187], v[36:39], v[96:99], v[184:187]
  ds_read_b64_tr_b16 v[54:55], v23 offset:5312
  v_mfma_f32_16x16x32_bf16 v[188:191], v[36:39], v[100:103], v[188:191]
  ds_read_b64_tr_b16 v[32:33], v22 offset:256
  s_waitcnt lgkmcnt(6)
  v_mfma_f32_16x16x32_bf16 v[192:195], v[40:43], v[96:99], v[192:195]
  ds_read_b64_tr_b16 v[34:35], v22 offset:5376
  buffer_load_dwordx4 v[84:87], v7, s[24:27], s45 offen offset:1024 sc1
  v_mfma_f32_16x16x32_bf16 v[196:199], v[40:43], v[100:103], v[196:199]
  ds_read_b64_tr_b16 v[36:37], v23 offset:256
  s_add_u32 s45, s45, 14336
  v_mfma_f32_16x16x32_bf16 v[200:203], v[44:47], v[96:99], v[200:203]
  ds_read_b64_tr_b16 v[38:39], v23 offset:5376
  s_setprio 2
  v_mfma_f32_16x16x32_bf16 v[204:207], v[44:47], v[100:103], v[204:207]
  ds_read_b64_tr_b16 v[40:41], v22 offset:10240
  s_waitcnt lgkmcnt(5)
  v_mfma_f32_16x16x32_bf16 v[208:211], v[48:51], v[96:99], v[208:211]
  ds_read_b64_tr_b16 v[42:43], v22 offset:15360
  v_mfma_f32_16x16x32_bf16 v[212:215], v[48:51], v[100:103], v[212:215]
  ds_read_b64_tr_b16 v[44:45], v23 offset:10240
  v_mfma_f32_16x16x32_bf16 v[216:219], v[52:55], v[96:99], v[216:219]
  ds_read_b64_tr_b16 v[46:47], v23 offset:15360
  buffer_load_dwordx4 v[88:91], v7, s[24:27], s45 offen sc1
  v_mfma_f32_16x16x32_bf16 v[220:223], v[52:55], v[100:103], v[220:223]
  ds_read_b64_tr_b16 v[48:49], v22 offset:10304
  s_waitcnt lgkmcnt(5)
  v_mfma_f32_16x16x32_bf16 v[224:227], v[32:35], v[96:99], v[224:227]
  ds_read_b64_tr_b16 v[50:51], v22 offset:15424
  v_mfma_f32_16x16x32_bf16 v[228:231], v[32:35], v[100:103], v[228:231]
  ds_read_b64_tr_b16 v[52:53], v23 offset:10304
  v_mfma_f32_16x16x32_bf16 v[232:235], v[36:39], v[96:99], v[232:235]
  ds_read_b64_tr_b16 v[54:55], v23 offset:15424
  v_mfma_f32_16x16x32_bf16 v[236:239], v[36:39], v[100:103], v[236:239]
  ds_read_b64_tr_b16 v[32:33], v22 offset:10368
  s_waitcnt lgkmcnt(5)
  s_waitcnt vmcnt(8)
  v_mfma_f32_16x16x32_bf16 v[160:163], v[40:43], v[104:107], v[160:163]
  ds_read_b64_tr_b16 v[34:35], v22 offset:15488
  s_setprio 1
  buffer_load_dwordx4 v[92:95], v7, s[24:27], s45 offen offset:1024 sc1
  v_readfirstlane_b32 s67, v2
  s_waitcnt vmcnt(8)
  v_mfma_f32_16x16x32_bf16 v[164:167], v[40:43], v[108:111], v[164:167]
  ds_read_b64_tr_b16 v[36:37], v23 offset:10368
  s_add_u32 s45, s45, 14336
  v_mfma_f32_16x16x32_bf16 v[168:171], v[44:47], v[104:107], v[168:171]
  ds_read_b64_tr_b16 v[38:39], v23 offset:15488
  v_mfma_f32_16x16x32_bf16 v[172:175], v[44:47], v[108:111], v[172:175]
  ds_read_b64_tr_b16 v[40:41], v22 offset:10432
  s_waitcnt lgkmcnt(5)
  v_mfma_f32_16x16x32_bf16 v[176:179], v[48:51], v[104:107], v[176:179]
  ds_read_b64_tr_b16 v[42:43], v22 offset:15552
  s_lshr_b32 s39, s67, 28
  v_mfma_f32_16x16x32_bf16 v[180:183], v[48:51], v[108:111], v[180:183]
  ds_read_b64_tr_b16 v[44:45], v23 offset:10432
  v_mfma_f32_16x16x32_bf16 v[184:187], v[52:55], v[104:107], v[184:187]
  ds_read_b64_tr_b16 v[46:47], v23 offset:15552
  s_and_b32 s38, s2, 3
  v_mfma_f32_16x16x32_bf16 v[188:191], v[52:55], v[108:111], v[188:191]
  ds_read_b64_tr_b16 v[48:49], v22 offset:10496
  s_waitcnt lgkmcnt(5)
  v_mfma_f32_16x16x32_bf16 v[192:195], v[32:35], v[104:107], v[192:195]
  ds_read_b64_tr_b16 v[50:51], v22 offset:15616
  v_add_u32 v22, 4294834176, v22
  s_mul_i32 s38, s38, 688128
  v_mfma_f32_16x16x32_bf16 v[196:199], v[32:35], v[108:111], v[196:199]
  ds_read_b64_tr_b16 v[52:53], v23 offset:10496
  v_mfma_f32_16x16x32_bf16 v[200:203], v[36:39], v[104:107], v[200:203]
  ds_read_b64_tr_b16 v[54:55], v23 offset:15616
  s_setprio 0
  v_add_u32 v23, 4294834176, v23
  s_sub_u32 s65, s65, s38
  v_mfma_f32_16x16x32_bf16 v[204:207], v[36:39], v[108:111], v[204:207]
  ds_read_b64_tr_b16 v[32:33], v22 offset:0
  s_waitcnt lgkmcnt(5)
  v_mfma_f32_16x16x32_bf16 v[208:211], v[40:43], v[104:107], v[208:211]
  ds_read_b64_tr_b16 v[34:35], v22 offset:5120
  s_mov_b32 s40, s53
  v_mfma_f32_16x16x32_bf16 v[212:215], v[40:43], v[108:111], v[212:215]
  ds_read_b64_tr_b16 v[36:37], v23 offset:0
  v_mfma_f32_16x16x32_bf16 v[216:219], v[44:47], v[104:107], v[216:219]
  ds_read_b64_tr_b16 v[38:39], v23 offset:5120
  v_mfma_f32_16x16x32_bf16 v[220:223], v[44:47], v[108:111], v[220:223]
  ds_read_b64_tr_b16 v[40:41], v22 offset:64
  s_waitcnt lgkmcnt(5)
  v_mfma_f32_16x16x32_bf16 v[224:227], v[48:51], v[104:107], v[224:227]
  ds_read_b64_tr_b16 v[42:43], v22 offset:5184
  v_mfma_f32_16x16x32_bf16 v[228:231], v[48:51], v[108:111], v[228:231]
  ds_read_b64_tr_b16 v[44:45], v23 offset:64
  v_mfma_f32_16x16x32_bf16 v[232:235], v[52:55], v[104:107], v[232:235]
  ds_read_b64_tr_b16 v[46:47], v23 offset:5184
  s_cmp_gt_u32 s39, 1
  v_mfma_f32_16x16x32_bf16 v[236:239], v[52:55], v[108:111], v[236:239]
  s_cbranch_scc0 L_otail
L_oloop:
  s_barrier
  ds_read_b64_tr_b16 v[48:49], v22 offset:128
  s_waitcnt lgkmcnt(5)
  s_waitcnt vmcnt(7)
  v_mfma_f32_16x16x32_bf16 v[160:163], v[32:35], v[64:67], v[160:163]
  ds_read_b64_tr_b16 v[50:51], v22 offset:5248
  s_setprio 3
  s_waitcnt vmcnt(6)
  v_mfma_f32_16x16x32_bf16 v[164:167], v[32:35], v[68:71], v[164:167]
  ds_read_b64_tr_b16 v[52:53], v23 offset:128
  v_mfma_f32_16x16x32_bf16 v[168:171], v[36:39], v[64:67], v[168:171]
  ds_read_b64_tr_b16 v[54:55], v23 offset:5248
  buffer_load_dwordx4 v[96:99], v7, s[24:27], s45 offen sc1
  v_mfma_f32_16x16x32_bf16 v[172:175], v[36:39], v[68:71], v[172:175]
  ds_read_b64_tr_b16 v[32:33], v22 offset:192
  s_waitcnt lgkmcnt(5)
  v_mfma_f32_16x16x32_bf16 v[176:179], v[40:43], v[64:67], v[176:179]
  ds_read_b64_tr_b16 v[34:35], v22 offset:5312
  v_mfma_f32_16x16x32_bf16 v[180:183], v[40:43], v[68:71], v[180:183]
  ds_read_b64_tr_b16 v[36:37], v23 offset:192
  v_mfma_f32_16x16x32_bf16 v[184:187], v[44:47], v[64:67], v[184:187]
  ds_read_b64_tr_b16 v[38:39], v23 offset:5312
  v_mfma_f32_16x16x32_bf16 v[188:191], v[44:47], v[68:71], v[188:191]
  ds_read_b64_tr_b16 v[40:41], v22 offset:256
  s_waitcnt lgkmcnt(5)
  v_mfma_f32_16x16x32_bf16 v[192:195], v[48:51], v[64:67], v[192:195]
  ds_read_b64_tr_b16 v[42:43], v22 offset:5376
  buffer_load_dwordx4 v[100:103], v7, s[24:27], s45 offen offset:1024 sc1
  v_mfma_f32_16x16x32_bf16 v[196:199], v[48:51], v[68:71], v[196:199]
  ds_read_b64_tr_b16 v[44:45], v23 offset:256
  s_add_u32 s45, s45, 14336
  v_mfma_f32_16x16x32_bf16 v[200:203], v[52:55], v[64:67], v[200:203]
  ds_read_b64_tr_b16 v[46:47], v23 offset:5376
  s_setprio 2
  v_mfma_f32_16x16x32_bf16 v[204:207], v[52:55], v[68:71], v[204:207]
  ds_read_b64_tr_b16 v[48:49], v22 offset:10240
  s_waitcnt lgkmcnt(5)
  v_mfma_f32_16x16x32_bf16 v[208:211], v[32:35], v[64:67], v[208:211]
  ds_read_b64_tr_b16 v[50:51], v22 offset:15360
  v_mfma_f32_16x16x32_bf16 v[212:215], v[32:35], v[68:71], v[212:215]
  ds_read_b64_tr_b16 v[52:53], v23 offset:10240
  v_mfma_f32_16x16x32_bf16 v[216:219], v[36:39], v[64:67], v[216:219]
  ds_read_b64_tr_b16 v[54:55], v23 offset:15360
  buffer_load_dwordx4 v[104:107], v7, s[24:27], s45 offen sc1
  v_mfma_f32_16x16x32_bf16 v[220:223], v[36:39], v[68:71], v[220:223]
  ds_read_b64_tr_b16 v[32:33], v22 offset:10304
  s_waitcnt lgkmcnt(5)
  v_mfma_f32_16x16x32_bf16 v[224:227], v[40:43], v[64:67], v[224:227]
  ds_read_b64_tr_b16 v[34:35], v22 offset:15424
  v_mfma_f32_16x16x32_bf16 v[228:231], v[40:43], v[68:71], v[228:231]
  ds_read_b64_tr_b16 v[36:37], v23 offset:10304
  v_mfma_f32_16x16x32_bf16 v[232:235], v[44:47], v[64:67], v[232:235]
  ds_read_b64_tr_b16 v[38:39], v23 offset:15424
  v_mfma_f32_16x16x32_bf16 v[236:239], v[44:47], v[68:71], v[236:239]
  ds_read_b64_tr_b16 v[40:41], v22 offset:10368
  s_waitcnt lgkmcnt(5)
  s_waitcnt vmcnt(8)
  v_mfma_f32_16x16x32_bf16 v[160:163], v[48:51], v[72:75], v[160:163]
  ds_read_b64_tr_b16 v[42:43], v22 offset:15488
  s_setprio 1
  buffer_load_dwordx4 v[108:111], v7, s[24:27], s45 offen offset:1024 sc1
  s_waitcnt vmcnt(8)
  v_mfma_f32_16x16x32_bf16 v[164:167], v[48:51], v[76:79], v[164:167]
  ds_read_b64_tr_b16 v[44:45], v23 offset:10368
  s_add_u32 s45, s45, 14336
  v_mfma_f32_16x16x32_bf16 v[168:171], v[52:55], v[72:75], v[168:171]
  ds_read_b64_tr_b16 v[46:47], v23 offset:15488
  v_mfma_f32_16x16x32_bf16 v[172:175], v[52:55], v[76:79], v[172:175]
  ds_read_b64_tr_b16 v[48:49], v22 offset:10432
  s_waitcnt lgkmcnt(5)
  v_mfma_f32_16x16x32_bf16 v[176:179], v[32:35], v[72:75], v[176:179]
  ds_read_b64_tr_b16 v[50:51], v22 offset:15552
  v_mfma_f32_16x16x32_bf16 v[180:183], v[32:35], v[76:79], v[180:183]
  ds_read_b64_tr_b16 v[52:53], v23 offset:10432
  v_mfma_f32_16x16x32_bf16 v[184:187], v[36:39], v[72:75], v[184:187]
  ds_read_b64_tr_b16 v[54:55], v23 offset:15552
  v_mfma_f32_16x16x32_bf16 v[188:191], v[36:39], v[76:79], v[188:191]
  ds_read_b64_tr_b16 v[32:33], v22 offset:10496
  s_waitcnt lgkmcnt(5)
  v_mfma_f32_16x16x32_bf16 v[192:195], v[40:43], v[72:75], v[192:195]
  ds_read_b64_tr_b16 v[34:35], v22 offset:15616
  v_add_u32 v22, 26624, v22
  v_mfma_f32_16x16x32_bf16 v[196:199], v[40:43], v[76:79], v[196:199]
  ds_read_b64_tr_b16 v[36:37], v23 offset:10496
  v_mfma_f32_16x16x32_bf16 v[200:203], v[44:47], v[72:75], v[200:203]
  ds_read_b64_tr_b16 v[38:39], v23 offset:15616
  s_setprio 0
  v_add_u32 v23, 26624, v23
  v_mfma_f32_16x16x32_bf16 v[204:207], v[44:47], v[76:79], v[204:207]
  ds_read_b64_tr_b16 v[40:41], v22 offset:0
  s_waitcnt lgkmcnt(5)
  v_mfma_f32_16x16x32_bf16 v[208:211], v[48:51], v[72:75], v[208:211]
  ds_read_b64_tr_b16 v[42:43], v22 offset:5120
  v_mfma_f32_16x16x32_bf16 v[212:215], v[48:51], v[76:79], v[212:215]
  ds_read_b64_tr_b16 v[44:45], v23 offset:0
  v_mfma_f32_16x16x32_bf16 v[216:219], v[52:55], v[72:75], v[216:219]
  ds_read_b64_tr_b16 v[46:47], v23 offset:5120
  v_mfma_f32_16x16x32_bf16 v[220:223], v[52:55], v[76:79], v[220:223]
  ds_read_b64_tr_b16 v[48:49], v22 offset:64
  s_waitcnt lgkmcnt(5)
  v_mfma_f32_16x16x32_bf16 v[224:227], v[32:35], v[72:75], v[224:227]
  ds_read_b64_tr_b16 v[50:51], v22 offset:5184
  v_mfma_f32_16x16x32_bf16 v[228:231], v[32:35], v[76:79], v[228:231]
  ds_read_b64_tr_b16 v[52:53], v23 offset:64
  v_mfma_f32_16x16x32_bf16 v[232:235], v[36:39], v[72:75], v[232:235]
  ds_read_b64_tr_b16 v[54:55], v23 offset:5184
  v_mfma_f32_16x16x32_bf16 v[236:239], v[36:39], v[76:79], v[236:239]
  s_barrier
  ds_read_b64_tr_b16 v[32:33], v22 offset:128
  s_and_b32 s38, s67, 15
  s_lshr_b32 s67, s67, 4
  s_waitcnt lgkmcnt(5)
  s_waitcnt vmcnt(7)
  v_mfma_f32_16x16x32_bf16 v[160:163], v[40:43], v[80:83], v[160:163]
  ds_read_b64_tr_b16 v[34:35], v22 offset:5248
  s_setprio 3
  s_mul_i32 s38, s38, 172032
  s_add_u32 s45, s65, s38
  s_waitcnt vmcnt(6)
  v_mfma_f32_16x16x32_bf16 v[164:167], v[40:43], v[84:87], v[164:167]
  ds_read_b64_tr_b16 v[36:37], v23 offset:128
  v_mfma_f32_16x16x32_bf16 v[168:171], v[44:47], v[80:83], v[168:171]
  ds_read_b64_tr_b16 v[38:39], v23 offset:5248
  buffer_load_dwordx4 v[64:67], v7, s[24:27], s45 offen sc1
  v_mfma_f32_16x16x32_bf16 v[172:175], v[44:47], v[84:87], v[172:175]
  ds_read_b64_tr_b16 v[40:41], v22 offset:192
  s_waitcnt lgkmcnt(5)
  v_mfma_f32_16x16x32_bf16 v[176:179], v[48:51], v[80:83], v[176:179]
  ds_read_b64_tr_b16 v[42:43], v22 offset:5312
  v_mfma_f32_16x16x32_bf16 v[180:183], v[48:51], v[84:87], v[180:183]
  ds_read_b64_tr_b16 v[44:45], v23 offset:192
  v_mfma_f32_16x16x32_bf16 v[184:187], v[52:55], v[80:83], v[184:187]
  ds_read_b64_tr_b16 v[46:47], v23 offset:5312
  v_mfma_f32_16x16x32_bf16 v[188:191], v[52:55], v[84:87], v[188:191]
  ds_read_b64_tr_b16 v[48:49], v22 offset:256
  s_waitcnt lgkmcnt(5)
  v_mfma_f32_16x16x32_bf16 v[192:195], v[32:35], v[80:83], v[192:195]
  ds_read_b64_tr_b16 v[50:51], v22 offset:5376
  buffer_load_dwordx4 v[68:71], v7, s[24:27], s45 offen offset:1024 sc1
  v_mfma_f32_16x16x32_bf16 v[196:199], v[32:35], v[84:87], v[196:199]
  ds_read_b64_tr_b16 v[52:53], v23 offset:256
  s_add_u32 s45, s45, 14336
  v_mfma_f32_16x16x32_bf16 v[200:203], v[36:39], v[80:83], v[200:203]
  ds_read_b64_tr_b16 v[54:55], v23 offset:5376
  s_setprio 2
  v_mfma_f32_16x16x32_bf16 v[204:207], v[36:39], v[84:87], v[204:207]
  ds_read_b64_tr_b16 v[32:33], v22 offset:10240
  s_waitcnt lgkmcnt(5)
  v_mfma_f32_16x16x32_bf16 v[208:211], v[40:43], v[80:83], v[208:211]
  ds_read_b64_tr_b16 v[34:35], v22 offset:15360
  v_mfma_f32_16x16x32_bf16 v[212:215], v[40:43], v[84:87], v[212:215]
  ds_read_b64_tr_b16 v[36:37], v23 offset:10240
  v_mfma_f32_16x16x32_bf16 v[216:219], v[44:47], v[80:83], v[216:219]
  ds_read_b64_tr_b16 v[38:39], v23 offset:15360
  buffer_load_dwordx4 v[72:75], v7, s[24:27], s45 offen sc1
  v_mfma_f32_16x16x32_bf16 v[220:223], v[44:47], v[84:87], v[220:223]
  ds_read_b64_tr_b16 v[40:41], v22 offset:10304
  s_waitcnt lgkmcnt(5)
  v_mfma_f32_16x16x32_bf16 v[224:227], v[48:51], v[80:83], v[224:227]
  ds_read_b64_tr_b16 v[42:43], v22 offset:15424
  v_mfma_f32_16x16x32_bf16 v[228:231], v[48:51], v[84:87], v[228:231]
  ds_read_b64_tr_b16 v[44:45], v23 offset:10304
  v_mfma_f32_16x16x32_bf16 v[232:235], v[52:55], v[80:83], v[232:235]
  ds_read_b64_tr_b16 v[46:47], v23 offset:15424
  v_mfma_f32_16x16x32_bf16 v[236:239], v[52:55], v[84:87], v[236:239]
  ds_read_b64_tr_b16 v[48:49], v22 offset:10368
  s_waitcnt lgkmcnt(5)
  s_waitcnt vmcnt(8)
  v_mfma_f32_16x16x32_bf16 v[160:163], v[32:35], v[88:91], v[160:163]
  ds_read_b64_tr_b16 v[50:51], v22 offset:15488
  s_setprio 1
  buffer_load_dwordx4 v[76:79], v7, s[24:27], s45 offen offset:1024 sc1
  s_waitcnt vmcnt(8)
  v_mfma_f32_16x16x32_bf16 v[164:167], v[32:35], v[92:95], v[164:167]
  ds_read_b64_tr_b16 v[52:53], v23 offset:10368
  s_add_u32 s45, s45, 14336
  v_mfma_f32_16x16x32_bf16 v[168:171], v[36:39], v[88:91], v[168:171]
  ds_read_b64_tr_b16 v[54:55], v23 offset:15488
  v_mfma_f32_16x16x32_bf16 v[172:175], v[36:39], v[92:95], v[172:175]
  ds_read_b64_tr_b16 v[32:33], v22 offset:10432
  s_waitcnt lgkmcnt(5)
  v_mfma_f32_16x16x32_bf16 v[176:179], v[40:43], v[88:91], v[176:179]
  ds_read_b64_tr_b16 v[34:35], v22 offset:15552
  v_mfma_f32_16x16x32_bf16 v[180:183], v[40:43], v[92:95], v[180:183]
  ds_read_b64_tr_b16 v[36:37], v23 offset:10432
  v_mfma_f32_16x16x32_bf16 v[184:187], v[44:47], v[88:91], v[184:187]
  ds_read_b64_tr_b16 v[38:39], v23 offset:15552
  v_mfma_f32_16x16x32_bf16 v[188:191], v[44:47], v[92:95], v[188:191]
  ds_read_b64_tr_b16 v[40:41], v22 offset:10496
  s_waitcnt lgkmcnt(5)
  v_mfma_f32_16x16x32_bf16 v[192:195], v[48:51], v[88:91], v[192:195]
  ds_read_b64_tr_b16 v[42:43], v22 offset:15616
  v_add_u32 v22, 26624, v22
  v_mfma_f32_16x16x32_bf16 v[196:199], v[48:51], v[92:95], v[196:199]
  ds_read_b64_tr_b16 v[44:45], v23 offset:10496
  v_mfma_f32_16x16x32_bf16 v[200:203], v[52:55], v[88:91], v[200:203]
  ds_read_b64_tr_b16 v[46:47], v23 offset:15616
  s_setprio 0
  v_add_u32 v23, 26624, v23
  v_mfma_f32_16x16x32_bf16 v[204:207], v[52:55], v[92:95], v[204:207]
  ds_read_b64_tr_b16 v[48:49], v22 offset:0
  s_waitcnt lgkmcnt(5)
  v_mfma_f32_16x16x32_bf16 v[208:211], v[32:35], v[88:91], v[208:211]
  ds_read_b64_tr_b16 v[50:51], v22 offset:5120
  v_mfma_f32_16x16x32_bf16 v[212:215], v[32:35], v[92:95], v[212:215]
  ds_read_b64_tr_b16 v[52:53], v23 offset:0
  v_mfma_f32_16x16x32_bf16 v[216:219], v[36:39], v[88:91], v[216:219]
  ds_read_b64_tr_b16 v[54:55], v23 offset:5120
  v_mfma_f32_16x16x32_bf16 v[220:223], v[36:39], v[92:95], v[220:223]
  ds_read_b64_tr_b16 v[32:33], v22 offset:64
  s_waitcnt lgkmcnt(5)
  v_mfma_f32_16x16x32_bf16 v[224:227], v[40:43], v[88:91], v[224:227]
  ds_read_b64_tr_b16 v[34:35], v22 offset:5184
  v_mfma_f32_16x16x32_bf16 v[228:231], v[40:43], v[92:95], v[228:231]
  ds_read_b64_tr_b16 v[36:37], v23 offset:64
  v_mfma_f32_16x16x32_bf16 v[232:235], v[44:47], v[88:91], v[232:235]
  ds_read_b64_tr_b16 v[38:39], v23 offset:5184
  v_mfma_f32_16x16x32_bf16 v[236:239], v[44:47], v[92:95], v[236:239]
  s_barrier
  ds_read_b64_tr_b16 v[40:41], v22 offset:128
  s_waitcnt lgkmcnt(5)
  s_waitcnt vmcnt(7)
  v_mfma_f32_16x16x32_bf16 v[160:163], v[48:51], v[96:99], v[160:163]
  ds_read_b64_tr_b16 v[42:43], v22 offset:5248
  s_setprio 3
  s_waitcnt vmcnt(6)
  v_mfma_f32_16x16x32_bf16 v[164:167], v[48:51], v[100:103], v[164:167]
  ds_read_b64_tr_b16 v[44:45], v23 offset:128
  v_mfma_f32_16x16x32_bf16 v[168:171], v[52:55], v[96:99], v[168:171]
  ds_read_b64_tr_b16 v[46:47], v23 offset:5248
  buffer_load_dwordx4 v[80:83], v7, s[24:27], s45 offen sc1
  v_mfma_f32_16x16x32_bf16 v[172:175], v[52:55], v[100:103], v[172:175]
  ds_read_b64_tr_b16 v[48:49], v22 offset:192
  s_waitcnt lgkmcnt(5)
  v_mfma_f32_16x16x32_bf16 v[176:179], v[32:35], v[96:99], v[176:179]
  ds_read_b64_tr_b16 v[50:51], v22 offset:5312
  v_mfma_f32_16x16x32_bf16 v[180:183], v[32:35], v[100:103], v[180:183]
  ds_read_b64_tr_b16 v[52:53], v23 offset:192
  v_mfma_f32_16x16x32_bf16 v[184:187], v[36:39], v[96:99], v[184:187]
  ds_read_b64_tr_b16 v[54:55], v23 offset:5312
  v_mfma_f32_16x16x32_bf16 v[188:191], v[36:39], v[100:103], v[188:191]
  ds_read_b64_tr_b16 v[32:33], v22 offset:256
  s_waitcnt lgkmcnt(5)
  v_mfma_f32_16x16x32_bf16 v[192:195], v[40:43], v[96:99], v[192:195]
  ds_read_b64_tr_b16 v[34:35], v22 offset:5376
  buffer_load_dwordx4 v[84:87], v7, s[24:27], s45 offen offset:1024 sc1
  v_mfma_f32_16x16x32_bf16 v[196:199], v[40:43], v[100:103], v[196:199]
  ds_read_b64_tr_b16 v[36:37], v23 offset:256
  s_add_u32 s45, s45, 14336
  v_mfma_f32_16x16x32_bf16 v[200:203], v[44:47], v[96:99], v[200:203]
  ds_read_b64_tr_b16 v[38:39], v23 offset:5376
  s_setprio 2
  v_mfma_f32_16x16x32_bf16 v[204:207], v[44:47], v[100:103], v[204:207]
  ds_read_b64_tr_b16 v[40:41], v22 offset:10240
  s_waitcnt lgkmcnt(5)
  v_mfma_f32_16x16x32_bf16 v[208:211], v[48:51], v[96:99], v[208:211]
  ds_read_b64_tr_b16 v[42:43], v22 offset:15360
  v_mfma_f32_16x16x32_bf16 v[212:215], v[48:51], v[100:103], v[212:215]
  ds_read_b64_tr_b16 v[44:45], v23 offset:10240
  v_mfma_f32_16x16x32_bf16 v[216:219], v[52:55], v[96:99], v[216:219]
  ds_read_b64_tr_b16 v[46:47], v23 offset:15360
  buffer_load_dwordx4 v[88:91], v7, s[24:27], s45 offen sc1
  v_mfma_f32_16x16x32_bf16 v[220:223], v[52:55], v[100:103], v[220:223]
  ds_read_b64_tr_b16 v[48:49], v22 offset:10304
  s_waitcnt lgkmcnt(5)
  v_mfma_f32_16x16x32_bf16 v[224:227], v[32:35], v[96:99], v[224:227]
  ds_read_b64_tr_b16 v[50:51], v22 offset:15424
  v_mfma_f32_16x16x32_bf16 v[228:231], v[32:35], v[100:103], v[228:231]
  ds_read_b64_tr_b16 v[52:53], v23 offset:10304
  v_mfma_f32_16x16x32_bf16 v[232:235], v[36:39], v[96:99], v[232:235]
  ds_read_b64_tr_b16 v[54:55], v23 offset:15424
  v_mfma_f32_16x16x32_bf16 v[236:239], v[36:39], v[100:103], v[236:239]
  ds_read_b64_tr_b16 v[32:33], v22 offset:10368
  s_waitcnt lgkmcnt(5)
  s_waitcnt vmcnt(8)
  v_mfma_f32_16x16x32_bf16 v[160:163], v[40:43], v[104:107], v[160:163]
  ds_read_b64_tr_b16 v[34:35], v22 offset:15488
  s_setprio 1
  buffer_load_dwordx4 v[92:95], v7, s[24:27], s45 offen offset:1024 sc1
  s_waitcnt vmcnt(8)
  v_mfma_f32_16x16x32_bf16 v[164:167], v[40:43], v[108:111], v[164:167]
  ds_read_b64_tr_b16 v[36:37], v23 offset:10368
  s_add_u32 s45, s45, 14336
  v_mfma_f32_16x16x32_bf16 v[168:171], v[44:47], v[104:107], v[168:171]
  ds_read_b64_tr_b16 v[38:39], v23 offset:15488
  v_mfma_f32_16x16x32_bf16 v[172:175], v[44:47], v[108:111], v[172:175]
  ds_read_b64_tr_b16 v[40:41], v22 offset:10432
  s_waitcnt lgkmcnt(5)
  v_mfma_f32_16x16x32_bf16 v[176:179], v[48:51], v[104:107], v[176:179]
  ds_read_b64_tr_b16 v[42:43], v22 offset:15552
  v_mfma_f32_16x16x32_bf16 v[180:183], v[48:51], v[108:111], v[180:183]
  ds_read_b64_tr_b16 v[44:45], v23 offset:10432
  v_mfma_f32_16x16x32_bf16 v[184:187], v[52:55], v[104:107], v[184:187]
  ds_read_b64_tr_b16 v[46:47], v23 offset:15552
  v_mfma_f32_16x16x32_bf16 v[188:191], v[52:55], v[108:111], v[188:191]
  ds_read_b64_tr_b16 v[48:49], v22 offset:10496
  s_waitcnt lgkmcnt(5)
  v_mfma_f32_16x16x32_bf16 v[192:195], v[32:35], v[104:107], v[192:195]
  ds_read_b64_tr_b16 v[50:51], v22 offset:15616
  v_add_u32 v22, s40, v22
  v_mfma_f32_16x16x32_bf16 v[196:199], v[32:35], v[108:111], v[196:199]
  ds_read_b64_tr_b16 v[52:53], v23 offset:10496
  v_mfma_f32_16x16x32_bf16 v[200:203], v[36:39], v[104:107], v[200:203]
  ds_read_b64_tr_b16 v[54:55], v23 offset:15616
  s_setprio 0
  v_add_u32 v23, s40, v23
  v_mfma_f32_16x16x32_bf16 v[204:207], v[36:39], v[108:111], v[204:207]
  ds_read_b64_tr_b16 v[32:33], v22 offset:0
  s_waitcnt lgkmcnt(5)
  v_mfma_f32_16x16x32_bf16 v[208:211], v[40:43], v[104:107], v[208:211]
  ds_read_b64_tr_b16 v[34:35], v22 offset:5120
  v_mfma_f32_16x16x32_bf16 v[212:215], v[40:43], v[108:111], v[212:215]
  ds_read_b64_tr_b16 v[36:37], v23 offset:0
  v_mfma_f32_16x16x32_bf16 v[216:219], v[44:47], v[104:107], v[216:219]
  ds_read_b64_tr_b16 v[38:39], v23 offset:5120
  v_mfma_f32_16x16x32_bf16 v[220:223], v[44:47], v[108:111], v[220:223]
  ds_read_b64_tr_b16 v[40:41], v22 offset:64
  s_sub_u32 s40, 4294860800, s40
  s_waitcnt lgkmcnt(5)
  v_mfma_f32_16x16x32_bf16 v[224:227], v[48:51], v[104:107], v[224:227]
  ds_read_b64_tr_b16 v[42:43], v22 offset:5184
  s_sub_u32 s39, s39, 1
  v_mfma_f32_16x16x32_bf16 v[228:231], v[48:51], v[108:111], v[228:231]
  ds_read_b64_tr_b16 v[44:45], v23 offset:64
  v_mfma_f32_16x16x32_bf16 v[232:235], v[52:55], v[104:107], v[232:235]
  ds_read_b64_tr_b16 v[46:47], v23 offset:5184
  s_cmp_gt_u32 s39, 1
  v_mfma_f32_16x16x32_bf16 v[236:239], v[52:55], v[108:111], v[236:239]
  s_cbranch_scc1 L_oloop
L_otail:
  s_barrier
  v_mov_b32 v14, v22
  v_mov_b32 v15, v23
  ds_read_b64_tr_b16 v[48:49], v14 offset:128
  s_add_u32 s38, s40, 53248
  s_waitcnt lgkmcnt(5)
  s_waitcnt vmcnt(7)
  v_mfma_f32_16x16x32_bf16 v[160:163], v[32:35], v[64:67], v[160:163]
  ds_read_b64_tr_b16 v[50:51], v14 offset:5248
  s_setprio 3
  v_add_u32 v16, 53248, v22
  s_waitcnt vmcnt(6)
  v_mfma_f32_16x16x32_bf16 v[164:167], v[32:35], v[68:71], v[164:167]
  ds_read_b64_tr_b16 v[52:53], v15 offset:128
  v_add_u32 v17, 53248, v23
  v_mfma_f32_16x16x32_bf16 v[168:171], v[36:39], v[64:67], v[168:171]
  ds_read_b64_tr_b16 v[54:55], v15 offset:5248
  v_add_u32 v22, s38, v22
  buffer_load_dwordx4 v[96:99], v7, s[24:27], s45 offen sc1
  v_mfma_f32_16x16x32_bf16 v[172:175], v[36:39], v[68:71], v[172:175]
  ds_read_b64_tr_b16 v[32:33], v14 offset:192
  v_add_u32 v23, s38, v23
  s_waitcnt lgkmcnt(5)
  v_mfma_f32_16x16x32_bf16 v[176:179], v[40:43], v[64:67], v[176:179]
  ds_read_b64_tr_b16 v[34:35], v14 offset:5312
  v_add_u32 v12, 53248, v22
  v_mfma_f32_16x16x32_bf16 v[180:183], v[40:43], v[68:71], v[180:183]
  ds_read_b64_tr_b16 v[36:37], v15 offset:192
  v_add_u32 v13, 53248, v23
  v_mfma_f32_16x16x32_bf16 v[184:187], v[44:47], v[64:67], v[184:187]
  ds_read_b64_tr_b16 v[38:39], v15 offset:5312
  v_mfma_f32_16x16x32_bf16 v[188:191], v[44:47], v[68:71], v[188:191]
  ds_read_b64_tr_b16 v[40:41], v14 offset:10240
  s_setprio 2
  s_waitcnt lgkmcnt(5)
  v_mfma_f32_16x16x32_bf16 v[192:195], v[48:51], v[64:67], v[192:195]
  ds_read_b64_tr_b16 v[42:43], v14 offset:15360
  buffer_load_dwordx4 v[100:103], v7, s[24:27], s45 offen offset:1024 sc1
  v_mfma_f32_16x16x32_bf16 v[196:199], v[48:51], v[68:71], v[196:199]
  ds_read_b64_tr_b16 v[44:45], v15 offset:10240
  s_add_u32 s45, s45, 14336
  v_mfma_f32_16x16x32_bf16 v[200:203], v[52:55], v[64:67], v[200:203]
  ds_read_b64_tr_b16 v[46:47], v15 offset:15360
  v_mfma_f32_16x16x32_bf16 v[204:207], v[52:55], v[68:71], v[204:207]
  ds_read_b64_tr_b16 v[48:49], v14 offset:10304
  s_waitcnt lgkmcnt(5)
  v_mfma_f32_16x16x32_bf16 v[208:211], v[32:35], v[64:67], v[208:211]
  ds_read_b64_tr_b16 v[50:51], v14 offset:15424
  v_mfma_f32_16x16x32_bf16 v[212:215], v[32:35], v[68:71], v[212:215]
  ds_read_b64_tr_b16 v[52:53], v15 offset:10304
  v_mfma_f32_16x16x32_bf16 v[216:219], v[36:39], v[64:67], v[216:219]
  ds_read_b64_tr_b16 v[54:55], v15 offset:15424
  buffer_load_dwordx4 v[104:107], v7, s[24:27], s45 offen sc1
  v_mfma_f32_16x16x32_bf16 v[220:223], v[36:39], v[68:71], v[220:223]
  ds_read_b64_tr_b16 v[32:33], v14 offset:10368
  s_setprio 1
  s_waitcnt lgkmcnt(5)
  s_waitcnt vmcnt(8)
  v_mfma_f32_16x16x32_bf16 v[160:163], v[40:43], v[72:75], v[160:163]
  ds_read_b64_tr_b16 v[34:35], v14 offset:15488
  s_waitcnt vmcnt(7)
  v_mfma_f32_16x16x32_bf16 v[164:167], v[40:43], v[76:79], v[164:167]
  ds_read_b64_tr_b16 v[36:37], v15 offset:10368
  v_mfma_f32_16x16x32_bf16 v[168:171], v[44:47], v[72:75], v[168:171]
  ds_read_b64_tr_b16 v[38:39], v15 offset:15488
  v_mfma_f32_16x16x32_bf16 v[172:175], v[44:47], v[76:79], v[172:175]
  ds_read_b64_tr_b16 v[40:41], v14 offset:10432
  s_waitcnt lgkmcnt(5)
  v_mfma_f32_16x16x32_bf16 v[176:179], v[48:51], v[72:75], v[176:179]
  ds_read_b64_tr_b16 v[42:43], v14 offset:15552
  buffer_load_dwordx4 v[108:111], v7, s[24:27], s45 offen offset:1024 sc1
  v_mfma_f32_16x16x32_bf16 v[180:183], v[48:51], v[76:79], v[180:183]
  ds_read_b64_tr_b16 v[44:45], v15 offset:10432
  s_add_u32 s45, s45, 14336
  v_mfma_f32_16x16x32_bf16 v[184:187], v[52:55], v[72:75], v[184:187]
  ds_read_b64_tr_b16 v[46:47], v15 offset:15552
  v_mfma_f32_16x16x32_bf16 v[188:191], v[52:55], v[76:79], v[188:191]
  ds_read_b64_tr_b16 v[48:49], v14 offset:26624
  s_setprio 0
  s_waitcnt lgkmcnt(5)
  v_mfma_f32_16x16x32_bf16 v[192:195], v[32:35], v[72:75], v[192:195]
  ds_read_b64_tr_b16 v[50:51], v14 offset:31744
  v_mfma_f32_16x16x32_bf16 v[196:199], v[32:35], v[76:79], v[196:199]
  ds_read_b64_tr_b16 v[52:53], v15 offset:26624
  v_mfma_f32_16x16x32_bf16 v[200:203], v[36:39], v[72:75], v[200:203]
  ds_read_b64_tr_b16 v[54:55], v15 offset:31744
  v_mfma_f32_16x16x32_bf16 v[204:207], v[36:39], v[76:79], v[204:207]
  ds_read_b64_tr_b16 v[32:33], v14 offset:26688
  s_waitcnt lgkmcnt(5)
  v_mfma_f32_16x16x32_bf16 v[208:211], v[40:43], v[72:75], v[208:211]
  ds_read_b64_tr_b16 v[34:35], v14 offset:31808
  v_mfma_f32_16x16x32_bf16 v[212:215], v[40:43], v[76:79], v[212:215]
  ds_read_b64_tr_b16 v[36:37], v15 offset:26688
  v_mfma_f32_16x16x32_bf16 v[216:219], v[44:47], v[72:75], v[216:219]
  ds_read_b64_tr_b16 v[38:39], v15 offset:31808
  v_mfma_f32_16x16x32_bf16 v[220:223], v[44:47], v[76:79], v[220:223]
  s_barrier
  ds_read_b64_tr_b16 v[40:41], v14 offset:26752
  s_and_b32 s38, s67, 15
  s_waitcnt lgkmcnt(5)
  s_waitcnt vmcnt(7)
  v_mfma_f32_16x16x32_bf16 v[160:163], v[48:51], v[80:83], v[160:163]
  ds_read_b64_tr_b16 v[42:43], v14 offset:31872
  s_setprio 3
  s_mul_i32 s38, s38, 172032
  s_waitcnt vmcnt(6)
  v_mfma_f32_16x16x32_bf16 v[164:167], v[48:51], v[84:87], v[164:167]
  ds_read_b64_tr_b16 v[44:45], v15 offset:26752
  s_add_u32 s45, s65, s38
  v_mfma_f32_16x16x32_bf16 v[168:171], v[52:55], v[80:83], v[168:171]
  ds_read_b64_tr_b16 v[46:47], v15 offset:31872
  v_mfma_f32_16x16x32_bf16 v[172:175], v[52:55], v[84:87], v[172:175]
  ds_read_b64_tr_b16 v[48:49], v14 offset:26816
  buffer_load_dwordx4 v[112:115], v7, s[24:27], s45 offen sc1
  s_waitcnt lgkmcnt(5)
  v_mfma_f32_16x16x32_bf16 v[176:179], v[32:35], v[80:83], v[176:179]
  ds_read_b64_tr_b16 v[50:51], v14 offset:31936
  v_mfma_f32_16x16x32_bf16 v[180:183], v[32:35], v[84:87], v[180:183]
  ds_read_b64_tr_b16 v[52:53], v15 offset:26816
  v_mfma_f32_16x16x32_bf16 v[184:187], v[36:39], v[80:83], v[184:187]
  ds_read_b64_tr_b16 v[54:55], v15 offset:31936
  v_mfma_f32_16x16x32_bf16 v[188:191], v[36:39], v[84:87], v[188:191]
  ds_read_b64_tr_b16 v[32:33], v14 offset:36864
  s_setprio 2
  s_waitcnt lgkmcnt(5)
  v_mfma_f32_16x16x32_bf16 v[192:195], v[40:43], v[80:83], v[192:195]
  ds_read_b64_tr_b16 v[34:35], v14 offset:41984
  buffer_load_dwordx4 v[116:119], v7, s[24:27], s45 offen offset:1024 sc1
  v_mfma_f32_16x16x32_bf16 v[196:199], v[40:43], v[84:87], v[196:199]
  ds_read_b64_tr_b16 v[36:37], v15 offset:36864
  s_add_u32 s45, s45, 14336
  v_mfma_f32_16x16x32_bf16 v[200:203], v[44:47], v[80:83], v[200:203]
  ds_read_b64_tr_b16 v[38:39], v15 offset:41984
  v_mfma_f32_16x16x32_bf16 v[204:207], v[44:47], v[84:87], v[204:207]
  ds_read_b64_tr_b16 v[40:41], v14 offset:36928
  s_waitcnt lgkmcnt(5)
  v_mfma_f32_16x16x32_bf16 v[208:211], v[48:51], v[80:83], v[208:211]
  ds_read_b64_tr_b16 v[42:43], v14 offset:42048
  v_mfma_f32_16x16x32_bf16 v[212:215], v[48:51], v[84:87], v[212:215]
  ds_read_b64_tr_b16 v[44:45], v15 offset:36928
  buffer_load_dwordx4 v[120:123], v7, s[24:27], s45 offen sc1
  v_mfma_f32_16x16x32_bf16 v[216:219], v[52:55], v[80:83], v[216:219]
  ds_read_b64_tr_b16 v[46:47], v15 offset:42048
  v_mfma_f32_16x16x32_bf16 v[220:223], v[52:55], v[84:87], v[220:223]
  ds_read_b64_tr_b16 v[48:49], v14 offset:36992
  s_setprio 1
  s_waitcnt lgkmcnt(5)
  s_waitcnt vmcnt(8)
  v_mfma_f32_16x16x32_bf16 v[160:163], v[32:35], v[88:91], v[160:163]
  ds_read_b64_tr_b16 v[50:51], v14 offset:42112
  s_waitcnt vmcnt(7)
  v_mfma_f32_16x16x32_bf16 v[164:167], v[32:35], v[92:95], v[164:167]
  ds_read_b64_tr_b16 v[52:53], v15 offset:36992
  v_mfma_f32_16x16x32_bf16 v[168:171], v[36:39], v[88:91], v[168:171]
  ds_read_b64_tr_b16 v[54:55], v15 offset:42112
  buffer_load_dwordx4 v[124:127], v7, s[24:27], s45 offen offset:1024 sc1
  v_mfma_f32_16x16x32_bf16 v[172:175], v[36:39], v[92:95], v[172:175]
  ds_read_b64_tr_b16 v[32:33], v14 offset:37056
  s_add_u32 s45, s45, 14336
  s_waitcnt lgkmcnt(5)
  v_mfma_f32_16x16x32_bf16 v[176:179], v[40:43], v[88:91], v[176:179]
  ds_read_b64_tr_b16 v[34:35], v14 offset:42176
  v_mfma_f32_16x16x32_bf16 v[180:183], v[40:43], v[92:95], v[180:183]
  ds_read_b64_tr_b16 v[36:37], v15 offset:37056
  v_mfma_f32_16x16x32_bf16 v[184:187], v[44:47], v[88:91], v[184:187]
  ds_read_b64_tr_b16 v[38:39], v15 offset:42176
  v_mfma_f32_16x16x32_bf16 v[188:191], v[44:47], v[92:95], v[188:191]
  ds_read_b64_tr_b16 v[40:41], v16 offset:0
  s_setprio 0
  s_waitcnt lgkmcnt(5)
  v_mfma_f32_16x16x32_bf16 v[192:195], v[48:51], v[88:91], v[192:195]
  ds_read_b64_tr_b16 v[42:43], v16 offset:5120
  buffer_load_dwordx4 v[128:131], v7, s[24:27], s45 offen sc1
  v_mfma_f32_16x16x32_bf16 v[196:199], v[48:51], v[92:95], v[196:199]
  ds_read_b64_tr_b16 v[44:45], v17 offset:0
  v_mfma_f32_16x16x32_bf16 v[200:203], v[52:55], v[88:91], v[200:203]
  ds_read_b64_tr_b16 v[46:47], v17 offset:5120
  v_mfma_f32_16x16x32_bf16 v[204:207], v[52:55], v[92:95], v[204:207]
  ds_read_b64_tr_b16 v[48:49], v16 offset:64
  s_waitcnt lgkmcnt(5)
  v_mfma_f32_16x16x32_bf16 v[208:211], v[32:35], v[88:91], v[208:211]
  ds_read_b64_tr_b16 v[50:51], v16 offset:5184
  v_mfma_f32_16x16x32_bf16 v[212:215], v[32:35], v[92:95], v[212:215]
  ds_read_b64_tr_b16 v[52:53], v17 offset:64
  buffer_load_dwordx4 v[132:135], v7, s[24:27], s45 offen offset:1024 sc1
  v_mfma_f32_16x16x32_bf16 v[216:219], v[36:39], v[88:91], v[216:219]
  ds_read_b64_tr_b16 v[54:55], v17 offset:5184
  s_add_u32 s45, s45, 14336
  v_mfma_f32_16x16x32_bf16 v[220:223], v[36:39], v[92:95], v[220:223]
  s_barrier
  ds_read_b64_tr_b16 v[32:33], v16 offset:128
  s_waitcnt lgkmcnt(5)
  s_waitcnt vmcnt(9)
  v_mfma_f32_16x16x32_bf16 v[160:163], v[40:43], v[96:99], v[160:163]
  ds_read_b64_tr_b16 v[34:35], v16 offset:5248
  s_setprio 3
  s_waitcnt vmcnt(8)
  v_mfma_f32_16x16x32_bf16 v[164:167], v[40:43], v[100:103], v[164:167]
  ds_read_b64_tr_b16 v[36:37], v17 offset:128
  v_mfma_f32_16x16x32_bf16 v[168:171], v[44:47], v[96:99], v[168:171]
  ds_read_b64_tr_b16 v[38:39], v17 offset:5248
  buffer_load_dwordx4 v[136:139], v7, s[24:27], s45 offen sc1
  v_mfma_f32_16x16x32_bf16 v[172:175], v[44:47], v[100:103], v[172:175]
  ds_read_b64_tr_b16 v[40:41], v16 offset:192
  s_waitcnt lgkmcnt(5)
  v_mfma_f32_16x16x32_bf16 v[176:179], v[48:51], v[96:99], v[176:179]
  ds_read_b64_tr_b16 v[42:43], v16 offset:5312
  v_mfma_f32_16x16x32_bf16 v[180:183], v[48:51], v[100:103], v[180:183]
  ds_read_b64_tr_b16 v[44:45], v17 offset:192
  s_setprio 2
  v_mfma_f32_16x16x32_bf16 v[184:187], v[52:55], v[96:99], v[184:187]
  ds_read_b64_tr_b16 v[46:47], v17 offset:5312
  v_mfma_f32_16x16x32_bf16 v[188:191], v[52:55], v[100:103], v[188:191]
  ds_read_b64_tr_b16 v[48:49], v16 offset:10240
  buffer_load_dwordx4 v[140:143], v7, s[24:27], s45 offen offset:1024 sc1
  s_waitcnt lgkmcnt(5)
  v_mfma_f32_16x16x32_bf16 v[192:195], v[32:35], v[96:99], v[192:195]
  ds_read_b64_tr_b16 v[50:51], v16 offset:15360
  s_add_u32 s45, s45, 14336
  v_mfma_f32_16x16x32_bf16 v[196:199], v[32:35], v[100:103], v[196:199]
  ds_read_b64_tr_b16 v[52:53], v17 offset:10240
  v_mfma_f32_16x16x32_bf16 v[200:203], v[36:39], v[96:99], v[200:203]
  ds_read_b64_tr_b16 v[54:55], v17 offset:15360
  v_mfma_f32_16x16x32_bf16 v[204:207], v[36:39], v[100:103], v[204:207]
  ds_read_b64_tr_b16 v[32:33], v16 offset:10304
  s_setprio 1
  s_waitcnt lgkmcnt(5)
  v_mfma_f32_16x16x32_bf16 v[208:211], v[40:43], v[96:99], v[208:211]
  ds_read_b64_tr_b16 v[34:35], v16 offset:15424
  v_mfma_f32_16x16x32_bf16 v[212:215], v[40:43], v[100:103], v[212:215]
  ds_read_b64_tr_b16 v[36:37], v17 offset:10304
  buffer_load_dwordx4 v[144:147], v7, s[24:27], s45 offen sc1
  v_mfma_f32_16x16x32_bf16 v[216:219], v[44:47], v[96:99], v[216:219]
  ds_read_b64_tr_b16 v[38:39], v17 offset:15424
  v_mfma_f32_16x16x32_bf16 v[220:223], v[44:47], v[100:103], v[220:223]
  ds_read_b64_tr_b16 v[40:41], v16 offset:10368
  s_waitcnt lgkmcnt(5)
  s_waitcnt vmcnt(10)
  v_mfma_f32_16x16x32_bf16 v[160:163], v[48:51], v[104:107], v[160:163]
  ds_read_b64_tr_b16 v[42:43], v16 offset:15488
  s_waitcnt vmcnt(9)
  v_mfma_f32_16x16x32_bf16 v[164:167], v[48:51], v[108:111], v[164:167]
  ds_read_b64_tr_b16 v[44:45], v17 offset:10368
  s_setprio 0
  v_mfma_f32_16x16x32_bf16 v[168:171], v[52:55], v[104:107], v[168:171]
  ds_read_b64_tr_b16 v[46:47], v17 offset:15488
  buffer_load_dwordx4 v[148:151], v7, s[24:27], s45 offen offset:1024 sc1
  v_mfma_f32_16x16x32_bf16 v[172:175], v[52:55], v[108:111], v[172:175]
  ds_read_b64_tr_b16 v[48:49], v16 offset:10432
  s_add_u32 s45, s45, 14336
  s_waitcnt lgkmcnt(5)
  v_mfma_f32_16x16x32_bf16 v[176:179], v[32:35], v[104:107], v[176:179]
  ds_read_b64_tr_b16 v[50:51], v16 offset:15552
  v_mfma_f32_16x16x32_bf16 v[180:183], v[32:35], v[108:111], v[180:183]
  ds_read_b64_tr_b16 v[52:53], v17 offset:10432
  v_mfma_f32_16x16x32_bf16 v[184:187], v[36:39], v[104:107], v[184:187]
  ds_read_b64_tr_b16 v[54:55], v17 offset:15552
  v_mfma_f32_16x16x32_bf16 v[188:191], v[36:39], v[108:111], v[188:191]
  s_barrier
  ds_read_b64_tr_b16 v[32:33], v22 offset:0
  buffer_load_dwordx4 v[152:155], v7, s[24:27], s45 offen sc1
  s_waitcnt lgkmcnt(5)
  v_mfma_f32_16x16x32_bf16 v[192:195], v[40:43], v[104:107], v[192:195]
  ds_read_b64_tr_b16 v[34:35], v22 offset:5120
  s_setprio 3
  v_mfma_f32_16x16x32_bf16 v[196:199], v[40:43], v[108:111], v[196:199]
  ds_read_b64_tr_b16 v[36:37], v22 offset:10240
  v_mfma_f32_16x16x32_bf16 v[200:203], v[44:47], v[104:107], v[200:203]
  ds_read_b64_tr_b16 v[38:39], v22 offset:15360
  v_mfma_f32_16x16x32_bf16 v[204:207], v[44:47], v[108:111], v[204:207]
  ds_read_b64_tr_b16 v[40:41], v22 offset:26624
  s_waitcnt lgkmcnt(5)
  v_mfma_f32_16x16x32_bf16 v[208:211], v[48:51], v[104:107], v[208:211]
  ds_read_b64_tr_b16 v[42:43], v22 offset:31744
  buffer_load_dwordx4 v[156:159], v7, s[24:27], s45 offen offset:1024 sc1
  v_mfma_f32_16x16x32_bf16 v[212:215], v[48:51], v[108:111], v[212:215]
  ds_read_b64_tr_b16 v[44:45], v22 offset:36864
  s_add_u32 s45, s45, 14336
  v_mfma_f32_16x16x32_bf16 v[216:219], v[52:55], v[104:107], v[216:219]
  ds_read_b64_tr_b16 v[46:47], v22 offset:41984
  v_mfma_f32_16x16x32_bf16 v[220:223], v[52:55], v[108:111], v[220:223]
  ds_read_b64_tr_b16 v[48:49], v23 offset:0
  s_setprio 2
  s_waitcnt lgkmcnt(5)
  s_waitcnt vmcnt(11)
  v_mfma_f32_16x16x32_bf16 v[160:163], v[32:35], v[112:115], v[160:163]
  ds_read_b64_tr_b16 v[50:51], v23 offset:5120
  s_waitcnt vmcnt(10)
  v_mfma_f32_16x16x32_bf16 v[164:167], v[32:35], v[116:119], v[164:167]
  ds_read_b64_tr_b16 v[52:53], v23 offset:10240
  s_waitcnt vmcnt(9)
  v_mfma_f32_16x16x32_bf16 v[160:163], v[36:39], v[120:123], v[160:163]
  ds_read_b64_tr_b16 v[54:55], v23 offset:15360
  s_waitcnt vmcnt(8)
  v_mfma_f32_16x16x32_bf16 v[164:167], v[36:39], v[124:127], v[164:167]
  ds_read_b64_tr_b16 v[32:33], v23 offset:26624
  s_waitcnt lgkmcnt(5)
  s_waitcnt vmcnt(7)
  v_mfma_f32_16x16x32_bf16 v[160:163], v[40:43], v[128:131], v[160:163]
  ds_read_b64_tr_b16 v[34:35], v23 offset:31744
  s_waitcnt vmcnt(6)
  v_mfma_f32_16x16x32_bf16 v[164:167], v[40:43], v[132:135], v[164:167]
  ds_read_b64_tr_b16 v[36:37], v23 offset:36864
  s_waitcnt vmcnt(5)
  v_mfma_f32_16x16x32_bf16 v[160:163], v[44:47], v[136:139], v[160:163]
  ds_read_b64_tr_b16 v[38:39], v23 offset:41984
  s_waitcnt vmcnt(4)
  v_mfma_f32_16x16x32_bf16 v[164:167], v[44:47], v[140:143], v[164:167]
  ds_read_b64_tr_b16 v[40:41], v22 offset:64
  s_setprio 1
  s_waitcnt lgkmcnt(5)
  v_mfma_f32_16x16x32_bf16 v[168:171], v[48:51], v[112:115], v[168:171]
  ds_read_b64_tr_b16 v[42:43], v22 offset:5184
  v_mfma_f32_16x16x32_bf16 v[172:175], v[48:51], v[116:119], v[172:175]
  ds_read_b64_tr_b16 v[44:45], v22 offset:10304
  v_mfma_f32_16x16x32_bf16 v[168:171], v[52:55], v[120:123], v[168:171]
  ds_read_b64_tr_b16 v[46:47], v22 offset:15424
  v_mfma_f32_16x16x32_bf16 v[172:175], v[52:55], v[124:127], v[172:175]
  ds_read_b64_tr_b16 v[48:49], v22 offset:26688
  s_waitcnt lgkmcnt(5)
  v_mfma_f32_16x16x32_bf16 v[168:171], v[32:35], v[128:131], v[168:171]
  ds_read_b64_tr_b16 v[50:51], v22 offset:31808
  v_mfma_f32_16x16x32_bf16 v[172:175], v[32:35], v[132:135], v[172:175]
  ds_read_b64_tr_b16 v[52:53], v22 offset:36928
  v_mfma_f32_16x16x32_bf16 v[168:171], v[36:39], v[136:139], v[168:171]
  ds_read_b64_tr_b16 v[54:55], v22 offset:42048
  v_mfma_f32_16x16x32_bf16 v[172:175], v[36:39], v[140:143], v[172:175]
  ds_read_b64_tr_b16 v[32:33], v23 offset:64
  s_setprio 0
  s_waitcnt lgkmcnt(5)
  v_mfma_f32_16x16x32_bf16 v[176:179], v[40:43], v[112:115], v[176:179]
  ds_read_b64_tr_b16 v[34:35], v23 offset:5184
  v_mfma_f32_16x16x32_bf16 v[180:183], v[40:43], v[116:119], v[180:183]
  ds_read_b64_tr_b16 v[36:37], v23 offset:10304
  v_mfma_f32_16x16x32_bf16 v[176:179], v[44:47], v[120:123], v[176:179]
  ds_read_b64_tr_b16 v[38:39], v23 offset:15424
  v_and_b32 v1, 1023, v7
  v_mfma_f32_16x16x32_bf16 v[180:183], v[44:47], v[124:127], v[180:183]
  ds_read_b64_tr_b16 v[40:41], v23 offset:26688
  s_mul_i32 s45, s3, 10240
  s_waitcnt lgkmcnt(5)
  v_mfma_f32_16x16x32_bf16 v[176:179], v[48:51], v[128:131], v[176:179]
  ds_read_b64_tr_b16 v[42:43], v23 offset:31808
  s_add_u32 s45, s45, 50331648
  v_mfma_f32_16x16x32_bf16 v[180:183], v[48:51], v[132:135], v[180:183]
  ds_read_b64_tr_b16 v[44:45], v23 offset:36928
  s_mul_i32 s46, s2, 71680
  v_mfma_f32_16x16x32_bf16 v[176:179], v[52:55], v[136:139], v[176:179]
  ds_read_b64_tr_b16 v[46:47], v23 offset:42048
  s_add_u32 s46, s46, s45
  v_mfma_f32_16x16x32_bf16 v[180:183], v[52:55], v[140:143], v[180:183]
  s_barrier
  ds_read_b64_tr_b16 v[48:49], v12 offset:0
  v_lshrrev_b32 v2, 4, v1
  s_waitcnt lgkmcnt(5)
  v_mfma_f32_16x16x32_bf16 v[184:187], v[32:35], v[112:115], v[184:187]
  ds_read_b64_tr_b16 v[50:51], v12 offset:5120
  s_setprio 3
  v_and_b32 v3, 15, v2
  v_mfma_f32_16x16x32_bf16 v[188:191], v[32:35], v[116:119], v[188:191]
  ds_read_b64_tr_b16 v[52:53], v12 offset:10240
  v_mul_u32_u24 v3, 2560, v3
  v_mfma_f32_16x16x32_bf16 v[184:187], v[36:39], v[120:123], v[184:187]
  ds_read_b64_tr_b16 v[54:55], v12 offset:15360
  v_lshrrev_b32 v2, 4, v2
  v_mfma_f32_16x16x32_bf16 v[188:191], v[36:39], v[124:127], v[188:191]
  ds_read_b64_tr_b16 v[32:33], v13 offset:0
  v_lshl_add_u32 v2, v2, 3, v3
  s_waitcnt lgkmcnt(5)
  v_mfma_f32_16x16x32_bf16 v[184:187], v[40:43], v[128:131], v[184:187]
  ds_read_b64_tr_b16 v[34:35], v13 offset:5120
  s_mul_i32 s40, s33, 573440
  v_mfma_f32_16x16x32_bf16 v[188:191], v[40:43], v[132:135], v[188:191]
  ds_read_b64_tr_b16 v[36:37], v13 offset:10240
  s_mul_i32 s41, s3, 81920
  v_mfma_f32_16x16x32_bf16 v[184:187], v[44:47], v[136:139], v[184:187]
  ds_read_b64_tr_b16 v[38:39], v13 offset:15360
  s_add_u32 s40, s40, s41
  v_mfma_f32_16x16x32_bf16 v[188:191], v[44:47], v[140:143], v[188:191]
  ds_read_b64_tr_b16 v[40:41], v12 offset:64
  s_mul_i32 s41, s32, 1280
  s_waitcnt lgkmcnt(5)
  s_waitcnt vmcnt(3)
  v_mfma_f32_16x16x32_bf16 v[160:163], v[48:51], v[144:147], v[160:163]
  ds_read_b64_tr_b16 v[42:43], v12 offset:5184
  s_add_u32 s40, s40, s41
  s_waitcnt vmcnt(2)
  v_mfma_f32_16x16x32_bf16 v[164:167], v[48:51], v[148:151], v[164:167]
  ds_read_b64_tr_b16 v[44:45], v12 offset:10304
  s_mul_i32 s41, s35, 320
  s_waitcnt vmcnt(1)
  v_mfma_f32_16x16x32_bf16 v[160:163], v[52:55], v[152:155], v[160:163]
  ds_read_b64_tr_b16 v[46:47], v12 offset:15424
  s_add_u32 s40, s40, s41
  s_waitcnt vmcnt(0)
  v_mfma_f32_16x16x32_bf16 v[164:167], v[52:55], v[156:159], v[164:167]
  ds_read_b64_tr_b16 v[48:49], v13 offset:64
  s_mov_b32 s43, 0xffff0000
  s_waitcnt lgkmcnt(5)
  v_mfma_f32_16x16x32_bf16 v[168:171], v[32:35], v[144:147], v[168:171]
  ds_read_b64_tr_b16 v[50:51], v13 offset:5184
  v_cvt_pk_bf16_f32 v240, v160, v161
  v_cvt_pk_bf16_f32 v241, v162, v163
  v_mfma_f32_16x16x32_bf16 v[172:175], v[32:35], v[148:151], v[172:175]
  ds_read_b64_tr_b16 v[52:53], v13 offset:10304
  v_cvt_pk_bf16_f32 v242, v164, v165
  v_cvt_pk_bf16_f32 v243, v166, v167
  v_mfma_f32_16x16x32_bf16 v[168:171], v[36:39], v[152:155], v[168:171]
  ds_read_b64_tr_b16 v[54:55], v13 offset:15424
  v_mfma_f32_16x16x32_bf16 v[172:175], v[36:39], v[156:159], v[172:175]
  ds_read_b64_tr_b16 v[32:33], v22 offset:128
  s_waitcnt lgkmcnt(5)
  v_mfma_f32_16x16x32_bf16 v[176:179], v[40:43], v[144:147], v[176:179]
  ds_read_b64_tr_b16 v[34:35], v22 offset:5248
  s_add_u32 s47, s50, 0
  s_cmp_ge_u32 s47, 10
  s_cselect_b32 s38, 10, 0
  s_sub_u32 s47, s47, s38
  s_lshl_b32 s47, s47, 10
  s_add_u32 s47, s47, s46
  v_cvt_pk_bf16_f32 v244, v168, v169
  v_cvt_pk_bf16_f32 v245, v170, v171
  v_mfma_f32_16x16x32_bf16 v[180:183], v[40:43], v[148:151], v[180:183]
  ds_read_b64_tr_b16 v[36:37], v22 offset:10368
  buffer_store_dwordx4 v[240:243], v1, s[24:27], s47 offen sc1
  v_cvt_pk_bf16_f32 v246, v172, v173
  v_cvt_pk_bf16_f32 v247, v174, v175
  v_mfma_f32_16x16x32_bf16 v[176:179], v[44:47], v[152:155], v[176:179]
  ds_read_b64_tr_b16 v[38:39], v22 offset:15488
  v_mfma_f32_16x16x32_bf16 v[180:183], v[44:47], v[156:159], v[180:183]
  ds_read_b64_tr_b16 v[40:41], v22 offset:26752
  s_waitcnt lgkmcnt(5)
  v_mfma_f32_16x16x32_bf16 v[184:187], v[48:51], v[144:147], v[184:187]
  ds_read_b64_tr_b16 v[42:43], v22 offset:31872
  s_add_u32 s47, s50, 1
  s_cmp_ge_u32 s47, 10
  s_cselect_b32 s38, 10, 0
  s_sub_u32 s47, s47, s38
  s_lshl_b32 s47, s47, 10
  s_add_u32 s47, s47, s46
  v_cvt_pk_bf16_f32 v248, v176, v177
  v_cvt_pk_bf16_f32 v249, v178, v179
  v_mfma_f32_16x16x32_bf16 v[188:191], v[48:51], v[148:151], v[188:191]
  ds_read_b64_tr_b16 v[44:45], v22 offset:36992
  buffer_store_dwordx4 v[244:247], v1, s[24:27], s47 offen sc1
  v_cvt_pk_bf16_f32 v250, v180, v181
  v_cvt_pk_bf16_f32 v251, v182, v183
  v_mfma_f32_16x16x32_bf16 v[184:187], v[52:55], v[152:155], v[184:187]
  ds_read_b64_tr_b16 v[46:47], v22 offset:42112
  v_mfma_f32_16x16x32_bf16 v[188:191], v[52:55], v[156:159], v[188:191]
  ds_read_b64_tr_b16 v[48:49], v12 offset:128
  s_waitcnt lgkmcnt(5)
  v_mfma_f32_16x16x32_bf16 v[192:195], v[32:35], v[112:115], v[192:195]
  ds_read_b64_tr_b16 v[50:51], v12 offset:5248
  s_add_u32 s47, s50, 2
  s_cmp_ge_u32 s47, 10
  s_cselect_b32 s38, 10, 0
  s_sub_u32 s47, s47, s38
  s_lshl_b32 s47, s47, 10
  s_add_u32 s47, s47, s46
  v_cvt_pk_bf16_f32 v252, v184, v185
  v_cvt_pk_bf16_f32 v253, v186, v187
  v_mfma_f32_16x16x32_bf16 v[196:199], v[32:35], v[116:119], v[196:199]
  ds_read_b64_tr_b16 v[52:53], v12 offset:10368
  buffer_store_dwordx4 v[248:251], v1, s[24:27], s47 offen sc1
  v_cvt_pk_bf16_f32 v254, v188, v189
  v_cvt_pk_bf16_f32 v255, v190, v191
  v_mfma_f32_16x16x32_bf16 v[192:195], v[36:39], v[120:123], v[192:195]
  ds_read_b64_tr_b16 v[54:55], v12 offset:15488
  v_mfma_f32_16x16x32_bf16 v[196:199], v[36:39], v[124:127], v[196:199]
  ds_read_b64_tr_b16 v[32:33], v23 offset:128
  s_waitcnt lgkmcnt(5)
  v_mfma_f32_16x16x32_bf16 v[192:195], v[40:43], v[128:131], v[192:195]
  ds_read_b64_tr_b16 v[34:35], v23 offset:5248
  s_add_u32 s47, s50, 3
  s_cmp_ge_u32 s47, 10
  s_cselect_b32 s38, 10, 0
  s_sub_u32 s47, s47, s38
  s_lshl_b32 s47, s47, 10
  s_add_u32 s47, s47, s46
  v_mfma_f32_16x16x32_bf16 v[196:199], v[40:43], v[132:135], v[196:199]
  ds_read_b64_tr_b16 v[36:37], v23 offset:10368
  s_setprio 2
  buffer_store_dwordx4 v[252:255], v1, s[24:27], s47 offen sc1
  v_mfma_f32_16x16x32_bf16 v[192:195], v[44:47], v[136:139], v[192:195]
  ds_read_b64_tr_b16 v[38:39], v23 offset:15488
  v_mfma_f32_16x16x32_bf16 v[196:199], v[44:47], v[140:143], v[196:199]
  ds_read_b64_tr_b16 v[40:41], v23 offset:26752
  s_waitcnt lgkmcnt(5)
  v_mfma_f32_16x16x32_bf16 v[192:195], v[48:51], v[144:147], v[192:195]
  ds_read_b64_tr_b16 v[42:43], v23 offset:31872
  v_mfma_f32_16x16x32_bf16 v[196:199], v[48:51], v[148:151], v[196:199]
  ds_read_b64_tr_b16 v[44:45], v23 offset:36992
  v_mfma_f32_16x16x32_bf16 v[192:195], v[52:55], v[152:155], v[192:195]
  ds_read_b64_tr_b16 v[46:47], v23 offset:42112
  v_mfma_f32_16x16x32_bf16 v[196:199], v[52:55], v[156:159], v[196:199]
  ds_read_b64_tr_b16 v[48:49], v13 offset:128
  s_waitcnt lgkmcnt(5)
  v_mfma_f32_16x16x32_bf16 v[200:203], v[32:35], v[112:115], v[200:203]
  ds_read_b64_tr_b16 v[50:51], v13 offset:5248
  s_nop 1
  v_cvt_pk_bf16_f32 v24, v192, v193
  v_cvt_pk_bf16_f32 v25, v194, v195
  v_mfma_f32_16x16x32_bf16 v[204:207], v[32:35], v[116:119], v[204:207]
  ds_read_b64_tr_b16 v[52:53], v13 offset:10368
  v_cvt_pk_bf16_f32 v26, v196, v197
  v_cvt_pk_bf16_f32 v27, v198, v199
  v_mfma_f32_16x16x32_bf16 v[200:203], v[36:39], v[120:123], v[200:203]
  ds_read_b64_tr_b16 v[54:55], v13 offset:15488
  v_mfma_f32_16x16x32_bf16 v[204:207], v[36:39], v[124:127], v[204:207]
  ds_read_b64_tr_b16 v[32:33], v22 offset:192
  s_waitcnt lgkmcnt(5)
  v_mfma_f32_16x16x32_bf16 v[200:203], v[40:43], v[128:131], v[200:203]
  ds_read_b64_tr_b16 v[34:35], v22 offset:5312
  s_add_u32 s47, s50, 4
  s_cmp_ge_u32 s47, 10
  s_cselect_b32 s38, 10, 0
  s_sub_u32 s47, s47, s38
  s_lshl_b32 s47, s47, 10
  s_add_u32 s47, s47, s46
  v_mfma_f32_16x16x32_bf16 v[204:207], v[40:43], v[132:135], v[204:207]
  ds_read_b64_tr_b16 v[36:37], v22 offset:10432
  buffer_store_dwordx4 v[24:27], v1, s[24:27], s47 offen sc1
  v_mfma_f32_16x16x32_bf16 v[200:203], v[44:47], v[136:139], v[200:203]
  ds_read_b64_tr_b16 v[38:39], v22 offset:15552
  v_mfma_f32_16x16x32_bf16 v[204:207], v[44:47], v[140:143], v[204:207]
  ds_read_b64_tr_b16 v[40:41], v22 offset:26816
  s_waitcnt lgkmcnt(5)
  v_mfma_f32_16x16x32_bf16 v[200:203], v[48:51], v[144:147], v[200:203]
  ds_read_b64_tr_b16 v[42:43], v22 offset:31936
  v_mfma_f32_16x16x32_bf16 v[204:207], v[48:51], v[148:151], v[204:207]
  ds_read_b64_tr_b16 v[44:45], v22 offset:37056
  v_mfma_f32_16x16x32_bf16 v[200:203], v[52:55], v[152:155], v[200:203]
  ds_read_b64_tr_b16 v[46:47], v22 offset:42176
  v_mfma_f32_16x16x32_bf16 v[204:207], v[52:55], v[156:159], v[204:207]
  ds_read_b64_tr_b16 v[48:49], v12 offset:192
  s_waitcnt lgkmcnt(5)
  v_mfma_f32_16x16x32_bf16 v[208:211], v[32:35], v[112:115], v[208:211]
  ds_read_b64_tr_b16 v[50:51], v12 offset:5312
  s_nop 1
  v_cvt_pk_bf16_f32 v28, v200, v201
  v_cvt_pk_bf16_f32 v29, v202, v203
  v_mfma_f32_16x16x32_bf16 v[212:215], v[32:35], v[116:119], v[212:215]
  ds_read_b64_tr_b16 v[52:53], v12 offset:10432
  v_cvt_pk_bf16_f32 v30, v204, v205
  v_cvt_pk_bf16_f32 v31, v206, v207
  v_mfma_f32_16x16x32_bf16 v[208:211], v[36:39], v[120:123], v[208:211]
  ds_read_b64_tr_b16 v[54:55], v12 offset:15552
  v_mfma_f32_16x16x32_bf16 v[212:215], v[36:39], v[124:127], v[212:215]
  ds_read_b64_tr_b16 v[32:33], v23 offset:192
  s_waitcnt lgkmcnt(5)
  v_mfma_f32_16x16x32_bf16 v[208:211], v[40:43], v[128:131], v[208:211]
  ds_read_b64_tr_b16 v[34:35], v23 offset:5312
  s_add_u32 s47, s50, 5
  s_cmp_ge_u32 s47, 10
  s_cselect_b32 s38, 10, 0
  s_sub_u32 s47, s47, s38
  s_lshl_b32 s47, s47, 10
  s_add_u32 s47, s47, s46
  v_mfma_f32_16x16x32_bf16 v[212:215], v[40:43], v[132:135], v[212:215]
  ds_read_b64_tr_b16 v[36:37], v23 offset:10432
  buffer_store_dwordx4 v[28:31], v1, s[24:27], s47 offen sc1
  v_mfma_f32_16x16x32_bf16 v[208:211], v[44:47], v[136:139], v[208:211]
  ds_read_b64_tr_b16 v[38:39], v23 offset:15552
  v_mfma_f32_16x16x32_bf16 v[212:215], v[44:47], v[140:143], v[212:215]
  ds_read_b64_tr_b16 v[40:41], v23 offset:26816
  s_waitcnt lgkmcnt(5)
  v_mfma_f32_16x16x32_bf16 v[208:211], v[48:51], v[144:147], v[208:211]
  ds_read_b64_tr_b16 v[42:43], v23 offset:31936
  v_mfma_f32_16x16x32_bf16 v[212:215], v[48:51], v[148:151], v[212:215]
  ds_read_b64_tr_b16 v[44:45], v23 offset:37056
  v_mfma_f32_16x16x32_bf16 v[208:211], v[52:55], v[152:155], v[208:211]
  ds_read_b64_tr_b16 v[46:47], v23 offset:42176
  s_setprio 1
  v_mfma_f32_16x16x32_bf16 v[212:215], v[52:55], v[156:159], v[212:215]
  ds_read_b64_tr_b16 v[48:49], v13 offset:192
  s_waitcnt lgkmcnt(5)
  v_mfma_f32_16x16x32_bf16 v[216:219], v[32:35], v[112:115], v[216:219]
  ds_read_b64_tr_b16 v[50:51], v13 offset:5312
  s_nop 0
  v_cvt_pk_bf16_f32 v56, v208, v209
  v_cvt_pk_bf16_f32 v57, v210, v211
  v_mfma_f32_16x16x32_bf16 v[220:223], v[32:35], v[116:119], v[220:223]
  ds_read_b64_tr_b16 v[52:53], v13 offset:10432
  v_cvt_pk_bf16_f32 v58, v212, v213
  v_cvt_pk_bf16_f32 v59, v214, v215
  v_mfma_f32_16x16x32_bf16 v[216:219], v[36:39], v[120:123], v[216:219]
  ds_read_b64_tr_b16 v[54:55], v13 offset:15552
  v_mfma_f32_16x16x32_bf16 v[220:223], v[36:39], v[124:127], v[220:223]
  ds_read_b64_tr_b16 v[32:33], v14 offset:256
  s_waitcnt lgkmcnt(5)
  v_mfma_f32_16x16x32_bf16 v[216:219], v[40:43], v[128:131], v[216:219]
  ds_read_b64_tr_b16 v[34:35], v14 offset:5376
  s_add_u32 s47, s50, 6
  s_cmp_ge_u32 s47, 10
  s_cselect_b32 s38, 10, 0
  s_sub_u32 s47, s47, s38
  s_lshl_b32 s47, s47, 10
  s_add_u32 s47, s47, s46
  v_mfma_f32_16x16x32_bf16 v[220:223], v[40:43], v[132:135], v[220:223]
  ds_read_b64_tr_b16 v[36:37], v14 offset:10496
  buffer_store_dwordx4 v[56:59], v1, s[24:27], s47 offen sc1
  v_mfma_f32_16x16x32_bf16 v[216:219], v[44:47], v[136:139], v[216:219]
  ds_read_b64_tr_b16 v[38:39], v14 offset:15616
  v_mfma_f32_16x16x32_bf16 v[220:223], v[44:47], v[140:143], v[220:223]
  ds_read_b64_tr_b16 v[40:41], v14 offset:26880
  s_waitcnt lgkmcnt(5)
  v_mfma_f32_16x16x32_bf16 v[216:219], v[48:51], v[144:147], v[216:219]
  ds_read_b64_tr_b16 v[42:43], v14 offset:32000
  v_mfma_f32_16x16x32_bf16 v[220:223], v[48:51], v[148:151], v[220:223]
  ds_read_b64_tr_b16 v[44:45], v14 offset:37120
  v_mfma_f32_16x16x32_bf16 v[216:219], v[52:55], v[152:155], v[216:219]
  ds_read_b64_tr_b16 v[46:47], v14 offset:42240
  v_mfma_f32_16x16x32_bf16 v[220:223], v[52:55], v[156:159], v[220:223]
  ds_read_b64_tr_b16 v[48:49], v16 offset:256
  s_waitcnt lgkmcnt(5)
  v_mfma_f32_16x16x32_bf16 v[224:227], v[32:35], v[64:67], v[224:227]
  ds_read_b64_tr_b16 v[50:51], v16 offset:5376
  s_nop 1
  v_cvt_pk_bf16_f32 v60, v216, v217
  v_cvt_pk_bf16_f32 v61, v218, v219
  v_mfma_f32_16x16x32_bf16 v[228:231], v[32:35], v[68:71], v[228:231]
  ds_read_b64_tr_b16 v[52:53], v16 offset:10496
  v_cvt_pk_bf16_f32 v62, v220, v221
  v_cvt_pk_bf16_f32 v63, v222, v223
  v_mfma_f32_16x16x32_bf16 v[224:227], v[36:39], v[72:75], v[224:227]
  ds_read_b64_tr_b16 v[54:55], v16 offset:15616
  v_mfma_f32_16x16x32_bf16 v[228:231], v[36:39], v[76:79], v[228:231]
  ds_read_b64_tr_b16 v[32:33], v22 offset:256
  s_waitcnt lgkmcnt(5)
  v_mfma_f32_16x16x32_bf16 v[224:227], v[40:43], v[80:83], v[224:227]
  ds_read_b64_tr_b16 v[34:35], v22 offset:5376
  s_add_u32 s47, s50, 7
  s_cmp_ge_u32 s47, 10
  s_cselect_b32 s38, 10, 0
  s_sub_u32 s47, s47, s38
  s_lshl_b32 s47, s47, 10
  s_add_u32 s47, s47, s46
  v_mfma_f32_16x16x32_bf16 v[228:231], v[40:43], v[84:87], v[228:231]
  ds_read_b64_tr_b16 v[36:37], v22 offset:10496
  s_bitcmp1_b32 s2, 1
  s_cbranch_scc0 L_own7
  buffer_store_dwordx4 v[60:63], v1, s[24:27], s47 offen sc1
L_own7:
  v_mfma_f32_16x16x32_bf16 v[224:227], v[44:47], v[88:91], v[224:227]
  ds_read_b64_tr_b16 v[38:39], v22 offset:15616
  v_mfma_f32_16x16x32_bf16 v[228:231], v[44:47], v[92:95], v[228:231]
  ds_read_b64_tr_b16 v[40:41], v22 offset:26880
  s_waitcnt lgkmcnt(5)
  v_mfma_f32_16x16x32_bf16 v[224:227], v[48:51], v[96:99], v[224:227]
  ds_read_b64_tr_b16 v[42:43], v22 offset:32000
  v_mfma_f32_16x16x32_bf16 v[228:231], v[48:51], v[100:103], v[228:231]
  ds_read_b64_tr_b16 v[44:45], v22 offset:37120
  v_mfma_f32_16x16x32_bf16 v[224:227], v[52:55], v[104:107], v[224:227]
  ds_read_b64_tr_b16 v[46:47], v22 offset:42240
  v_mfma_f32_16x16x32_bf16 v[228:231], v[52:55], v[108:111], v[228:231]
  ds_read_b64_tr_b16 v[48:49], v12 offset:256
  s_waitcnt lgkmcnt(5)
  v_mfma_f32_16x16x32_bf16 v[224:227], v[32:35], v[112:115], v[224:227]
  ds_read_b64_tr_b16 v[50:51], v12 offset:5376
  v_mfma_f32_16x16x32_bf16 v[228:231], v[32:35], v[116:119], v[228:231]
  ds_read_b64_tr_b16 v[52:53], v12 offset:10496
  v_mfma_f32_16x16x32_bf16 v[224:227], v[36:39], v[120:123], v[224:227]
  ds_read_b64_tr_b16 v[54:55], v12 offset:15616
  v_mfma_f32_16x16x32_bf16 v[228:231], v[36:39], v[124:127], v[228:231]
  ds_read_b64_tr_b16 v[32:33], v15 offset:256
  s_setprio 0
  s_waitcnt lgkmcnt(5)
  v_mfma_f32_16x16x32_bf16 v[224:227], v[40:43], v[128:131], v[224:227]
  ds_read_b64_tr_b16 v[34:35], v15 offset:5376
  v_mfma_f32_16x16x32_bf16 v[228:231], v[40:43], v[132:135], v[228:231]
  ds_read_b64_tr_b16 v[36:37], v15 offset:10496
  v_mfma_f32_16x16x32_bf16 v[224:227], v[44:47], v[136:139], v[224:227]
  ds_read_b64_tr_b16 v[38:39], v15 offset:15616
  v_mfma_f32_16x16x32_bf16 v[228:231], v[44:47], v[140:143], v[228:231]
  ds_read_b64_tr_b16 v[40:41], v15 offset:26880
  s_waitcnt lgkmcnt(5)
  v_mfma_f32_16x16x32_bf16 v[224:227], v[48:51], v[144:147], v[224:227]
  ds_read_b64_tr_b16 v[42:43], v15 offset:32000
  v_mfma_f32_16x16x32_bf16 v[228:231], v[48:51], v[148:151], v[228:231]
  ds_read_b64_tr_b16 v[44:45], v15 offset:37120
  v_mfma_f32_16x16x32_bf16 v[224:227], v[52:55], v[152:155], v[224:227]
  ds_read_b64_tr_b16 v[46:47], v15 offset:42240
  v_mfma_f32_16x16x32_bf16 v[228:231], v[52:55], v[156:159], v[228:231]
  ds_read_b64_tr_b16 v[48:49], v17 offset:256
  s_waitcnt lgkmcnt(5)
  v_mfma_f32_16x16x32_bf16 v[232:235], v[32:35], v[64:67], v[232:235]
  ds_read_b64_tr_b16 v[50:51], v17 offset:5376
  v_mfma_f32_16x16x32_bf16 v[236:239], v[32:35], v[68:71], v[236:239]
  ds_read_b64_tr_b16 v[52:53], v17 offset:10496
  v_mfma_f32_16x16x32_bf16 v[232:235], v[36:39], v[72:75], v[232:235]
  ds_read_b64_tr_b16 v[54:55], v17 offset:15616
  v_mfma_f32_16x16x32_bf16 v[236:239], v[36:39], v[76:79], v[236:239]
  ds_read_b64_tr_b16 v[32:33], v23 offset:256
  s_waitcnt lgkmcnt(5)
  v_mfma_f32_16x16x32_bf16 v[232:235], v[40:43], v[80:83], v[232:235]
  ds_read_b64_tr_b16 v[34:35], v23 offset:5376
  v_mfma_f32_16x16x32_bf16 v[236:239], v[40:43], v[84:87], v[236:239]
  ds_read_b64_tr_b16 v[36:37], v23 offset:10496
  v_mfma_f32_16x16x32_bf16 v[232:235], v[44:47], v[88:91], v[232:235]
  ds_read_b64_tr_b16 v[38:39], v23 offset:15616
  v_mfma_f32_16x16x32_bf16 v[236:239], v[44:47], v[92:95], v[236:239]
  ds_read_b64_tr_b16 v[40:41], v23 offset:26880
  s_waitcnt vmcnt(0)
  s_barrier
  s_waitcnt lgkmcnt(5)
  v_mfma_f32_16x16x32_bf16 v[232:235], v[48:51], v[96:99], v[232:235]
  ds_read_b64_tr_b16 v[42:43], v23 offset:32000
  v_mfma_f32_16x16x32_bf16 v[236:239], v[48:51], v[100:103], v[236:239]
  ds_read_b64_tr_b16 v[44:45], v23 offset:37120
  v_mfma_f32_16x16x32_bf16 v[232:235], v[52:55], v[104:107], v[232:235]
  ds_read_b64_tr_b16 v[46:47], v23 offset:42240
  v_mfma_f32_16x16x32_bf16 v[236:239], v[52:55], v[108:111], v[236:239]
  ds_read_b64_tr_b16 v[48:49], v13 offset:256
  s_waitcnt lgkmcnt(5)
  v_mfma_f32_16x16x32_bf16 v[232:235], v[32:35], v[112:115], v[232:235]
  ds_read_b64_tr_b16 v[50:51], v13 offset:5376
  v_mfma_f32_16x16x32_bf16 v[236:239], v[32:35], v[116:119], v[236:239]
  ds_read_b64_tr_b16 v[52:53], v13 offset:10496
  v_mfma_f32_16x16x32_bf16 v[232:235], v[36:39], v[120:123], v[232:235]
  ds_read_b64_tr_b16 v[54:55], v13 offset:15616
  v_mfma_f32_16x16x32_bf16 v[236:239], v[36:39], v[124:127], v[236:239]
  s_waitcnt lgkmcnt(4)
  v_mfma_f32_16x16x32_bf16 v[232:235], v[40:43], v[128:131], v[232:235]
  v_mfma_f32_16x16x32_bf16 v[236:239], v[40:43], v[132:135], v[236:239]
  v_mfma_f32_16x16x32_bf16 v[232:235], v[44:47], v[136:139], v[232:235]
  v_mfma_f32_16x16x32_bf16 v[236:239], v[44:47], v[140:143], v[236:239]
  s_waitcnt lgkmcnt(0)
  v_mfma_f32_16x16x32_bf16 v[232:235], v[48:51], v[144:147], v[232:235]
  v_mfma_f32_16x16x32_bf16 v[236:239], v[48:51], v[148:151], v[236:239]
  v_mfma_f32_16x16x32_bf16 v[232:235], v[52:55], v[152:155], v[232:235]
  v_mfma_f32_16x16x32_bf16 v[236:239], v[52:55], v[156:159], v[236:239]
  s_add_u32 s47, s50, 8
  s_cmp_ge_u32 s47, 10
  s_cselect_b32 s38, 10, 0
  s_sub_u32 s47, s47, s38
  s_lshl_b32 s38, s47, 10
  s_add_u32 s45, s45, s38
  s_sub_u32 s45, s45, 1024
  s_xor_b32 s46, s2, 1
  s_mul_i32 s46, s46, 71680
  s_add_u32 s68, s46, s45
  s_xor_b32 s46, s2, 2
  s_mul_i32 s46, s46, 71680
  s_add_u32 s69, s46, s45
  s_xor_b32 s46, s2, 3
  s_mul_i32 s46, s46, 71680
  s_add_u32 s70, s46, s45
  s_lshl_b32 s38, s47, 5
  s_add_u32 s40, s40, s38
  s_add_u32 s41, s40, 40960
  s_sub_u32 s42, s40, 32
  s_sub_u32 s44, s41, 32
  v_and_b32 v8, 24, v2
  v_add_u32 v8, v8, v2
  s_barrier
  s_bitcmp1_b32 s2, 1
  s_cbranch_scc1 L_red2
  buffer_load_dwordx4 v[36:39], v1, s[24:27], s68 offen offset:1024 sc1
  buffer_load_dwordx4 v[48:51], v1, s[24:27], s69 offen offset:1024 sc1
  buffer_load_dwordx4 v[60:63], v1, s[24:27], s70 offen offset:1024 sc1
  buffer_load_dwordx4 v[40:43], v1, s[24:27], s68 offen offset:2048 sc1
  buffer_load_dwordx4 v[52:55], v1, s[24:27], s69 offen offset:2048 sc1
  buffer_load_dwordx4 v[64:67], v1, s[24:27], s70 offen offset:2048 sc1
  buffer_load_dwordx4 v[32:35], v1, s[24:27], s68 offen offset:0 sc1
  buffer_load_dwordx4 v[44:47], v1, s[24:27], s69 offen offset:0 sc1
  buffer_load_dwordx4 v[56:59], v1, s[24:27], s70 offen offset:0 sc1
  s_waitcnt vmcnt(8)
  v_lshlrev_b32 v3, 16, v36
  v_and_b32 v4, s43, v36
  v_add_f32 v224, v224, v3
  v_add_f32 v225, v225, v4
  v_lshlrev_b32 v5, 16, v37
  v_and_b32 v6, s43, v37
  v_add_f32 v226, v226, v5
  v_add_f32 v227, v227, v6
  v_lshlrev_b32 v3, 16, v38
  v_and_b32 v4, s43, v38
  v_add_f32 v228, v228, v3
  v_add_f32 v229, v229, v4
  v_lshlrev_b32 v5, 16, v39
  v_and_b32 v6, s43, v39
  v_add_f32 v230, v230, v5
  v_add_f32 v231, v231, v6
  s_waitcnt vmcnt(7)
  v_lshlrev_b32 v3, 16, v48
  v_and_b32 v4, s43, v48
  v_add_f32 v224, v224, v3
  v_add_f32 v225, v225, v4
  v_lshlrev_b32 v5, 16, v49
  v_and_b32 v6, s43, v49
  v_add_f32 v226, v226, v5
  v_add_f32 v227, v227, v6
  v_lshlrev_b32 v3, 16, v50
  v_and_b32 v4, s43, v50
  v_add_f32 v228, v228, v3
  v_add_f32 v229, v229, v4
  v_lshlrev_b32 v5, 16, v51
  v_and_b32 v6, s43, v51
  v_add_f32 v230, v230, v5
  v_add_f32 v231, v231, v6
  s_waitcnt vmcnt(6)
  v_lshlrev_b32 v3, 16, v60
  v_and_b32 v4, s43, v60
  v_add_f32 v224, v224, v3
  v_add_f32 v225, v225, v4
  v_lshlrev_b32 v5, 16, v61
  v_and_b32 v6, s43, v61
  v_add_f32 v226, v226, v5
  v_add_f32 v227, v227, v6
  v_lshlrev_b32 v3, 16, v62
  v_and_b32 v4, s43, v62
  v_add_f32 v228, v228, v3
  v_add_f32 v229, v229, v4
  v_lshlrev_b32 v5, 16, v63
  v_and_b32 v6, s43, v63
  v_add_f32 v230, v230, v5
  v_add_f32 v231, v231, v6
  s_waitcnt vmcnt(5)
  v_lshlrev_b32 v3, 16, v40
  v_and_b32 v4, s43, v40
  v_add_f32 v232, v232, v3
  v_add_f32 v233, v233, v4
  v_lshlrev_b32 v5, 16, v41
  v_and_b32 v6, s43, v41
  v_add_f32 v234, v234, v5
  v_add_f32 v235, v235, v6
  v_lshlrev_b32 v3, 16, v42
  v_and_b32 v4, s43, v42
  v_add_f32 v236, v236, v3
  v_add_f32 v237, v237, v4
  v_lshlrev_b32 v5, 16, v43
  v_and_b32 v6, s43, v43
  v_add_f32 v238, v238, v5
  v_add_f32 v239, v239, v6
  s_waitcnt vmcnt(4)
  v_lshlrev_b32 v3, 16, v52
  v_and_b32 v4, s43, v52
  v_add_f32 v232, v232, v3
  v_add_f32 v233, v233, v4
  v_lshlrev_b32 v5, 16, v53
  v_and_b32 v6, s43, v53
  v_add_f32 v234, v234, v5
  v_add_f32 v235, v235, v6
  v_lshlrev_b32 v3, 16, v54
  v_and_b32 v4, s43, v54
  v_add_f32 v236, v236, v3
  v_add_f32 v237, v237, v4
  v_lshlrev_b32 v5, 16, v55
  v_and_b32 v6, s43, v55
  v_add_f32 v238, v238, v5
  v_add_f32 v239, v239, v6
  s_waitcnt vmcnt(3)
  v_lshlrev_b32 v3, 16, v64
  v_and_b32 v4, s43, v64
  v_add_f32 v232, v232, v3
  v_add_f32 v233, v233, v4
  v_lshlrev_b32 v5, 16, v65
  v_and_b32 v6, s43, v65
  v_add_f32 v234, v234, v5
  v_add_f32 v235, v235, v6
  v_lshlrev_b32 v3, 16, v66
  v_and_b32 v4, s43, v66
  v_add_f32 v236, v236, v3
  v_add_f32 v237, v237, v4
  v_lshlrev_b32 v5, 16, v67
  v_and_b32 v6, s43, v67
  v_add_f32 v238, v238, v5
  v_add_f32 v239, v239, v6
  v_cvt_pk_bf16_f32 v112, v224, v225
  v_cvt_pk_bf16_f32 v114, v232, v233
  v_cvt_pk_bf16_f32 v113, v226, v227
  v_cvt_pk_bf16_f32 v115, v234, v235
  v_cvt_pk_bf16_f32 v116, v228, v229
  v_cvt_pk_bf16_f32 v118, v236, v237
  v_cvt_pk_bf16_f32 v117, v230, v231
  v_cvt_pk_bf16_f32 v119, v238, v239
  v_permlane32_swap_b32 v112, v114
  v_permlane32_swap_b32 v113, v115
  v_permlane32_swap_b32 v116, v118
  v_permlane32_swap_b32 v117, v119
  v_permlane16_swap_b32 v112, v114
  v_permlane16_swap_b32 v113, v115
  v_permlane16_swap_b32 v116, v118
  v_permlane16_swap_b32 v117, v119
  buffer_store_dwordx4 v[112:115], v8, s[56:59], s40 offen
  buffer_store_dwordx4 v[116:119], v8, s[56:59], s41 offen
  s_waitcnt vmcnt(4)
  v_lshlrev_b32 v3, 16, v32
  v_and_b32 v4, s43, v32
  v_add_f32 v216, v216, v3
  v_add_f32 v217, v217, v4
  v_lshlrev_b32 v5, 16, v33
  v_and_b32 v6, s43, v33
  v_add_f32 v218, v218, v5
  v_add_f32 v219, v219, v6
  v_lshlrev_b32 v3, 16, v34
  v_and_b32 v4, s43, v34
  v_add_f32 v220, v220, v3
  v_add_f32 v221, v221, v4
  v_lshlrev_b32 v5, 16, v35
  v_and_b32 v6, s43, v35
  v_add_f32 v222, v222, v5
  v_add_f32 v223, v223, v6
  s_waitcnt vmcnt(3)
  v_lshlrev_b32 v3, 16, v44
  v_and_b32 v4, s43, v44
  v_add_f32 v216, v216, v3
  v_add_f32 v217, v217, v4
  v_lshlrev_b32 v5, 16, v45
  v_and_b32 v6, s43, v45
  v_add_f32 v218, v218, v5
  v_add_f32 v219, v219, v6
  v_lshlrev_b32 v3, 16, v46
  v_and_b32 v4, s43, v46
  v_add_f32 v220, v220, v3
  v_add_f32 v221, v221, v4
  v_lshlrev_b32 v5, 16, v47
  v_and_b32 v6, s43, v47
  v_add_f32 v222, v222, v5
  v_add_f32 v223, v223, v6
  s_waitcnt vmcnt(2)
  v_lshlrev_b32 v3, 16, v56
  v_and_b32 v4, s43, v56
  v_add_f32 v216, v216, v3
  v_add_f32 v217, v217, v4
  v_lshlrev_b32 v5, 16, v57
  v_and_b32 v6, s43, v57
  v_add_f32 v218, v218, v5
  v_add_f32 v219, v219, v6
  v_lshlrev_b32 v3, 16, v58
  v_and_b32 v4, s43, v58
  v_add_f32 v220, v220, v3
  v_add_f32 v221, v221, v4
  v_lshlrev_b32 v5, 16, v59
  v_and_b32 v6, s43, v59
  v_add_f32 v222, v222, v5
  v_add_f32 v223, v223, v6
  v_cvt_pk_bf16_f32 v216, v216, v217
  v_cvt_pk_bf16_f32 v217, v218, v219
  buffer_store_dwordx2 v[216:217], v2, s[56:59], s42 offen
  v_cvt_pk_bf16_f32 v220, v220, v221
  v_cvt_pk_bf16_f32 v221, v222, v223
  buffer_store_dwordx2 v[220:221], v2, s[56:59], s44 offen
  s_endpgm
L_red2:
  buffer_load_dwordx4 v[36:39], v1, s[24:27], s68 offen offset:1024 sc1
  buffer_load_dwordx4 v[48:51], v1, s[24:27], s69 offen offset:1024 sc1
  buffer_load_dwordx4 v[60:63], v1, s[24:27], s70 offen offset:1024 sc1
  buffer_load_dwordx4 v[40:43], v1, s[24:27], s68 offen offset:2048 sc1
  buffer_load_dwordx4 v[52:55], v1, s[24:27], s69 offen offset:2048 sc1
  buffer_load_dwordx4 v[64:67], v1, s[24:27], s70 offen offset:2048 sc1
  s_waitcnt vmcnt(5)
  v_lshlrev_b32 v3, 16, v36
  v_and_b32 v4, s43, v36
  v_add_f32 v224, v224, v3
  v_add_f32 v225, v225, v4
  v_lshlrev_b32 v5, 16, v37
  v_and_b32 v6, s43, v37
  v_add_f32 v226, v226, v5
  v_add_f32 v227, v227, v6
  v_lshlrev_b32 v3, 16, v38
  v_and_b32 v4, s43, v38
  v_add_f32 v228, v228, v3
  v_add_f32 v229, v229, v4
  v_lshlrev_b32 v5, 16, v39
  v_and_b32 v6, s43, v39
  v_add_f32 v230, v230, v5
  v_add_f32 v231, v231, v6
  s_waitcnt vmcnt(4)
  v_lshlrev_b32 v3, 16, v48
  v_and_b32 v4, s43, v48
  v_add_f32 v224, v224, v3
  v_add_f32 v225, v225, v4
  v_lshlrev_b32 v5, 16, v49
  v_and_b32 v6, s43, v49
  v_add_f32 v226, v226, v5
  v_add_f32 v227, v227, v6
  v_lshlrev_b32 v3, 16, v50
  v_and_b32 v4, s43, v50
  v_add_f32 v228, v228, v3
  v_add_f32 v229, v229, v4
  v_lshlrev_b32 v5, 16, v51
  v_and_b32 v6, s43, v51
  v_add_f32 v230, v230, v5
  v_add_f32 v231, v231, v6
  s_waitcnt vmcnt(3)
  v_lshlrev_b32 v3, 16, v60
  v_and_b32 v4, s43, v60
  v_add_f32 v224, v224, v3
  v_add_f32 v225, v225, v4
  v_lshlrev_b32 v5, 16, v61
  v_and_b32 v6, s43, v61
  v_add_f32 v226, v226, v5
  v_add_f32 v227, v227, v6
  v_lshlrev_b32 v3, 16, v62
  v_and_b32 v4, s43, v62
  v_add_f32 v228, v228, v3
  v_add_f32 v229, v229, v4
  v_lshlrev_b32 v5, 16, v63
  v_and_b32 v6, s43, v63
  v_add_f32 v230, v230, v5
  v_add_f32 v231, v231, v6
  s_waitcnt vmcnt(2)
  v_lshlrev_b32 v3, 16, v40
  v_and_b32 v4, s43, v40
  v_add_f32 v232, v232, v3
  v_add_f32 v233, v233, v4
  v_lshlrev_b32 v5, 16, v41
  v_and_b32 v6, s43, v41
  v_add_f32 v234, v234, v5
  v_add_f32 v235, v235, v6
  v_lshlrev_b32 v3, 16, v42
  v_and_b32 v4, s43, v42
  v_add_f32 v236, v236, v3
  v_add_f32 v237, v237, v4
  v_lshlrev_b32 v5, 16, v43
  v_and_b32 v6, s43, v43
  v_add_f32 v238, v238, v5
  v_add_f32 v239, v239, v6
  s_waitcnt vmcnt(1)
  v_lshlrev_b32 v3, 16, v52
  v_and_b32 v4, s43, v52
  v_add_f32 v232, v232, v3
  v_add_f32 v233, v233, v4
  v_lshlrev_b32 v5, 16, v53
  v_and_b32 v6, s43, v53
  v_add_f32 v234, v234, v5
  v_add_f32 v235, v235, v6
  v_lshlrev_b32 v3, 16, v54
  v_and_b32 v4, s43, v54
  v_add_f32 v236, v236, v3
  v_add_f32 v237, v237, v4
  v_lshlrev_b32 v5, 16, v55
  v_and_b32 v6, s43, v55
  v_add_f32 v238, v238, v5
  v_add_f32 v239, v239, v6
  s_waitcnt vmcnt(0)
  v_lshlrev_b32 v3, 16, v64
  v_and_b32 v4, s43, v64
  v_add_f32 v232, v232, v3
  v_add_f32 v233, v233, v4
  v_lshlrev_b32 v5, 16, v65
  v_and_b32 v6, s43, v65
  v_add_f32 v234, v234, v5
  v_add_f32 v235, v235, v6
  v_lshlrev_b32 v3, 16, v66
  v_and_b32 v4, s43, v66
  v_add_f32 v236, v236, v3
  v_add_f32 v237, v237, v4
  v_lshlrev_b32 v5, 16, v67
  v_and_b32 v6, s43, v67
  v_add_f32 v238, v238, v5
  v_add_f32 v239, v239, v6
  v_cvt_pk_bf16_f32 v112, v224, v225
  v_cvt_pk_bf16_f32 v114, v232, v233
  v_cvt_pk_bf16_f32 v113, v226, v227
  v_cvt_pk_bf16_f32 v115, v234, v235
  v_cvt_pk_bf16_f32 v116, v228, v229
  v_cvt_pk_bf16_f32 v118, v236, v237
  v_cvt_pk_bf16_f32 v117, v230, v231
  v_cvt_pk_bf16_f32 v119, v238, v239
  v_permlane32_swap_b32 v112, v114
  v_permlane32_swap_b32 v113, v115
  v_permlane32_swap_b32 v116, v118
  v_permlane32_swap_b32 v117, v119
  v_permlane16_swap_b32 v112, v114
  v_permlane16_swap_b32 v113, v115
  v_permlane16_swap_b32 v116, v118
  v_permlane16_swap_b32 v117, v119
  buffer_store_dwordx4 v[112:115], v8, s[56:59], s40 offen
  buffer_store_dwordx4 v[116:119], v8, s[56:59], s41 offen
  s_endpgm
L_exit:
  s_endpgm
L_loader:
  s_mov_b32 s45, 0
  v_add_u32 v33, 64, v1
  v_add_u32 v3, 0, v1
  v_mul_u32_u24 v4, s46, v3
  v_lshrrev_b32 v4, 16, v4
  v_bfe_u32 v5, v4, 1, 3
  v_lshlrev_b32 v5, 4, v5
  v_xor_b32 v10, v2, v5
  v_add_u32 v3, 64, v1
  v_mul_u32_u24 v4, s46, v3
  v_lshrrev_b32 v4, 16, v4
  v_bfe_u32 v5, v4, 1, 3
  v_lshlrev_b32 v5, 4, v5
  v_xor_b32 v11, v2, v5
  v_add_u32 v3, 128, v1
  v_mul_u32_u24 v4, s46, v3
  v_lshrrev_b32 v4, 16, v4
  v_bfe_u32 v5, v4, 1, 3
  v_lshlrev_b32 v5, 4, v5
  v_xor_b32 v12, v2, v5
  v_add_u32 v3, 192, v1
  v_mul_u32_u24 v4, s46, v3
  v_lshrrev_b32 v4, 16, v4
  v_bfe_u32 v5, v4, 1, 3
  v_lshlrev_b32 v5, 4, v5
  v_xor_b32 v13, v2, v5
  v_add_u32 v3, 256, v1
  v_mul_u32_u24 v4, s46, v3
  v_lshrrev_b32 v4, 16, v4
  v_bfe_u32 v5, v4, 1, 3
  v_lshlrev_b32 v5, 4, v5
  v_xor_b32 v14, v2, v5
  v_add_u32 v3, 320, v1
  v_mul_u32_u24 v4, s46, v3
  v_lshrrev_b32 v4, 16, v4
  v_bfe_u32 v5, v4, 1, 3
  v_lshlrev_b32 v5, 4, v5
  v_xor_b32 v15, v2, v5
  s_lshl_b32 s51, s33, 5
  s_lshl_b32 s53, s34, 1
  s_add_u32 s51, s51, s53
  s_add_u32 s51, s51, s93
  s_mul_i32 s51, s51, 196608
  s_lshl_b32 s84, s84, 1
  s_add_u32 s84, s84, 7863936
  s_mul_i32 s85, s93, 393216
  s_sub_u32 s85, 196608, s85
  s_mul_i32 s86, s93, 245760
  s_sub_u32 s87, 245760, s86
  s_add_u32 s74, s51, 196608
  s_mov_b32 s75, s74
  s_mul_i32 s53, s2, 1
  s_lshr_b32 s54, s2, 4
  s_add_u32 s53, s53, s54
  s_and_b32 s53, s53, 15
  s_mul_i32 s53, s53, 12288
  s_add_u32 s51, s51, s53
  s_mov_b32 s52, s51
  s_mov_b32 s41, 79872
  s_mov_b32 s42, 79872
  s_mov_b32 s44, 0
  s_add_u32 m0, s43, 0
  s_add_u32 s49, s49, 98304
  buffer_load_dwordx4 v20, s[12:15], s49 offen offset:0  lds
  buffer_load_dwordx4 v21, s[12:15], s49 offen offset:1024  lds
  buffer_load_dwordx4 v22, s[12:15], s49 offen offset:2048  lds
  s_add_u32 m0, s43, 3072
  s_add_u32 s49, s49, 98304
  buffer_load_dwordx4 v23, s[12:15], s49 offen offset:0  lds
  buffer_load_dwordx4 v24, s[12:15], s49 offen offset:1024  lds
  buffer_load_dwordx4 v25, s[12:15], s49 offen offset:2048  lds
  s_add_u32 m0, s43, 6144
  s_add_u32 s49, s49, 98304
  buffer_load_dwordx4 v20, s[12:15], s49 offen offset:0  lds
  buffer_load_dwordx4 v21, s[12:15], s49 offen offset:1024  lds
  buffer_load_dwordx4 v22, s[12:15], s49 offen offset:2048  lds
  s_add_u32 m0, s43, 9216
  s_add_u32 s49, s49, 98304
  buffer_load_dwordx4 v23, s[12:15], s49 offen offset:0  lds
  buffer_load_dwordx4 v24, s[12:15], s49 offen offset:1024  lds
  buffer_load_dwordx4 v25, s[12:15], s49 offen offset:2048  lds
  s_add_u32 m0, s43, 12288
  s_add_u32 s49, s49, 98304
  buffer_load_dwordx4 v20, s[12:15], s49 offen offset:0  lds
  buffer_load_dwordx4 v21, s[12:15], s49 offen offset:1024  lds
  buffer_load_dwordx4 v22, s[12:15], s49 offen offset:2048  lds
  s_add_u32 m0, s43, 15360
  s_add_u32 s49, s49, 98304
  buffer_load_dwordx4 v23, s[12:15], s49 offen offset:0  lds
  buffer_load_dwordx4 v24, s[12:15], s49 offen offset:1024  lds
  buffer_load_dwordx4 v25, s[12:15], s49 offen offset:2048  lds
  s_add_u32 m0, s43, 18432
  s_add_u32 s49, s49, 98304
  buffer_load_dwordx4 v20, s[12:15], s49 offen offset:0  lds
  buffer_load_dwordx4 v21, s[12:15], s49 offen offset:1024  lds
  buffer_load_dwordx4 v22, s[12:15], s49 offen offset:2048  lds
  s_add_u32 m0, s43, 21504
  s_add_u32 s49, s49, 98304
  buffer_load_dwordx4 v23, s[12:15], s49 offen offset:0  lds
  buffer_load_dwordx4 v24, s[12:15], s49 offen offset:1024  lds
  buffer_load_dwordx4 v25, s[12:15], s49 offen offset:2048  lds
  s_add_u32 s43, s43, 53248
  s_cmp_ge_u32 s43, 159744
  s_cselect_b32 s53, 159744, 0
  s_sub_u32 s43, s43, s53
  s_movk_i32 s46, 3277
  s_lshl_b32 s47, s50, 1
  v_add_u32 v3, 0, v1
  v_mul_u32_u24 v4, s46, v3
  v_lshrrev_b32 v4, 16, v4
  v_mul_u32_u24 v5, 20, v4
  v_sub_u32 v5, v3, v5
  v_bfe_u32 v6, v4, 2, 1
  v_lshlrev_b32 v6, 1, v6
  v_xor_b32 v5, v5, v6
  v_add_u32 v5, s47, v5
  v_subrev_u32 v6, 20, v5
  v_min_u32 v5, v5, v6
  v_mul_u32_u24 v6, 1280, v4
  v_lshl_add_u32 v5, v5, 4, v6
  v_subrev_u32 v28, 0, v5
  v_add_u32 v3, 64, v1
  v_mul_u32_u24 v4, s46, v3
  v_lshrrev_b32 v4, 16, v4
  v_mul_u32_u24 v5, 20, v4
  v_sub_u32 v5, v3, v5
  v_bfe_u32 v6, v4, 2, 1
  v_lshlrev_b32 v6, 1, v6
  v_xor_b32 v5, v5, v6
  v_add_u32 v5, s47, v5
  v_subrev_u32 v6, 20, v5
  v_min_u32 v5, v5, v6
  v_mul_u32_u24 v6, 1280, v4
  v_lshl_add_u32 v5, v5, 4, v6
  v_subrev_u32 v29, 1024, v5
  v_add_u32 v3, 128, v1
  v_mul_u32_u24 v4, s46, v3
  v_lshrrev_b32 v4, 16, v4
  v_mul_u32_u24 v5, 20, v4
  v_sub_u32 v5, v3, v5
  v_bfe_u32 v6, v4, 2, 1
  v_lshlrev_b32 v6, 1, v6
  v_xor_b32 v5, v5, v6
  v_add_u32 v5, s47, v5
  v_subrev_u32 v6, 20, v5
  v_min_u32 v5, v5, v6
  v_mul_u32_u24 v6, 1280, v4
  v_lshl_add_u32 v5, v5, 4, v6
  v_subrev_u32 v30, 2048, v5
  v_add_u32 v3, 192, v1
  v_mul_u32_u24 v4, s46, v3
  v_lshrrev_b32 v4, 16, v4
  v_mul_u32_u24 v5, 20, v4
  v_sub_u32 v5, v3, v5
  v_bfe_u32 v6, v4, 2, 1
  v_lshlrev_b32 v6, 1, v6
  v_xor_b32 v5, v5, v6
  v_add_u32 v5, s47, v5
  v_subrev_u32 v6, 20, v5
  v_min_u32 v5, v5, v6
  v_mul_u32_u24 v6, 1280, v4
  v_lshl_add_u32 v5, v5, 4, v6
  v_subrev_u32 v31, 0, v5
  v_add_u32 v3, 256, v1
  v_mul_u32_u24 v4, s46, v3
  v_lshrrev_b32 v4, 16, v4
  v_mul_u32_u24 v5, 20, v4
  v_sub_u32 v5, v3, v5
  v_bfe_u32 v6, v4, 2, 1
  v_lshlrev_b32 v6, 1, v6
  v_xor_b32 v5, v5, v6
  v_add_u32 v5, s47, v5
  v_subrev_u32 v6, 20, v5
  v_min_u32 v5, v5, v6
  v_mul_u32_u24 v6, 1280, v4
  v_lshl_add_u32 v5, v5, 4, v6
  v_subrev_u32 v32, 1024, v5
  s_lshl_b32 s53, s32, 3
  s_add_u32 s53, s53, s33
  s_lshl_b32 s53, s53, 4
  s_mov_b32 s91, s53
  s_lshr_b32 s54, s34, 2
  s_lshl_b32 s54, s54, 2
  s_add_u32 s54, s54, s53
  v_mov_b32 v8, s54
  s_lshl_b32 s54, s35, 2
  s_add_u32 s54, s54, s53
  v_mov_b32 v7, s54
  s_mul_i32 s50, s35, 320
  v_lshlrev_b32 v34, 7, v1
  v_mul_u32_u24 v3, 0x556, v1
  v_lshrrev_b32 v3, 14, v3
  v_mul_u32_u24 v4, 12, v3
  v_sub_u32 v4, v1, v4
  v_mul_u32_u24 v5, 0x56, v4
  v_lshrrev_b32 v5, 8, v5
  v_mul_u32_u24 v6, 3, v5
  v_sub_u32 v6, v4, v6
  v_min_u32 v3, 4, v3
  v_mul_u32_u24 v3, 12288, v3
  v_mul_u32_u24 v5, 768, v5
  v_add_u32 v3, v3, v5
  v_lshl_add_u32 v35, v6, 7, v3
  s_waitcnt vmcnt(36)
  s_barrier
  s_add_u32 m0, s43, 0
  s_add_u32 s49, s49, 98304
  buffer_load_dwordx4 v20, s[12:15], s49 offen offset:0  lds
  buffer_load_dwordx4 v21, s[12:15], s49 offen offset:1024  lds
  buffer_load_dwordx4 v22, s[12:15], s49 offen offset:2048  lds
  s_add_u32 m0, s43, 3072
  s_add_u32 s49, s49, 98304
  buffer_load_dwordx4 v23, s[12:15], s49 offen offset:0  lds
  buffer_load_dwordx4 v24, s[12:15], s49 offen offset:1024  lds
  buffer_load_dwordx4 v25, s[12:15], s49 offen offset:2048  lds
  s_add_u32 m0, s43, 6144
  s_add_u32 s49, s49, 98304
  buffer_load_dwordx4 v20, s[12:15], s49 offen offset:0  lds
  buffer_load_dwordx4 v21, s[12:15], s49 offen offset:1024  lds
  buffer_load_dwordx4 v22, s[12:15], s49 offen offset:2048  lds
  s_add_u32 m0, s43, 9216
  s_add_u32 s49, s49, 98304
  buffer_load_dwordx4 v23, s[12:15], s49 offen offset:0  lds
  buffer_load_dwordx4 v24, s[12:15], s49 offen offset:1024  lds
  buffer_load_dwordx4 v25, s[12:15], s49 offen offset:2048  lds
  s_add_u32 m0, s43, 12288
  s_add_u32 s49, s49, 98304
  buffer_load_dwordx4 v20, s[12:15], s49 offen offset:0  lds
  buffer_load_dwordx4 v21, s[12:15], s49 offen offset:1024  lds
  buffer_load_dwordx4 v22, s[12:15], s49 offen offset:2048  lds
  s_add_u32 m0, s43, 15360
  s_add_u32 s49, s49, 98304
  buffer_load_dwordx4 v23, s[12:15], s49 offen offset:0  lds
  buffer_load_dwordx4 v24, s[12:15], s49 offen offset:1024  lds
  buffer_load_dwordx4 v25, s[12:15], s49 offen offset:2048  lds
  s_add_u32 m0, s43, 18432
  s_add_u32 s49, s49, 98304
  buffer_load_dwordx4 v20, s[12:15], s49 offen offset:0  lds
  buffer_load_dwordx4 v21, s[12:15], s49 offen offset:1024  lds
  buffer_load_dwordx4 v22, s[12:15], s49 offen offset:2048  lds
  s_add_u32 m0, s43, 21504
  s_add_u32 s49, s49, 98304
  buffer_load_dwordx4 v23, s[12:15], s49 offen offset:0  lds
  buffer_load_dwordx4 v24, s[12:15], s49 offen offset:1024  lds
  buffer_load_dwordx4 v25, s[12:15], s49 offen offset:2048  lds
  s_add_u32 s43, s43, 53248
  s_cmp_ge_u32 s43, 159744
  s_cselect_b32 s53, 159744, 0
  s_sub_u32 s43, s43, s53
  s_waitcnt vmcnt(48)
  s_barrier
  s_mov_b32 s40, 6
L_ld0:
  s_waitcnt vmcnt(36)
  s_barrier
  s_add_u32 m0, s43, 0
  s_add_u32 s49, s49, 98304
  buffer_load_dwordx4 v20, s[12:15], s49 offen offset:0  lds
  buffer_load_dwordx4 v21, s[12:15], s49 offen offset:1024  lds
  buffer_load_dwordx4 v22, s[12:15], s49 offen offset:2048  lds
  s_add_u32 m0, s43, 3072
  s_add_u32 s49, s49, 98304
  buffer_load_dwordx4 v23, s[12:15], s49 offen offset:0  lds
  buffer_load_dwordx4 v24, s[12:15], s49 offen offset:1024  lds
  buffer_load_dwordx4 v25, s[12:15], s49 offen offset:2048  lds
  s_add_u32 m0, s43, 6144
  s_add_u32 s49, s49, 98304
  buffer_load_dwordx4 v20, s[12:15], s49 offen offset:0  lds
  buffer_load_dwordx4 v21, s[12:15], s49 offen offset:1024  lds
  buffer_load_dwordx4 v22, s[12:15], s49 offen offset:2048  lds
  s_add_u32 m0, s43, 9216
  s_add_u32 s49, s49, 98304
  buffer_load_dwordx4 v23, s[12:15], s49 offen offset:0  lds
  buffer_load_dwordx4 v24, s[12:15], s49 offen offset:1024  lds
  buffer_load_dwordx4 v25, s[12:15], s49 offen offset:2048  lds
  s_waitcnt vmcnt(36)
  s_barrier
  s_add_u32 m0, s43, 12288
  s_add_u32 s49, s49, 98304
  buffer_load_dwordx4 v20, s[12:15], s49 offen offset:0  lds
  buffer_load_dwordx4 v21, s[12:15], s49 offen offset:1024  lds
  buffer_load_dwordx4 v22, s[12:15], s49 offen offset:2048  lds
  s_add_u32 m0, s43, 15360
  s_add_u32 s49, s49, 98304
  buffer_load_dwordx4 v23, s[12:15], s49 offen offset:0  lds
  buffer_load_dwordx4 v24, s[12:15], s49 offen offset:1024  lds
  buffer_load_dwordx4 v25, s[12:15], s49 offen offset:2048  lds
  s_add_u32 m0, s43, 18432
  s_add_u32 s49, s49, 98304
  buffer_load_dwordx4 v20, s[12:15], s49 offen offset:0  lds
  buffer_load_dwordx4 v21, s[12:15], s49 offen offset:1024  lds
  buffer_load_dwordx4 v22, s[12:15], s49 offen offset:2048  lds
  s_add_u32 m0, s43, 21504
  s_add_u32 s49, s49, 98304
  buffer_load_dwordx4 v23, s[12:15], s49 offen offset:0  lds
  buffer_load_dwordx4 v24, s[12:15], s49 offen offset:1024  lds
  buffer_load_dwordx4 v25, s[12:15], s49 offen offset:2048  lds
  s_add_u32 s43, s43, 53248
  s_cmp_ge_u32 s43, 159744
  s_cselect_b32 s53, 159744, 0
  s_sub_u32 s43, s43, s53
  s_sub_u32 s40, s40, 1
  s_cmp_lg_u32 s40, 0
  s_cbranch_scc1 L_ld0
  s_waitcnt vmcnt(36)
  s_barrier
  s_add_u32 m0, s43, 0
  s_add_u32 s49, s49, 98304
  buffer_load_dwordx4 v20, s[12:15], s49 offen offset:0  lds
  buffer_load_dwordx4 v21, s[12:15], s49 offen offset:1024  lds
  buffer_load_dwordx4 v22, s[12:15], s49 offen offset:2048  lds
  s_add_u32 m0, s43, 3072
  s_add_u32 s49, s49, 98304
  buffer_load_dwordx4 v23, s[12:15], s49 offen offset:0  lds
  buffer_load_dwordx4 v24, s[12:15], s49 offen offset:1024  lds
  buffer_load_dwordx4 v25, s[12:15], s49 offen offset:2048  lds
  s_add_u32 m0, s43, 6144
  s_add_u32 s49, s49, 98304
  buffer_load_dwordx4 v20, s[12:15], s49 offen offset:0  lds
  buffer_load_dwordx4 v21, s[12:15], s49 offen offset:1024  lds
  buffer_load_dwordx4 v22, s[12:15], s49 offen offset:2048  lds
  s_add_u32 m0, s43, 9216
  s_add_u32 s49, s49, 98304
  buffer_load_dwordx4 v23, s[12:15], s49 offen offset:0  lds
  buffer_load_dwordx4 v24, s[12:15], s49 offen offset:1024  lds
  buffer_load_dwordx4 v25, s[12:15], s49 offen offset:2048  lds
  s_waitcnt vmcnt(36)
  s_barrier
  s_add_u32 m0, s43, 12288
  s_add_u32 s49, s49, 98304
  buffer_load_dwordx4 v20, s[12:15], s49 offen offset:0  lds
  buffer_load_dwordx4 v21, s[12:15], s49 offen offset:1024  lds
  buffer_load_dwordx4 v22, s[12:15], s49 offen offset:2048  lds
  s_add_u32 m0, s43, 15360
  s_add_u32 s49, s49, 98304
  buffer_load_dwordx4 v23, s[12:15], s49 offen offset:0  lds
  buffer_load_dwordx4 v24, s[12:15], s49 offen offset:1024  lds
  buffer_load_dwordx4 v25, s[12:15], s49 offen offset:2048  lds
  s_add_u32 m0, s43, 18432
  s_add_u32 s49, s49, 98304
  buffer_load_dwordx4 v20, s[12:15], s49 offen offset:0  lds
  buffer_load_dwordx4 v21, s[12:15], s49 offen offset:1024  lds
  buffer_load_dwordx4 v22, s[12:15], s49 offen offset:2048  lds
  s_add_u32 m0, s43, 21504
  s_add_u32 s49, s49, 98304
  buffer_load_dwordx4 v23, s[12:15], s49 offen offset:0  lds
  buffer_load_dwordx4 v24, s[12:15], s49 offen offset:1024  lds
  buffer_load_dwordx4 v25, s[12:15], s49 offen offset:2048  lds
  s_sub_u32 s49, s49, s84
  s_add_u32 m0, s41, 0
  s_nop 0
  buffer_load_dwordx4 v10, s[16:19], s51 offen offset:0 nt lds
  buffer_load_dwordx4 v11, s[16:19], s51 offen offset:1024 nt lds
  buffer_load_dwordx4 v12, s[16:19], s51 offen offset:2048 nt lds
  buffer_load_dwordx4 v13, s[16:19], s51 offen offset:3072 nt lds
  s_add_u32 m0, s41, 4096
  s_add_u32 s51, s51, 4096
  buffer_load_dwordx4 v14, s[16:19], s51 offen offset:0 nt lds
  buffer_load_dwordx4 v15, s[16:19], s51 offen offset:1024 nt lds
  buffer_load_dwordx4 v10, s[16:19], s51 offen offset:2048 nt lds
  buffer_load_dwordx4 v11, s[16:19], s51 offen offset:3072 nt lds
  s_add_u32 m0, s41, 8192
  s_add_u32 s51, s51, 4096
  buffer_load_dwordx4 v12, s[16:19], s51 offen offset:0 nt lds
  buffer_load_dwordx4 v13, s[16:19], s51 offen offset:1024 nt lds
  buffer_load_dwordx4 v14, s[16:19], s51 offen offset:2048 nt lds
  buffer_load_dwordx4 v15, s[16:19], s51 offen offset:3072 nt lds
  s_add_u32 s51, s51, 4096
  s_cmp_eq_u32 s51, s74
  s_cselect_b32 s53, 196608, 0
  s_sub_u32 s51, s51, s53
  s_sub_u32 s41, s41, 26624
  s_waitcnt vmcnt(36)
  s_barrier
  s_add_u32 m0, s41, 0
  s_nop 0
  buffer_load_dwordx4 v10, s[16:19], s51 offen offset:0 nt lds
  buffer_load_dwordx4 v11, s[16:19], s51 offen offset:1024 nt lds
  buffer_load_dwordx4 v12, s[16:19], s51 offen offset:2048 nt lds
  buffer_load_dwordx4 v13, s[16:19], s51 offen offset:3072 nt lds
  s_add_u32 m0, s41, 4096
  s_add_u32 s51, s51, 4096
  buffer_load_dwordx4 v14, s[16:19], s51 offen offset:0 nt lds
  buffer_load_dwordx4 v15, s[16:19], s51 offen offset:1024 nt lds
  buffer_load_dwordx4 v10, s[16:19], s51 offen offset:2048 nt lds
  buffer_load_dwordx4 v11, s[16:19], s51 offen offset:3072 nt lds
  s_add_u32 m0, s41, 8192
  s_add_u32 s51, s51, 4096
  buffer_load_dwordx4 v12, s[16:19], s51 offen offset:0 nt lds
  buffer_load_dwordx4 v13, s[16:19], s51 offen offset:1024 nt lds
  buffer_load_dwordx4 v14, s[16:19], s51 offen offset:2048 nt lds
  buffer_load_dwordx4 v15, s[16:19], s51 offen offset:3072 nt lds
  s_add_u32 s51, s51, 4096
  s_cmp_eq_u32 s51, s74
  s_cselect_b32 s53, 196608, 0
  s_sub_u32 s51, s51, s53
  s_add_u32 s41, s41, 79872
  s_cmp_ge_u32 s41, 159744
  s_cselect_b32 s53, 159744, 0
  s_sub_u32 s41, s41, s53
  s_waitcnt vmcnt(24)
  s_barrier
  s_add_u32 m0, s41, 0
  s_nop 0
  buffer_load_dwordx4 v10, s[16:19], s51 offen offset:0 nt lds
  buffer_load_dwordx4 v11, s[16:19], s51 offen offset:1024 nt lds
  buffer_load_dwordx4 v12, s[16:19], s51 offen offset:2048 nt lds
  buffer_load_dwordx4 v13, s[16:19], s51 offen offset:3072 nt lds
  s_add_u32 m0, s41, 4096
  s_add_u32 s51, s51, 4096
  buffer_load_dwordx4 v14, s[16:19], s51 offen offset:0 nt lds
  buffer_load_dwordx4 v15, s[16:19], s51 offen offset:1024 nt lds
  buffer_load_dwordx4 v10, s[16:19], s51 offen offset:2048 nt lds
  buffer_load_dwordx4 v11, s[16:19], s51 offen offset:3072 nt lds
  s_add_u32 m0, s41, 8192
  s_add_u32 s51, s51, 4096
  buffer_load_dwordx4 v12, s[16:19], s51 offen offset:0 nt lds
  buffer_load_dwordx4 v13, s[16:19], s51 offen offset:1024 nt lds
  buffer_load_dwordx4 v14, s[16:19], s51 offen offset:2048 nt lds
  buffer_load_dwordx4 v15, s[16:19], s51 offen offset:3072 nt lds
  s_add_u32 s51, s51, 4096
  s_cmp_eq_u32 s51, s74
  s_cselect_b32 s53, 196608, 0
  s_sub_u32 s51, s51, s53
  s_sub_u32 s41, s41, 26624
  s_add_u32 m0, s42, 12288
  s_nop 0
  buffer_load_dwordx4 v16, s[20:23], s52 offen offset:0 nt lds
  buffer_load_dwordx4 v17, s[20:23], s52 offen offset:1024 nt lds
  buffer_load_dwordx4 v18, s[20:23], s52 offen offset:2048 nt lds
  buffer_load_dwordx4 v16, s[20:23], s52 offen offset:3072 nt lds
  s_add_u32 m0, s42, 16384
  s_add_u32 s52, s52, 4096
  buffer_load_dwordx4 v17, s[20:23], s52 offen offset:0 nt lds
  buffer_load_dwordx4 v18, s[20:23], s52 offen offset:1024 nt lds
  buffer_load_dwordx4 v16, s[20:23], s52 offen offset:2048 nt lds
  buffer_load_dwordx4 v17, s[20:23], s52 offen offset:3072 nt lds
  s_add_u32 m0, s42, 20480
  s_add_u32 s52, s52, 4096
  buffer_load_dwordx4 v18, s[20:23], s52 offen offset:0 nt lds
  buffer_load_dwordx4 v16, s[20:23], s52 offen offset:1024 nt lds
  buffer_load_dwordx4 v17, s[20:23], s52 offen offset:2048 nt lds
  buffer_load_dwordx4 v18, s[20:23], s52 offen offset:3072 nt lds
  s_add_u32 s52, s52, 4096
  s_cmp_eq_u32 s52, s75
  s_cselect_b32 s53, 196608, 0
  s_sub_u32 s52, s52, s53
  s_sub_u32 s42, s42, 26624
  s_add_u32 m0, s42, 12288
  s_nop 0
  buffer_load_dwordx4 v16, s[20:23], s52 offen offset:0 nt lds
  buffer_load_dwordx4 v17, s[20:23], s52 offen offset:1024 nt lds
  buffer_load_dwordx4 v18, s[20:23], s52 offen offset:2048 nt lds
  buffer_load_dwordx4 v16, s[20:23], s52 offen offset:3072 nt lds
  s_add_u32 m0, s42, 16384
  s_add_u32 s52, s52, 4096
  buffer_load_dwordx4 v17, s[20:23], s52 offen offset:0 nt lds
  buffer_load_dwordx4 v18, s[20:23], s52 offen offset:1024 nt lds
  buffer_load_dwordx4 v16, s[20:23], s52 offen offset:2048 nt lds
  buffer_load_dwordx4 v17, s[20:23], s52 offen offset:3072 nt lds
  s_add_u32 m0, s42, 20480
  s_add_u32 s52, s52, 4096
  buffer_load_dwordx4 v18, s[20:23], s52 offen offset:0 nt lds
  buffer_load_dwordx4 v16, s[20:23], s52 offen offset:1024 nt lds
  buffer_load_dwordx4 v17, s[20:23], s52 offen offset:2048 nt lds
  buffer_load_dwordx4 v18, s[20:23], s52 offen offset:3072 nt lds
  s_add_u32 s52, s52, 4096
  s_cmp_eq_u32 s52, s75
  s_cselect_b32 s53, 196608, 0
  s_sub_u32 s52, s52, s53
  s_add_u32 s42, s42, 79872
  s_cmp_ge_u32 s42, 159744
  s_cselect_b32 s53, 159744, 0
  s_sub_u32 s42, s42, s53
  s_waitcnt vmcnt(48)
  s_add_u32 m0, s42, 12288
  s_nop 0
  buffer_load_dwordx4 v16, s[20:23], s52 offen offset:0 nt lds
  buffer_load_dwordx4 v17, s[20:23], s52 offen offset:1024 nt lds
  buffer_load_dwordx4 v18, s[20:23], s52 offen offset:2048 nt lds
  buffer_load_dwordx4 v16, s[20:23], s52 offen offset:3072 nt lds
  s_add_u32 m0, s42, 16384
  s_add_u32 s52, s52, 4096
  buffer_load_dwordx4 v17, s[20:23], s52 offen offset:0 nt lds
  buffer_load_dwordx4 v18, s[20:23], s52 offen offset:1024 nt lds
  buffer_load_dwordx4 v16, s[20:23], s52 offen offset:2048 nt lds
  buffer_load_dwordx4 v17, s[20:23], s52 offen offset:3072 nt lds
  s_add_u32 m0, s42, 20480
  s_add_u32 s52, s52, 4096
  buffer_load_dwordx4 v18, s[20:23], s52 offen offset:0 nt lds
  buffer_load_dwordx4 v16, s[20:23], s52 offen offset:1024 nt lds
  buffer_load_dwordx4 v17, s[20:23], s52 offen offset:2048 nt lds
  buffer_load_dwordx4 v18, s[20:23], s52 offen offset:3072 nt lds
  s_add_u32 s52, s52, 4096
  s_cmp_eq_u32 s52, s75
  s_cselect_b32 s53, 196608, 0
  s_sub_u32 s52, s52, s53
  s_sub_u32 s42, s42, 26624
  s_barrier
  s_waitcnt vmcnt(48)
  s_barrier
  s_add_u32 m0, s41, 0
  s_nop 0
  buffer_load_dwordx4 v10, s[16:19], s51 offen offset:0 nt lds
  buffer_load_dwordx4 v11, s[16:19], s51 offen offset:1024 nt lds
  buffer_load_dwordx4 v12, s[16:19], s51 offen offset:2048 nt lds
  buffer_load_dwordx4 v13, s[16:19], s51 offen offset:3072 nt lds
  s_add_u32 m0, s41, 4096
  s_add_u32 s51, s51, 4096
  buffer_load_dwordx4 v14, s[16:19], s51 offen offset:0 nt lds
  buffer_load_dwordx4 v15, s[16:19], s51 offen offset:1024 nt lds
  buffer_load_dwordx4 v10, s[16:19], s51 offen offset:2048 nt lds
  buffer_load_dwordx4 v11, s[16:19], s51 offen offset:3072 nt lds
  s_add_u32 m0, s41, 8192
  s_add_u32 s51, s51, 4096
  buffer_load_dwordx4 v12, s[16:19], s51 offen offset:0 nt lds
  buffer_load_dwordx4 v13, s[16:19], s51 offen offset:1024 nt lds
  buffer_load_dwordx4 v14, s[16:19], s51 offen offset:2048 nt lds
  buffer_load_dwordx4 v15, s[16:19], s51 offen offset:3072 nt lds
  s_add_u32 s51, s51, 4096
  s_cmp_eq_u32 s51, s74
  s_cselect_b32 s53, 196608, 0
  s_sub_u32 s51, s51, s53
  s_add_u32 s41, s41, 79872
  s_cmp_ge_u32 s41, 159744
  s_cselect_b32 s53, 159744, 0
  s_sub_u32 s41, s41, s53
  s_waitcnt vmcnt(48)
  s_add_u32 m0, s41, 0
  s_nop 0
  buffer_load_dwordx4 v10, s[16:19], s51 offen offset:0 nt lds
  buffer_load_dwordx4 v11, s[16:19], s51 offen offset:1024 nt lds
  buffer_load_dwordx4 v12, s[16:19], s51 offen offset:2048 nt lds
  buffer_load_dwordx4 v13, s[16:19], s51 offen offset:3072 nt lds
  s_add_u32 m0, s41, 4096
  s_add_u32 s51, s51, 4096
  buffer_load_dwordx4 v14, s[16:19], s51 offen offset:0 nt lds
  buffer_load_dwordx4 v15, s[16:19], s51 offen offset:1024 nt lds
  buffer_load_dwordx4 v10, s[16:19], s51 offen offset:2048 nt lds
  buffer_load_dwordx4 v11, s[16:19], s51 offen offset:3072 nt lds
  s_add_u32 m0, s41, 8192
  s_add_u32 s51, s51, 4096
  buffer_load_dwordx4 v12, s[16:19], s51 offen offset:0 nt lds
  buffer_load_dwordx4 v13, s[16:19], s51 offen offset:1024 nt lds
  buffer_load_dwordx4 v14, s[16:19], s51 offen offset:2048 nt lds
  buffer_load_dwordx4 v15, s[16:19], s51 offen offset:3072 nt lds
  s_add_u32 s51, s51, 4096
  s_cmp_eq_u32 s51, s74
  s_cselect_b32 s53, 196608, 0
  s_sub_u32 s51, s51, s53
  s_sub_u32 s41, s41, 26624
  s_waitcnt vmcnt(48)
  s_barrier
  s_add_u32 m0, s41, 0
  s_nop 0
  buffer_load_dwordx4 v10, s[16:19], s51 offen offset:0 nt lds
  buffer_load_dwordx4 v11, s[16:19], s51 offen offset:1024 nt lds
  buffer_load_dwordx4 v12, s[16:19], s51 offen offset:2048 nt lds
  buffer_load_dwordx4 v13, s[16:19], s51 offen offset:3072 nt lds
  s_add_u32 m0, s41, 4096
  s_add_u32 s51, s51, 4096
  buffer_load_dwordx4 v14, s[16:19], s51 offen offset:0 nt lds
  buffer_load_dwordx4 v15, s[16:19], s51 offen offset:1024 nt lds
  buffer_load_dwordx4 v10, s[16:19], s51 offen offset:2048 nt lds
  buffer_load_dwordx4 v11, s[16:19], s51 offen offset:3072 nt lds
  s_add_u32 m0, s41, 8192
  s_add_u32 s51, s51, 4096
  buffer_load_dwordx4 v12, s[16:19], s51 offen offset:0 nt lds
  buffer_load_dwordx4 v13, s[16:19], s51 offen offset:1024 nt lds
  buffer_load_dwordx4 v14, s[16:19], s51 offen offset:2048 nt lds
  buffer_load_dwordx4 v15, s[16:19], s51 offen offset:3072 nt lds
  s_add_u32 s51, s51, 4096
  s_cmp_eq_u32 s51, s74
  s_cselect_b32 s53, 196608, 0
  s_sub_u32 s51, s51, s53
  s_add_u32 s41, s41, 79872
  s_cmp_ge_u32 s41, 159744
  s_cselect_b32 s53, 159744, 0
  s_sub_u32 s41, s41, s53
  s_waitcnt vmcnt(48)
  s_add_u32 m0, s42, 12288
  s_nop 0
  buffer_load_dwordx4 v16, s[20:23], s52 offen offset:0 nt lds
  buffer_load_dwordx4 v17, s[20:23], s52 offen offset:1024 nt lds
  buffer_load_dwordx4 v18, s[20:23], s52 offen offset:2048 nt lds
  buffer_load_dwordx4 v16, s[20:23], s52 offen offset:3072 nt lds
  s_add_u32 m0, s42, 16384
  s_add_u32 s52, s52, 4096
  buffer_load_dwordx4 v17, s[20:23], s52 offen offset:0 nt lds
  buffer_load_dwordx4 v18, s[20:23], s52 offen offset:1024 nt lds
  buffer_load_dwordx4 v16, s[20:23], s52 offen offset:2048 nt lds
  buffer_load_dwordx4 v17, s[20:23], s52 offen offset:3072 nt lds
  s_add_u32 m0, s42, 20480
  s_add_u32 s52, s52, 4096
  buffer_load_dwordx4 v18, s[20:23], s52 offen offset:0 nt lds
  buffer_load_dwordx4 v16, s[20:23], s52 offen offset:1024 nt lds
  buffer_load_dwordx4 v17, s[20:23], s52 offen offset:2048 nt lds
  buffer_load_dwordx4 v18, s[20:23], s52 offen offset:3072 nt lds
  s_add_u32 s52, s52, 4096
  s_cmp_eq_u32 s52, s75
  s_cselect_b32 s53, 196608, 0
  s_sub_u32 s52, s52, s53
  s_add_u32 s42, s42, 79872
  s_cmp_ge_u32 s42, 159744
  s_cselect_b32 s53, 159744, 0
  s_sub_u32 s42, s42, s53
  s_waitcnt vmcnt(48)
  s_add_u32 m0, s41, 0
  s_nop 0
  buffer_load_dwordx4 v10, s[16:19], s51 offen offset:0 nt lds
  buffer_load_dwordx4 v11, s[16:19], s51 offen offset:1024 nt lds
  buffer_load_dwordx4 v12, s[16:19], s51 offen offset:2048 nt lds
  buffer_load_dwordx4 v13, s[16:19], s51 offen offset:3072 nt lds
  s_add_u32 m0, s41, 4096
  s_add_u32 s51, s51, 4096
  buffer_load_dwordx4 v14, s[16:19], s51 offen offset:0 nt lds
  buffer_load_dwordx4 v15, s[16:19], s51 offen offset:1024 nt lds
  buffer_load_dwordx4 v10, s[16:19], s51 offen offset:2048 nt lds
  buffer_load_dwordx4 v11, s[16:19], s51 offen offset:3072 nt lds
  s_add_u32 m0, s41, 8192
  s_add_u32 s51, s51, 4096
  buffer_load_dwordx4 v12, s[16:19], s51 offen offset:0 nt lds
  buffer_load_dwordx4 v13, s[16:19], s51 offen offset:1024 nt lds
  buffer_load_dwordx4 v14, s[16:19], s51 offen offset:2048 nt lds
  buffer_load_dwordx4 v15, s[16:19], s51 offen offset:3072 nt lds
  s_add_u32 s51, s51, 4096
  s_cmp_eq_u32 s51, s74
  s_cselect_b32 s53, 196608, 0
  s_sub_u32 s51, s51, s53
  s_sub_u32 s41, s41, 26624
  s_waitcnt vmcnt(48)
  s_add_u32 m0, s42, 12288
  s_nop 0
  buffer_load_dwordx4 v16, s[20:23], s52 offen offset:0 nt lds
  buffer_load_dwordx4 v17, s[20:23], s52 offen offset:1024 nt lds
  buffer_load_dwordx4 v18, s[20:23], s52 offen offset:2048 nt lds
  buffer_load_dwordx4 v16, s[20:23], s52 offen offset:3072 nt lds
  s_add_u32 m0, s42, 16384
  s_add_u32 s52, s52, 4096
  buffer_load_dwordx4 v17, s[20:23], s52 offen offset:0 nt lds
  buffer_load_dwordx4 v18, s[20:23], s52 offen offset:1024 nt lds
  buffer_load_dwordx4 v16, s[20:23], s52 offen offset:2048 nt lds
  buffer_load_dwordx4 v17, s[20:23], s52 offen offset:3072 nt lds
  s_add_u32 m0, s42, 20480
  s_add_u32 s52, s52, 4096
  buffer_load_dwordx4 v18, s[20:23], s52 offen offset:0 nt lds
  buffer_load_dwordx4 v16, s[20:23], s52 offen offset:1024 nt lds
  buffer_load_dwordx4 v17, s[20:23], s52 offen offset:2048 nt lds
  buffer_load_dwordx4 v18, s[20:23], s52 offen offset:3072 nt lds
  s_add_u32 s52, s52, 4096
  s_cmp_eq_u32 s52, s75
  s_cselect_b32 s53, 196608, 0
  s_sub_u32 s52, s52, s53
  s_sub_u32 s42, s42, 26624
  s_barrier
  s_waitcnt vmcnt(48)
  s_add_u32 m0, s41, 0
  s_nop 0
  buffer_load_dwordx4 v10, s[16:19], s51 offen offset:0 nt lds
  buffer_load_dwordx4 v11, s[16:19], s51 offen offset:1024 nt lds
  buffer_load_dwordx4 v12, s[16:19], s51 offen offset:2048 nt lds
  buffer_load_dwordx4 v13, s[16:19], s51 offen offset:3072 nt lds
  s_add_u32 m0, s41, 4096
  s_add_u32 s51, s51, 4096
  buffer_load_dwordx4 v14, s[16:19], s51 offen offset:0 nt lds
  buffer_load_dwordx4 v15, s[16:19], s51 offen offset:1024 nt lds
  buffer_load_dwordx4 v10, s[16:19], s51 offen offset:2048 nt lds
  buffer_load_dwordx4 v11, s[16:19], s51 offen offset:3072 nt lds
  s_add_u32 m0, s41, 8192
  s_add_u32 s51, s51, 4096
  buffer_load_dwordx4 v12, s[16:19], s51 offen offset:0 nt lds
  buffer_load_dwordx4 v13, s[16:19], s51 offen offset:1024 nt lds
  buffer_load_dwordx4 v14, s[16:19], s51 offen offset:2048 nt lds
  buffer_load_dwordx4 v15, s[16:19], s51 offen offset:3072 nt lds
  s_add_u32 s51, s51, 4096
  s_cmp_eq_u32 s51, s74
  s_cselect_b32 s53, 196608, 0
  s_sub_u32 s51, s51, s53
  s_add_u32 s41, s41, 79872
  s_cmp_ge_u32 s41, 159744
  s_cselect_b32 s53, 159744, 0
  s_sub_u32 s41, s41, s53
  s_mov_b32 s40, 3
L_ld1:
  s_barrier
  s_waitcnt vmcnt(48)
  s_add_u32 m0, s42, 12288
  s_nop 0
  buffer_load_dwordx4 v16, s[20:23], s52 offen offset:0 nt lds
  buffer_load_dwordx4 v17, s[20:23], s52 offen offset:1024 nt lds
  buffer_load_dwordx4 v18, s[20:23], s52 offen offset:2048 nt lds
  buffer_load_dwordx4 v16, s[20:23], s52 offen offset:3072 nt lds
  s_add_u32 m0, s42, 16384
  s_add_u32 s52, s52, 4096
  buffer_load_dwordx4 v17, s[20:23], s52 offen offset:0 nt lds
  buffer_load_dwordx4 v18, s[20:23], s52 offen offset:1024 nt lds
  buffer_load_dwordx4 v16, s[20:23], s52 offen offset:2048 nt lds
  buffer_load_dwordx4 v17, s[20:23], s52 offen offset:3072 nt lds
  s_add_u32 m0, s42, 20480
  s_add_u32 s52, s52, 4096
  buffer_load_dwordx4 v18, s[20:23], s52 offen offset:0 nt lds
  buffer_load_dwordx4 v16, s[20:23], s52 offen offset:1024 nt lds
  buffer_load_dwordx4 v17, s[20:23], s52 offen offset:2048 nt lds
  buffer_load_dwordx4 v18, s[20:23], s52 offen offset:3072 nt lds
  s_add_u32 s52, s52, 4096
  s_cmp_eq_u32 s52, s75
  s_cselect_b32 s53, 196608, 0
  s_sub_u32 s52, s52, s53
  s_add_u32 s42, s42, 79872
  s_cmp_ge_u32 s42, 159744
  s_cselect_b32 s53, 159744, 0
  s_sub_u32 s42, s42, s53
  s_waitcnt vmcnt(48)
  s_add_u32 m0, s41, 0
  s_nop 0
  buffer_load_dwordx4 v10, s[16:19], s51 offen offset:0 nt lds
  buffer_load_dwordx4 v11, s[16:19], s51 offen offset:1024 nt lds
  buffer_load_dwordx4 v12, s[16:19], s51 offen offset:2048 nt lds
  buffer_load_dwordx4 v13, s[16:19], s51 offen offset:3072 nt lds
  s_add_u32 m0, s41, 4096
  s_add_u32 s51, s51, 4096
  buffer_load_dwordx4 v14, s[16:19], s51 offen offset:0 nt lds
  buffer_load_dwordx4 v15, s[16:19], s51 offen offset:1024 nt lds
  buffer_load_dwordx4 v10, s[16:19], s51 offen offset:2048 nt lds
  buffer_load_dwordx4 v11, s[16:19], s51 offen offset:3072 nt lds
  s_add_u32 m0, s41, 8192
  s_add_u32 s51, s51, 4096
  buffer_load_dwordx4 v12, s[16:19], s51 offen offset:0 nt lds
  buffer_load_dwordx4 v13, s[16:19], s51 offen offset:1024 nt lds
  buffer_load_dwordx4 v14, s[16:19], s51 offen offset:2048 nt lds
  buffer_load_dwordx4 v15, s[16:19], s51 offen offset:3072 nt lds
  s_add_u32 s51, s51, 4096
  s_cmp_eq_u32 s51, s74
  s_cselect_b32 s53, 196608, 0
  s_sub_u32 s51, s51, s53
  s_sub_u32 s41, s41, 26624
  s_barrier
  s_waitcnt vmcnt(48)
  s_add_u32 m0, s42, 12288
  s_nop 0
  buffer_load_dwordx4 v16, s[20:23], s52 offen offset:0 nt lds
  buffer_load_dwordx4 v17, s[20:23], s52 offen offset:1024 nt lds
  buffer_load_dwordx4 v18, s[20:23], s52 offen offset:2048 nt lds
  buffer_load_dwordx4 v16, s[20:23], s52 offen offset:3072 nt lds
  s_add_u32 m0, s42, 16384
  s_add_u32 s52, s52, 4096
  buffer_load_dwordx4 v17, s[20:23], s52 offen offset:0 nt lds
  buffer_load_dwordx4 v18, s[20:23], s52 offen offset:1024 nt lds
  buffer_load_dwordx4 v16, s[20:23], s52 offen offset:2048 nt lds
  buffer_load_dwordx4 v17, s[20:23], s52 offen offset:3072 nt lds
  s_add_u32 m0, s42, 20480
  s_add_u32 s52, s52, 4096
  buffer_load_dwordx4 v18, s[20:23], s52 offen offset:0 nt lds
  buffer_load_dwordx4 v16, s[20:23], s52 offen offset:1024 nt lds
  buffer_load_dwordx4 v17, s[20:23], s52 offen offset:2048 nt lds
  buffer_load_dwordx4 v18, s[20:23], s52 offen offset:3072 nt lds
  s_add_u32 s52, s52, 4096
  s_cmp_eq_u32 s52, s75
  s_cselect_b32 s53, 196608, 0
  s_sub_u32 s52, s52, s53
  s_sub_u32 s42, s42, 26624
  s_waitcnt vmcnt(48)
  s_add_u32 m0, s41, 0
  s_nop 0
  buffer_load_dwordx4 v10, s[16:19], s51 offen offset:0 nt lds
  buffer_load_dwordx4 v11, s[16:19], s51 offen offset:1024 nt lds
  buffer_load_dwordx4 v12, s[16:19], s51 offen offset:2048 nt lds
  buffer_load_dwordx4 v13, s[16:19], s51 offen offset:3072 nt lds
  s_add_u32 m0, s41, 4096
  s_add_u32 s51, s51, 4096
  buffer_load_dwordx4 v14, s[16:19], s51 offen offset:0 nt lds
  buffer_load_dwordx4 v15, s[16:19], s51 offen offset:1024 nt lds
  buffer_load_dwordx4 v10, s[16:19], s51 offen offset:2048 nt lds
  buffer_load_dwordx4 v11, s[16:19], s51 offen offset:3072 nt lds
  s_add_u32 m0, s41, 8192
  s_add_u32 s51, s51, 4096
  buffer_load_dwordx4 v12, s[16:19], s51 offen offset:0 nt lds
  buffer_load_dwordx4 v13, s[16:19], s51 offen offset:1024 nt lds
  buffer_load_dwordx4 v14, s[16:19], s51 offen offset:2048 nt lds
  buffer_load_dwordx4 v15, s[16:19], s51 offen offset:3072 nt lds
  s_add_u32 s51, s51, 4096
  s_cmp_eq_u32 s51, s74
  s_cselect_b32 s53, 196608, 0
  s_sub_u32 s51, s51, s53
  s_add_u32 s41, s41, 79872
  s_cmp_ge_u32 s41, 159744
  s_cselect_b32 s53, 159744, 0
  s_sub_u32 s41, s41, s53
  s_sub_u32 s40, s40, 1
  s_cmp_lg_u32 s40, 0
  s_cbranch_scc1 L_ld1
  s_barrier
  s_waitcnt vmcnt(48)
  s_add_u32 m0, s42, 12288
  s_nop 0
  buffer_load_dwordx4 v16, s[20:23], s52 offen offset:0 nt lds
  buffer_load_dwordx4 v17, s[20:23], s52 offen offset:1024 nt lds
  buffer_load_dwordx4 v18, s[20:23], s52 offen offset:2048 nt lds
  buffer_load_dwordx4 v16, s[20:23], s52 offen offset:3072 nt lds
  s_add_u32 m0, s42, 16384
  s_add_u32 s52, s52, 4096
  buffer_load_dwordx4 v17, s[20:23], s52 offen offset:0 nt lds
  buffer_load_dwordx4 v18, s[20:23], s52 offen offset:1024 nt lds
  buffer_load_dwordx4 v16, s[20:23], s52 offen offset:2048 nt lds
  buffer_load_dwordx4 v17, s[20:23], s52 offen offset:3072 nt lds
  s_add_u32 m0, s42, 20480
  s_add_u32 s52, s52, 4096
  buffer_load_dwordx4 v18, s[20:23], s52 offen offset:0 nt lds
  buffer_load_dwordx4 v16, s[20:23], s52 offen offset:1024 nt lds
  buffer_load_dwordx4 v17, s[20:23], s52 offen offset:2048 nt lds
  buffer_load_dwordx4 v18, s[20:23], s52 offen offset:3072 nt lds
  s_add_u32 s52, s52, 4096
  s_cmp_eq_u32 s52, s75
  s_cselect_b32 s53, 196608, 0
  s_sub_u32 s52, s52, s53
  s_add_u32 s42, s42, 79872
  s_cmp_ge_u32 s42, 159744
  s_cselect_b32 s53, 159744, 0
  s_sub_u32 s42, s42, s53
  s_waitcnt vmcnt(48)
  s_add_u32 m0, s41, 0
  s_nop 0
  buffer_load_dwordx4 v10, s[16:19], s51 offen offset:0 nt lds
  buffer_load_dwordx4 v11, s[16:19], s51 offen offset:1024 nt lds
  buffer_load_dwordx4 v12, s[16:19], s51 offen offset:2048 nt lds
  buffer_load_dwordx4 v13, s[16:19], s51 offen offset:3072 nt lds
  s_add_u32 m0, s41, 4096
  s_add_u32 s51, s51, 4096
  buffer_load_dwordx4 v14, s[16:19], s51 offen offset:0 nt lds
  buffer_load_dwordx4 v15, s[16:19], s51 offen offset:1024 nt lds
  buffer_load_dwordx4 v10, s[16:19], s51 offen offset:2048 nt lds
  buffer_load_dwordx4 v11, s[16:19], s51 offen offset:3072 nt lds
  s_add_u32 m0, s41, 8192
  s_add_u32 s51, s51, 4096
  buffer_load_dwordx4 v12, s[16:19], s51 offen offset:0 nt lds
  buffer_load_dwordx4 v13, s[16:19], s51 offen offset:1024 nt lds
  buffer_load_dwordx4 v14, s[16:19], s51 offen offset:2048 nt lds
  buffer_load_dwordx4 v15, s[16:19], s51 offen offset:3072 nt lds
  s_add_u32 s51, s51, 4096
  s_cmp_eq_u32 s51, s74
  s_cselect_b32 s53, 196608, 0
  s_sub_u32 s51, s51, s53
  s_sub_u32 s41, s41, 26624
  s_barrier
  s_waitcnt vmcnt(48)
  s_add_u32 m0, s42, 12288
  s_nop 0
  buffer_load_dwordx4 v16, s[20:23], s52 offen offset:0 nt lds
  buffer_load_dwordx4 v17, s[20:23], s52 offen offset:1024 nt lds
  buffer_load_dwordx4 v18, s[20:23], s52 offen offset:2048 nt lds
  buffer_load_dwordx4 v16, s[20:23], s52 offen offset:3072 nt lds
  s_add_u32 m0, s42, 16384
  s_add_u32 s52, s52, 4096
  buffer_load_dwordx4 v17, s[20:23], s52 offen offset:0 nt lds
  buffer_load_dwordx4 v18, s[20:23], s52 offen offset:1024 nt lds
  buffer_load_dwordx4 v16, s[20:23], s52 offen offset:2048 nt lds
  buffer_load_dwordx4 v17, s[20:23], s52 offen offset:3072 nt lds
  s_add_u32 m0, s42, 20480
  s_add_u32 s52, s52, 4096
  buffer_load_dwordx4 v18, s[20:23], s52 offen offset:0 nt lds
  buffer_load_dwordx4 v16, s[20:23], s52 offen offset:1024 nt lds
  buffer_load_dwordx4 v17, s[20:23], s52 offen offset:2048 nt lds
  buffer_load_dwordx4 v18, s[20:23], s52 offen offset:3072 nt lds
  s_add_u32 s52, s52, 4096
  s_cmp_eq_u32 s52, s75
  s_cselect_b32 s53, 196608, 0
  s_sub_u32 s52, s52, s53
  s_sub_u32 s42, s42, 26624
  s_waitcnt vmcnt(48)
  s_add_u32 m0, s41, 0
  s_nop 0
  buffer_load_dwordx4 v10, s[16:19], s51 offen offset:0 nt lds
  buffer_load_dwordx4 v11, s[16:19], s51 offen offset:1024 nt lds
  buffer_load_dwordx4 v12, s[16:19], s51 offen offset:2048 nt lds
  buffer_load_dwordx4 v13, s[16:19], s51 offen offset:3072 nt lds
  s_add_u32 m0, s41, 4096
  s_add_u32 s51, s51, 4096
  buffer_load_dwordx4 v14, s[16:19], s51 offen offset:0 nt lds
  buffer_load_dwordx4 v15, s[16:19], s51 offen offset:1024 nt lds
  buffer_load_dwordx4 v10, s[16:19], s51 offen offset:2048 nt lds
  buffer_load_dwordx4 v11, s[16:19], s51 offen offset:3072 nt lds
  s_add_u32 m0, s41, 8192
  s_add_u32 s51, s51, 4096
  buffer_load_dwordx4 v12, s[16:19], s51 offen offset:0 nt lds
  buffer_load_dwordx4 v13, s[16:19], s51 offen offset:1024 nt lds
  buffer_load_dwordx4 v14, s[16:19], s51 offen offset:2048 nt lds
  buffer_load_dwordx4 v15, s[16:19], s51 offen offset:3072 nt lds
  s_add_u32 s51, s51, 4096
  s_cmp_eq_u32 s51, s74
  s_cselect_b32 s53, 196608, 0
  s_sub_u32 s51, s51, s53
  s_add_u32 s51, s51, s85
  s_add_u32 s74, s74, s85
  s_mov_b32 s41, 79872
  s_barrier
  s_waitcnt vmcnt(48)
  s_add_u32 m0, s42, 12288
  s_nop 0
  buffer_load_dwordx4 v16, s[20:23], s52 offen offset:0 nt lds
  buffer_load_dwordx4 v17, s[20:23], s52 offen offset:1024 nt lds
  buffer_load_dwordx4 v18, s[20:23], s52 offen offset:2048 nt lds
  buffer_load_dwordx4 v16, s[20:23], s52 offen offset:3072 nt lds
  s_add_u32 m0, s42, 16384
  s_add_u32 s52, s52, 4096
  buffer_load_dwordx4 v17, s[20:23], s52 offen offset:0 nt lds
  buffer_load_dwordx4 v18, s[20:23], s52 offen offset:1024 nt lds
  buffer_load_dwordx4 v16, s[20:23], s52 offen offset:2048 nt lds
  buffer_load_dwordx4 v17, s[20:23], s52 offen offset:3072 nt lds
  s_add_u32 m0, s42, 20480
  s_add_u32 s52, s52, 4096
  buffer_load_dwordx4 v18, s[20:23], s52 offen offset:0 nt lds
  buffer_load_dwordx4 v16, s[20:23], s52 offen offset:1024 nt lds
  buffer_load_dwordx4 v17, s[20:23], s52 offen offset:2048 nt lds
  buffer_load_dwordx4 v18, s[20:23], s52 offen offset:3072 nt lds
  s_add_u32 s52, s52, 4096
  s_cmp_eq_u32 s52, s75
  s_cselect_b32 s53, 196608, 0
  s_sub_u32 s52, s52, s53
  s_add_u32 s42, s42, 79872
  s_cmp_ge_u32 s42, 159744
  s_cselect_b32 s53, 159744, 0
  s_sub_u32 s42, s42, s53
  s_waitcnt vmcnt(48)
  s_add_u32 m0, s42, 12288
  s_nop 0
  buffer_load_dwordx4 v16, s[20:23], s52 offen offset:0 nt lds
  buffer_load_dwordx4 v17, s[20:23], s52 offen offset:1024 nt lds
  buffer_load_dwordx4 v18, s[20:23], s52 offen offset:2048 nt lds
  buffer_load_dwordx4 v16, s[20:23], s52 offen offset:3072 nt lds
  s_add_u32 m0, s42, 16384
  s_add_u32 s52, s52, 4096
  buffer_load_dwordx4 v17, s[20:23], s52 offen offset:0 nt lds
  buffer_load_dwordx4 v18, s[20:23], s52 offen offset:1024 nt lds
  buffer_load_dwordx4 v16, s[20:23], s52 offen offset:2048 nt lds
  buffer_load_dwordx4 v17, s[20:23], s52 offen offset:3072 nt lds
  s_add_u32 m0, s42, 20480
  s_add_u32 s52, s52, 4096
  buffer_load_dwordx4 v18, s[20:23], s52 offen offset:0 nt lds
  buffer_load_dwordx4 v16, s[20:23], s52 offen offset:1024 nt lds
  buffer_load_dwordx4 v17, s[20:23], s52 offen offset:2048 nt lds
  buffer_load_dwordx4 v18, s[20:23], s52 offen offset:3072 nt lds
  s_add_u32 s52, s52, 4096
  s_cmp_eq_u32 s52, s75
  s_cselect_b32 s53, 196608, 0
  s_sub_u32 s52, s52, s53
  s_sub_u32 s42, s42, 26624
  s_barrier
  s_waitcnt vmcnt(48)
  s_add_u32 m0, s42, 12288
  s_nop 0
  buffer_load_dwordx4 v16, s[20:23], s52 offen offset:0 nt lds
  buffer_load_dwordx4 v17, s[20:23], s52 offen offset:1024 nt lds
  buffer_load_dwordx4 v18, s[20:23], s52 offen offset:2048 nt lds
  buffer_load_dwordx4 v16, s[20:23], s52 offen offset:3072 nt lds
  s_add_u32 m0, s42, 16384
  s_add_u32 s52, s52, 4096
  buffer_load_dwordx4 v17, s[20:23], s52 offen offset:0 nt lds
  buffer_load_dwordx4 v18, s[20:23], s52 offen offset:1024 nt lds
  buffer_load_dwordx4 v16, s[20:23], s52 offen offset:2048 nt lds
  buffer_load_dwordx4 v17, s[20:23], s52 offen offset:3072 nt lds
  s_add_u32 m0, s42, 20480
  s_add_u32 s52, s52, 4096
  buffer_load_dwordx4 v18, s[20:23], s52 offen offset:0 nt lds
  buffer_load_dwordx4 v16, s[20:23], s52 offen offset:1024 nt lds
  buffer_load_dwordx4 v17, s[20:23], s52 offen offset:2048 nt lds
  buffer_load_dwordx4 v18, s[20:23], s52 offen offset:3072 nt lds
  s_add_u32 s52, s52, 4096
  s_cmp_eq_u32 s52, s75
  s_cselect_b32 s53, 196608, 0
  s_sub_u32 s52, s52, s53
  s_add_u32 s52, s52, s85
  s_add_u32 s75, s75, s85
  s_mov_b32 s42, 79872
  s_waitcnt vmcnt(48)
  s_add_u32 m0, s43, 0
  s_add_u32 s49, s49, 98304
  buffer_load_dwordx4 v20, s[12:15], s49 offen offset:0  lds
  buffer_load_dwordx4 v21, s[12:15], s49 offen offset:1024  lds
  buffer_load_dwordx4 v22, s[12:15], s49 offen offset:2048  lds
  s_add_u32 m0, s43, 3072
  s_add_u32 s49, s49, 98304
  buffer_load_dwordx4 v23, s[12:15], s49 offen offset:0  lds
  buffer_load_dwordx4 v24, s[12:15], s49 offen offset:1024  lds
  buffer_load_dwordx4 v25, s[12:15], s49 offen offset:2048  lds
  s_add_u32 m0, s43, 6144
  s_add_u32 s49, s49, 98304
  buffer_load_dwordx4 v20, s[12:15], s49 offen offset:0  lds
  buffer_load_dwordx4 v21, s[12:15], s49 offen offset:1024  lds
  buffer_load_dwordx4 v22, s[12:15], s49 offen offset:2048  lds
  s_add_u32 m0, s43, 9216
  s_add_u32 s49, s49, 98304
  buffer_load_dwordx4 v23, s[12:15], s49 offen offset:0  lds
  buffer_load_dwordx4 v24, s[12:15], s49 offen offset:1024  lds
  buffer_load_dwordx4 v25, s[12:15], s49 offen offset:2048  lds
  s_barrier
  s_waitcnt vmcnt(48)
  s_add_u32 m0, s43, 12288
  s_add_u32 s49, s49, 98304
  buffer_load_dwordx4 v20, s[12:15], s49 offen offset:0  lds
  buffer_load_dwordx4 v21, s[12:15], s49 offen offset:1024  lds
  buffer_load_dwordx4 v22, s[12:15], s49 offen offset:2048  lds
  s_add_u32 m0, s43, 15360
  s_add_u32 s49, s49, 98304
  buffer_load_dwordx4 v23, s[12:15], s49 offen offset:0  lds
  buffer_load_dwordx4 v24, s[12:15], s49 offen offset:1024  lds
  buffer_load_dwordx4 v25, s[12:15], s49 offen offset:2048  lds
  s_add_u32 m0, s43, 18432
  s_add_u32 s49, s49, 98304
  buffer_load_dwordx4 v20, s[12:15], s49 offen offset:0  lds
  buffer_load_dwordx4 v21, s[12:15], s49 offen offset:1024  lds
  buffer_load_dwordx4 v22, s[12:15], s49 offen offset:2048  lds
  s_add_u32 m0, s43, 21504
  s_add_u32 s49, s49, 98304
  buffer_load_dwordx4 v23, s[12:15], s49 offen offset:0  lds
  buffer_load_dwordx4 v24, s[12:15], s49 offen offset:1024  lds
  buffer_load_dwordx4 v25, s[12:15], s49 offen offset:2048  lds
  s_add_u32 s43, s43, 53248
  s_cmp_ge_u32 s43, 159744
  s_cselect_b32 s53, 159744, 0
  s_sub_u32 s43, s43, s53
  s_waitcnt vmcnt(48)
  s_barrier
  s_add_u32 m0, s43, 0
  s_add_u32 s49, s49, 98304
  buffer_load_dwordx4 v20, s[12:15], s49 offen offset:0  lds
  buffer_load_dwordx4 v21, s[12:15], s49 offen offset:1024  lds
  buffer_load_dwordx4 v22, s[12:15], s49 offen offset:2048  lds
  s_add_u32 m0, s43, 3072
  s_add_u32 s49, s49, 98304
  buffer_load_dwordx4 v23, s[12:15], s49 offen offset:0  lds
  buffer_load_dwordx4 v24, s[12:15], s49 offen offset:1024  lds
  buffer_load_dwordx4 v25, s[12:15], s49 offen offset:2048  lds
  s_add_u32 m0, s43, 6144
  s_add_u32 s49, s49, 98304
  buffer_load_dwordx4 v20, s[12:15], s49 offen offset:0  lds
  buffer_load_dwordx4 v21, s[12:15], s49 offen offset:1024  lds
  buffer_load_dwordx4 v22, s[12:15], s49 offen offset:2048  lds
  s_add_u32 m0, s43, 9216
  s_add_u32 s49, s49, 98304
  buffer_load_dwordx4 v23, s[12:15], s49 offen offset:0  lds
  buffer_load_dwordx4 v24, s[12:15], s49 offen offset:1024  lds
  buffer_load_dwordx4 v25, s[12:15], s49 offen offset:2048  lds
  s_waitcnt vmcnt(36)
  s_barrier
  s_add_u32 m0, s43, 12288
  s_add_u32 s49, s49, 98304
  buffer_load_dwordx4 v20, s[12:15], s49 offen offset:0  lds
  buffer_load_dwordx4 v21, s[12:15], s49 offen offset:1024  lds
  buffer_load_dwordx4 v22, s[12:15], s49 offen offset:2048  lds
  s_add_u32 m0, s43, 15360
  s_add_u32 s49, s49, 98304
  buffer_load_dwordx4 v23, s[12:15], s49 offen offset:0  lds
  buffer_load_dwordx4 v24, s[12:15], s49 offen offset:1024  lds
  buffer_load_dwordx4 v25, s[12:15], s49 offen offset:2048  lds
  s_add_u32 m0, s43, 18432
  s_add_u32 s49, s49, 98304
  buffer_load_dwordx4 v20, s[12:15], s49 offen offset:0  lds
  buffer_load_dwordx4 v21, s[12:15], s49 offen offset:1024  lds
  buffer_load_dwordx4 v22, s[12:15], s49 offen offset:2048  lds
  s_add_u32 m0, s43, 21504
  s_add_u32 s49, s49, 98304
  buffer_load_dwordx4 v23, s[12:15], s49 offen offset:0  lds
  buffer_load_dwordx4 v24, s[12:15], s49 offen offset:1024  lds
  buffer_load_dwordx4 v25, s[12:15], s49 offen offset:2048  lds
  s_add_u32 s43, s43, 53248
  s_cmp_ge_u32 s43, 159744
  s_cselect_b32 s53, 159744, 0
  s_sub_u32 s43, s43, s53
  s_waitcnt vmcnt(24)
  s_barrier
  s_add_u32 m0, s43, 0
  s_add_u32 s49, s49, 98304
  buffer_load_dwordx4 v20, s[12:15], s49 offen offset:0  lds
  buffer_load_dwordx4 v21, s[12:15], s49 offen offset:1024  lds
  buffer_load_dwordx4 v22, s[12:15], s49 offen offset:2048  lds
  s_add_u32 m0, s43, 3072
  s_add_u32 s49, s49, 98304
  buffer_load_dwordx4 v23, s[12:15], s49 offen offset:0  lds
  buffer_load_dwordx4 v24, s[12:15], s49 offen offset:1024  lds
  buffer_load_dwordx4 v25, s[12:15], s49 offen offset:2048  lds
  s_add_u32 m0, s43, 6144
  s_add_u32 s49, s49, 98304
  buffer_load_dwordx4 v20, s[12:15], s49 offen offset:0  lds
  buffer_load_dwordx4 v21, s[12:15], s49 offen offset:1024  lds
  buffer_load_dwordx4 v22, s[12:15], s49 offen offset:2048  lds
  s_add_u32 m0, s43, 9216
  s_add_u32 s49, s49, 98304
  buffer_load_dwordx4 v23, s[12:15], s49 offen offset:0  lds
  buffer_load_dwordx4 v24, s[12:15], s49 offen offset:1024  lds
  buffer_load_dwordx4 v25, s[12:15], s49 offen offset:2048  lds
  s_waitcnt vmcnt(24)
  s_barrier
  s_add_u32 m0, s43, 12288
  s_add_u32 s49, s49, 98304
  buffer_load_dwordx4 v20, s[12:15], s49 offen offset:0  lds
  buffer_load_dwordx4 v21, s[12:15], s49 offen offset:1024  lds
  buffer_load_dwordx4 v22, s[12:15], s49 offen offset:2048  lds
  s_add_u32 m0, s43, 15360
  s_add_u32 s49, s49, 98304
  buffer_load_dwordx4 v23, s[12:15], s49 offen offset:0  lds
  buffer_load_dwordx4 v24, s[12:15], s49 offen offset:1024  lds
  buffer_load_dwordx4 v25, s[12:15], s49 offen offset:2048  lds
  s_add_u32 m0, s43, 18432
  s_add_u32 s49, s49, 98304
  buffer_load_dwordx4 v20, s[12:15], s49 offen offset:0  lds
  buffer_load_dwordx4 v21, s[12:15], s49 offen offset:1024  lds
  buffer_load_dwordx4 v22, s[12:15], s49 offen offset:2048  lds
  s_add_u32 m0, s43, 21504
  s_add_u32 s49, s49, 98304
  buffer_load_dwordx4 v23, s[12:15], s49 offen offset:0  lds
  buffer_load_dwordx4 v24, s[12:15], s49 offen offset:1024  lds
  buffer_load_dwordx4 v25, s[12:15], s49 offen offset:2048  lds
  s_add_u32 s43, s43, 53248
  s_cmp_ge_u32 s43, 159744
  s_cselect_b32 s53, 159744, 0
  s_sub_u32 s43, s43, s53
  s_waitcnt vmcnt(24)
  s_barrier
  s_add_u32 m0, s43, 0
  s_add_u32 s49, s49, 98304
  buffer_load_dwordx4 v20, s[12:15], s49 offen offset:0  lds
  buffer_load_dwordx4 v21, s[12:15], s49 offen offset:1024  lds
  buffer_load_dwordx4 v22, s[12:15], s49 offen offset:2048  lds
  s_add_u32 m0, s43, 3072
  s_add_u32 s49, s49, 98304
  buffer_load_dwordx4 v23, s[12:15], s49 offen offset:0  lds
  buffer_load_dwordx4 v24, s[12:15], s49 offen offset:1024  lds
  buffer_load_dwordx4 v25, s[12:15], s49 offen offset:2048  lds
  s_add_u32 m0, s43, 6144
  s_add_u32 s49, s49, 98304
  buffer_load_dwordx4 v20, s[12:15], s49 offen offset:0  lds
  buffer_load_dwordx4 v21, s[12:15], s49 offen offset:1024  lds
  buffer_load_dwordx4 v22, s[12:15], s49 offen offset:2048  lds
  s_add_u32 m0, s43, 9216
  s_add_u32 s49, s49, 98304
  buffer_load_dwordx4 v23, s[12:15], s49 offen offset:0  lds
  buffer_load_dwordx4 v24, s[12:15], s49 offen offset:1024  lds
  buffer_load_dwordx4 v25, s[12:15], s49 offen offset:2048  lds
  s_add_u32 m0, s43, 12288
  s_add_u32 s49, s49, 98304
  buffer_load_dwordx4 v20, s[12:15], s49 offen offset:0  lds
  buffer_load_dwordx4 v21, s[12:15], s49 offen offset:1024  lds
  buffer_load_dwordx4 v22, s[12:15], s49 offen offset:2048  lds
  s_add_u32 m0, s43, 15360
  s_add_u32 s49, s49, 98304
  buffer_load_dwordx4 v23, s[12:15], s49 offen offset:0  lds
  buffer_load_dwordx4 v24, s[12:15], s49 offen offset:1024  lds
  buffer_load_dwordx4 v25, s[12:15], s49 offen offset:2048  lds
  s_add_u32 m0, s43, 18432
  s_add_u32 s49, s49, 98304
  buffer_load_dwordx4 v20, s[12:15], s49 offen offset:0  lds
  buffer_load_dwordx4 v21, s[12:15], s49 offen offset:1024  lds
  buffer_load_dwordx4 v22, s[12:15], s49 offen offset:2048  lds
  s_add_u32 m0, s43, 21504
  s_add_u32 s49, s49, 98304
  buffer_load_dwordx4 v23, s[12:15], s49 offen offset:0  lds
  buffer_load_dwordx4 v24, s[12:15], s49 offen offset:1024  lds
  buffer_load_dwordx4 v25, s[12:15], s49 offen offset:2048  lds
  s_add_u32 s43, s43, 53248
  s_cmp_ge_u32 s43, 159744
  s_cselect_b32 s53, 159744, 0
  s_sub_u32 s43, s43, s53
  s_mov_b32 s40, 5
L_ld2:
  s_waitcnt vmcnt(36)
  s_barrier
  s_add_u32 m0, s43, 0
  s_add_u32 s49, s49, 98304
  buffer_load_dwordx4 v20, s[12:15], s49 offen offset:0  lds
  buffer_load_dwordx4 v21, s[12:15], s49 offen offset:1024  lds
  buffer_load_dwordx4 v22, s[12:15], s49 offen offset:2048  lds
  s_add_u32 m0, s43, 3072
  s_add_u32 s49, s49, 98304
  buffer_load_dwordx4 v23, s[12:15], s49 offen offset:0  lds
  buffer_load_dwordx4 v24, s[12:15], s49 offen offset:1024  lds
  buffer_load_dwordx4 v25, s[12:15], s49 offen offset:2048  lds
  s_add_u32 m0, s43, 6144
  s_add_u32 s49, s49, 98304
  buffer_load_dwordx4 v20, s[12:15], s49 offen offset:0  lds
  buffer_load_dwordx4 v21, s[12:15], s49 offen offset:1024  lds
  buffer_load_dwordx4 v22, s[12:15], s49 offen offset:2048  lds
  s_add_u32 m0, s43, 9216
  s_add_u32 s49, s49, 98304
  buffer_load_dwordx4 v23, s[12:15], s49 offen offset:0  lds
  buffer_load_dwordx4 v24, s[12:15], s49 offen offset:1024  lds
  buffer_load_dwordx4 v25, s[12:15], s49 offen offset:2048  lds
  s_waitcnt vmcnt(36)
  s_barrier
  s_add_u32 m0, s43, 12288
  s_add_u32 s49, s49, 98304
  buffer_load_dwordx4 v20, s[12:15], s49 offen offset:0  lds
  buffer_load_dwordx4 v21, s[12:15], s49 offen offset:1024  lds
  buffer_load_dwordx4 v22, s[12:15], s49 offen offset:2048  lds
  s_add_u32 m0, s43, 15360
  s_add_u32 s49, s49, 98304
  buffer_load_dwordx4 v23, s[12:15], s49 offen offset:0  lds
  buffer_load_dwordx4 v24, s[12:15], s49 offen offset:1024  lds
  buffer_load_dwordx4 v25, s[12:15], s49 offen offset:2048  lds
  s_add_u32 m0, s43, 18432
  s_add_u32 s49, s49, 98304
  buffer_load_dwordx4 v20, s[12:15], s49 offen offset:0  lds
  buffer_load_dwordx4 v21, s[12:15], s49 offen offset:1024  lds
  buffer_load_dwordx4 v22, s[12:15], s49 offen offset:2048  lds
  s_add_u32 m0, s43, 21504
  s_add_u32 s49, s49, 98304
  buffer_load_dwordx4 v23, s[12:15], s49 offen offset:0  lds
  buffer_load_dwordx4 v24, s[12:15], s49 offen offset:1024  lds
  buffer_load_dwordx4 v25, s[12:15], s49 offen offset:2048  lds
  s_add_u32 s43, s43, 53248
  s_cmp_ge_u32 s43, 159744
  s_cselect_b32 s53, 159744, 0
  s_sub_u32 s43, s43, s53
  s_sub_u32 s40, s40, 1
  s_cmp_lg_u32 s40, 0
  s_cbranch_scc1 L_ld2
  s_waitcnt vmcnt(36)
  s_barrier
  s_add_u32 m0, s43, 0
  s_add_u32 s49, s49, 98304
  buffer_load_dwordx4 v20, s[12:15], s49 offen offset:0  lds
  buffer_load_dwordx4 v21, s[12:15], s49 offen offset:1024  lds
  buffer_load_dwordx4 v22, s[12:15], s49 offen offset:2048  lds
  s_add_u32 m0, s43, 3072
  s_add_u32 s49, s49, 98304
  buffer_load_dwordx4 v23, s[12:15], s49 offen offset:0  lds
  buffer_load_dwordx4 v24, s[12:15], s49 offen offset:1024  lds
  buffer_load_dwordx4 v25, s[12:15], s49 offen offset:2048  lds
  s_add_u32 m0, s43, 6144
  s_add_u32 s49, s49, 98304
  buffer_load_dwordx4 v20, s[12:15], s49 offen offset:0  lds
  buffer_load_dwordx4 v21, s[12:15], s49 offen offset:1024  lds
  buffer_load_dwordx4 v22, s[12:15], s49 offen offset:2048  lds
  s_add_u32 m0, s43, 9216
  s_add_u32 s49, s49, 98304
  buffer_load_dwordx4 v23, s[12:15], s49 offen offset:0  lds
  buffer_load_dwordx4 v24, s[12:15], s49 offen offset:1024  lds
  buffer_load_dwordx4 v25, s[12:15], s49 offen offset:2048  lds
  s_waitcnt vmcnt(36)
  s_barrier
  s_add_u32 m0, s43, 12288
  s_add_u32 s49, s49, 98304
  buffer_load_dwordx4 v20, s[12:15], s49 offen offset:0  lds
  buffer_load_dwordx4 v21, s[12:15], s49 offen offset:1024  lds
  buffer_load_dwordx4 v22, s[12:15], s49 offen offset:2048  lds
  s_add_u32 m0, s43, 15360
  s_add_u32 s49, s49, 98304
  buffer_load_dwordx4 v23, s[12:15], s49 offen offset:0  lds
  buffer_load_dwordx4 v24, s[12:15], s49 offen offset:1024  lds
  buffer_load_dwordx4 v25, s[12:15], s49 offen offset:2048  lds
  s_add_u32 m0, s43, 18432
  s_add_u32 s49, s49, 98304
  buffer_load_dwordx4 v20, s[12:15], s49 offen offset:0  lds
  buffer_load_dwordx4 v21, s[12:15], s49 offen offset:1024  lds
  buffer_load_dwordx4 v22, s[12:15], s49 offen offset:2048  lds
  s_add_u32 m0, s43, 21504
  s_add_u32 s49, s49, 98304
  buffer_load_dwordx4 v23, s[12:15], s49 offen offset:0  lds
  buffer_load_dwordx4 v24, s[12:15], s49 offen offset:1024  lds
  buffer_load_dwordx4 v25, s[12:15], s49 offen offset:2048  lds
  s_sub_u32 s49, s49, s84
  s_add_u32 m0, s41, 0
  s_nop 0
  buffer_load_dwordx4 v10, s[16:19], s51 offen offset:0 nt lds
  buffer_load_dwordx4 v11, s[16:19], s51 offen offset:1024 nt lds
  buffer_load_dwordx4 v12, s[16:19], s51 offen offset:2048 nt lds
  buffer_load_dwordx4 v13, s[16:19], s51 offen offset:3072 nt lds
  s_add_u32 m0, s41, 4096
  s_add_u32 s51, s51, 4096
  buffer_load_dwordx4 v14, s[16:19], s51 offen offset:0 nt lds
  buffer_load_dwordx4 v15, s[16:19], s51 offen offset:1024 nt lds
  buffer_load_dwordx4 v10, s[16:19], s51 offen offset:2048 nt lds
  buffer_load_dwordx4 v11, s[16:19], s51 offen offset:3072 nt lds
  s_add_u32 m0, s41, 8192
  s_add_u32 s51, s51, 4096
  buffer_load_dwordx4 v12, s[16:19], s51 offen offset:0 nt lds
  buffer_load_dwordx4 v13, s[16:19], s51 offen offset:1024 nt lds
  buffer_load_dwordx4 v14, s[16:19], s51 offen offset:2048 nt lds
  buffer_load_dwordx4 v15, s[16:19], s51 offen offset:3072 nt lds
  s_add_u32 s51, s51, 4096
  s_cmp_eq_u32 s51, s74
  s_cselect_b32 s53, 196608, 0
  s_sub_u32 s51, s51, s53
  s_sub_u32 s41, s41, 26624
  s_waitcnt vmcnt(36)
  s_barrier
  s_add_u32 m0, s41, 0
  s_nop 0
  buffer_load_dwordx4 v10, s[16:19], s51 offen offset:0 nt lds
  buffer_load_dwordx4 v11, s[16:19], s51 offen offset:1024 nt lds
  buffer_load_dwordx4 v12, s[16:19], s51 offen offset:2048 nt lds
  buffer_load_dwordx4 v13, s[16:19], s51 offen offset:3072 nt lds
  s_add_u32 m0, s41, 4096
  s_add_u32 s51, s51, 4096
  buffer_load_dwordx4 v14, s[16:19], s51 offen offset:0 nt lds
  buffer_load_dwordx4 v15, s[16:19], s51 offen offset:1024 nt lds
  buffer_load_dwordx4 v10, s[16:19], s51 offen offset:2048 nt lds
  buffer_load_dwordx4 v11, s[16:19], s51 offen offset:3072 nt lds
  s_add_u32 m0, s41, 8192
  s_add_u32 s51, s51, 4096
  buffer_load_dwordx4 v12, s[16:19], s51 offen offset:0 nt lds
  buffer_load_dwordx4 v13, s[16:19], s51 offen offset:1024 nt lds
  buffer_load_dwordx4 v14, s[16:19], s51 offen offset:2048 nt lds
  buffer_load_dwordx4 v15, s[16:19], s51 offen offset:3072 nt lds
  s_add_u32 s51, s51, 4096
  s_cmp_eq_u32 s51, s74
  s_cselect_b32 s53, 196608, 0
  s_sub_u32 s51, s51, s53
  s_add_u32 s41, s41, 79872
  s_cmp_ge_u32 s41, 159744
  s_cselect_b32 s53, 159744, 0
  s_sub_u32 s41, s41, s53
  s_waitcnt vmcnt(24)
  s_barrier
  s_add_u32 m0, s41, 0
  s_nop 0
  buffer_load_dwordx4 v10, s[16:19], s51 offen offset:0 nt lds
  buffer_load_dwordx4 v11, s[16:19], s51 offen offset:1024 nt lds
  buffer_load_dwordx4 v12, s[16:19], s51 offen offset:2048 nt lds
  buffer_load_dwordx4 v13, s[16:19], s51 offen offset:3072 nt lds
  s_add_u32 m0, s41, 4096
  s_add_u32 s51, s51, 4096
  buffer_load_dwordx4 v14, s[16:19], s51 offen offset:0 nt lds
  buffer_load_dwordx4 v15, s[16:19], s51 offen offset:1024 nt lds
  buffer_load_dwordx4 v10, s[16:19], s51 offen offset:2048 nt lds
  buffer_load_dwordx4 v11, s[16:19], s51 offen offset:3072 nt lds
  s_add_u32 m0, s41, 8192
  s_add_u32 s51, s51, 4096
  buffer_load_dwordx4 v12, s[16:19], s51 offen offset:0 nt lds
  buffer_load_dwordx4 v13, s[16:19], s51 offen offset:1024 nt lds
  buffer_load_dwordx4 v14, s[16:19], s51 offen offset:2048 nt lds
  buffer_load_dwordx4 v15, s[16:19], s51 offen offset:3072 nt lds
  s_add_u32 s51, s51, 4096
  s_cmp_eq_u32 s51, s74
  s_cselect_b32 s53, 196608, 0
  s_sub_u32 s51, s51, s53
  s_sub_u32 s41, s41, 26624
  s_add_u32 m0, s42, 12288
  s_nop 0
  buffer_load_dwordx4 v16, s[20:23], s52 offen offset:0 nt lds
  buffer_load_dwordx4 v17, s[20:23], s52 offen offset:1024 nt lds
  buffer_load_dwordx4 v18, s[20:23], s52 offen offset:2048 nt lds
  buffer_load_dwordx4 v16, s[20:23], s52 offen offset:3072 nt lds
  s_add_u32 m0, s42, 16384
  s_add_u32 s52, s52, 4096
  buffer_load_dwordx4 v17, s[20:23], s52 offen offset:0 nt lds
  buffer_load_dwordx4 v18, s[20:23], s52 offen offset:1024 nt lds
  buffer_load_dwordx4 v16, s[20:23], s52 offen offset:2048 nt lds
  buffer_load_dwordx4 v17, s[20:23], s52 offen offset:3072 nt lds
  s_add_u32 m0, s42, 20480
  s_add_u32 s52, s52, 4096
  buffer_load_dwordx4 v18, s[20:23], s52 offen offset:0 nt lds
  buffer_load_dwordx4 v16, s[20:23], s52 offen offset:1024 nt lds
  buffer_load_dwordx4 v17, s[20:23], s52 offen offset:2048 nt lds
  buffer_load_dwordx4 v18, s[20:23], s52 offen offset:3072 nt lds
  s_add_u32 s52, s52, 4096
  s_cmp_eq_u32 s52, s75
  s_cselect_b32 s53, 196608, 0
  s_sub_u32 s52, s52, s53
  s_sub_u32 s42, s42, 26624
  s_add_u32 m0, s42, 12288
  s_nop 0
  buffer_load_dwordx4 v16, s[20:23], s52 offen offset:0 nt lds
  buffer_load_dwordx4 v17, s[20:23], s52 offen offset:1024 nt lds
  buffer_load_dwordx4 v18, s[20:23], s52 offen offset:2048 nt lds
  buffer_load_dwordx4 v16, s[20:23], s52 offen offset:3072 nt lds
  s_add_u32 m0, s42, 16384
  s_add_u32 s52, s52, 4096
  buffer_load_dwordx4 v17, s[20:23], s52 offen offset:0 nt lds
  buffer_load_dwordx4 v18, s[20:23], s52 offen offset:1024 nt lds
  buffer_load_dwordx4 v16, s[20:23], s52 offen offset:2048 nt lds
  buffer_load_dwordx4 v17, s[20:23], s52 offen offset:3072 nt lds
  s_add_u32 m0, s42, 20480
  s_add_u32 s52, s52, 4096
  buffer_load_dwordx4 v18, s[20:23], s52 offen offset:0 nt lds
  buffer_load_dwordx4 v16, s[20:23], s52 offen offset:1024 nt lds
  buffer_load_dwordx4 v17, s[20:23], s52 offen offset:2048 nt lds
  buffer_load_dwordx4 v18, s[20:23], s52 offen offset:3072 nt lds
  s_add_u32 s52, s52, 4096
  s_cmp_eq_u32 s52, s75
  s_cselect_b32 s53, 196608, 0
  s_sub_u32 s52, s52, s53
  s_add_u32 s42, s42, 79872
  s_cmp_ge_u32 s42, 159744
  s_cselect_b32 s53, 159744, 0
  s_sub_u32 s42, s42, s53
  s_waitcnt vmcnt(48)
  s_add_u32 m0, s42, 12288
  s_nop 0
  buffer_load_dwordx4 v16, s[20:23], s52 offen offset:0 nt lds
  buffer_load_dwordx4 v17, s[20:23], s52 offen offset:1024 nt lds
  buffer_load_dwordx4 v18, s[20:23], s52 offen offset:2048 nt lds
  buffer_load_dwordx4 v16, s[20:23], s52 offen offset:3072 nt lds
  s_add_u32 m0, s42, 16384
  s_add_u32 s52, s52, 4096
  buffer_load_dwordx4 v17, s[20:23], s52 offen offset:0 nt lds
  buffer_load_dwordx4 v18, s[20:23], s52 offen offset:1024 nt lds
  buffer_load_dwordx4 v16, s[20:23], s52 offen offset:2048 nt lds
  buffer_load_dwordx4 v17, s[20:23], s52 offen offset:3072 nt lds
  s_add_u32 m0, s42, 20480
  s_add_u32 s52, s52, 4096
  buffer_load_dwordx4 v18, s[20:23], s52 offen offset:0 nt lds
  buffer_load_dwordx4 v16, s[20:23], s52 offen offset:1024 nt lds
  buffer_load_dwordx4 v17, s[20:23], s52 offen offset:2048 nt lds
  buffer_load_dwordx4 v18, s[20:23], s52 offen offset:3072 nt lds
  s_add_u32 s52, s52, 4096
  s_cmp_eq_u32 s52, s75
  s_cselect_b32 s53, 196608, 0
  s_sub_u32 s52, s52, s53
  s_sub_u32 s42, s42, 26624
  s_barrier
  s_waitcnt vmcnt(48)
  s_barrier
  s_lshl_b32 s53, 16, s35
  v_mov_b32 v9, s53
  s_mov_b64 exec, 1
  buffer_atomic_add v9, v8, s[60:63], 0 offen sc1
  s_mov_b64 exec, -1
  s_add_u32 m0, s41, 0
  s_nop 0
  buffer_load_dwordx4 v10, s[16:19], s51 offen offset:0 nt lds
  buffer_load_dwordx4 v11, s[16:19], s51 offen offset:1024 nt lds
  buffer_load_dwordx4 v12, s[16:19], s51 offen offset:2048 nt lds
  buffer_load_dwordx4 v13, s[16:19], s51 offen offset:3072 nt lds
  s_add_u32 m0, s41, 4096
  s_add_u32 s51, s51, 4096
  buffer_load_dwordx4 v14, s[16:19], s51 offen offset:0 nt lds
  buffer_load_dwordx4 v15, s[16:19], s51 offen offset:1024 nt lds
  buffer_load_dwordx4 v10, s[16:19], s51 offen offset:2048 nt lds
  buffer_load_dwordx4 v11, s[16:19], s51 offen offset:3072 nt lds
  s_add_u32 m0, s41, 8192
  s_add_u32 s51, s51, 4096
  buffer_load_dwordx4 v12, s[16:19], s51 offen offset:0 nt lds
  buffer_load_dwordx4 v13, s[16:19], s51 offen offset:1024 nt lds
  buffer_load_dwordx4 v14, s[16:19], s51 offen offset:2048 nt lds
  buffer_load_dwordx4 v15, s[16:19], s51 offen offset:3072 nt lds
  s_add_u32 s51, s51, 4096
  s_cmp_eq_u32 s51, s74
  s_cselect_b32 s53, 196608, 0
  s_sub_u32 s51, s51, s53
  s_add_u32 s41, s41, 79872
  s_cmp_ge_u32 s41, 159744
  s_cselect_b32 s53, 159744, 0
  s_sub_u32 s41, s41, s53
  s_waitcnt vmcnt(48)
  s_add_u32 m0, s41, 0
  s_nop 0
  buffer_load_dwordx4 v10, s[16:19], s51 offen offset:0 nt lds
  buffer_load_dwordx4 v11, s[16:19], s51 offen offset:1024 nt lds
  buffer_load_dwordx4 v12, s[16:19], s51 offen offset:2048 nt lds
  buffer_load_dwordx4 v13, s[16:19], s51 offen offset:3072 nt lds
  s_add_u32 m0, s41, 4096
  s_add_u32 s51, s51, 4096
  buffer_load_dwordx4 v14, s[16:19], s51 offen offset:0 nt lds
  buffer_load_dwordx4 v15, s[16:19], s51 offen offset:1024 nt lds
  buffer_load_dwordx4 v10, s[16:19], s51 offen offset:2048 nt lds
  buffer_load_dwordx4 v11, s[16:19], s51 offen offset:3072 nt lds
  s_add_u32 m0, s41, 8192
  s_add_u32 s51, s51, 4096
  buffer_load_dwordx4 v12, s[16:19], s51 offen offset:0 nt lds
  buffer_load_dwordx4 v13, s[16:19], s51 offen offset:1024 nt lds
  buffer_load_dwordx4 v14, s[16:19], s51 offen offset:2048 nt lds
  buffer_load_dwordx4 v15, s[16:19], s51 offen offset:3072 nt lds
  s_add_u32 s51, s51, 4096
  s_cmp_eq_u32 s51, s74
  s_cselect_b32 s53, 196608, 0
  s_sub_u32 s51, s51, s53
  s_sub_u32 s41, s41, 26624
  s_waitcnt vmcnt(48)
  s_barrier
  s_add_u32 m0, s41, 0
  s_nop 0
  buffer_load_dwordx4 v10, s[16:19], s51 offen offset:0 nt lds
  buffer_load_dwordx4 v11, s[16:19], s51 offen offset:1024 nt lds
  buffer_load_dwordx4 v12, s[16:19], s51 offen offset:2048 nt lds
  buffer_load_dwordx4 v13, s[16:19], s51 offen offset:3072 nt lds
  s_add_u32 m0, s41, 4096
  s_add_u32 s51, s51, 4096
  buffer_load_dwordx4 v14, s[16:19], s51 offen offset:0 nt lds
  buffer_load_dwordx4 v15, s[16:19], s51 offen offset:1024 nt lds
  buffer_load_dwordx4 v10, s[16:19], s51 offen offset:2048 nt lds
  buffer_load_dwordx4 v11, s[16:19], s51 offen offset:3072 nt lds
  s_add_u32 m0, s41, 8192
  s_add_u32 s51, s51, 4096
  buffer_load_dwordx4 v12, s[16:19], s51 offen offset:0 nt lds
  buffer_load_dwordx4 v13, s[16:19], s51 offen offset:1024 nt lds
  buffer_load_dwordx4 v14, s[16:19], s51 offen offset:2048 nt lds
  buffer_load_dwordx4 v15, s[16:19], s51 offen offset:3072 nt lds
  s_add_u32 s51, s51, 4096
  s_cmp_eq_u32 s51, s74
  s_cselect_b32 s53, 196608, 0
  s_sub_u32 s51, s51, s53
  s_add_u32 s41, s41, 79872
  s_cmp_ge_u32 s41, 159744
  s_cselect_b32 s53, 159744, 0
  s_sub_u32 s41, s41, s53
  s_waitcnt vmcnt(48)
  s_add_u32 m0, s42, 12288
  s_nop 0
  buffer_load_dwordx4 v16, s[20:23], s52 offen offset:0 nt lds
  buffer_load_dwordx4 v17, s[20:23], s52 offen offset:1024 nt lds
  buffer_load_dwordx4 v18, s[20:23], s52 offen offset:2048 nt lds
  buffer_load_dwordx4 v16, s[20:23], s52 offen offset:3072 nt lds
  s_add_u32 m0, s42, 16384
  s_add_u32 s52, s52, 4096
  buffer_load_dwordx4 v17, s[20:23], s52 offen offset:0 nt lds
  buffer_load_dwordx4 v18, s[20:23], s52 offen offset:1024 nt lds
  buffer_load_dwordx4 v16, s[20:23], s52 offen offset:2048 nt lds
  buffer_load_dwordx4 v17, s[20:23], s52 offen offset:3072 nt lds
  s_add_u32 m0, s42, 20480
  s_add_u32 s52, s52, 4096
  buffer_load_dwordx4 v18, s[20:23], s52 offen offset:0 nt lds
  buffer_load_dwordx4 v16, s[20:23], s52 offen offset:1024 nt lds
  buffer_load_dwordx4 v17, s[20:23], s52 offen offset:2048 nt lds
  buffer_load_dwordx4 v18, s[20:23], s52 offen offset:3072 nt lds
  s_add_u32 s52, s52, 4096
  s_cmp_eq_u32 s52, s75
  s_cselect_b32 s53, 196608, 0
  s_sub_u32 s52, s52, s53
  s_add_u32 s42, s42, 79872
  s_cmp_ge_u32 s42, 159744
  s_cselect_b32 s53, 159744, 0
  s_sub_u32 s42, s42, s53
  s_waitcnt vmcnt(48)
  s_add_u32 m0, s41, 0
  s_nop 0
  buffer_load_dwordx4 v10, s[16:19], s51 offen offset:0 nt lds
  buffer_load_dwordx4 v11, s[16:19], s51 offen offset:1024 nt lds
  buffer_load_dwordx4 v12, s[16:19], s51 offen offset:2048 nt lds
  buffer_load_dwordx4 v13, s[16:19], s51 offen offset:3072 nt lds
  s_add_u32 m0, s41, 4096
  s_add_u32 s51, s51, 4096
  buffer_load_dwordx4 v14, s[16:19], s51 offen offset:0 nt lds
  buffer_load_dwordx4 v15, s[16:19], s51 offen offset:1024 nt lds
  buffer_load_dwordx4 v10, s[16:19], s51 offen offset:2048 nt lds
  buffer_load_dwordx4 v11, s[16:19], s51 offen offset:3072 nt lds
  s_add_u32 m0, s41, 8192
  s_add_u32 s51, s51, 4096
  buffer_load_dwordx4 v12, s[16:19], s51 offen offset:0 nt lds
  buffer_load_dwordx4 v13, s[16:19], s51 offen offset:1024 nt lds
  buffer_load_dwordx4 v14, s[16:19], s51 offen offset:2048 nt lds
  buffer_load_dwordx4 v15, s[16:19], s51 offen offset:3072 nt lds
  s_add_u32 s51, s51, 4096
  s_cmp_eq_u32 s51, s74
  s_cselect_b32 s53, 196608, 0
  s_sub_u32 s51, s51, s53
  s_sub_u32 s41, s41, 26624
  s_waitcnt vmcnt(48)
  s_add_u32 m0, s42, 12288
  s_nop 0
  buffer_load_dwordx4 v16, s[20:23], s52 offen offset:0 nt lds
  buffer_load_dwordx4 v17, s[20:23], s52 offen offset:1024 nt lds
  buffer_load_dwordx4 v18, s[20:23], s52 offen offset:2048 nt lds
  buffer_load_dwordx4 v16, s[20:23], s52 offen offset:3072 nt lds
  s_add_u32 m0, s42, 16384
  s_add_u32 s52, s52, 4096
  buffer_load_dwordx4 v17, s[20:23], s52 offen offset:0 nt lds
  buffer_load_dwordx4 v18, s[20:23], s52 offen offset:1024 nt lds
  buffer_load_dwordx4 v16, s[20:23], s52 offen offset:2048 nt lds
  buffer_load_dwordx4 v17, s[20:23], s52 offen offset:3072 nt lds
  s_add_u32 m0, s42, 20480
  s_add_u32 s52, s52, 4096
  buffer_load_dwordx4 v18, s[20:23], s52 offen offset:0 nt lds
  buffer_load_dwordx4 v16, s[20:23], s52 offen offset:1024 nt lds
  buffer_load_dwordx4 v17, s[20:23], s52 offen offset:2048 nt lds
  buffer_load_dwordx4 v18, s[20:23], s52 offen offset:3072 nt lds
  s_add_u32 s52, s52, 4096
  s_cmp_eq_u32 s52, s75
  s_cselect_b32 s53, 196608, 0
  s_sub_u32 s52, s52, s53
  s_sub_u32 s42, s42, 26624
  s_barrier
  s_waitcnt vmcnt(48)
  s_add_u32 m0, s41, 0
  s_nop 0
  buffer_load_dwordx4 v10, s[16:19], s51 offen offset:0 nt lds
  buffer_load_dwordx4 v11, s[16:19], s51 offen offset:1024 nt lds
  buffer_load_dwordx4 v12, s[16:19], s51 offen offset:2048 nt lds
  buffer_load_dwordx4 v13, s[16:19], s51 offen offset:3072 nt lds
  s_add_u32 m0, s41, 4096
  s_add_u32 s51, s51, 4096
  buffer_load_dwordx4 v14, s[16:19], s51 offen offset:0 nt lds
  buffer_load_dwordx4 v15, s[16:19], s51 offen offset:1024 nt lds
  buffer_load_dwordx4 v10, s[16:19], s51 offen offset:2048 nt lds
  buffer_load_dwordx4 v11, s[16:19], s51 offen offset:3072 nt lds
  s_add_u32 m0, s41, 8192
  s_add_u32 s51, s51, 4096
  buffer_load_dwordx4 v12, s[16:19], s51 offen offset:0 nt lds
  buffer_load_dwordx4 v13, s[16:19], s51 offen offset:1024 nt lds
  buffer_load_dwordx4 v14, s[16:19], s51 offen offset:2048 nt lds
  buffer_load_dwordx4 v15, s[16:19], s51 offen offset:3072 nt lds
  s_add_u32 s51, s51, 4096
  s_cmp_eq_u32 s51, s74
  s_cselect_b32 s53, 196608, 0
  s_sub_u32 s51, s51, s53
  s_add_u32 s41, s41, 79872
  s_cmp_ge_u32 s41, 159744
  s_cselect_b32 s53, 159744, 0
  s_sub_u32 s41, s41, s53
  s_mov_b32 s40, 3
L_ld3:
  s_barrier
  s_waitcnt vmcnt(48)
  s_add_u32 m0, s42, 12288
  s_nop 0
  buffer_load_dwordx4 v16, s[20:23], s52 offen offset:0 nt lds
  buffer_load_dwordx4 v17, s[20:23], s52 offen offset:1024 nt lds
  buffer_load_dwordx4 v18, s[20:23], s52 offen offset:2048 nt lds
  buffer_load_dwordx4 v16, s[20:23], s52 offen offset:3072 nt lds
  s_add_u32 m0, s42, 16384
  s_add_u32 s52, s52, 4096
  buffer_load_dwordx4 v17, s[20:23], s52 offen offset:0 nt lds
  buffer_load_dwordx4 v18, s[20:23], s52 offen offset:1024 nt lds
  buffer_load_dwordx4 v16, s[20:23], s52 offen offset:2048 nt lds
  buffer_load_dwordx4 v17, s[20:23], s52 offen offset:3072 nt lds
  s_add_u32 m0, s42, 20480
  s_add_u32 s52, s52, 4096
  buffer_load_dwordx4 v18, s[20:23], s52 offen offset:0 nt lds
  buffer_load_dwordx4 v16, s[20:23], s52 offen offset:1024 nt lds
  buffer_load_dwordx4 v17, s[20:23], s52 offen offset:2048 nt lds
  buffer_load_dwordx4 v18, s[20:23], s52 offen offset:3072 nt lds
  s_add_u32 s52, s52, 4096
  s_cmp_eq_u32 s52, s75
  s_cselect_b32 s53, 196608, 0
  s_sub_u32 s52, s52, s53
  s_add_u32 s42, s42, 79872
  s_cmp_ge_u32 s42, 159744
  s_cselect_b32 s53, 159744, 0
  s_sub_u32 s42, s42, s53
  s_waitcnt vmcnt(48)
  s_add_u32 m0, s41, 0
  s_nop 0
  buffer_load_dwordx4 v10, s[16:19], s51 offen offset:0 nt lds
  buffer_load_dwordx4 v11, s[16:19], s51 offen offset:1024 nt lds
  buffer_load_dwordx4 v12, s[16:19], s51 offen offset:2048 nt lds
  buffer_load_dwordx4 v13, s[16:19], s51 offen offset:3072 nt lds
  s_add_u32 m0, s41, 4096
  s_add_u32 s51, s51, 4096
  buffer_load_dwordx4 v14, s[16:19], s51 offen offset:0 nt lds
  buffer_load_dwordx4 v15, s[16:19], s51 offen offset:1024 nt lds
  buffer_load_dwordx4 v10, s[16:19], s51 offen offset:2048 nt lds
  buffer_load_dwordx4 v11, s[16:19], s51 offen offset:3072 nt lds
  s_add_u32 m0, s41, 8192
  s_add_u32 s51, s51, 4096
  buffer_load_dwordx4 v12, s[16:19], s51 offen offset:0 nt lds
  buffer_load_dwordx4 v13, s[16:19], s51 offen offset:1024 nt lds
  buffer_load_dwordx4 v14, s[16:19], s51 offen offset:2048 nt lds
  buffer_load_dwordx4 v15, s[16:19], s51 offen offset:3072 nt lds
  s_add_u32 s51, s51, 4096
  s_cmp_eq_u32 s51, s74
  s_cselect_b32 s53, 196608, 0
  s_sub_u32 s51, s51, s53
  s_sub_u32 s41, s41, 26624
  s_barrier
  s_waitcnt vmcnt(48)
  s_add_u32 m0, s42, 12288
  s_nop 0
  buffer_load_dwordx4 v16, s[20:23], s52 offen offset:0 nt lds
  buffer_load_dwordx4 v17, s[20:23], s52 offen offset:1024 nt lds
  buffer_load_dwordx4 v18, s[20:23], s52 offen offset:2048 nt lds
  buffer_load_dwordx4 v16, s[20:23], s52 offen offset:3072 nt lds
  s_add_u32 m0, s42, 16384
  s_add_u32 s52, s52, 4096
  buffer_load_dwordx4 v17, s[20:23], s52 offen offset:0 nt lds
  buffer_load_dwordx4 v18, s[20:23], s52 offen offset:1024 nt lds
  buffer_load_dwordx4 v16, s[20:23], s52 offen offset:2048 nt lds
  buffer_load_dwordx4 v17, s[20:23], s52 offen offset:3072 nt lds
  s_add_u32 m0, s42, 20480
  s_add_u32 s52, s52, 4096
  buffer_load_dwordx4 v18, s[20:23], s52 offen offset:0 nt lds
  buffer_load_dwordx4 v16, s[20:23], s52 offen offset:1024 nt lds
  buffer_load_dwordx4 v17, s[20:23], s52 offen offset:2048 nt lds
  buffer_load_dwordx4 v18, s[20:23], s52 offen offset:3072 nt lds
  s_add_u32 s52, s52, 4096
  s_cmp_eq_u32 s52, s75
  s_cselect_b32 s53, 196608, 0
  s_sub_u32 s52, s52, s53
  s_sub_u32 s42, s42, 26624
  s_waitcnt vmcnt(48)
  s_add_u32 m0, s41, 0
  s_nop 0
  buffer_load_dwordx4 v10, s[16:19], s51 offen offset:0 nt lds
  buffer_load_dwordx4 v11, s[16:19], s51 offen offset:1024 nt lds
  buffer_load_dwordx4 v12, s[16:19], s51 offen offset:2048 nt lds
  buffer_load_dwordx4 v13, s[16:19], s51 offen offset:3072 nt lds
  s_add_u32 m0, s41, 4096
  s_add_u32 s51, s51, 4096
  buffer_load_dwordx4 v14, s[16:19], s51 offen offset:0 nt lds
  buffer_load_dwordx4 v15, s[16:19], s51 offen offset:1024 nt lds
  buffer_load_dwordx4 v10, s[16:19], s51 offen offset:2048 nt lds
  buffer_load_dwordx4 v11, s[16:19], s51 offen offset:3072 nt lds
  s_add_u32 m0, s41, 8192
  s_add_u32 s51, s51, 4096
  buffer_load_dwordx4 v12, s[16:19], s51 offen offset:0 nt lds
  buffer_load_dwordx4 v13, s[16:19], s51 offen offset:1024 nt lds
  buffer_load_dwordx4 v14, s[16:19], s51 offen offset:2048 nt lds
  buffer_load_dwordx4 v15, s[16:19], s51 offen offset:3072 nt lds
  s_add_u32 s51, s51, 4096
  s_cmp_eq_u32 s51, s74
  s_cselect_b32 s53, 196608, 0
  s_sub_u32 s51, s51, s53
  s_add_u32 s41, s41, 79872
  s_cmp_ge_u32 s41, 159744
  s_cselect_b32 s53, 159744, 0
  s_sub_u32 s41, s41, s53
  s_sub_u32 s40, s40, 1
  s_cmp_lg_u32 s40, 0
  s_cbranch_scc1 L_ld3
  s_barrier
  s_waitcnt vmcnt(48)
  s_add_u32 m0, s42, 12288
  s_nop 0
  buffer_load_dwordx4 v16, s[20:23], s52 offen offset:0 nt lds
  buffer_load_dwordx4 v17, s[20:23], s52 offen offset:1024 nt lds
  buffer_load_dwordx4 v18, s[20:23], s52 offen offset:2048 nt lds
  buffer_load_dwordx4 v16, s[20:23], s52 offen offset:3072 nt lds
  s_add_u32 m0, s42, 16384
  s_add_u32 s52, s52, 4096
  buffer_load_dwordx4 v17, s[20:23], s52 offen offset:0 nt lds
  buffer_load_dwordx4 v18, s[20:23], s52 offen offset:1024 nt lds
  buffer_load_dwordx4 v16, s[20:23], s52 offen offset:2048 nt lds
  buffer_load_dwordx4 v17, s[20:23], s52 offen offset:3072 nt lds
  s_add_u32 m0, s42, 20480
  s_add_u32 s52, s52, 4096
  buffer_load_dwordx4 v18, s[20:23], s52 offen offset:0 nt lds
  buffer_load_dwordx4 v16, s[20:23], s52 offen offset:1024 nt lds
  buffer_load_dwordx4 v17, s[20:23], s52 offen offset:2048 nt lds
  buffer_load_dwordx4 v18, s[20:23], s52 offen offset:3072 nt lds
  s_add_u32 s52, s52, 4096
  s_cmp_eq_u32 s52, s75
  s_cselect_b32 s53, 196608, 0
  s_sub_u32 s52, s52, s53
  s_add_u32 s42, s42, 79872
  s_cmp_ge_u32 s42, 159744
  s_cselect_b32 s53, 159744, 0
  s_sub_u32 s42, s42, s53
  s_waitcnt vmcnt(48)
  s_add_u32 m0, s41, 0
  s_nop 0
  buffer_load_dwordx4 v10, s[16:19], s51 offen offset:0 nt lds
  buffer_load_dwordx4 v11, s[16:19], s51 offen offset:1024 nt lds
  buffer_load_dwordx4 v12, s[16:19], s51 offen offset:2048 nt lds
  buffer_load_dwordx4 v13, s[16:19], s51 offen offset:3072 nt lds
  s_add_u32 m0, s41, 4096
  s_add_u32 s51, s51, 4096
  buffer_load_dwordx4 v14, s[16:19], s51 offen offset:0 nt lds
  buffer_load_dwordx4 v15, s[16:19], s51 offen offset:1024 nt lds
  buffer_load_dwordx4 v10, s[16:19], s51 offen offset:2048 nt lds
  buffer_load_dwordx4 v11, s[16:19], s51 offen offset:3072 nt lds
  s_add_u32 m0, s41, 8192
  s_add_u32 s51, s51, 4096
  buffer_load_dwordx4 v12, s[16:19], s51 offen offset:0 nt lds
  buffer_load_dwordx4 v13, s[16:19], s51 offen offset:1024 nt lds
  buffer_load_dwordx4 v14, s[16:19], s51 offen offset:2048 nt lds
  buffer_load_dwordx4 v15, s[16:19], s51 offen offset:3072 nt lds
  s_add_u32 s51, s51, 4096
  s_cmp_eq_u32 s51, s74
  s_cselect_b32 s53, 196608, 0
  s_sub_u32 s51, s51, s53
  s_sub_u32 s41, s41, 26624
  s_barrier
  s_waitcnt vmcnt(48)
  s_add_u32 m0, s42, 12288
  s_nop 0
  buffer_load_dwordx4 v16, s[20:23], s52 offen offset:0 nt lds
  buffer_load_dwordx4 v17, s[20:23], s52 offen offset:1024 nt lds
  buffer_load_dwordx4 v18, s[20:23], s52 offen offset:2048 nt lds
  buffer_load_dwordx4 v16, s[20:23], s52 offen offset:3072 nt lds
  s_add_u32 m0, s42, 16384
  s_add_u32 s52, s52, 4096
  buffer_load_dwordx4 v17, s[20:23], s52 offen offset:0 nt lds
  buffer_load_dwordx4 v18, s[20:23], s52 offen offset:1024 nt lds
  buffer_load_dwordx4 v16, s[20:23], s52 offen offset:2048 nt lds
  buffer_load_dwordx4 v17, s[20:23], s52 offen offset:3072 nt lds
  s_add_u32 m0, s42, 20480
  s_add_u32 s52, s52, 4096
  buffer_load_dwordx4 v18, s[20:23], s52 offen offset:0 nt lds
  buffer_load_dwordx4 v16, s[20:23], s52 offen offset:1024 nt lds
  buffer_load_dwordx4 v17, s[20:23], s52 offen offset:2048 nt lds
  buffer_load_dwordx4 v18, s[20:23], s52 offen offset:3072 nt lds
  s_add_u32 s52, s52, 4096
  s_cmp_eq_u32 s52, s75
  s_cselect_b32 s53, 196608, 0
  s_sub_u32 s52, s52, s53
  s_sub_u32 s42, s42, 26624
  s_waitcnt vmcnt(48)
  s_add_u32 m0, s41, 0
  s_nop 0
  buffer_load_dwordx4 v10, s[16:19], s51 offen offset:0 nt lds
  buffer_load_dwordx4 v11, s[16:19], s51 offen offset:1024 nt lds
  buffer_load_dwordx4 v12, s[16:19], s51 offen offset:2048 nt lds
  buffer_load_dwordx4 v13, s[16:19], s51 offen offset:3072 nt lds
  s_add_u32 m0, s41, 4096
  s_add_u32 s51, s51, 4096
  buffer_load_dwordx4 v14, s[16:19], s51 offen offset:0 nt lds
  buffer_load_dwordx4 v15, s[16:19], s51 offen offset:1024 nt lds
  buffer_load_dwordx4 v10, s[16:19], s51 offen offset:2048 nt lds
  buffer_load_dwordx4 v11, s[16:19], s51 offen offset:3072 nt lds
  s_add_u32 m0, s41, 8192
  s_add_u32 s51, s51, 4096
  buffer_load_dwordx4 v12, s[16:19], s51 offen offset:0 nt lds
  buffer_load_dwordx4 v13, s[16:19], s51 offen offset:1024 nt lds
  buffer_load_dwordx4 v14, s[16:19], s51 offen offset:2048 nt lds
  buffer_load_dwordx4 v15, s[16:19], s51 offen offset:3072 nt lds
  s_add_u32 s51, s51, 4096
  s_cmp_eq_u32 s51, s74
  s_cselect_b32 s53, 196608, 0
  s_sub_u32 s51, s51, s53
  s_add_u32 s51, s51, s85
  s_add_u32 s74, s74, s85
  s_mov_b32 s41, 79872
  s_barrier
  s_memrealtime s[66:67]
  s_memtime s[64:65]
  s_waitcnt lgkmcnt(0)
  s_sub_u32 s53, s66, s98
  s_sub_u32 s54, s64, s94
  v_cvt_f32_u32 v37, s53
  v_cvt_f32_u32 v38, s54
  v_rcp_f32 v38, v38
  v_mul_f32 v37, 0x472be000, v37
  v_mul_f32 v37, v37, v38
  v_cvt_u32_f32 v37, v37
  s_nop 0
  v_readfirstlane_b32 s53, v37
  s_nop 0
  s_add_u32 s53, s53, s66
  v_mov_b32 v9, s53
  s_and_b32 s54, s2, 3
  s_lshl_b32 s54, s54, 2
  s_add_u32 s54, s54, 71303168
  v_lshlrev_b32 v36, 2, v7
  s_mov_b64 exec, 1
  buffer_store_dword v9, v36, s[24:27], s54 offen sc1
  s_mov_b64 exec, -1
  s_waitcnt vmcnt(48)
  s_add_u32 m0, s42, 12288
  s_nop 0
  buffer_load_dwordx4 v16, s[20:23], s52 offen offset:0 nt lds
  buffer_load_dwordx4 v17, s[20:23], s52 offen offset:1024 nt lds
  buffer_load_dwordx4 v18, s[20:23], s52 offen offset:2048 nt lds
  buffer_load_dwordx4 v16, s[20:23], s52 offen offset:3072 nt lds
  s_add_u32 m0, s42, 16384
  s_add_u32 s52, s52, 4096
  buffer_load_dwordx4 v17, s[20:23], s52 offen offset:0 nt lds
  buffer_load_dwordx4 v18, s[20:23], s52 offen offset:1024 nt lds
  buffer_load_dwordx4 v16, s[20:23], s52 offen offset:2048 nt lds
  buffer_load_dwordx4 v17, s[20:23], s52 offen offset:3072 nt lds
  s_add_u32 m0, s42, 20480
  s_add_u32 s52, s52, 4096
  buffer_load_dwordx4 v18, s[20:23], s52 offen offset:0 nt lds
  buffer_load_dwordx4 v16, s[20:23], s52 offen offset:1024 nt lds
  buffer_load_dwordx4 v17, s[20:23], s52 offen offset:2048 nt lds
  buffer_load_dwordx4 v18, s[20:23], s52 offen offset:3072 nt lds
  s_add_u32 s52, s52, 4096
  s_cmp_eq_u32 s52, s75
  s_cselect_b32 s53, 196608, 0
  s_sub_u32 s52, s52, s53
  s_add_u32 s42, s42, 79872
  s_cmp_ge_u32 s42, 159744
  s_cselect_b32 s53, 159744, 0
  s_sub_u32 s42, s42, s53
  s_waitcnt vmcnt(48)
  s_add_u32 m0, s42, 12288
  s_nop 0
  buffer_load_dwordx4 v16, s[20:23], s52 offen offset:0 nt lds
  buffer_load_dwordx4 v17, s[20:23], s52 offen offset:1024 nt lds
  buffer_load_dwordx4 v18, s[20:23], s52 offen offset:2048 nt lds
  buffer_load_dwordx4 v16, s[20:23], s52 offen offset:3072 nt lds
  s_add_u32 m0, s42, 16384
  s_add_u32 s52, s52, 4096
  buffer_load_dwordx4 v17, s[20:23], s52 offen offset:0 nt lds
  buffer_load_dwordx4 v18, s[20:23], s52 offen offset:1024 nt lds
  buffer_load_dwordx4 v16, s[20:23], s52 offen offset:2048 nt lds
  buffer_load_dwordx4 v17, s[20:23], s52 offen offset:3072 nt lds
  s_add_u32 m0, s42, 20480
  s_add_u32 s52, s52, 4096
  buffer_load_dwordx4 v18, s[20:23], s52 offen offset:0 nt lds
  buffer_load_dwordx4 v16, s[20:23], s52 offen offset:1024 nt lds
  buffer_load_dwordx4 v17, s[20:23], s52 offen offset:2048 nt lds
  buffer_load_dwordx4 v18, s[20:23], s52 offen offset:3072 nt lds
  s_add_u32 s52, s52, 4096
  s_cmp_eq_u32 s52, s75
  s_cselect_b32 s53, 196608, 0
  s_sub_u32 s52, s52, s53
  s_sub_u32 s42, s42, 26624
  s_barrier
  s_waitcnt vmcnt(48)
  s_add_u32 m0, s42, 12288
  s_nop 0
  buffer_load_dwordx4 v16, s[20:23], s52 offen offset:0 nt lds
  buffer_load_dwordx4 v17, s[20:23], s52 offen offset:1024 nt lds
  buffer_load_dwordx4 v18, s[20:23], s52 offen offset:2048 nt lds
  buffer_load_dwordx4 v16, s[20:23], s52 offen offset:3072 nt lds
  s_add_u32 m0, s42, 16384
  s_add_u32 s52, s52, 4096
  buffer_load_dwordx4 v17, s[20:23], s52 offen offset:0 nt lds
  buffer_load_dwordx4 v18, s[20:23], s52 offen offset:1024 nt lds
  buffer_load_dwordx4 v16, s[20:23], s52 offen offset:2048 nt lds
  buffer_load_dwordx4 v17, s[20:23], s52 offen offset:3072 nt lds
  s_add_u32 m0, s42, 20480
  s_add_u32 s52, s52, 4096
  buffer_load_dwordx4 v18, s[20:23], s52 offen offset:0 nt lds
  buffer_load_dwordx4 v16, s[20:23], s52 offen offset:1024 nt lds
  buffer_load_dwordx4 v17, s[20:23], s52 offen offset:2048 nt lds
  buffer_load_dwordx4 v18, s[20:23], s52 offen offset:3072 nt lds
  s_add_u32 s52, s52, 4096
  s_cmp_eq_u32 s52, s75
  s_cselect_b32 s53, 196608, 0
  s_sub_u32 s52, s52, s53
  s_add_u32 s52, s52, s85
  s_add_u32 s75, s75, s85
  s_mov_b32 s42, 79872
  s_waitcnt vmcnt(48)
  s_barrier
  s_waitcnt vmcnt(40)
  s_mul_i32 s53, s34, 491520
  s_add_u32 s53, s53, s87
  s_add_u32 s48, s53, s50
  s_add_u32 m0, s44, 0
  s_nop 0
  buffer_load_dwordx4 v28, s[28:31], s48 offen offset:0  lds
  buffer_load_dwordx4 v29, s[28:31], s48 offen offset:1024  lds
  buffer_load_dwordx4 v30, s[28:31], s48 offen offset:2048  lds
  s_add_u32 m0, s44, 3072
  s_nop 0
  buffer_load_dwordx4 v31, s[28:31], s48 offen offset:0  lds
  buffer_load_dwordx4 v32, s[28:31], s48 offen offset:1024  lds
  s_add_u32 s48, s48, 20480
  s_add_u32 m0, s44, 5120
  s_nop 0
  buffer_load_dwordx4 v28, s[28:31], s48 offen offset:0  lds
  buffer_load_dwordx4 v29, s[28:31], s48 offen offset:1024  lds
  buffer_load_dwordx4 v30, s[28:31], s48 offen offset:2048  lds
  s_add_u32 m0, s44, 8192
  s_nop 0
  buffer_load_dwordx4 v31, s[28:31], s48 offen offset:0  lds
  buffer_load_dwordx4 v32, s[28:31], s48 offen offset:1024  lds
  s_add_u32 s48, s48, 20480
  s_add_u32 m0, s44, 10240
  s_nop 0
  buffer_load_dwordx4 v28, s[28:31], s48 offen offset:0  lds
  buffer_load_dwordx4 v29, s[28:31], s48 offen offset:1024  lds
  buffer_load_dwordx4 v30, s[28:31], s48 offen offset:2048  lds
  s_add_u32 m0, s44, 13312
  s_nop 0
  buffer_load_dwordx4 v31, s[28:31], s48 offen offset:0  lds
  buffer_load_dwordx4 v32, s[28:31], s48 offen offset:1024  lds
  s_add_u32 s48, s48, 20480
  s_add_u32 m0, s44, 15360
  s_nop 0
  buffer_load_dwordx4 v28, s[28:31], s48 offen offset:0  lds
  buffer_load_dwordx4 v29, s[28:31], s48 offen offset:1024  lds
  buffer_load_dwordx4 v30, s[28:31], s48 offen offset:2048  lds
  s_add_u32 m0, s44, 18432
  s_nop 0
  buffer_load_dwordx4 v31, s[28:31], s48 offen offset:0  lds
  buffer_load_dwordx4 v32, s[28:31], s48 offen offset:1024  lds
  s_add_u32 s48, s48, 20480
  s_add_u32 s44, s44, 26624
  s_cmp_ge_u32 s44, 159744
  s_cselect_b32 s53, 159744, 0
  s_sub_u32 s44, s44, s53
  s_waitcnt vmcnt(44)
  s_barrier
  s_and_b32 s54, s2, 3
  s_lshl_b32 s53, 256, s54
  v_mov_b32 v9, s53
  s_mov_b64 exec, 1
  buffer_atomic_add v9, v7, s[60:63], 0 offen sc1
  s_mov_b64 exec, -1
  s_waitcnt vmcnt(40)
  s_add_u32 m0, s44, 0
  s_nop 0
  buffer_load_dwordx4 v28, s[28:31], s48 offen offset:0  lds
  buffer_load_dwordx4 v29, s[28:31], s48 offen offset:1024  lds
  buffer_load_dwordx4 v30, s[28:31], s48 offen offset:2048  lds
  s_add_u32 m0, s44, 3072
  s_nop 0
  buffer_load_dwordx4 v31, s[28:31], s48 offen offset:0  lds
  buffer_load_dwordx4 v32, s[28:31], s48 offen offset:1024  lds
  s_add_u32 s48, s48, 20480
  s_add_u32 m0, s44, 5120
  s_nop 0
  buffer_load_dwordx4 v28, s[28:31], s48 offen offset:0  lds
  buffer_load_dwordx4 v29, s[28:31], s48 offen offset:1024  lds
  buffer_load_dwordx4 v30, s[28:31], s48 offen offset:2048  lds
  s_add_u32 m0, s44, 8192
  s_nop 0
  buffer_load_dwordx4 v31, s[28:31], s48 offen offset:0  lds
  buffer_load_dwordx4 v32, s[28:31], s48 offen offset:1024  lds
  s_add_u32 s48, s48, 20480
  s_add_u32 m0, s44, 10240
  s_nop 0
  buffer_load_dwordx4 v28, s[28:31], s48 offen offset:0  lds
  buffer_load_dwordx4 v29, s[28:31], s48 offen offset:1024  lds
  buffer_load_dwordx4 v30, s[28:31], s48 offen offset:2048  lds
  s_add_u32 m0, s44, 13312
  s_nop 0
  buffer_load_dwordx4 v31, s[28:31], s48 offen offset:0  lds
  buffer_load_dwordx4 v32, s[28:31], s48 offen offset:1024  lds
  s_add_u32 s48, s48, 20480
  s_add_u32 m0, s44, 15360
  s_nop 0
  buffer_load_dwordx4 v28, s[28:31], s48 offen offset:0  lds
  buffer_load_dwordx4 v29, s[28:31], s48 offen offset:1024  lds
  buffer_load_dwordx4 v30, s[28:31], s48 offen offset:2048  lds
  s_add_u32 m0, s44, 18432
  s_nop 0
  buffer_load_dwordx4 v31, s[28:31], s48 offen offset:0  lds
  buffer_load_dwordx4 v32, s[28:31], s48 offen offset:1024  lds
  s_add_u32 s48, s48, 20480
  s_add_u32 s44, s44, 26624
  s_cmp_ge_u32 s44, 159744
  s_cselect_b32 s53, 159744, 0
  s_sub_u32 s44, s44, s53
  s_waitcnt vmcnt(52)
  s_mul_i32 s38, s7, 61440
  s_andn2_b32 s53, s34, 3
  s_mul_i32 s53, s53, 491520
  s_add_u32 s38, s38, s53
  buffer_load_dword v50, v34, s[28:31], s38 offen
  s_add_u32 s38, s38, 8192
  buffer_load_dword v50, v34, s[28:31], s38 offen
  s_add_u32 s38, s38, 8192
  buffer_load_dword v50, v34, s[28:31], s38 offen
  s_add_u32 s38, s38, 8192
  buffer_load_dword v50, v34, s[28:31], s38 offen
  s_add_u32 s38, s38, 8192
  buffer_load_dword v50, v34, s[28:31], s38 offen
  s_add_u32 s38, s38, 8192
  buffer_load_dword v50, v34, s[28:31], s38 offen
  s_add_u32 s38, s38, 8192
  buffer_load_dword v50, v34, s[28:31], s38 offen
  s_add_u32 s38, s38, 8192
  buffer_load_dword v50, v34, s[28:31], s38 offen
  s_add_u32 s38, s38, 8192
  s_waitcnt vmcnt(48)
  s_barrier
  s_waitcnt vmcnt(40)
  s_add_u32 m0, s44, 0
  s_nop 0
  buffer_load_dwordx4 v28, s[28:31], s48 offen offset:0  lds
  buffer_load_dwordx4 v29, s[28:31], s48 offen offset:1024  lds
  buffer_load_dwordx4 v30, s[28:31], s48 offen offset:2048  lds
  s_add_u32 m0, s44, 3072
  s_nop 0
  buffer_load_dwordx4 v31, s[28:31], s48 offen offset:0  lds
  buffer_load_dwordx4 v32, s[28:31], s48 offen offset:1024  lds
  s_add_u32 s48, s48, 20480
  s_add_u32 m0, s44, 5120
  s_nop 0
  buffer_load_dwordx4 v28, s[28:31], s48 offen offset:0  lds
  buffer_load_dwordx4 v29, s[28:31], s48 offen offset:1024  lds
  buffer_load_dwordx4 v30, s[28:31], s48 offen offset:2048  lds
  s_add_u32 m0, s44, 8192
  s_nop 0
  buffer_load_dwordx4 v31, s[28:31], s48 offen offset:0  lds
  buffer_load_dwordx4 v32, s[28:31], s48 offen offset:1024  lds
  s_add_u32 s48, s48, 20480
  s_add_u32 m0, s44, 10240
  s_nop 0
  buffer_load_dwordx4 v28, s[28:31], s48 offen offset:0  lds
  buffer_load_dwordx4 v29, s[28:31], s48 offen offset:1024  lds
  buffer_load_dwordx4 v30, s[28:31], s48 offen offset:2048  lds
  s_add_u32 m0, s44, 13312
  s_nop 0
  buffer_load_dwordx4 v31, s[28:31], s48 offen offset:0  lds
  buffer_load_dwordx4 v32, s[28:31], s48 offen offset:1024  lds
  s_add_u32 s48, s48, 20480
  s_add_u32 m0, s44, 15360
  s_nop 0
  buffer_load_dwordx4 v28, s[28:31], s48 offen offset:0  lds
  buffer_load_dwordx4 v29, s[28:31], s48 offen offset:1024  lds
  buffer_load_dwordx4 v30, s[28:31], s48 offen offset:2048  lds
  s_add_u32 m0, s44, 18432
  s_nop 0
  buffer_load_dwordx4 v31, s[28:31], s48 offen offset:0  lds
  buffer_load_dwordx4 v32, s[28:31], s48 offen offset:1024  lds
  s_add_u32 s48, s48, 20480
  s_add_u32 s44, s44, 26624
  s_cmp_ge_u32 s44, 159744
  s_cselect_b32 s53, 159744, 0
  s_sub_u32 s44, s44, s53
  s_waitcnt vmcnt(48)
  s_barrier
  buffer_load_dword v9, v8, s[60:63], 0 offen sc1
  s_waitcnt vmcnt(40)
  s_add_u32 s54, s92, 0
  s_and_b32 s54, s54, 3
  s_andn2_b32 s53, s34, 3
  s_add_u32 s53, s53, s54
  s_mul_i32 s53, s53, 491520
  s_add_u32 s53, s53, s86
  s_add_u32 s48, s53, s50
  s_add_u32 m0, s44, 0
  s_nop 0
  buffer_load_dwordx4 v28, s[28:31], s48 offen offset:0  lds
  buffer_load_dwordx4 v29, s[28:31], s48 offen offset:1024  lds
  buffer_load_dwordx4 v30, s[28:31], s48 offen offset:2048  lds
  s_add_u32 m0, s44, 3072
  s_nop 0
  buffer_load_dwordx4 v31, s[28:31], s48 offen offset:0  lds
  buffer_load_dwordx4 v32, s[28:31], s48 offen offset:1024  lds
  s_add_u32 s48, s48, 20480
  s_add_u32 m0, s44, 5120
  s_nop 0
  buffer_load_dwordx4 v28, s[28:31], s48 offen offset:0  lds
  buffer_load_dwordx4 v29, s[28:31], s48 offen offset:1024  lds
  buffer_load_dwordx4 v30, s[28:31], s48 offen offset:2048  lds
  s_add_u32 m0, s44, 8192
  s_nop 0
  buffer_load_dwordx4 v31, s[28:31], s48 offen offset:0  lds
  buffer_load_dwordx4 v32, s[28:31], s48 offen offset:1024  lds
  s_add_u32 s48, s48, 20480
  s_add_u32 m0, s44, 10240
  s_nop 0
  buffer_load_dwordx4 v28, s[28:31], s48 offen offset:0  lds
  buffer_load_dwordx4 v29, s[28:31], s48 offen offset:1024  lds
  buffer_load_dwordx4 v30, s[28:31], s48 offen offset:2048  lds
  s_add_u32 m0, s44, 13312
  s_nop 0
  buffer_load_dwordx4 v31, s[28:31], s48 offen offset:0  lds
  buffer_load_dwordx4 v32, s[28:31], s48 offen offset:1024  lds
  s_add_u32 s48, s48, 20480
  s_add_u32 m0, s44, 15360
  s_nop 0
  buffer_load_dwordx4 v28, s[28:31], s48 offen offset:0  lds
  buffer_load_dwordx4 v29, s[28:31], s48 offen offset:1024  lds
  buffer_load_dwordx4 v30, s[28:31], s48 offen offset:2048  lds
  s_add_u32 m0, s44, 18432
  s_nop 0
  buffer_load_dwordx4 v31, s[28:31], s48 offen offset:0  lds
  buffer_load_dwordx4 v32, s[28:31], s48 offen offset:1024  lds
  s_add_u32 s48, s48, 20480
  s_add_u32 s44, s44, 26624
  s_cmp_ge_u32 s44, 159744
  s_cselect_b32 s53, 159744, 0
  s_sub_u32 s44, s44, s53
  s_mov_b32 s53, 400000
  s_waitcnt vmcnt(20)
  s_branch L_pchk_h0
L_poll_h0:
  buffer_load_dword v9, v8, s[60:63], 0 offen sc1
  s_waitcnt vmcnt(0)
L_pchk_h0:
  v_readfirstlane_b32 s54, v9
  s_nop 0
  s_lshr_b32 s54, s54, 4
  s_and_b32 s54, s54, 15
  s_cmp_eq_u32 s54, 15
  s_cbranch_scc1 L_pdone_h0
  s_sleep 2
  s_sub_u32 s53, s53, 1
  s_cmp_lg_u32 s53, 0
  s_cbranch_scc1 L_poll_h0
L_pdone_h0:
  s_waitcnt vmcnt(48)
  s_barrier
  s_waitcnt vmcnt(40)
  s_add_u32 m0, s44, 0
  s_nop 0
  buffer_load_dwordx4 v28, s[28:31], s48 offen offset:0  lds
  buffer_load_dwordx4 v29, s[28:31], s48 offen offset:1024  lds
  buffer_load_dwordx4 v30, s[28:31], s48 offen offset:2048  lds
  s_add_u32 m0, s44, 3072
  s_nop 0
  buffer_load_dwordx4 v31, s[28:31], s48 offen offset:0  lds
  buffer_load_dwordx4 v32, s[28:31], s48 offen offset:1024  lds
  s_add_u32 s48, s48, 20480
  s_add_u32 m0, s44, 5120
  s_nop 0
  buffer_load_dwordx4 v28, s[28:31], s48 offen offset:0  lds
  buffer_load_dwordx4 v29, s[28:31], s48 offen offset:1024  lds
  buffer_load_dwordx4 v30, s[28:31], s48 offen offset:2048  lds
  s_add_u32 m0, s44, 8192
  s_nop 0
  buffer_load_dwordx4 v31, s[28:31], s48 offen offset:0  lds
  buffer_load_dwordx4 v32, s[28:31], s48 offen offset:1024  lds
  s_add_u32 s48, s48, 20480
  s_add_u32 m0, s44, 10240
  s_nop 0
  buffer_load_dwordx4 v28, s[28:31], s48 offen offset:0  lds
  buffer_load_dwordx4 v29, s[28:31], s48 offen offset:1024  lds
  buffer_load_dwordx4 v30, s[28:31], s48 offen offset:2048  lds
  s_add_u32 m0, s44, 13312
  s_nop 0
  buffer_load_dwordx4 v31, s[28:31], s48 offen offset:0  lds
  buffer_load_dwordx4 v32, s[28:31], s48 offen offset:1024  lds
  s_add_u32 s48, s48, 20480
  s_add_u32 m0, s44, 15360
  s_nop 0
  buffer_load_dwordx4 v28, s[28:31], s48 offen offset:0  lds
  buffer_load_dwordx4 v29, s[28:31], s48 offen offset:1024  lds
  buffer_load_dwordx4 v30, s[28:31], s48 offen offset:2048  lds
  s_add_u32 m0, s44, 18432
  s_nop 0
  buffer_load_dwordx4 v31, s[28:31], s48 offen offset:0  lds
  buffer_load_dwordx4 v32, s[28:31], s48 offen offset:1024  lds
  s_add_u32 s48, s48, 20480
  s_add_u32 s44, s44, 26624
  s_cmp_ge_u32 s44, 159744
  s_cselect_b32 s53, 159744, 0
  s_sub_u32 s44, s44, s53
  s_waitcnt vmcnt(40)
  s_add_u32 m0, s44, 0
  s_nop 0
  buffer_load_dwordx4 v28, s[28:31], s48 offen offset:0  lds
  buffer_load_dwordx4 v29, s[28:31], s48 offen offset:1024  lds
  buffer_load_dwordx4 v30, s[28:31], s48 offen offset:2048  lds
  s_add_u32 m0, s44, 3072
  s_nop 0
  buffer_load_dwordx4 v31, s[28:31], s48 offen offset:0  lds
  buffer_load_dwordx4 v32, s[28:31], s48 offen offset:1024  lds
  s_add_u32 s48, s48, 20480
  s_add_u32 m0, s44, 5120
  s_nop 0
  buffer_load_dwordx4 v28, s[28:31], s48 offen offset:0  lds
  buffer_load_dwordx4 v29, s[28:31], s48 offen offset:1024  lds
  buffer_load_dwordx4 v30, s[28:31], s48 offen offset:2048  lds
  s_add_u32 m0, s44, 8192
  s_nop 0
  buffer_load_dwordx4 v31, s[28:31], s48 offen offset:0  lds
  buffer_load_dwordx4 v32, s[28:31], s48 offen offset:1024  lds
  s_add_u32 s48, s48, 20480
  s_add_u32 m0, s44, 10240
  s_nop 0
  buffer_load_dwordx4 v28, s[28:31], s48 offen offset:0  lds
  buffer_load_dwordx4 v29, s[28:31], s48 offen offset:1024  lds
  buffer_load_dwordx4 v30, s[28:31], s48 offen offset:2048  lds
  s_add_u32 m0, s44, 13312
  s_nop 0
  buffer_load_dwordx4 v31, s[28:31], s48 offen offset:0  lds
  buffer_load_dwordx4 v32, s[28:31], s48 offen offset:1024  lds
  s_add_u32 s48, s48, 20480
  s_add_u32 m0, s44, 15360
  s_nop 0
  buffer_load_dwordx4 v28, s[28:31], s48 offen offset:0  lds
  buffer_load_dwordx4 v29, s[28:31], s48 offen offset:1024  lds
  buffer_load_dwordx4 v30, s[28:31], s48 offen offset:2048  lds
  s_add_u32 m0, s44, 18432
  s_nop 0
  buffer_load_dwordx4 v31, s[28:31], s48 offen offset:0  lds
  buffer_load_dwordx4 v32, s[28:31], s48 offen offset:1024  lds
  s_add_u32 s48, s48, 20480
  s_add_u32 s44, s44, 26624
  s_cmp_ge_u32 s44, 159744
  s_cselect_b32 s53, 159744, 0
  s_sub_u32 s44, s44, s53
  s_barrier
  s_waitcnt vmcnt(40)
  s_barrier
  s_add_u32 s54, s92, 1
  s_and_b32 s54, s54, 3
  s_andn2_b32 s53, s34, 3
  s_add_u32 s53, s53, s54
  s_mul_i32 s53, s53, 491520
  s_add_u32 s53, s53, s86
  s_add_u32 s48, s53, s50
  s_add_u32 m0, s44, 0
  s_nop 0
  buffer_load_dwordx4 v28, s[28:31], s48 offen offset:0  lds
  buffer_load_dwordx4 v29, s[28:31], s48 offen offset:1024  lds
  buffer_load_dwordx4 v30, s[28:31], s48 offen offset:2048  lds
  s_add_u32 m0, s44, 3072
  s_nop 0
  buffer_load_dwordx4 v31, s[28:31], s48 offen offset:0  lds
  buffer_load_dwordx4 v32, s[28:31], s48 offen offset:1024  lds
  s_add_u32 s48, s48, 20480
  s_add_u32 m0, s44, 5120
  s_nop 0
  buffer_load_dwordx4 v28, s[28:31], s48 offen offset:0  lds
  buffer_load_dwordx4 v29, s[28:31], s48 offen offset:1024  lds
  buffer_load_dwordx4 v30, s[28:31], s48 offen offset:2048  lds
  s_add_u32 m0, s44, 8192
  s_nop 0
  buffer_load_dwordx4 v31, s[28:31], s48 offen offset:0  lds
  buffer_load_dwordx4 v32, s[28:31], s48 offen offset:1024  lds
  s_add_u32 s48, s48, 20480
  s_add_u32 m0, s44, 10240
  s_nop 0
  buffer_load_dwordx4 v28, s[28:31], s48 offen offset:0  lds
  buffer_load_dwordx4 v29, s[28:31], s48 offen offset:1024  lds
  buffer_load_dwordx4 v30, s[28:31], s48 offen offset:2048  lds
  s_add_u32 m0, s44, 13312
  s_nop 0
  buffer_load_dwordx4 v31, s[28:31], s48 offen offset:0  lds
  buffer_load_dwordx4 v32, s[28:31], s48 offen offset:1024  lds
  s_add_u32 s48, s48, 20480
  s_add_u32 m0, s44, 15360
  s_nop 0
  buffer_load_dwordx4 v28, s[28:31], s48 offen offset:0  lds
  buffer_load_dwordx4 v29, s[28:31], s48 offen offset:1024  lds
  buffer_load_dwordx4 v30, s[28:31], s48 offen offset:2048  lds
  s_add_u32 m0, s44, 18432
  s_nop 0
  buffer_load_dwordx4 v31, s[28:31], s48 offen offset:0  lds
  buffer_load_dwordx4 v32, s[28:31], s48 offen offset:1024  lds
  s_add_u32 s48, s48, 20480
  s_add_u32 s44, s44, 26624
  s_cmp_ge_u32 s44, 159744
  s_cselect_b32 s53, 159744, 0
  s_sub_u32 s44, s44, s53
  s_waitcnt vmcnt(40)
  s_add_u32 m0, s44, 0
  s_nop 0
  buffer_load_dwordx4 v28, s[28:31], s48 offen offset:0  lds
  buffer_load_dwordx4 v29, s[28:31], s48 offen offset:1024  lds
  buffer_load_dwordx4 v30, s[28:31], s48 offen offset:2048  lds
  s_add_u32 m0, s44, 3072
  s_nop 0
  buffer_load_dwordx4 v31, s[28:31], s48 offen offset:0  lds
  buffer_load_dwordx4 v32, s[28:31], s48 offen offset:1024  lds
  s_add_u32 s48, s48, 20480
  s_add_u32 m0, s44, 5120
  s_nop 0
  buffer_load_dwordx4 v28, s[28:31], s48 offen offset:0  lds
  buffer_load_dwordx4 v29, s[28:31], s48 offen offset:1024  lds
  buffer_load_dwordx4 v30, s[28:31], s48 offen offset:2048  lds
  s_add_u32 m0, s44, 8192
  s_nop 0
  buffer_load_dwordx4 v31, s[28:31], s48 offen offset:0  lds
  buffer_load_dwordx4 v32, s[28:31], s48 offen offset:1024  lds
  s_add_u32 s48, s48, 20480
  s_add_u32 m0, s44, 10240
  s_nop 0
  buffer_load_dwordx4 v28, s[28:31], s48 offen offset:0  lds
  buffer_load_dwordx4 v29, s[28:31], s48 offen offset:1024  lds
  buffer_load_dwordx4 v30, s[28:31], s48 offen offset:2048  lds
  s_add_u32 m0, s44, 13312
  s_nop 0
  buffer_load_dwordx4 v31, s[28:31], s48 offen offset:0  lds
  buffer_load_dwordx4 v32, s[28:31], s48 offen offset:1024  lds
  s_add_u32 s48, s48, 20480
  s_add_u32 m0, s44, 15360
  s_nop 0
  buffer_load_dwordx4 v28, s[28:31], s48 offen offset:0  lds
  buffer_load_dwordx4 v29, s[28:31], s48 offen offset:1024  lds
  buffer_load_dwordx4 v30, s[28:31], s48 offen offset:2048  lds
  s_add_u32 m0, s44, 18432
  s_nop 0
  buffer_load_dwordx4 v31, s[28:31], s48 offen offset:0  lds
  buffer_load_dwordx4 v32, s[28:31], s48 offen offset:1024  lds
  s_add_u32 s48, s48, 20480
  s_add_u32 s44, s44, 26624
  s_cmp_ge_u32 s44, 159744
  s_cselect_b32 s53, 159744, 0
  s_sub_u32 s44, s44, s53
  s_barrier
  s_waitcnt vmcnt(40)
  s_add_u32 m0, s44, 0
  s_nop 0
  buffer_load_dwordx4 v28, s[28:31], s48 offen offset:0  lds
  buffer_load_dwordx4 v29, s[28:31], s48 offen offset:1024  lds
  buffer_load_dwordx4 v30, s[28:31], s48 offen offset:2048  lds
  s_add_u32 m0, s44, 3072
  s_nop 0
  buffer_load_dwordx4 v31, s[28:31], s48 offen offset:0  lds
  buffer_load_dwordx4 v32, s[28:31], s48 offen offset:1024  lds
  s_add_u32 s48, s48, 20480
  s_add_u32 m0, s44, 5120
  s_nop 0
  buffer_load_dwordx4 v28, s[28:31], s48 offen offset:0  lds
  buffer_load_dwordx4 v29, s[28:31], s48 offen offset:1024  lds
  buffer_load_dwordx4 v30, s[28:31], s48 offen offset:2048  lds
  s_add_u32 m0, s44, 8192
  s_nop 0
  buffer_load_dwordx4 v31, s[28:31], s48 offen offset:0  lds
  buffer_load_dwordx4 v32, s[28:31], s48 offen offset:1024  lds
  s_add_u32 s48, s48, 20480
  s_add_u32 m0, s44, 10240
  s_nop 0
  buffer_load_dwordx4 v28, s[28:31], s48 offen offset:0  lds
  buffer_load_dwordx4 v29, s[28:31], s48 offen offset:1024  lds
  buffer_load_dwordx4 v30, s[28:31], s48 offen offset:2048  lds
  s_add_u32 m0, s44, 13312
  s_nop 0
  buffer_load_dwordx4 v31, s[28:31], s48 offen offset:0  lds
  buffer_load_dwordx4 v32, s[28:31], s48 offen offset:1024  lds
  s_add_u32 s48, s48, 20480
  s_add_u32 m0, s44, 15360
  s_nop 0
  buffer_load_dwordx4 v28, s[28:31], s48 offen offset:0  lds
  buffer_load_dwordx4 v29, s[28:31], s48 offen offset:1024  lds
  buffer_load_dwordx4 v30, s[28:31], s48 offen offset:2048  lds
  s_add_u32 m0, s44, 18432
  s_nop 0
  buffer_load_dwordx4 v31, s[28:31], s48 offen offset:0  lds
  buffer_load_dwordx4 v32, s[28:31], s48 offen offset:1024  lds
  s_add_u32 s48, s48, 20480
  s_add_u32 s44, s44, 26624
  s_cmp_ge_u32 s44, 159744
  s_cselect_b32 s53, 159744, 0
  s_sub_u32 s44, s44, s53
  s_barrier
  s_waitcnt vmcnt(40)
  s_add_u32 s54, s92, 2
  s_and_b32 s54, s54, 3
  s_andn2_b32 s53, s34, 3
  s_add_u32 s53, s53, s54
  s_mul_i32 s53, s53, 491520
  s_add_u32 s53, s53, s86
  s_add_u32 s48, s53, s50
  s_add_u32 m0, s44, 0
  s_nop 0
  buffer_load_dwordx4 v28, s[28:31], s48 offen offset:0  lds
  buffer_load_dwordx4 v29, s[28:31], s48 offen offset:1024  lds
  buffer_load_dwordx4 v30, s[28:31], s48 offen offset:2048  lds
  s_add_u32 m0, s44, 3072
  s_nop 0
  buffer_load_dwordx4 v31, s[28:31], s48 offen offset:0  lds
  buffer_load_dwordx4 v32, s[28:31], s48 offen offset:1024  lds
  s_add_u32 s48, s48, 20480
  s_add_u32 m0, s44, 5120
  s_nop 0
  buffer_load_dwordx4 v28, s[28:31], s48 offen offset:0  lds
  buffer_load_dwordx4 v29, s[28:31], s48 offen offset:1024  lds
  buffer_load_dwordx4 v30, s[28:31], s48 offen offset:2048  lds
  s_add_u32 m0, s44, 8192
  s_nop 0
  buffer_load_dwordx4 v31, s[28:31], s48 offen offset:0  lds
  buffer_load_dwordx4 v32, s[28:31], s48 offen offset:1024  lds
  s_add_u32 s48, s48, 20480
  s_add_u32 m0, s44, 10240
  s_nop 0
  buffer_load_dwordx4 v28, s[28:31], s48 offen offset:0  lds
  buffer_load_dwordx4 v29, s[28:31], s48 offen offset:1024  lds
  buffer_load_dwordx4 v30, s[28:31], s48 offen offset:2048  lds
  s_add_u32 m0, s44, 13312
  s_nop 0
  buffer_load_dwordx4 v31, s[28:31], s48 offen offset:0  lds
  buffer_load_dwordx4 v32, s[28:31], s48 offen offset:1024  lds
  s_add_u32 s48, s48, 20480
  s_add_u32 m0, s44, 15360
  s_nop 0
  buffer_load_dwordx4 v28, s[28:31], s48 offen offset:0  lds
  buffer_load_dwordx4 v29, s[28:31], s48 offen offset:1024  lds
  buffer_load_dwordx4 v30, s[28:31], s48 offen offset:2048  lds
  s_add_u32 m0, s44, 18432
  s_nop 0
  buffer_load_dwordx4 v31, s[28:31], s48 offen offset:0  lds
  buffer_load_dwordx4 v32, s[28:31], s48 offen offset:1024  lds
  s_add_u32 s48, s48, 20480
  s_add_u32 s44, s44, 26624
  s_cmp_ge_u32 s44, 159744
  s_cselect_b32 s53, 159744, 0
  s_sub_u32 s44, s44, s53
  s_mov_b32 s40, 2
L_ld4:
  s_barrier
  s_waitcnt vmcnt(40)
  s_add_u32 m0, s44, 0
  s_nop 0
  buffer_load_dwordx4 v28, s[28:31], s48 offen offset:0  lds
  buffer_load_dwordx4 v29, s[28:31], s48 offen offset:1024  lds
  buffer_load_dwordx4 v30, s[28:31], s48 offen offset:2048  lds
  s_add_u32 m0, s44, 3072
  s_nop 0
  buffer_load_dwordx4 v31, s[28:31], s48 offen offset:0  lds
  buffer_load_dwordx4 v32, s[28:31], s48 offen offset:1024  lds
  s_add_u32 s48, s48, 20480
  s_add_u32 m0, s44, 5120
  s_nop 0
  buffer_load_dwordx4 v28, s[28:31], s48 offen offset:0  lds
  buffer_load_dwordx4 v29, s[28:31], s48 offen offset:1024  lds
  buffer_load_dwordx4 v30, s[28:31], s48 offen offset:2048  lds
  s_add_u32 m0, s44, 8192
  s_nop 0
  buffer_load_dwordx4 v31, s[28:31], s48 offen offset:0  lds
  buffer_load_dwordx4 v32, s[28:31], s48 offen offset:1024  lds
  s_add_u32 s48, s48, 20480
  s_add_u32 m0, s44, 10240
  s_nop 0
  buffer_load_dwordx4 v28, s[28:31], s48 offen offset:0  lds
  buffer_load_dwordx4 v29, s[28:31], s48 offen offset:1024  lds
  buffer_load_dwordx4 v30, s[28:31], s48 offen offset:2048  lds
  s_add_u32 m0, s44, 13312
  s_nop 0
  buffer_load_dwordx4 v31, s[28:31], s48 offen offset:0  lds
  buffer_load_dwordx4 v32, s[28:31], s48 offen offset:1024  lds
  s_add_u32 s48, s48, 20480
  s_add_u32 m0, s44, 15360
  s_nop 0
  buffer_load_dwordx4 v28, s[28:31], s48 offen offset:0  lds
  buffer_load_dwordx4 v29, s[28:31], s48 offen offset:1024  lds
  buffer_load_dwordx4 v30, s[28:31], s48 offen offset:2048  lds
  s_add_u32 m0, s44, 18432
  s_nop 0
  buffer_load_dwordx4 v31, s[28:31], s48 offen offset:0  lds
  buffer_load_dwordx4 v32, s[28:31], s48 offen offset:1024  lds
  s_add_u32 s48, s48, 20480
  s_add_u32 s44, s44, 26624
  s_cmp_ge_u32 s44, 159744
  s_cselect_b32 s53, 159744, 0
  s_sub_u32 s44, s44, s53
  s_sub_u32 s40, s40, 1
  s_cmp_lg_u32 s40, 0
  s_cbranch_scc1 L_ld4
  s_barrier
  buffer_load_dword v9, v7, s[60:63], 0 offen sc1
  s_waitcnt vmcnt(40)
  s_add_u32 s54, s92, 3
  s_and_b32 s54, s54, 3
  s_andn2_b32 s53, s34, 3
  s_add_u32 s53, s53, s54
  s_mul_i32 s53, s53, 491520
  s_add_u32 s53, s53, s86
  s_add_u32 s48, s53, s50
  s_add_u32 m0, s44, 0
  s_nop 0
  buffer_load_dwordx4 v28, s[28:31], s48 offen offset:0  lds
  buffer_load_dwordx4 v29, s[28:31], s48 offen offset:1024  lds
  buffer_load_dwordx4 v30, s[28:31], s48 offen offset:2048  lds
  s_add_u32 m0, s44, 3072
  s_nop 0
  buffer_load_dwordx4 v31, s[28:31], s48 offen offset:0  lds
  buffer_load_dwordx4 v32, s[28:31], s48 offen offset:1024  lds
  s_add_u32 s48, s48, 20480
  s_add_u32 m0, s44, 5120
  s_nop 0
  buffer_load_dwordx4 v28, s[28:31], s48 offen offset:0  lds
  buffer_load_dwordx4 v29, s[28:31], s48 offen offset:1024  lds
  buffer_load_dwordx4 v30, s[28:31], s48 offen offset:2048  lds
  s_add_u32 m0, s44, 8192
  s_nop 0
  buffer_load_dwordx4 v31, s[28:31], s48 offen offset:0  lds
  buffer_load_dwordx4 v32, s[28:31], s48 offen offset:1024  lds
  s_add_u32 s48, s48, 20480
  s_add_u32 m0, s44, 10240
  s_nop 0
  buffer_load_dwordx4 v28, s[28:31], s48 offen offset:0  lds
  buffer_load_dwordx4 v29, s[28:31], s48 offen offset:1024  lds
  buffer_load_dwordx4 v30, s[28:31], s48 offen offset:2048  lds
  s_add_u32 m0, s44, 13312
  s_nop 0
  buffer_load_dwordx4 v31, s[28:31], s48 offen offset:0  lds
  buffer_load_dwordx4 v32, s[28:31], s48 offen offset:1024  lds
  s_add_u32 s48, s48, 20480
  s_add_u32 m0, s44, 15360
  s_nop 0
  buffer_load_dwordx4 v28, s[28:31], s48 offen offset:0  lds
  buffer_load_dwordx4 v29, s[28:31], s48 offen offset:1024  lds
  buffer_load_dwordx4 v30, s[28:31], s48 offen offset:2048  lds
  s_add_u32 m0, s44, 18432
  s_nop 0
  buffer_load_dwordx4 v31, s[28:31], s48 offen offset:0  lds
  buffer_load_dwordx4 v32, s[28:31], s48 offen offset:1024  lds
  s_add_u32 s48, s48, 20480
  s_add_u32 s44, s44, 26624
  s_cmp_ge_u32 s44, 159744
  s_cselect_b32 s53, 159744, 0
  s_sub_u32 s44, s44, s53
  s_mov_b32 s53, 400000
  s_waitcnt vmcnt(20)
  s_branch L_pchk_fin
L_poll_fin:
  buffer_load_dword v9, v7, s[60:63], 0 offen sc1
  s_waitcnt vmcnt(0)
L_pchk_fin:
  v_readfirstlane_b32 s54, v9
  s_nop 0
  s_lshr_b32 s54, s54, 8
  s_and_b32 s54, s54, 15
  s_cmp_eq_u32 s54, 15
  s_cbranch_scc1 L_pdone_fin
  s_sleep 2
  s_sub_u32 s53, s53, 1
  s_cmp_lg_u32 s53, 0
  s_cbranch_scc1 L_poll_fin
L_pdone_fin:
  s_barrier
  s_mov_b32 s54, 71303168
  buffer_load_dwordx4 v[40:43], v36, s[24:27], s54 offen sc1
  s_waitcnt vmcnt(40)
  s_add_u32 m0, s44, 0
  s_nop 0
  buffer_load_dwordx4 v28, s[28:31], s48 offen offset:0  lds
  buffer_load_dwordx4 v29, s[28:31], s48 offen offset:1024  lds
  buffer_load_dwordx4 v30, s[28:31], s48 offen offset:2048  lds
  s_add_u32 m0, s44, 3072
  s_nop 0
  buffer_load_dwordx4 v31, s[28:31], s48 offen offset:0  lds
  buffer_load_dwordx4 v32, s[28:31], s48 offen offset:1024  lds
  s_add_u32 s48, s48, 20480
  s_add_u32 m0, s44, 5120
  s_nop 0
  buffer_load_dwordx4 v28, s[28:31], s48 offen offset:0  lds
  buffer_load_dwordx4 v29, s[28:31], s48 offen offset:1024  lds
  buffer_load_dwordx4 v30, s[28:31], s48 offen offset:2048  lds
  s_add_u32 m0, s44, 8192
  s_nop 0
  buffer_load_dwordx4 v31, s[28:31], s48 offen offset:0  lds
  buffer_load_dwordx4 v32, s[28:31], s48 offen offset:1024  lds
  s_add_u32 s48, s48, 20480
  s_add_u32 m0, s44, 10240
  s_nop 0
  buffer_load_dwordx4 v28, s[28:31], s48 offen offset:0  lds
  buffer_load_dwordx4 v29, s[28:31], s48 offen offset:1024  lds
  buffer_load_dwordx4 v30, s[28:31], s48 offen offset:2048  lds
  s_add_u32 m0, s44, 13312
  s_nop 0
  buffer_load_dwordx4 v31, s[28:31], s48 offen offset:0  lds
  buffer_load_dwordx4 v32, s[28:31], s48 offen offset:1024  lds
  s_add_u32 s48, s48, 20480
  s_add_u32 m0, s44, 15360
  s_nop 0
  buffer_load_dwordx4 v28, s[28:31], s48 offen offset:0  lds
  buffer_load_dwordx4 v29, s[28:31], s48 offen offset:1024  lds
  buffer_load_dwordx4 v30, s[28:31], s48 offen offset:2048  lds
  s_add_u32 m0, s44, 18432
  s_nop 0
  buffer_load_dwordx4 v31, s[28:31], s48 offen offset:0  lds
  buffer_load_dwordx4 v32, s[28:31], s48 offen offset:1024  lds
  s_add_u32 s48, s48, 20480
  s_add_u32 s44, s44, 26624
  s_cmp_ge_u32 s44, 159744
  s_cselect_b32 s53, 159744, 0
  s_sub_u32 s44, s44, s53
  s_barrier
  s_waitcnt vmcnt(40)
  s_add_u32 m0, s44, 0
  s_nop 0
  buffer_load_dwordx4 v28, s[28:31], s48 offen offset:0  lds
  buffer_load_dwordx4 v29, s[28:31], s48 offen offset:1024  lds
  buffer_load_dwordx4 v30, s[28:31], s48 offen offset:2048  lds
  s_add_u32 m0, s44, 3072
  s_nop 0
  buffer_load_dwordx4 v31, s[28:31], s48 offen offset:0  lds
  buffer_load_dwordx4 v32, s[28:31], s48 offen offset:1024  lds
  s_add_u32 s48, s48, 20480
  s_add_u32 m0, s44, 5120
  s_nop 0
  buffer_load_dwordx4 v28, s[28:31], s48 offen offset:0  lds
  buffer_load_dwordx4 v29, s[28:31], s48 offen offset:1024  lds
  buffer_load_dwordx4 v30, s[28:31], s48 offen offset:2048  lds
  s_add_u32 m0, s44, 8192
  s_nop 0
  buffer_load_dwordx4 v31, s[28:31], s48 offen offset:0  lds
  buffer_load_dwordx4 v32, s[28:31], s48 offen offset:1024  lds
  s_add_u32 s48, s48, 20480
  s_add_u32 m0, s44, 10240
  s_nop 0
  buffer_load_dwordx4 v28, s[28:31], s48 offen offset:0  lds
  buffer_load_dwordx4 v29, s[28:31], s48 offen offset:1024  lds
  buffer_load_dwordx4 v30, s[28:31], s48 offen offset:2048  lds
  s_add_u32 m0, s44, 13312
  s_nop 0
  buffer_load_dwordx4 v31, s[28:31], s48 offen offset:0  lds
  buffer_load_dwordx4 v32, s[28:31], s48 offen offset:1024  lds
  s_add_u32 s48, s48, 20480
  s_add_u32 m0, s44, 15360
  s_nop 0
  buffer_load_dwordx4 v28, s[28:31], s48 offen offset:0  lds
  buffer_load_dwordx4 v29, s[28:31], s48 offen offset:1024  lds
  buffer_load_dwordx4 v30, s[28:31], s48 offen offset:2048  lds
  s_add_u32 m0, s44, 18432
  s_nop 0
  buffer_load_dwordx4 v31, s[28:31], s48 offen offset:0  lds
  buffer_load_dwordx4 v32, s[28:31], s48 offen offset:1024  lds
  s_add_u32 s48, s48, 20480
  s_add_u32 s44, s44, 26624
  s_cmp_ge_u32 s44, 159744
  s_cselect_b32 s53, 159744, 0
  s_sub_u32 s44, s44, s53
  s_waitcnt vmcnt(40)
  v_readfirstlane_b32 s64, v40
  v_readfirstlane_b32 s65, v41
  v_readfirstlane_b32 s66, v42
  v_readfirstlane_b32 s67, v43
  s_nop 0
  s_sub_u32 s67, s67, s64
  s_add_u32 s67, s67, 0x400000
  s_lshl_b32 s67, s67, 2
  s_add_u32 s67, s67, 3
  s_sub_u32 s66, s66, s64
  s_add_u32 s66, s66, 0x400000
  s_lshl_b32 s66, s66, 2
  s_add_u32 s66, s66, 2
  s_sub_u32 s65, s65, s64
  s_add_u32 s65, s65, 0x400000
  s_lshl_b32 s65, s65, 2
  s_add_u32 s65, s65, 1
  s_sub_u32 s64, s64, s64
  s_add_u32 s64, s64, 0x400000
  s_lshl_b32 s64, s64, 2
  s_add_u32 s64, s64, 0
  s_min_u32 s53, s64, s65
  s_max_u32 s65, s64, s65
  s_mov_b32 s64, s53
  s_min_u32 s53, s66, s67
  s_max_u32 s67, s66, s67
  s_mov_b32 s66, s53
  s_min_u32 s53, s64, s66
  s_max_u32 s66, s64, s66
  s_mov_b32 s64, s53
  s_min_u32 s53, s65, s67
  s_max_u32 s67, s65, s67
  s_mov_b32 s65, s53
  s_min_u32 s53, s65, s66
  s_max_u32 s66, s65, s66
  s_mov_b32 s65, s53
  s_and_b32 s68, s64, 3
  s_lshr_b32 s64, s64, 2
  s_and_b32 s69, s65, 3
  s_lshr_b32 s65, s65, 2
  s_and_b32 s70, s66, 3
  s_lshr_b32 s66, s66, 2
  s_and_b32 s71, s67, 3
  s_lshr_b32 s67, s67, 2
  s_sub_u32 s53, s67, s64
  s_cmp_gt_u32 s53, 205
  s_cselect_b32 s76, 1, 0
  s_sub_u32 s53, s66, s65
  s_cmp_gt_u32 s53, 205
  s_cselect_b32 s77, s76, 0
  s_sub_u32 s67, s67, 225
  s_add_u32 s64, s64, 225
  s_cmp_lt_u32 s65, s64
  s_cselect_b32 s53, 1, 0
  s_andn2_b32 s53, s53, s77
  s_cmp_eq_u32 s53, 1
  s_cselect_b32 s79, s69, s68
  s_cselect_b32 s54, s65, s64
  s_add_u32 s54, s54, 205
  s_cmp_gt_u32 s67, s54
  s_cselect_b32 s78, s76, 0
  s_mul_i32 s53, s77, 225
  s_sub_u32 s66, s66, s53
  s_cmp_gt_u32 s67, s66
  s_cselect_b32 s78, s78, 0
  s_and_b32 s72, s2, 3
  s_add_u32 s53, s76, s78
  s_cmp_eq_u32 s72, s71
  s_cselect_b32 s54, s53, 0
  s_cmp_eq_u32 s72, s70
  s_cselect_b32 s54, s77, s54
  s_sub_u32 s89, 3, s54
  s_cmp_le_u32 s35, 0
  s_addc_u32 s64, 0, 0
  s_cmp_le_u32 s35, 1
  s_addc_u32 s65, 1, 0
  s_cmp_le_u32 s35, 2
  s_addc_u32 s66, 2, 0
  s_lshl_b32 s53, s65, 4
  s_lshl_b32 s54, s66, 8
  s_add_u32 s88, s64, s53
  s_add_u32 s88, s88, s54
  s_mul_i32 s53, s72, 0x444
  s_add_u32 s88, s88, s53
  s_lshl_b32 s53, s89, 2
  s_bfm_b32 s53, s53, 0
  s_and_b32 s88, s88, s53
  s_cmp_eq_u32 s72, s68
  s_cselect_b32 s55, s76, 0
  s_lshl_b32 s53, s71, 2
  s_add_u32 s53, s53, s66
  s_mul_i32 s53, s53, s55
  s_lshl_b32 s54, s89, 2
  s_lshl_b32 s53, s53, s54
  s_add_u32 s88, s88, s53
  s_add_u32 s89, s89, s55
  s_cmp_eq_u32 s72, s69
  s_cselect_b32 s55, s77, 0
  s_lshl_b32 s53, s70, 2
  s_add_u32 s53, s53, s66
  s_mul_i32 s53, s53, s55
  s_lshl_b32 s54, s89, 2
  s_lshl_b32 s53, s53, s54
  s_add_u32 s88, s88, s53
  s_add_u32 s89, s89, s55
  s_cmp_eq_u32 s72, s79
  s_cselect_b32 s55, s78, 0
  s_lshl_b32 s53, s71, 2
  s_add_u32 s53, s53, s65
  s_mul_i32 s53, s53, s55
  s_lshl_b32 s54, s89, 2
  s_lshl_b32 s53, s53, s54
  s_add_u32 s88, s88, s53
  s_add_u32 s89, s89, s55
  s_lshl_b32 s53, s89, 28
  s_add_u32 s53, s53, s88
  v_mov_b32 v44, s53
  v_mov_b32 v45, 159744
  ds_write_b32 v45, v44
  s_waitcnt lgkmcnt(0)
  s_barrier
  s_lshl_b32 s53, 1, s35
  v_mov_b32 v9, s53
  s_mov_b64 exec, 1
  buffer_atomic_add v9, v8, s[60:63], 0 offen sc1
  s_mov_b64 exec, -1
  s_waitcnt vmcnt(40)
  s_barrier
L_dyn:
  s_waitcnt vmcnt(20)
  s_barrier
  s_and_b32 s53, s88, 15
  s_lshr_b32 s88, s88, 4
  s_and_b32 s55, s53, 3
  s_andn2_b32 s54, s53, 3
  s_add_u32 s54, s54, s91
  v_mov_b32 v8, s54
  s_mul_i32 s53, s53, 491520
  s_add_u32 s53, s53, s87
  s_add_u32 s48, s53, s50
  buffer_load_dword v9, v8, s[60:63], 0 offen sc1
  s_add_u32 m0, s44, 0
  s_nop 0
  buffer_load_dwordx4 v28, s[28:31], s48 offen offset:0  lds
  buffer_load_dwordx4 v29, s[28:31], s48 offen offset:1024  lds
  buffer_load_dwordx4 v30, s[28:31], s48 offen offset:2048  lds
  s_add_u32 m0, s44, 3072
  s_nop 0
  buffer_load_dwordx4 v31, s[28:31], s48 offen offset:0  lds
  buffer_load_dwordx4 v32, s[28:31], s48 offen offset:1024  lds
  s_add_u32 s48, s48, 20480
  s_add_u32 m0, s44, 5120
  s_nop 0
  buffer_load_dwordx4 v28, s[28:31], s48 offen offset:0  lds
  buffer_load_dwordx4 v29, s[28:31], s48 offen offset:1024  lds
  buffer_load_dwordx4 v30, s[28:31], s48 offen offset:2048  lds
  s_add_u32 m0, s44, 8192
  s_nop 0
  buffer_load_dwordx4 v31, s[28:31], s48 offen offset:0  lds
  buffer_load_dwordx4 v32, s[28:31], s48 offen offset:1024  lds
  s_add_u32 s48, s48, 20480
  s_add_u32 m0, s44, 10240
  s_nop 0
  buffer_load_dwordx4 v28, s[28:31], s48 offen offset:0  lds
  buffer_load_dwordx4 v29, s[28:31], s48 offen offset:1024  lds
  buffer_load_dwordx4 v30, s[28:31], s48 offen offset:2048  lds
  s_add_u32 m0, s44, 13312
  s_nop 0
  buffer_load_dwordx4 v31, s[28:31], s48 offen offset:0  lds
  buffer_load_dwordx4 v32, s[28:31], s48 offen offset:1024  lds
  s_add_u32 s48, s48, 20480
  s_add_u32 m0, s44, 15360
  s_nop 0
  buffer_load_dwordx4 v28, s[28:31], s48 offen offset:0  lds
  buffer_load_dwordx4 v29, s[28:31], s48 offen offset:1024  lds
  buffer_load_dwordx4 v30, s[28:31], s48 offen offset:2048  lds
  s_add_u32 m0, s44, 18432
  s_nop 0
  buffer_load_dwordx4 v31, s[28:31], s48 offen offset:0  lds
  buffer_load_dwordx4 v32, s[28:31], s48 offen offset:1024  lds
  s_add_u32 s48, s48, 20480
  s_add_u32 s44, s44, 26624
  s_cmp_ge_u32 s44, 159744
  s_cselect_b32 s53, 159744, 0
  s_sub_u32 s44, s44, s53
  s_mov_b32 s53, 400000
  s_waitcnt vmcnt(20)
  s_branch L_pchk_dyn
L_poll_dyn:
  buffer_load_dword v9, v8, s[60:63], 0 offen sc1
  s_waitcnt vmcnt(0)
L_pchk_dyn:
  v_readfirstlane_b32 s54, v9
  s_nop 0
  s_lshr_b32 s54, s54, s55
  s_and_b32 s54, s54, 1
  s_cmp_eq_u32 s54, 1
  s_cbranch_scc1 L_pdone_dyn
  s_sleep 2
  s_sub_u32 s53, s53, 1
  s_cmp_lg_u32 s53, 0
  s_cbranch_scc1 L_poll_dyn
L_pdone_dyn:
  s_barrier
  s_add_u32 m0, s44, 0
  s_nop 0
  buffer_load_dwordx4 v28, s[28:31], s48 offen offset:0  lds
  buffer_load_dwordx4 v29, s[28:31], s48 offen offset:1024  lds
  buffer_load_dwordx4 v30, s[28:31], s48 offen offset:2048  lds
  s_add_u32 m0, s44, 3072
  s_nop 0
  buffer_load_dwordx4 v31, s[28:31], s48 offen offset:0  lds
  buffer_load_dwordx4 v32, s[28:31], s48 offen offset:1024  lds
  s_add_u32 s48, s48, 20480
  s_add_u32 m0, s44, 5120
  s_nop 0
  buffer_load_dwordx4 v28, s[28:31], s48 offen offset:0  lds
  buffer_load_dwordx4 v29, s[28:31], s48 offen offset:1024  lds
  buffer_load_dwordx4 v30, s[28:31], s48 offen offset:2048  lds
  s_add_u32 m0, s44, 8192
  s_nop 0
  buffer_load_dwordx4 v31, s[28:31], s48 offen offset:0  lds
  buffer_load_dwordx4 v32, s[28:31], s48 offen offset:1024  lds
  s_add_u32 s48, s48, 20480
  s_add_u32 m0, s44, 10240
  s_nop 0
  buffer_load_dwordx4 v28, s[28:31], s48 offen offset:0  lds
  buffer_load_dwordx4 v29, s[28:31], s48 offen offset:1024  lds
  buffer_load_dwordx4 v30, s[28:31], s48 offen offset:2048  lds
  s_add_u32 m0, s44, 13312
  s_nop 0
  buffer_load_dwordx4 v31, s[28:31], s48 offen offset:0  lds
  buffer_load_dwordx4 v32, s[28:31], s48 offen offset:1024  lds
  s_add_u32 s48, s48, 20480
  s_add_u32 m0, s44, 15360
  s_nop 0
  buffer_load_dwordx4 v28, s[28:31], s48 offen offset:0  lds
  buffer_load_dwordx4 v29, s[28:31], s48 offen offset:1024  lds
  buffer_load_dwordx4 v30, s[28:31], s48 offen offset:2048  lds
  s_add_u32 m0, s44, 18432
  s_nop 0
  buffer_load_dwordx4 v31, s[28:31], s48 offen offset:0  lds
  buffer_load_dwordx4 v32, s[28:31], s48 offen offset:1024  lds
  s_add_u32 s48, s48, 20480
  s_add_u32 s44, s44, 26624
  s_cmp_ge_u32 s44, 159744
  s_cselect_b32 s53, 159744, 0
  s_sub_u32 s44, s44, s53
  s_waitcnt vmcnt(20)
  s_barrier
  s_add_u32 m0, s44, 0
  s_nop 0
  buffer_load_dwordx4 v28, s[28:31], s48 offen offset:0  lds
  buffer_load_dwordx4 v29, s[28:31], s48 offen offset:1024  lds
  buffer_load_dwordx4 v30, s[28:31], s48 offen offset:2048  lds
  s_add_u32 m0, s44, 3072
  s_nop 0
  buffer_load_dwordx4 v31, s[28:31], s48 offen offset:0  lds
  buffer_load_dwordx4 v32, s[28:31], s48 offen offset:1024  lds
  s_add_u32 s48, s48, 20480
  s_add_u32 m0, s44, 5120
  s_nop 0
  buffer_load_dwordx4 v28, s[28:31], s48 offen offset:0  lds
  buffer_load_dwordx4 v29, s[28:31], s48 offen offset:1024  lds
  buffer_load_dwordx4 v30, s[28:31], s48 offen offset:2048  lds
  s_add_u32 m0, s44, 8192
  s_nop 0
  buffer_load_dwordx4 v31, s[28:31], s48 offen offset:0  lds
  buffer_load_dwordx4 v32, s[28:31], s48 offen offset:1024  lds
  s_add_u32 s48, s48, 20480
  s_add_u32 m0, s44, 10240
  s_nop 0
  buffer_load_dwordx4 v28, s[28:31], s48 offen offset:0  lds
  buffer_load_dwordx4 v29, s[28:31], s48 offen offset:1024  lds
  buffer_load_dwordx4 v30, s[28:31], s48 offen offset:2048  lds
  s_add_u32 m0, s44, 13312
  s_nop 0
  buffer_load_dwordx4 v31, s[28:31], s48 offen offset:0  lds
  buffer_load_dwordx4 v32, s[28:31], s48 offen offset:1024  lds
  s_add_u32 s48, s48, 20480
  s_add_u32 m0, s44, 15360
  s_nop 0
  buffer_load_dwordx4 v28, s[28:31], s48 offen offset:0  lds
  buffer_load_dwordx4 v29, s[28:31], s48 offen offset:1024  lds
  buffer_load_dwordx4 v30, s[28:31], s48 offen offset:2048  lds
  s_add_u32 m0, s44, 18432
  s_nop 0
  buffer_load_dwordx4 v31, s[28:31], s48 offen offset:0  lds
  buffer_load_dwordx4 v32, s[28:31], s48 offen offset:1024  lds
  s_add_u32 s48, s48, 20480
  s_add_u32 s44, s44, 26624
  s_cmp_ge_u32 s44, 159744
  s_cselect_b32 s53, 159744, 0
  s_sub_u32 s44, s44, s53
  s_sub_u32 s89, s89, 1
  s_cmp_lg_u32 s89, 0
  s_cbranch_scc1 L_dyn
  s_waitcnt vmcnt(20)
  s_barrier
  s_waitcnt vmcnt(0)
  s_barrier
  v_lshlrev_b32 v37, 5, v7
  s_and_b32 s54, s2, 3
  v_mov_b32 v9, v40
  s_cmp_eq_u32 s54, 1
  s_cselect_b64 vcc, -1, 0
  v_cndmask_b32 v9, v9, v41, vcc
  s_cmp_eq_u32 s54, 2
  s_cselect_b64 vcc, -1, 0
  v_cndmask_b32 v9, v9, v42, vcc
  s_cmp_eq_u32 s54, 3
  s_cselect_b64 vcc, -1, 0
  v_cndmask_b32 v9, v9, v43, vcc
  s_lshl_b32 s54, s54, 2
  s_add_u32 s54, s54, 71368704
  s_mov_b32 s55, 71368704
  s_mov_b32 s53, 400000
  s_barrier
  s_mov_b64 exec, 1
  buffer_store_dword v9, v37, s[24:27], s54 offen sc1
L_fin:
  buffer_load_dwordx4 v[44:47], v37, s[24:27], s55 offen sc1
  s_waitcnt vmcnt(0)
  v_xor_b32 v44, v44, v40
  v_xor_b32 v45, v45, v41
  v_xor_b32 v46, v46, v42
  v_xor_b32 v47, v47, v43
  v_or3_b32 v44, v44, v45, v46
  v_or_b32 v44, v44, v47
  s_nop 0
  v_readfirstlane_b32 s54, v44
  s_nop 0
  s_cmp_eq_u32 s54, 0
  s_cbranch_scc1 L_findone
  s_sub_u32 s53, s53, 1
  s_cmp_lg_u32 s53, 0
  s_cbranch_scc1 L_fin
L_findone:
  s_mov_b64 exec, -1
  s_barrier
  s_endpgm
L_rare_af0:
  v_max3_f32 v1, v96, v97, v98
  v_max3_f32 v2, v99, v104, v105
  v_max3_f32 v1, v1, v106, v107
  v_max_f32 v1, v1, v2
  v_mov_b32 v2, v1
  s_nop 1
  v_permlane32_swap_b32 v1, v2
  v_max_f32 v1, v1, v2
  v_mov_b32 v2, v1
  s_nop 1
  v_permlane16_swap_b32 v1, v2
  v_max_f32 v1, v1, v2
  v_max3_f32 v3, v100, v101, v102
  v_max3_f32 v4, v103, v108, v109
  v_max3_f32 v3, v3, v110, v111
  v_max_f32 v3, v3, v4
  v_mov_b32 v4, v3
  s_nop 1
  v_permlane32_swap_b32 v3, v4
  v_max_f32 v3, v3, v4
  v_mov_b32 v4, v3
  s_nop 1
  v_permlane16_swap_b32 v3, v4
  v_max_f32 v3, v3, v4
  v_max_f32 v1, 0, v1
  v_sub_f32 v2, 0, v1
  v_exp_f32 v2, v2
  v_sub_f32 v64, v64, v1
  v_sub_f32 v65, v65, v1
  v_sub_f32 v66, v66, v1
  v_sub_f32 v67, v67, v1
  v_mul_f32 v8, v8, v2
  v_mul_f32 v160, v160, v2
  v_mul_f32 v161, v161, v2
  v_mul_f32 v162, v162, v2
  v_mul_f32 v163, v163, v2
  v_mul_f32 v168, v168, v2
  v_mul_f32 v169, v169, v2
  v_mul_f32 v170, v170, v2
  v_mul_f32 v171, v171, v2
  v_mul_f32 v176, v176, v2
  v_mul_f32 v177, v177, v2
  v_mul_f32 v178, v178, v2
  v_mul_f32 v179, v179, v2
  v_mul_f32 v184, v184, v2
  v_mul_f32 v185, v185, v2
  v_mul_f32 v186, v186, v2
  v_mul_f32 v187, v187, v2
  v_mul_f32 v192, v192, v2
  v_mul_f32 v193, v193, v2
  v_mul_f32 v194, v194, v2
  v_mul_f32 v195, v195, v2
  v_mul_f32 v200, v200, v2
  v_mul_f32 v201, v201, v2
  v_mul_f32 v202, v202, v2
  v_mul_f32 v203, v203, v2
  v_mul_f32 v208, v208, v2
  v_mul_f32 v209, v209, v2
  v_mul_f32 v210, v210, v2
  v_mul_f32 v211, v211, v2
  v_mul_f32 v216, v216, v2
  v_mul_f32 v217, v217, v2
  v_mul_f32 v218, v218, v2
  v_mul_f32 v219, v219, v2
  v_mul_f32 v224, v224, v2
  v_mul_f32 v225, v225, v2
  v_mul_f32 v226, v226, v2
  v_mul_f32 v227, v227, v2
  v_mul_f32 v232, v232, v2
  v_mul_f32 v233, v233, v2
  v_mul_f32 v234, v234, v2
  v_mul_f32 v235, v235, v2
  v_mul_f32 v240, v240, v2
  v_mul_f32 v241, v241, v2
  v_mul_f32 v242, v242, v2
  v_mul_f32 v243, v243, v2
  v_mul_f32 v248, v248, v2
  v_mul_f32 v249, v249, v2
  v_mul_f32 v250, v250, v2
  v_mul_f32 v251, v251, v2
  v_max_f32 v3, 0, v3
  v_sub_f32 v4, 0, v3
  v_exp_f32 v4, v4
  v_sub_f32 v68, v68, v3
  v_sub_f32 v69, v69, v3
  v_sub_f32 v70, v70, v3
  v_sub_f32 v71, v71, v3
  v_mul_f32 v9, v9, v4
  v_mul_f32 v164, v164, v4
  v_mul_f32 v165, v165, v4
  v_mul_f32 v166, v166, v4
  v_mul_f32 v167, v167, v4
  v_mul_f32 v172, v172, v4
  v_mul_f32 v173, v173, v4
  v_mul_f32 v174, v174, v4
  v_mul_f32 v175, v175, v4
  v_mul_f32 v180, v180, v4
  v_mul_f32 v181, v181, v4
  v_mul_f32 v182, v182, v4
  v_mul_f32 v183, v183, v4
  v_mul_f32 v188, v188, v4
  v_mul_f32 v189, v189, v4
  v_mul_f32 v190, v190, v4
  v_mul_f32 v191, v191, v4
  v_mul_f32 v196, v196, v4
  v_mul_f32 v197, v197, v4
  v_mul_f32 v198, v198, v4
  v_mul_f32 v199, v199, v4
  v_mul_f32 v204, v204, v4
  v_mul_f32 v205, v205, v4
  v_mul_f32 v206, v206, v4
  v_mul_f32 v207, v207, v4
  v_mul_f32 v212, v212, v4
  v_mul_f32 v213, v213, v4
  v_mul_f32 v214, v214, v4
  v_mul_f32 v215, v215, v4
  v_mul_f32 v220, v220, v4
  v_mul_f32 v221, v221, v4
  v_mul_f32 v222, v222, v4
  v_mul_f32 v223, v223, v4
  v_mul_f32 v228, v228, v4
  v_mul_f32 v229, v229, v4
  v_mul_f32 v230, v230, v4
  v_mul_f32 v231, v231, v4
  v_mul_f32 v236, v236, v4
  v_mul_f32 v237, v237, v4
  v_mul_f32 v238, v238, v4
  v_mul_f32 v239, v239, v4
  v_mul_f32 v244, v244, v4
  v_mul_f32 v245, v245, v4
  v_mul_f32 v246, v246, v4
  v_mul_f32 v247, v247, v4
  v_mul_f32 v252, v252, v4
  v_mul_f32 v253, v253, v4
  v_mul_f32 v254, v254, v4
  v_mul_f32 v255, v255, v4
  v_sub_f32 v96, v96, v1
  v_sub_f32 v97, v97, v1
  v_sub_f32 v98, v98, v1
  v_sub_f32 v99, v99, v1
  v_exp_f32 v24, v96
  v_exp_f32 v25, v97
  v_exp_f32 v26, v98
  v_cvt_pk_bf16_f32 v80, v24, v25
  v_add_f32 v24, v24, v25
  v_exp_f32 v27, v99
  s_nop 0
  v_cvt_pk_bf16_f32 v81, v26, v27
  v_add_f32 v26, v26, v27
  v_add_f32 v10, v24, v26
  v_sub_f32 v100, v100, v3
  v_sub_f32 v101, v101, v3
  v_sub_f32 v102, v102, v3
  v_sub_f32 v103, v103, v3
  v_exp_f32 v28, v100
  v_exp_f32 v29, v101
  v_exp_f32 v30, v102
  v_cvt_pk_bf16_f32 v84, v28, v29
  v_add_f32 v28, v28, v29
  v_exp_f32 v31, v103
  s_nop 0
  v_cvt_pk_bf16_f32 v85, v30, v31
  v_add_f32 v30, v30, v31
  v_add_f32 v11, v28, v30
  v_sub_f32 v104, v104, v1
  v_sub_f32 v105, v105, v1
  v_sub_f32 v106, v106, v1
  v_sub_f32 v107, v107, v1
  v_exp_f32 v24, v104
  v_exp_f32 v25, v105
  v_exp_f32 v26, v106
  v_cvt_pk_bf16_f32 v82, v24, v25
  v_add_f32 v24, v24, v25
  v_exp_f32 v27, v107
  v_add_f32 v10, v10, v24
  v_cvt_pk_bf16_f32 v83, v26, v27
  v_add_f32 v26, v26, v27
  v_add_f32 v10, v10, v26
  v_sub_f32 v108, v108, v3
  v_sub_f32 v109, v109, v3
  v_sub_f32 v110, v110, v3
  v_sub_f32 v111, v111, v3
  v_exp_f32 v28, v108
  v_exp_f32 v29, v109
  v_exp_f32 v30, v110
  v_cvt_pk_bf16_f32 v86, v28, v29
  v_add_f32 v28, v28, v29
  v_exp_f32 v31, v111
  v_add_f32 v11, v11, v28
  v_cvt_pk_bf16_f32 v87, v30, v31
  v_add_f32 v30, v30, v31
  v_add_f32 v11, v11, v30
  s_branch L_ret_af0
L_rare_a2:
  v_max3_f32 v1, v96, v97, v98
  v_max3_f32 v2, v99, v104, v105
  v_max3_f32 v1, v1, v106, v107
  v_max_f32 v1, v1, v2
  v_mov_b32 v2, v1
  s_nop 1
  v_permlane32_swap_b32 v1, v2
  v_max_f32 v1, v1, v2
  v_mov_b32 v2, v1
  s_nop 1
  v_permlane16_swap_b32 v1, v2
  v_max_f32 v1, v1, v2
  v_max3_f32 v3, v100, v101, v102
  v_max3_f32 v4, v103, v108, v109
  v_max3_f32 v3, v3, v110, v111
  v_max_f32 v3, v3, v4
  v_mov_b32 v4, v3
  s_nop 1
  v_permlane32_swap_b32 v3, v4
  v_max_f32 v3, v3, v4
  v_mov_b32 v4, v3
  s_nop 1
  v_permlane16_swap_b32 v3, v4
  v_max_f32 v3, v3, v4
  v_max_f32 v1, 0, v1
  v_sub_f32 v2, 0, v1
  v_exp_f32 v2, v2
  v_sub_f32 v64, v64, v1
  v_sub_f32 v65, v65, v1
  v_sub_f32 v66, v66, v1
  v_sub_f32 v67, v67, v1
  v_sub_f32 v88, v88, v1
  v_sub_f32 v89, v89, v1
  v_sub_f32 v90, v90, v1
  v_sub_f32 v91, v91, v1
  v_mul_f32 v8, v8, v2
  v_mul_f32 v160, v160, v2
  v_mul_f32 v161, v161, v2
  v_mul_f32 v162, v162, v2
  v_mul_f32 v163, v163, v2
  v_mul_f32 v168, v168, v2
  v_mul_f32 v169, v169, v2
  v_mul_f32 v170, v170, v2
  v_mul_f32 v171, v171, v2
  v_mul_f32 v176, v176, v2
  v_mul_f32 v177, v177, v2
  v_mul_f32 v178, v178, v2
  v_mul_f32 v179, v179, v2
  v_mul_f32 v184, v184, v2
  v_mul_f32 v185, v185, v2
  v_mul_f32 v186, v186, v2
  v_mul_f32 v187, v187, v2
  v_mul_f32 v192, v192, v2
  v_mul_f32 v193, v193, v2
  v_mul_f32 v194, v194, v2
  v_mul_f32 v195, v195, v2
  v_mul_f32 v200, v200, v2
  v_mul_f32 v201, v201, v2
  v_mul_f32 v202, v202, v2
  v_mul_f32 v203, v203, v2
  v_mul_f32 v208, v208, v2
  v_mul_f32 v209, v209, v2
  v_mul_f32 v210, v210, v2
  v_mul_f32 v211, v211, v2
  v_mul_f32 v216, v216, v2
  v_mul_f32 v217, v217, v2
  v_mul_f32 v218, v218, v2
  v_mul_f32 v219, v219, v2
  v_mul_f32 v224, v224, v2
  v_mul_f32 v225, v225, v2
  v_mul_f32 v226, v226, v2
  v_mul_f32 v227, v227, v2
  v_mul_f32 v232, v232, v2
  v_mul_f32 v233, v233, v2
  v_mul_f32 v234, v234, v2
  v_mul_f32 v235, v235, v2
  v_mul_f32 v240, v240, v2
  v_mul_f32 v241, v241, v2
  v_mul_f32 v242, v242, v2
  v_mul_f32 v243, v243, v2
  v_mul_f32 v248, v248, v2
  v_mul_f32 v249, v249, v2
  v_mul_f32 v250, v250, v2
  v_mul_f32 v251, v251, v2
  v_max_f32 v3, 0, v3
  v_sub_f32 v4, 0, v3
  v_exp_f32 v4, v4
  v_sub_f32 v68, v68, v3
  v_sub_f32 v69, v69, v3
  v_sub_f32 v70, v70, v3
  v_sub_f32 v71, v71, v3
  v_sub_f32 v92, v92, v3
  v_sub_f32 v93, v93, v3
  v_sub_f32 v94, v94, v3
  v_sub_f32 v95, v95, v3
  v_mul_f32 v9, v9, v4
  v_mul_f32 v164, v164, v4
  v_mul_f32 v165, v165, v4
  v_mul_f32 v166, v166, v4
  v_mul_f32 v167, v167, v4
  v_mul_f32 v172, v172, v4
  v_mul_f32 v173, v173, v4
  v_mul_f32 v174, v174, v4
  v_mul_f32 v175, v175, v4
  v_mul_f32 v180, v180, v4
  v_mul_f32 v181, v181, v4
  v_mul_f32 v182, v182, v4
  v_mul_f32 v183, v183, v4
  v_mul_f32 v188, v188, v4
  v_mul_f32 v189, v189, v4
  v_mul_f32 v190, v190, v4
  v_mul_f32 v191, v191, v4
  v_mul_f32 v196, v196, v4
  v_mul_f32 v197, v197, v4
  v_mul_f32 v198, v198, v4
  v_mul_f32 v199, v199, v4
  v_mul_f32 v204, v204, v4
  v_mul_f32 v205, v205, v4
  v_mul_f32 v206, v206, v4
  v_mul_f32 v207, v207, v4
  v_mul_f32 v212, v212, v4
  v_mul_f32 v213, v213, v4
  v_mul_f32 v214, v214, v4
  v_mul_f32 v215, v215, v4
  v_mul_f32 v220, v220, v4
  v_mul_f32 v221, v221, v4
  v_mul_f32 v222, v222, v4
  v_mul_f32 v223, v223, v4
  v_mul_f32 v228, v228, v4
  v_mul_f32 v229, v229, v4
  v_mul_f32 v230, v230, v4
  v_mul_f32 v231, v231, v4
  v_mul_f32 v236, v236, v4
  v_mul_f32 v237, v237, v4
  v_mul_f32 v238, v238, v4
  v_mul_f32 v239, v239, v4
  v_mul_f32 v244, v244, v4
  v_mul_f32 v245, v245, v4
  v_mul_f32 v246, v246, v4
  v_mul_f32 v247, v247, v4
  v_mul_f32 v252, v252, v4
  v_mul_f32 v253, v253, v4
  v_mul_f32 v254, v254, v4
  v_mul_f32 v255, v255, v4
  v_sub_f32 v96, v96, v1
  v_sub_f32 v97, v97, v1
  v_sub_f32 v98, v98, v1
  v_sub_f32 v99, v99, v1
  v_exp_f32 v24, v96
  v_exp_f32 v25, v97
  v_exp_f32 v26, v98
  v_cvt_pk_bf16_f32 v80, v24, v25
  v_add_f32 v24, v24, v25
  v_exp_f32 v27, v99
  s_nop 0
  v_cvt_pk_bf16_f32 v81, v26, v27
  v_add_f32 v26, v26, v27
  v_add_f32 v10, v24, v26
  v_sub_f32 v100, v100, v3
  v_sub_f32 v101, v101, v3
  v_sub_f32 v102, v102, v3
  v_sub_f32 v103, v103, v3
  v_exp_f32 v28, v100
  v_exp_f32 v29, v101
  v_exp_f32 v30, v102
  v_cvt_pk_bf16_f32 v84, v28, v29
  v_add_f32 v28, v28, v29
  v_exp_f32 v31, v103
  s_nop 0
  v_cvt_pk_bf16_f32 v85, v30, v31
  v_add_f32 v30, v30, v31
  v_add_f32 v11, v28, v30
  v_sub_f32 v104, v104, v1
  v_sub_f32 v105, v105, v1
  v_sub_f32 v106, v106, v1
  v_sub_f32 v107, v107, v1
  v_exp_f32 v24, v104
  v_exp_f32 v25, v105
  v_exp_f32 v26, v106
  v_cvt_pk_bf16_f32 v82, v24, v25
  v_add_f32 v24, v24, v25
  v_exp_f32 v27, v107
  v_add_f32 v10, v10, v24
  v_cvt_pk_bf16_f32 v83, v26, v27
  v_add_f32 v26, v26, v27
  v_add_f32 v10, v10, v26
  v_sub_f32 v108, v108, v3
  v_sub_f32 v109, v109, v3
  v_sub_f32 v110, v110, v3
  v_sub_f32 v111, v111, v3
  v_exp_f32 v28, v108
  v_exp_f32 v29, v109
  v_exp_f32 v30, v110
  v_cvt_pk_bf16_f32 v86, v28, v29
  v_add_f32 v28, v28, v29
  v_exp_f32 v31, v111
  v_add_f32 v11, v11, v28
  v_cvt_pk_bf16_f32 v87, v30, v31
  v_add_f32 v30, v30, v31
  v_add_f32 v11, v11, v30
  s_branch L_ret_a2
L_rare_a3:
  v_max3_f32 v1, v88, v89, v90
  v_max3_f32 v2, v91, v104, v105
  v_max3_f32 v1, v1, v106, v107
  v_max_f32 v1, v1, v2
  v_mov_b32 v2, v1
  s_nop 1
  v_permlane32_swap_b32 v1, v2
  v_max_f32 v1, v1, v2
  v_mov_b32 v2, v1
  s_nop 1
  v_permlane16_swap_b32 v1, v2
  v_max_f32 v1, v1, v2
  v_max3_f32 v3, v92, v93, v94
  v_max3_f32 v4, v95, v108, v109
  v_max3_f32 v3, v3, v110, v111
  v_max_f32 v3, v3, v4
  v_mov_b32 v4, v3
  s_nop 1
  v_permlane32_swap_b32 v3, v4
  v_max_f32 v3, v3, v4
  v_mov_b32 v4, v3
  s_nop 1
  v_permlane16_swap_b32 v3, v4
  v_max_f32 v3, v3, v4
  v_max_f32 v1, 0, v1
  v_sub_f32 v2, 0, v1
  v_exp_f32 v2, v2
  v_sub_f32 v64, v64, v1
  v_sub_f32 v65, v65, v1
  v_sub_f32 v66, v66, v1
  v_sub_f32 v67, v67, v1
  v_sub_f32 v96, v96, v1
  v_sub_f32 v97, v97, v1
  v_sub_f32 v98, v98, v1
  v_sub_f32 v99, v99, v1
  v_mul_f32 v8, v8, v2
  v_mul_f32 v160, v160, v2
  v_mul_f32 v161, v161, v2
  v_mul_f32 v162, v162, v2
  v_mul_f32 v163, v163, v2
  v_mul_f32 v168, v168, v2
  v_mul_f32 v169, v169, v2
  v_mul_f32 v170, v170, v2
  v_mul_f32 v171, v171, v2
  v_mul_f32 v176, v176, v2
  v_mul_f32 v177, v177, v2
  v_mul_f32 v178, v178, v2
  v_mul_f32 v179, v179, v2
  v_mul_f32 v184, v184, v2
  v_mul_f32 v185, v185, v2
  v_mul_f32 v186, v186, v2
  v_mul_f32 v187, v187, v2
  v_mul_f32 v192, v192, v2
  v_mul_f32 v193, v193, v2
  v_mul_f32 v194, v194, v2
  v_mul_f32 v195, v195, v2
  v_mul_f32 v200, v200, v2
  v_mul_f32 v201, v201, v2
  v_mul_f32 v202, v202, v2
  v_mul_f32 v203, v203, v2
  v_mul_f32 v208, v208, v2
  v_mul_f32 v209, v209, v2
  v_mul_f32 v210, v210, v2
  v_mul_f32 v211, v211, v2
  v_mul_f32 v216, v216, v2
  v_mul_f32 v217, v217, v2
  v_mul_f32 v218, v218, v2
  v_mul_f32 v219, v219, v2
  v_mul_f32 v224, v224, v2
  v_mul_f32 v225, v225, v2
  v_mul_f32 v226, v226, v2
  v_mul_f32 v227, v227, v2
  v_mul_f32 v232, v232, v2
  v_mul_f32 v233, v233, v2
  v_mul_f32 v234, v234, v2
  v_mul_f32 v235, v235, v2
  v_mul_f32 v240, v240, v2
  v_mul_f32 v241, v241, v2
  v_mul_f32 v242, v242, v2
  v_mul_f32 v243, v243, v2
  v_mul_f32 v248, v248, v2
  v_mul_f32 v249, v249, v2
  v_mul_f32 v250, v250, v2
  v_mul_f32 v251, v251, v2
  v_max_f32 v3, 0, v3
  v_sub_f32 v4, 0, v3
  v_exp_f32 v4, v4
  v_sub_f32 v68, v68, v3
  v_sub_f32 v69, v69, v3
  v_sub_f32 v70, v70, v3
  v_sub_f32 v71, v71, v3
  v_sub_f32 v100, v100, v3
  v_sub_f32 v101, v101, v3
  v_sub_f32 v102, v102, v3
  v_sub_f32 v103, v103, v3
  v_mul_f32 v9, v9, v4
  v_mul_f32 v164, v164, v4
  v_mul_f32 v165, v165, v4
  v_mul_f32 v166, v166, v4
  v_mul_f32 v167, v167, v4
  v_mul_f32 v172, v172, v4
  v_mul_f32 v173, v173, v4
  v_mul_f32 v174, v174, v4
  v_mul_f32 v175, v175, v4
  v_mul_f32 v180, v180, v4
  v_mul_f32 v181, v181, v4
  v_mul_f32 v182, v182, v4
  v_mul_f32 v183, v183, v4
  v_mul_f32 v188, v188, v4
  v_mul_f32 v189, v189, v4
  v_mul_f32 v190, v190, v4
  v_mul_f32 v191, v191, v4
  v_mul_f32 v196, v196, v4
  v_mul_f32 v197, v197, v4
  v_mul_f32 v198, v198, v4
  v_mul_f32 v199, v199, v4
  v_mul_f32 v204, v204, v4
  v_mul_f32 v205, v205, v4
  v_mul_f32 v206, v206, v4
  v_mul_f32 v207, v207, v4
  v_mul_f32 v212, v212, v4
  v_mul_f32 v213, v213, v4
  v_mul_f32 v214, v214, v4
  v_mul_f32 v215, v215, v4
  v_mul_f32 v220, v220, v4
  v_mul_f32 v221, v221, v4
  v_mul_f32 v222, v222, v4
  v_mul_f32 v223, v223, v4
  v_mul_f32 v228, v228, v4
  v_mul_f32 v229, v229, v4
  v_mul_f32 v230, v230, v4
  v_mul_f32 v231, v231, v4
  v_mul_f32 v236, v236, v4
  v_mul_f32 v237, v237, v4
  v_mul_f32 v238, v238, v4
  v_mul_f32 v239, v239, v4
  v_mul_f32 v244, v244, v4
  v_mul_f32 v245, v245, v4
  v_mul_f32 v246, v246, v4
  v_mul_f32 v247, v247, v4
  v_mul_f32 v252, v252, v4
  v_mul_f32 v253, v253, v4
  v_mul_f32 v254, v254, v4
  v_mul_f32 v255, v255, v4
  v_sub_f32 v88, v88, v1
  v_sub_f32 v89, v89, v1
  v_sub_f32 v90, v90, v1
  v_sub_f32 v91, v91, v1
  v_exp_f32 v24, v88
  v_exp_f32 v25, v89
  v_exp_f32 v26, v90
  v_cvt_pk_bf16_f32 v72, v24, v25
  v_add_f32 v24, v24, v25
  v_exp_f32 v27, v91
  s_nop 0
  v_cvt_pk_bf16_f32 v73, v26, v27
  v_add_f32 v26, v26, v27
  v_add_f32 v10, v24, v26
  v_sub_f32 v92, v92, v3
  v_sub_f32 v93, v93, v3
  v_sub_f32 v94, v94, v3
  v_sub_f32 v95, v95, v3
  v_exp_f32 v28, v92
  v_exp_f32 v29, v93
  v_exp_f32 v30, v94
  v_cvt_pk_bf16_f32 v76, v28, v29
  v_add_f32 v28, v28, v29
  v_exp_f32 v31, v95
  s_nop 0
  v_cvt_pk_bf16_f32 v77, v30, v31
  v_add_f32 v30, v30, v31
  v_add_f32 v11, v28, v30
  v_sub_f32 v104, v104, v1
  v_sub_f32 v105, v105, v1
  v_sub_f32 v106, v106, v1
  v_sub_f32 v107, v107, v1
  v_exp_f32 v24, v104
  v_exp_f32 v25, v105
  v_exp_f32 v26, v106
  v_cvt_pk_bf16_f32 v74, v24, v25
  v_add_f32 v24, v24, v25
  v_exp_f32 v27, v107
  v_add_f32 v10, v10, v24
  v_cvt_pk_bf16_f32 v75, v26, v27
  v_add_f32 v26, v26, v27
  v_add_f32 v10, v10, v26
  v_sub_f32 v108, v108, v3
  v_sub_f32 v109, v109, v3
  v_sub_f32 v110, v110, v3
  v_sub_f32 v111, v111, v3
  v_exp_f32 v28, v108
  v_exp_f32 v29, v109
  v_exp_f32 v30, v110
  v_cvt_pk_bf16_f32 v78, v28, v29
  v_add_f32 v28, v28, v29
  v_exp_f32 v31, v111
  v_add_f32 v11, v11, v28
  v_cvt_pk_bf16_f32 v79, v30, v31
  v_add_f32 v30, v30, v31
  v_add_f32 v11, v11, v30
  s_branch L_ret_a3
L_rare_a4:
  v_max3_f32 v1, v96, v97, v98
  v_max3_f32 v2, v99, v104, v105
  v_max3_f32 v1, v1, v106, v107
  v_max_f32 v1, v1, v2
  v_mov_b32 v2, v1
  s_nop 1
  v_permlane32_swap_b32 v1, v2
  v_max_f32 v1, v1, v2
  v_mov_b32 v2, v1
  s_nop 1
  v_permlane16_swap_b32 v1, v2
  v_max_f32 v1, v1, v2
  v_max3_f32 v3, v100, v101, v102
  v_max3_f32 v4, v103, v108, v109
  v_max3_f32 v3, v3, v110, v111
  v_max_f32 v3, v3, v4
  v_mov_b32 v4, v3
  s_nop 1
  v_permlane32_swap_b32 v3, v4
  v_max_f32 v3, v3, v4
  v_mov_b32 v4, v3
  s_nop 1
  v_permlane16_swap_b32 v3, v4
  v_max_f32 v3, v3, v4
  v_max_f32 v1, 0, v1
  v_sub_f32 v2, 0, v1
  v_exp_f32 v2, v2
  v_sub_f32 v64, v64, v1
  v_sub_f32 v65, v65, v1
  v_sub_f32 v66, v66, v1
  v_sub_f32 v67, v67, v1
  v_sub_f32 v88, v88, v1
  v_sub_f32 v89, v89, v1
  v_sub_f32 v90, v90, v1
  v_sub_f32 v91, v91, v1
  v_mul_f32 v8, v8, v2
  v_mul_f32 v160, v160, v2
  v_mul_f32 v161, v161, v2
  v_mul_f32 v162, v162, v2
  v_mul_f32 v163, v163, v2
  v_mul_f32 v168, v168, v2
  v_mul_f32 v169, v169, v2
  v_mul_f32 v170, v170, v2
  v_mul_f32 v171, v171, v2
  v_mul_f32 v176, v176, v2
  v_mul_f32 v177, v177, v2
  v_mul_f32 v178, v178, v2
  v_mul_f32 v179, v179, v2
  v_mul_f32 v184, v184, v2
  v_mul_f32 v185, v185, v2
  v_mul_f32 v186, v186, v2
  v_mul_f32 v187, v187, v2
  v_mul_f32 v192, v192, v2
  v_mul_f32 v193, v193, v2
  v_mul_f32 v194, v194, v2
  v_mul_f32 v195, v195, v2
  v_mul_f32 v200, v200, v2
  v_mul_f32 v201, v201, v2
  v_mul_f32 v202, v202, v2
  v_mul_f32 v203, v203, v2
  v_mul_f32 v208, v208, v2
  v_mul_f32 v209, v209, v2
  v_mul_f32 v210, v210, v2
  v_mul_f32 v211, v211, v2
  v_mul_f32 v216, v216, v2
  v_mul_f32 v217, v217, v2
  v_mul_f32 v218, v218, v2
  v_mul_f32 v219, v219, v2
  v_mul_f32 v224, v224, v2
  v_mul_f32 v225, v225, v2
  v_mul_f32 v226, v226, v2
  v_mul_f32 v227, v227, v2
  v_mul_f32 v232, v232, v2
  v_mul_f32 v233, v233, v2
  v_mul_f32 v234, v234, v2
  v_mul_f32 v235, v235, v2
  v_mul_f32 v240, v240, v2
  v_mul_f32 v241, v241, v2
  v_mul_f32 v242, v242, v2
  v_mul_f32 v243, v243, v2
  v_mul_f32 v248, v248, v2
  v_mul_f32 v249, v249, v2
  v_mul_f32 v250, v250, v2
  v_mul_f32 v251, v251, v2
  v_max_f32 v3, 0, v3
  v_sub_f32 v4, 0, v3
  v_exp_f32 v4, v4
  v_sub_f32 v68, v68, v3
  v_sub_f32 v69, v69, v3
  v_sub_f32 v70, v70, v3
  v_sub_f32 v71, v71, v3
  v_sub_f32 v92, v92, v3
  v_sub_f32 v93, v93, v3
  v_sub_f32 v94, v94, v3
  v_sub_f32 v95, v95, v3
  v_mul_f32 v9, v9, v4
  v_mul_f32 v164, v164, v4
  v_mul_f32 v165, v165, v4
  v_mul_f32 v166, v166, v4
  v_mul_f32 v167, v167, v4
  v_mul_f32 v172, v172, v4
  v_mul_f32 v173, v173, v4
  v_mul_f32 v174, v174, v4
  v_mul_f32 v175, v175, v4
  v_mul_f32 v180, v180, v4
  v_mul_f32 v181, v181, v4
  v_mul_f32 v182, v182, v4
  v_mul_f32 v183, v183, v4
  v_mul_f32 v188, v188, v4
  v_mul_f32 v189, v189, v4
  v_mul_f32 v190, v190, v4
  v_mul_f32 v191, v191, v4
  v_mul_f32 v196, v196, v4
  v_mul_f32 v197, v197, v4
  v_mul_f32 v198, v198, v4
  v_mul_f32 v199, v199, v4
  v_mul_f32 v204, v204, v4
  v_mul_f32 v205, v205, v4
  v_mul_f32 v206, v206, v4
  v_mul_f32 v207, v207, v4
  v_mul_f32 v212, v212, v4
  v_mul_f32 v213, v213, v4
  v_mul_f32 v214, v214, v4
  v_mul_f32 v215, v215, v4
  v_mul_f32 v220, v220, v4
  v_mul_f32 v221, v221, v4
  v_mul_f32 v222, v222, v4
  v_mul_f32 v223, v223, v4
  v_mul_f32 v228, v228, v4
  v_mul_f32 v229, v229, v4
  v_mul_f32 v230, v230, v4
  v_mul_f32 v231, v231, v4
  v_mul_f32 v236, v236, v4
  v_mul_f32 v237, v237, v4
  v_mul_f32 v238, v238, v4
  v_mul_f32 v239, v239, v4
  v_mul_f32 v244, v244, v4
  v_mul_f32 v245, v245, v4
  v_mul_f32 v246, v246, v4
  v_mul_f32 v247, v247, v4
  v_mul_f32 v252, v252, v4
  v_mul_f32 v253, v253, v4
  v_mul_f32 v254, v254, v4
  v_mul_f32 v255, v255, v4
  v_sub_f32 v96, v96, v1
  v_sub_f32 v97, v97, v1
  v_sub_f32 v98, v98, v1
  v_sub_f32 v99, v99, v1
  v_exp_f32 v24, v96
  v_exp_f32 v25, v97
  v_exp_f32 v26, v98
  v_cvt_pk_bf16_f32 v80, v24, v25
  v_add_f32 v24, v24, v25
  v_exp_f32 v27, v99
  s_nop 0
  v_cvt_pk_bf16_f32 v81, v26, v27
  v_add_f32 v26, v26, v27
  v_add_f32 v10, v24, v26
  v_sub_f32 v100, v100, v3
  v_sub_f32 v101, v101, v3
  v_sub_f32 v102, v102, v3
  v_sub_f32 v103, v103, v3
  v_exp_f32 v28, v100
  v_exp_f32 v29, v101
  v_exp_f32 v30, v102
  v_cvt_pk_bf16_f32 v84, v28, v29
  v_add_f32 v28, v28, v29
  v_exp_f32 v31, v103
  s_nop 0
  v_cvt_pk_bf16_f32 v85, v30, v31
  v_add_f32 v30, v30, v31
  v_add_f32 v11, v28, v30
  v_sub_f32 v104, v104, v1
  v_sub_f32 v105, v105, v1
  v_sub_f32 v106, v106, v1
  v_sub_f32 v107, v107, v1
  v_exp_f32 v24, v104
  v_exp_f32 v25, v105
  v_exp_f32 v26, v106
  v_cvt_pk_bf16_f32 v82, v24, v25
  v_add_f32 v24, v24, v25
  v_exp_f32 v27, v107
  v_add_f32 v10, v10, v24
  v_cvt_pk_bf16_f32 v83, v26, v27
  v_add_f32 v26, v26, v27
  v_add_f32 v10, v10, v26
  v_sub_f32 v108, v108, v3
  v_sub_f32 v109, v109, v3
  v_sub_f32 v110, v110, v3
  v_sub_f32 v111, v111, v3
  v_exp_f32 v28, v108
  v_exp_f32 v29, v109
  v_exp_f32 v30, v110
  v_cvt_pk_bf16_f32 v86, v28, v29
  v_add_f32 v28, v28, v29
  v_exp_f32 v31, v111
  v_add_f32 v11, v11, v28
  v_cvt_pk_bf16_f32 v87, v30, v31
  v_add_f32 v30, v30, v31
  v_add_f32 v11, v11, v30
  s_branch L_ret_a4
L_rare_a5:
  v_max3_f32 v1, v88, v89, v90
  v_max3_f32 v2, v91, v104, v105
  v_max3_f32 v1, v1, v106, v107
  v_max_f32 v1, v1, v2
  v_mov_b32 v2, v1
  s_nop 1
  v_permlane32_swap_b32 v1, v2
  v_max_f32 v1, v1, v2
  v_mov_b32 v2, v1
  s_nop 1
  v_permlane16_swap_b32 v1, v2
  v_max_f32 v1, v1, v2
  v_max3_f32 v3, v92, v93, v94
  v_max3_f32 v4, v95, v108, v109
  v_max3_f32 v3, v3, v110, v111
  v_max_f32 v3, v3, v4
  v_mov_b32 v4, v3
  s_nop 1
  v_permlane32_swap_b32 v3, v4
  v_max_f32 v3, v3, v4
  v_mov_b32 v4, v3
  s_nop 1
  v_permlane16_swap_b32 v3, v4
  v_max_f32 v3, v3, v4
  v_max_f32 v1, 0, v1
  v_sub_f32 v2, 0, v1
  v_exp_f32 v2, v2
  v_sub_f32 v64, v64, v1
  v_sub_f32 v65, v65, v1
  v_sub_f32 v66, v66, v1
  v_sub_f32 v67, v67, v1
  v_sub_f32 v96, v96, v1
  v_sub_f32 v97, v97, v1
  v_sub_f32 v98, v98, v1
  v_sub_f32 v99, v99, v1
  v_mul_f32 v8, v8, v2
  v_mul_f32 v160, v160, v2
  v_mul_f32 v161, v161, v2
  v_mul_f32 v162, v162, v2
  v_mul_f32 v163, v163, v2
  v_mul_f32 v168, v168, v2
  v_mul_f32 v169, v169, v2
  v_mul_f32 v170, v170, v2
  v_mul_f32 v171, v171, v2
  v_mul_f32 v176, v176, v2
  v_mul_f32 v177, v177, v2
  v_mul_f32 v178, v178, v2
  v_mul_f32 v179, v179, v2
  v_mul_f32 v184, v184, v2
  v_mul_f32 v185, v185, v2
  v_mul_f32 v186, v186, v2
  v_mul_f32 v187, v187, v2
  v_mul_f32 v192, v192, v2
  v_mul_f32 v193, v193, v2
  v_mul_f32 v194, v194, v2
  v_mul_f32 v195, v195, v2
  v_mul_f32 v200, v200, v2
  v_mul_f32 v201, v201, v2
  v_mul_f32 v202, v202, v2
  v_mul_f32 v203, v203, v2
  v_mul_f32 v208, v208, v2
  v_mul_f32 v209, v209, v2
  v_mul_f32 v210, v210, v2
  v_mul_f32 v211, v211, v2
  v_mul_f32 v216, v216, v2
  v_mul_f32 v217, v217, v2
  v_mul_f32 v218, v218, v2
  v_mul_f32 v219, v219, v2
  v_mul_f32 v224, v224, v2
  v_mul_f32 v225, v225, v2
  v_mul_f32 v226, v226, v2
  v_mul_f32 v227, v227, v2
  v_mul_f32 v232, v232, v2
  v_mul_f32 v233, v233, v2
  v_mul_f32 v234, v234, v2
  v_mul_f32 v235, v235, v2
  v_mul_f32 v240, v240, v2
  v_mul_f32 v241, v241, v2
  v_mul_f32 v242, v242, v2
  v_mul_f32 v243, v243, v2
  v_mul_f32 v248, v248, v2
  v_mul_f32 v249, v249, v2
  v_mul_f32 v250, v250, v2
  v_mul_f32 v251, v251, v2
  v_max_f32 v3, 0, v3
  v_sub_f32 v4, 0, v3
  v_exp_f32 v4, v4
  v_sub_f32 v68, v68, v3
  v_sub_f32 v69, v69, v3
  v_sub_f32 v70, v70, v3
  v_sub_f32 v71, v71, v3
  v_sub_f32 v100, v100, v3
  v_sub_f32 v101, v101, v3
  v_sub_f32 v102, v102, v3
  v_sub_f32 v103, v103, v3
  v_mul_f32 v9, v9, v4
  v_mul_f32 v164, v164, v4
  v_mul_f32 v165, v165, v4
  v_mul_f32 v166, v166, v4
  v_mul_f32 v167, v167, v4
  v_mul_f32 v172, v172, v4
  v_mul_f32 v173, v173, v4
  v_mul_f32 v174, v174, v4
  v_mul_f32 v175, v175, v4
  v_mul_f32 v180, v180, v4
  v_mul_f32 v181, v181, v4
  v_mul_f32 v182, v182, v4
  v_mul_f32 v183, v183, v4
  v_mul_f32 v188, v188, v4
  v_mul_f32 v189, v189, v4
  v_mul_f32 v190, v190, v4
  v_mul_f32 v191, v191, v4
  v_mul_f32 v196, v196, v4
  v_mul_f32 v197, v197, v4
  v_mul_f32 v198, v198, v4
  v_mul_f32 v199, v199, v4
  v_mul_f32 v204, v204, v4
  v_mul_f32 v205, v205, v4
  v_mul_f32 v206, v206, v4
  v_mul_f32 v207, v207, v4
  v_mul_f32 v212, v212, v4
  v_mul_f32 v213, v213, v4
  v_mul_f32 v214, v214, v4
  v_mul_f32 v215, v215, v4
  v_mul_f32 v220, v220, v4
  v_mul_f32 v221, v221, v4
  v_mul_f32 v222, v222, v4
  v_mul_f32 v223, v223, v4
  v_mul_f32 v228, v228, v4
  v_mul_f32 v229, v229, v4
  v_mul_f32 v230, v230, v4
  v_mul_f32 v231, v231, v4
  v_mul_f32 v236, v236, v4
  v_mul_f32 v237, v237, v4
  v_mul_f32 v238, v238, v4
  v_mul_f32 v239, v239, v4
  v_mul_f32 v244, v244, v4
  v_mul_f32 v245, v245, v4
  v_mul_f32 v246, v246, v4
  v_mul_f32 v247, v247, v4
  v_mul_f32 v252, v252, v4
  v_mul_f32 v253, v253, v4
  v_mul_f32 v254, v254, v4
  v_mul_f32 v255, v255, v4
  v_sub_f32 v88, v88, v1
  v_sub_f32 v89, v89, v1
  v_sub_f32 v90, v90, v1
  v_sub_f32 v91, v91, v1
  v_exp_f32 v24, v88
  v_exp_f32 v25, v89
  v_exp_f32 v26, v90
  v_cvt_pk_bf16_f32 v72, v24, v25
  v_add_f32 v24, v24, v25
  v_exp_f32 v27, v91
  s_nop 0
  v_cvt_pk_bf16_f32 v73, v26, v27
  v_add_f32 v26, v26, v27
  v_add_f32 v10, v24, v26
  v_sub_f32 v92, v92, v3
  v_sub_f32 v93, v93, v3
  v_sub_f32 v94, v94, v3
  v_sub_f32 v95, v95, v3
  v_exp_f32 v28, v92
  v_exp_f32 v29, v93
  v_exp_f32 v30, v94
  v_cvt_pk_bf16_f32 v76, v28, v29
  v_add_f32 v28, v28, v29
  v_exp_f32 v31, v95
  s_nop 0
  v_cvt_pk_bf16_f32 v77, v30, v31
  v_add_f32 v30, v30, v31
  v_add_f32 v11, v28, v30
  v_sub_f32 v104, v104, v1
  v_sub_f32 v105, v105, v1
  v_sub_f32 v106, v106, v1
  v_sub_f32 v107, v107, v1
  v_exp_f32 v24, v104
  v_exp_f32 v25, v105
  v_exp_f32 v26, v106
  v_cvt_pk_bf16_f32 v74, v24, v25
  v_add_f32 v24, v24, v25
  v_exp_f32 v27, v107
  v_add_f32 v10, v10, v24
  v_cvt_pk_bf16_f32 v75, v26, v27
  v_add_f32 v26, v26, v27
  v_add_f32 v10, v10, v26
  v_sub_f32 v108, v108, v3
  v_sub_f32 v109, v109, v3
  v_sub_f32 v110, v110, v3
  v_sub_f32 v111, v111, v3
  v_exp_f32 v28, v108
  v_exp_f32 v29, v109
  v_exp_f32 v30, v110
  v_cvt_pk_bf16_f32 v78, v28, v29
  v_add_f32 v28, v28, v29
  v_exp_f32 v31, v111
  v_add_f32 v11, v11, v28
  v_cvt_pk_bf16_f32 v79, v30, v31
  v_add_f32 v30, v30, v31
  v_add_f32 v11, v11, v30
  s_branch L_ret_a5
L_rare_a6:
  v_max3_f32 v1, v96, v97, v98
  v_max3_f32 v2, v99, v104, v105
  v_max3_f32 v1, v1, v106, v107
  v_max_f32 v1, v1, v2
  v_mov_b32 v2, v1
  s_nop 1
  v_permlane32_swap_b32 v1, v2
  v_max_f32 v1, v1, v2
  v_mov_b32 v2, v1
  s_nop 1
  v_permlane16_swap_b32 v1, v2
  v_max_f32 v1, v1, v2
  v_max3_f32 v3, v100, v101, v102
  v_max3_f32 v4, v103, v108, v109
  v_max3_f32 v3, v3, v110, v111
  v_max_f32 v3, v3, v4
  v_mov_b32 v4, v3
  s_nop 1
  v_permlane32_swap_b32 v3, v4
  v_max_f32 v3, v3, v4
  v_mov_b32 v4, v3
  s_nop 1
  v_permlane16_swap_b32 v3, v4
  v_max_f32 v3, v3, v4
  v_max_f32 v1, 0, v1
  v_sub_f32 v2, 0, v1
  v_exp_f32 v2, v2
  v_sub_f32 v64, v64, v1
  v_sub_f32 v65, v65, v1
  v_sub_f32 v66, v66, v1
  v_sub_f32 v67, v67, v1
  v_sub_f32 v88, v88, v1
  v_sub_f32 v89, v89, v1
  v_sub_f32 v90, v90, v1
  v_sub_f32 v91, v91, v1
  v_mul_f32 v8, v8, v2
  v_mul_f32 v160, v160, v2
  v_mul_f32 v161, v161, v2
  v_mul_f32 v162, v162, v2
  v_mul_f32 v163, v163, v2
  v_mul_f32 v168, v168, v2
  v_mul_f32 v169, v169, v2
  v_mul_f32 v170, v170, v2
  v_mul_f32 v171, v171, v2
  v_mul_f32 v176, v176, v2
  v_mul_f32 v177, v177, v2
  v_mul_f32 v178, v178, v2
  v_mul_f32 v179, v179, v2
  v_mul_f32 v184, v184, v2
  v_mul_f32 v185, v185, v2
  v_mul_f32 v186, v186, v2
  v_mul_f32 v187, v187, v2
  v_mul_f32 v192, v192, v2
  v_mul_f32 v193, v193, v2
  v_mul_f32 v194, v194, v2
  v_mul_f32 v195, v195, v2
  v_mul_f32 v200, v200, v2
  v_mul_f32 v201, v201, v2
  v_mul_f32 v202, v202, v2
  v_mul_f32 v203, v203, v2
  v_mul_f32 v208, v208, v2
  v_mul_f32 v209, v209, v2
  v_mul_f32 v210, v210, v2
  v_mul_f32 v211, v211, v2
  v_mul_f32 v216, v216, v2
  v_mul_f32 v217, v217, v2
  v_mul_f32 v218, v218, v2
  v_mul_f32 v219, v219, v2
  v_mul_f32 v224, v224, v2
  v_mul_f32 v225, v225, v2
  v_mul_f32 v226, v226, v2
  v_mul_f32 v227, v227, v2
  v_mul_f32 v232, v232, v2
  v_mul_f32 v233, v233, v2
  v_mul_f32 v234, v234, v2
  v_mul_f32 v235, v235, v2
  v_mul_f32 v240, v240, v2
  v_mul_f32 v241, v241, v2
  v_mul_f32 v242, v242, v2
  v_mul_f32 v243, v243, v2
  v_mul_f32 v248, v248, v2
  v_mul_f32 v249, v249, v2
  v_mul_f32 v250, v250, v2
  v_mul_f32 v251, v251, v2
  v_max_f32 v3, 0, v3
  v_sub_f32 v4, 0, v3
  v_exp_f32 v4, v4
  v_sub_f32 v68, v68, v3
  v_sub_f32 v69, v69, v3
  v_sub_f32 v70, v70, v3
  v_sub_f32 v71, v71, v3
  v_sub_f32 v92, v92, v3
  v_sub_f32 v93, v93, v3
  v_sub_f32 v94, v94, v3
  v_sub_f32 v95, v95, v3
  v_mul_f32 v9, v9, v4
  v_mul_f32 v164, v164, v4
  v_mul_f32 v165, v165, v4
  v_mul_f32 v166, v166, v4
  v_mul_f32 v167, v167, v4
  v_mul_f32 v172, v172, v4
  v_mul_f32 v173, v173, v4
  v_mul_f32 v174, v174, v4
  v_mul_f32 v175, v175, v4
  v_mul_f32 v180, v180, v4
  v_mul_f32 v181, v181, v4
  v_mul_f32 v182, v182, v4
  v_mul_f32 v183, v183, v4
  v_mul_f32 v188, v188, v4
  v_mul_f32 v189, v189, v4
  v_mul_f32 v190, v190, v4
  v_mul_f32 v191, v191, v4
  v_mul_f32 v196, v196, v4
  v_mul_f32 v197, v197, v4
  v_mul_f32 v198, v198, v4
  v_mul_f32 v199, v199, v4
  v_mul_f32 v204, v204, v4
  v_mul_f32 v205, v205, v4
  v_mul_f32 v206, v206, v4
  v_mul_f32 v207, v207, v4
  v_mul_f32 v212, v212, v4
  v_mul_f32 v213, v213, v4
  v_mul_f32 v214, v214, v4
  v_mul_f32 v215, v215, v4
  v_mul_f32 v220, v220, v4
  v_mul_f32 v221, v221, v4
  v_mul_f32 v222, v222, v4
  v_mul_f32 v223, v223, v4
  v_mul_f32 v228, v228, v4
  v_mul_f32 v229, v229, v4
  v_mul_f32 v230, v230, v4
  v_mul_f32 v231, v231, v4
  v_mul_f32 v236, v236, v4
  v_mul_f32 v237, v237, v4
  v_mul_f32 v238, v238, v4
  v_mul_f32 v239, v239, v4
  v_mul_f32 v244, v244, v4
  v_mul_f32 v245, v245, v4
  v_mul_f32 v246, v246, v4
  v_mul_f32 v247, v247, v4
  v_mul_f32 v252, v252, v4
  v_mul_f32 v253, v253, v4
  v_mul_f32 v254, v254, v4
  v_mul_f32 v255, v255, v4
  v_sub_f32 v96, v96, v1
  v_sub_f32 v97, v97, v1
  v_sub_f32 v98, v98, v1
  v_sub_f32 v99, v99, v1
  v_exp_f32 v24, v96
  v_exp_f32 v25, v97
  v_exp_f32 v26, v98
  v_cvt_pk_bf16_f32 v80, v24, v25
  v_add_f32 v24, v24, v25
  v_exp_f32 v27, v99
  s_nop 0
  v_cvt_pk_bf16_f32 v81, v26, v27
  v_add_f32 v26, v26, v27
  v_add_f32 v10, v24, v26
  v_sub_f32 v100, v100, v3
  v_sub_f32 v101, v101, v3
  v_sub_f32 v102, v102, v3
  v_sub_f32 v103, v103, v3
  v_exp_f32 v28, v100
  v_exp_f32 v29, v101
  v_exp_f32 v30, v102
  v_cvt_pk_bf16_f32 v84, v28, v29
  v_add_f32 v28, v28, v29
  v_exp_f32 v31, v103
  s_nop 0
  v_cvt_pk_bf16_f32 v85, v30, v31
  v_add_f32 v30, v30, v31
  v_add_f32 v11, v28, v30
  v_sub_f32 v104, v104, v1
  v_sub_f32 v105, v105, v1
  v_sub_f32 v106, v106, v1
  v_sub_f32 v107, v107, v1
  v_exp_f32 v24, v104
  v_exp_f32 v25, v105
  v_exp_f32 v26, v106
  v_cvt_pk_bf16_f32 v82, v24, v25
  v_add_f32 v24, v24, v25
  v_exp_f32 v27, v107
  v_add_f32 v10, v10, v24
  v_cvt_pk_bf16_f32 v83, v26, v27
  v_add_f32 v26, v26, v27
  v_add_f32 v10, v10, v26
  v_sub_f32 v108, v108, v3
  v_sub_f32 v109, v109, v3
  v_sub_f32 v110, v110, v3
  v_sub_f32 v111, v111, v3
  v_exp_f32 v28, v108
  v_exp_f32 v29, v109
  v_exp_f32 v30, v110
  v_cvt_pk_bf16_f32 v86, v28, v29
  v_add_f32 v28, v28, v29
  v_exp_f32 v31, v111
  v_add_f32 v11, v11, v28
  v_cvt_pk_bf16_f32 v87, v30, v31
  v_add_f32 v30, v30, v31
  v_add_f32 v11, v11, v30
  s_branch L_ret_a6
L_rare_a7:
  v_max3_f32 v1, v88, v89, v90
  v_max3_f32 v2, v91, v104, v105
  v_max3_f32 v1, v1, v106, v107
  v_max_f32 v1, v1, v2
  v_mov_b32 v2, v1
  s_nop 1
  v_permlane32_swap_b32 v1, v2
  v_max_f32 v1, v1, v2
  v_mov_b32 v2, v1
  s_nop 1
  v_permlane16_swap_b32 v1, v2
  v_max_f32 v1, v1, v2
  v_max3_f32 v3, v92, v93, v94
  v_max3_f32 v4, v95, v108, v109
  v_max3_f32 v3, v3, v110, v111
  v_max_f32 v3, v3, v4
  v_mov_b32 v4, v3
  s_nop 1
  v_permlane32_swap_b32 v3, v4
  v_max_f32 v3, v3, v4
  v_mov_b32 v4, v3
  s_nop 1
  v_permlane16_swap_b32 v3, v4
  v_max_f32 v3, v3, v4
  v_max_f32 v1, 0, v1
  v_sub_f32 v2, 0, v1
  v_exp_f32 v2, v2
  v_sub_f32 v64, v64, v1
  v_sub_f32 v65, v65, v1
  v_sub_f32 v66, v66, v1
  v_sub_f32 v67, v67, v1
  v_sub_f32 v96, v96, v1
  v_sub_f32 v97, v97, v1
  v_sub_f32 v98, v98, v1
  v_sub_f32 v99, v99, v1
  v_mul_f32 v8, v8, v2
  v_mul_f32 v160, v160, v2
  v_mul_f32 v161, v161, v2
  v_mul_f32 v162, v162, v2
  v_mul_f32 v163, v163, v2
  v_mul_f32 v168, v168, v2
  v_mul_f32 v169, v169, v2
  v_mul_f32 v170, v170, v2
  v_mul_f32 v171, v171, v2
  v_mul_f32 v176, v176, v2
  v_mul_f32 v177, v177, v2
  v_mul_f32 v178, v178, v2
  v_mul_f32 v179, v179, v2
  v_mul_f32 v184, v184, v2
  v_mul_f32 v185, v185, v2
  v_mul_f32 v186, v186, v2
  v_mul_f32 v187, v187, v2
  v_mul_f32 v192, v192, v2
  v_mul_f32 v193, v193, v2
  v_mul_f32 v194, v194, v2
  v_mul_f32 v195, v195, v2
  v_mul_f32 v200, v200, v2
  v_mul_f32 v201, v201, v2
  v_mul_f32 v202, v202, v2
  v_mul_f32 v203, v203, v2
  v_mul_f32 v208, v208, v2
  v_mul_f32 v209, v209, v2
  v_mul_f32 v210, v210, v2
  v_mul_f32 v211, v211, v2
  v_mul_f32 v216, v216, v2
  v_mul_f32 v217, v217, v2
  v_mul_f32 v218, v218, v2
  v_mul_f32 v219, v219, v2
  v_mul_f32 v224, v224, v2
  v_mul_f32 v225, v225, v2
  v_mul_f32 v226, v226, v2
  v_mul_f32 v227, v227, v2
  v_mul_f32 v232, v232, v2
  v_mul_f32 v233, v233, v2
  v_mul_f32 v234, v234, v2
  v_mul_f32 v235, v235, v2
  v_mul_f32 v240, v240, v2
  v_mul_f32 v241, v241, v2
  v_mul_f32 v242, v242, v2
  v_mul_f32 v243, v243, v2
  v_mul_f32 v248, v248, v2
  v_mul_f32 v249, v249, v2
  v_mul_f32 v250, v250, v2
  v_mul_f32 v251, v251, v2
  v_max_f32 v3, 0, v3
  v_sub_f32 v4, 0, v3
  v_exp_f32 v4, v4
  v_sub_f32 v68, v68, v3
  v_sub_f32 v69, v69, v3
  v_sub_f32 v70, v70, v3
  v_sub_f32 v71, v71, v3
  v_sub_f32 v100, v100, v3
  v_sub_f32 v101, v101, v3
  v_sub_f32 v102, v102, v3
  v_sub_f32 v103, v103, v3
  v_mul_f32 v9, v9, v4
  v_mul_f32 v164, v164, v4
  v_mul_f32 v165, v165, v4
  v_mul_f32 v166, v166, v4
  v_mul_f32 v167, v167, v4
  v_mul_f32 v172, v172, v4
  v_mul_f32 v173, v173, v4
  v_mul_f32 v174, v174, v4
  v_mul_f32 v175, v175, v4
  v_mul_f32 v180, v180, v4
  v_mul_f32 v181, v181, v4
  v_mul_f32 v182, v182, v4
  v_mul_f32 v183, v183, v4
  v_mul_f32 v188, v188, v4
  v_mul_f32 v189, v189, v4
  v_mul_f32 v190, v190, v4
  v_mul_f32 v191, v191, v4
  v_mul_f32 v196, v196, v4
  v_mul_f32 v197, v197, v4
  v_mul_f32 v198, v198, v4
  v_mul_f32 v199, v199, v4
  v_mul_f32 v204, v204, v4
  v_mul_f32 v205, v205, v4
  v_mul_f32 v206, v206, v4
  v_mul_f32 v207, v207, v4
  v_mul_f32 v212, v212, v4
  v_mul_f32 v213, v213, v4
  v_mul_f32 v214, v214, v4
  v_mul_f32 v215, v215, v4
  v_mul_f32 v220, v220, v4
  v_mul_f32 v221, v221, v4
  v_mul_f32 v222, v222, v4
  v_mul_f32 v223, v223, v4
  v_mul_f32 v228, v228, v4
  v_mul_f32 v229, v229, v4
  v_mul_f32 v230, v230, v4
  v_mul_f32 v231, v231, v4
  v_mul_f32 v236, v236, v4
  v_mul_f32 v237, v237, v4
  v_mul_f32 v238, v238, v4
  v_mul_f32 v239, v239, v4
  v_mul_f32 v244, v244, v4
  v_mul_f32 v245, v245, v4
  v_mul_f32 v246, v246, v4
  v_mul_f32 v247, v247, v4
  v_mul_f32 v252, v252, v4
  v_mul_f32 v253, v253, v4
  v_mul_f32 v254, v254, v4
  v_mul_f32 v255, v255, v4
  v_sub_f32 v88, v88, v1
  v_sub_f32 v89, v89, v1
  v_sub_f32 v90, v90, v1
  v_sub_f32 v91, v91, v1
  v_exp_f32 v24, v88
  v_exp_f32 v25, v89
  v_exp_f32 v26, v90
  v_cvt_pk_bf16_f32 v72, v24, v25
  v_add_f32 v24, v24, v25
  v_exp_f32 v27, v91
  s_nop 0
  v_cvt_pk_bf16_f32 v73, v26, v27
  v_add_f32 v26, v26, v27
  v_add_f32 v10, v24, v26
  v_sub_f32 v92, v92, v3
  v_sub_f32 v93, v93, v3
  v_sub_f32 v94, v94, v3
  v_sub_f32 v95, v95, v3
  v_exp_f32 v28, v92
  v_exp_f32 v29, v93
  v_exp_f32 v30, v94
  v_cvt_pk_bf16_f32 v76, v28, v29
  v_add_f32 v28, v28, v29
  v_exp_f32 v31, v95
  s_nop 0
  v_cvt_pk_bf16_f32 v77, v30, v31
  v_add_f32 v30, v30, v31
  v_add_f32 v11, v28, v30
  v_sub_f32 v104, v104, v1
  v_sub_f32 v105, v105, v1
  v_sub_f32 v106, v106, v1
  v_sub_f32 v107, v107, v1
  v_exp_f32 v24, v104
  v_exp_f32 v25, v105
  v_exp_f32 v26, v106
  v_cvt_pk_bf16_f32 v74, v24, v25
  v_add_f32 v24, v24, v25
  v_exp_f32 v27, v107
  v_add_f32 v10, v10, v24
  v_cvt_pk_bf16_f32 v75, v26, v27
  v_add_f32 v26, v26, v27
  v_add_f32 v10, v10, v26
  v_sub_f32 v108, v108, v3
  v_sub_f32 v109, v109, v3
  v_sub_f32 v110, v110, v3
  v_sub_f32 v111, v111, v3
  v_exp_f32 v28, v108
  v_exp_f32 v29, v109
  v_exp_f32 v30, v110
  v_cvt_pk_bf16_f32 v78, v28, v29
  v_add_f32 v28, v28, v29
  v_exp_f32 v31, v111
  v_add_f32 v11, v11, v28
  v_cvt_pk_bf16_f32 v79, v30, v31
  v_add_f32 v30, v30, v31
  v_add_f32 v11, v11, v30
  s_branch L_ret_a7
L_rare_a14:
  v_max3_f32 v1, v96, v97, v98
  v_max3_f32 v2, v99, v104, v105
  v_max3_f32 v1, v1, v106, v107
  v_max_f32 v1, v1, v2
  v_mov_b32 v2, v1
  s_nop 1
  v_permlane32_swap_b32 v1, v2
  v_max_f32 v1, v1, v2
  v_mov_b32 v2, v1
  s_nop 1
  v_permlane16_swap_b32 v1, v2
  v_max_f32 v1, v1, v2
  v_max3_f32 v3, v100, v101, v102
  v_max3_f32 v4, v103, v108, v109
  v_max3_f32 v3, v3, v110, v111
  v_max_f32 v3, v3, v4
  v_mov_b32 v4, v3
  s_nop 1
  v_permlane32_swap_b32 v3, v4
  v_max_f32 v3, v3, v4
  v_mov_b32 v4, v3
  s_nop 1
  v_permlane16_swap_b32 v3, v4
  v_max_f32 v3, v3, v4
  v_max_f32 v1, 0, v1
  v_sub_f32 v2, 0, v1
  v_exp_f32 v2, v2
  v_sub_f32 v64, v64, v1
  v_sub_f32 v65, v65, v1
  v_sub_f32 v66, v66, v1
  v_sub_f32 v67, v67, v1
  v_sub_f32 v88, v88, v1
  v_sub_f32 v89, v89, v1
  v_sub_f32 v90, v90, v1
  v_sub_f32 v91, v91, v1
  v_mul_f32 v8, v8, v2
  v_mul_f32 v160, v160, v2
  v_mul_f32 v161, v161, v2
  v_mul_f32 v162, v162, v2
  v_mul_f32 v163, v163, v2
  v_mul_f32 v168, v168, v2
  v_mul_f32 v169, v169, v2
  v_mul_f32 v170, v170, v2
  v_mul_f32 v171, v171, v2
  v_mul_f32 v176, v176, v2
  v_mul_f32 v177, v177, v2
  v_mul_f32 v178, v178, v2
  v_mul_f32 v179, v179, v2
  v_mul_f32 v184, v184, v2
  v_mul_f32 v185, v185, v2
  v_mul_f32 v186, v186, v2
  v_mul_f32 v187, v187, v2
  v_mul_f32 v192, v192, v2
  v_mul_f32 v193, v193, v2
  v_mul_f32 v194, v194, v2
  v_mul_f32 v195, v195, v2
  v_mul_f32 v200, v200, v2
  v_mul_f32 v201, v201, v2
  v_mul_f32 v202, v202, v2
  v_mul_f32 v203, v203, v2
  v_mul_f32 v208, v208, v2
  v_mul_f32 v209, v209, v2
  v_mul_f32 v210, v210, v2
  v_mul_f32 v211, v211, v2
  v_mul_f32 v216, v216, v2
  v_mul_f32 v217, v217, v2
  v_mul_f32 v218, v218, v2
  v_mul_f32 v219, v219, v2
  v_mul_f32 v224, v224, v2
  v_mul_f32 v225, v225, v2
  v_mul_f32 v226, v226, v2
  v_mul_f32 v227, v227, v2
  v_mul_f32 v232, v232, v2
  v_mul_f32 v233, v233, v2
  v_mul_f32 v234, v234, v2
  v_mul_f32 v235, v235, v2
  v_mul_f32 v240, v240, v2
  v_mul_f32 v241, v241, v2
  v_mul_f32 v242, v242, v2
  v_mul_f32 v243, v243, v2
  v_mul_f32 v248, v248, v2
  v_mul_f32 v249, v249, v2
  v_mul_f32 v250, v250, v2
  v_mul_f32 v251, v251, v2
  v_max_f32 v3, 0, v3
  v_sub_f32 v4, 0, v3
  v_exp_f32 v4, v4
  v_sub_f32 v68, v68, v3
  v_sub_f32 v69, v69, v3
  v_sub_f32 v70, v70, v3
  v_sub_f32 v71, v71, v3
  v_sub_f32 v92, v92, v3
  v_sub_f32 v93, v93, v3
  v_sub_f32 v94, v94, v3
  v_sub_f32 v95, v95, v3
  v_mul_f32 v9, v9, v4
  v_mul_f32 v164, v164, v4
  v_mul_f32 v165, v165, v4
  v_mul_f32 v166, v166, v4
  v_mul_f32 v167, v167, v4
  v_mul_f32 v172, v172, v4
  v_mul_f32 v173, v173, v4
  v_mul_f32 v174, v174, v4
  v_mul_f32 v175, v175, v4
  v_mul_f32 v180, v180, v4
  v_mul_f32 v181, v181, v4
  v_mul_f32 v182, v182, v4
  v_mul_f32 v183, v183, v4
  v_mul_f32 v188, v188, v4
  v_mul_f32 v189, v189, v4
  v_mul_f32 v190, v190, v4
  v_mul_f32 v191, v191, v4
  v_mul_f32 v196, v196, v4
  v_mul_f32 v197, v197, v4
  v_mul_f32 v198, v198, v4
  v_mul_f32 v199, v199, v4
  v_mul_f32 v204, v204, v4
  v_mul_f32 v205, v205, v4
  v_mul_f32 v206, v206, v4
  v_mul_f32 v207, v207, v4
  v_mul_f32 v212, v212, v4
  v_mul_f32 v213, v213, v4
  v_mul_f32 v214, v214, v4
  v_mul_f32 v215, v215, v4
  v_mul_f32 v220, v220, v4
  v_mul_f32 v221, v221, v4
  v_mul_f32 v222, v222, v4
  v_mul_f32 v223, v223, v4
  v_mul_f32 v228, v228, v4
  v_mul_f32 v229, v229, v4
  v_mul_f32 v230, v230, v4
  v_mul_f32 v231, v231, v4
  v_mul_f32 v236, v236, v4
  v_mul_f32 v237, v237, v4
  v_mul_f32 v238, v238, v4
  v_mul_f32 v239, v239, v4
  v_mul_f32 v244, v244, v4
  v_mul_f32 v245, v245, v4
  v_mul_f32 v246, v246, v4
  v_mul_f32 v247, v247, v4
  v_mul_f32 v252, v252, v4
  v_mul_f32 v253, v253, v4
  v_mul_f32 v254, v254, v4
  v_mul_f32 v255, v255, v4
  v_sub_f32 v96, v96, v1
  v_sub_f32 v97, v97, v1
  v_sub_f32 v98, v98, v1
  v_sub_f32 v99, v99, v1
  v_exp_f32 v24, v96
  v_exp_f32 v25, v97
  v_exp_f32 v26, v98
  v_cvt_pk_bf16_f32 v80, v24, v25
  v_add_f32 v24, v24, v25
  v_exp_f32 v27, v99
  s_nop 0
  v_cvt_pk_bf16_f32 v81, v26, v27
  v_add_f32 v26, v26, v27
  v_add_f32 v10, v24, v26
  v_sub_f32 v100, v100, v3
  v_sub_f32 v101, v101, v3
  v_sub_f32 v102, v102, v3
  v_sub_f32 v103, v103, v3
  v_exp_f32 v28, v100
  v_exp_f32 v29, v101
  v_exp_f32 v30, v102
  v_cvt_pk_bf16_f32 v84, v28, v29
  v_add_f32 v28, v28, v29
  v_exp_f32 v31, v103
  s_nop 0
  v_cvt_pk_bf16_f32 v85, v30, v31
  v_add_f32 v30, v30, v31
  v_add_f32 v11, v28, v30
  v_sub_f32 v104, v104, v1
  v_sub_f32 v105, v105, v1
  v_sub_f32 v106, v106, v1
  v_sub_f32 v107, v107, v1
  v_exp_f32 v24, v104
  v_exp_f32 v25, v105
  v_exp_f32 v26, v106
  v_cvt_pk_bf16_f32 v82, v24, v25
  v_add_f32 v24, v24, v25
  v_exp_f32 v27, v107
  v_add_f32 v10, v10, v24
  v_cvt_pk_bf16_f32 v83, v26, v27
  v_add_f32 v26, v26, v27
  v_add_f32 v10, v10, v26
  v_sub_f32 v108, v108, v3
  v_sub_f32 v109, v109, v3
  v_sub_f32 v110, v110, v3
  v_sub_f32 v111, v111, v3
  v_exp_f32 v28, v108
  v_exp_f32 v29, v109
  v_exp_f32 v30, v110
  v_cvt_pk_bf16_f32 v86, v28, v29
  v_add_f32 v28, v28, v29
  v_exp_f32 v31, v111
  v_add_f32 v11, v11, v28
  v_cvt_pk_bf16_f32 v87, v30, v31
  v_add_f32 v30, v30, v31
  v_add_f32 v11, v11, v30
  s_branch L_ret_a14
L_rare_a15:
  v_max3_f32 v1, v88, v89, v90
  v_max3_f32 v2, v91, v104, v105
  v_max3_f32 v1, v1, v106, v107
  v_max_f32 v1, v1, v2
  v_mov_b32 v2, v1
  s_nop 1
  v_permlane32_swap_b32 v1, v2
  v_max_f32 v1, v1, v2
  v_mov_b32 v2, v1
  s_nop 1
  v_permlane16_swap_b32 v1, v2
  v_max_f32 v1, v1, v2
  v_max3_f32 v3, v92, v93, v94
  v_max3_f32 v4, v95, v108, v109
  v_max3_f32 v3, v3, v110, v111
  v_max_f32 v3, v3, v4
  v_mov_b32 v4, v3
  s_nop 1
  v_permlane32_swap_b32 v3, v4
  v_max_f32 v3, v3, v4
  v_mov_b32 v4, v3
  s_nop 1
  v_permlane16_swap_b32 v3, v4
  v_max_f32 v3, v3, v4
  v_max_f32 v1, 0, v1
  v_sub_f32 v2, 0, v1
  v_exp_f32 v2, v2
  v_sub_f32 v64, v64, v1
  v_sub_f32 v65, v65, v1
  v_sub_f32 v66, v66, v1
  v_sub_f32 v67, v67, v1
  v_sub_f32 v96, v96, v1
  v_sub_f32 v97, v97, v1
  v_sub_f32 v98, v98, v1
  v_sub_f32 v99, v99, v1
  v_mul_f32 v8, v8, v2
  v_mul_f32 v160, v160, v2
  v_mul_f32 v161, v161, v2
  v_mul_f32 v162, v162, v2
  v_mul_f32 v163, v163, v2
  v_mul_f32 v168, v168, v2
  v_mul_f32 v169, v169, v2
  v_mul_f32 v170, v170, v2
  v_mul_f32 v171, v171, v2
  v_mul_f32 v176, v176, v2
  v_mul_f32 v177, v177, v2
  v_mul_f32 v178, v178, v2
  v_mul_f32 v179, v179, v2
  v_mul_f32 v184, v184, v2
  v_mul_f32 v185, v185, v2
  v_mul_f32 v186, v186, v2
  v_mul_f32 v187, v187, v2
  v_mul_f32 v192, v192, v2
  v_mul_f32 v193, v193, v2
  v_mul_f32 v194, v194, v2
  v_mul_f32 v195, v195, v2
  v_mul_f32 v200, v200, v2
  v_mul_f32 v201, v201, v2
  v_mul_f32 v202, v202, v2
  v_mul_f32 v203, v203, v2
  v_mul_f32 v208, v208, v2
  v_mul_f32 v209, v209, v2
  v_mul_f32 v210, v210, v2
  v_mul_f32 v211, v211, v2
  v_mul_f32 v216, v216, v2
  v_mul_f32 v217, v217, v2
  v_mul_f32 v218, v218, v2
  v_mul_f32 v219, v219, v2
  v_mul_f32 v224, v224, v2
  v_mul_f32 v225, v225, v2
  v_mul_f32 v226, v226, v2
  v_mul_f32 v227, v227, v2
  v_mul_f32 v232, v232, v2
  v_mul_f32 v233, v233, v2
  v_mul_f32 v234, v234, v2
  v_mul_f32 v235, v235, v2
  v_mul_f32 v240, v240, v2
  v_mul_f32 v241, v241, v2
  v_mul_f32 v242, v242, v2
  v_mul_f32 v243, v243, v2
  v_mul_f32 v248, v248, v2
  v_mul_f32 v249, v249, v2
  v_mul_f32 v250, v250, v2
  v_mul_f32 v251, v251, v2
  v_max_f32 v3, 0, v3
  v_sub_f32 v4, 0, v3
  v_exp_f32 v4, v4
  v_sub_f32 v68, v68, v3
  v_sub_f32 v69, v69, v3
  v_sub_f32 v70, v70, v3
  v_sub_f32 v71, v71, v3
  v_sub_f32 v100, v100, v3
  v_sub_f32 v101, v101, v3
  v_sub_f32 v102, v102, v3
  v_sub_f32 v103, v103, v3
  v_mul_f32 v9, v9, v4
  v_mul_f32 v164, v164, v4
  v_mul_f32 v165, v165, v4
  v_mul_f32 v166, v166, v4
  v_mul_f32 v167, v167, v4
  v_mul_f32 v172, v172, v4
  v_mul_f32 v173, v173, v4
  v_mul_f32 v174, v174, v4
  v_mul_f32 v175, v175, v4
  v_mul_f32 v180, v180, v4
  v_mul_f32 v181, v181, v4
  v_mul_f32 v182, v182, v4
  v_mul_f32 v183, v183, v4
  v_mul_f32 v188, v188, v4
  v_mul_f32 v189, v189, v4
  v_mul_f32 v190, v190, v4
  v_mul_f32 v191, v191, v4
  v_mul_f32 v196, v196, v4
  v_mul_f32 v197, v197, v4
  v_mul_f32 v198, v198, v4
  v_mul_f32 v199, v199, v4
  v_mul_f32 v204, v204, v4
  v_mul_f32 v205, v205, v4
  v_mul_f32 v206, v206, v4
  v_mul_f32 v207, v207, v4
  v_mul_f32 v212, v212, v4
  v_mul_f32 v213, v213, v4
  v_mul_f32 v214, v214, v4
  v_mul_f32 v215, v215, v4
  v_mul_f32 v220, v220, v4
  v_mul_f32 v221, v221, v4
  v_mul_f32 v222, v222, v4
  v_mul_f32 v223, v223, v4
  v_mul_f32 v228, v228, v4
  v_mul_f32 v229, v229, v4
  v_mul_f32 v230, v230, v4
  v_mul_f32 v231, v231, v4
  v_mul_f32 v236, v236, v4
  v_mul_f32 v237, v237, v4
  v_mul_f32 v238, v238, v4
  v_mul_f32 v239, v239, v4
  v_mul_f32 v244, v244, v4
  v_mul_f32 v245, v245, v4
  v_mul_f32 v246, v246, v4
  v_mul_f32 v247, v247, v4
  v_mul_f32 v252, v252, v4
  v_mul_f32 v253, v253, v4
  v_mul_f32 v254, v254, v4
  v_mul_f32 v255, v255, v4
  v_sub_f32 v88, v88, v1
  v_sub_f32 v89, v89, v1
  v_sub_f32 v90, v90, v1
  v_sub_f32 v91, v91, v1
  v_exp_f32 v24, v88
  v_exp_f32 v25, v89
  v_exp_f32 v26, v90
  v_cvt_pk_bf16_f32 v72, v24, v25
  v_add_f32 v24, v24, v25
  v_exp_f32 v27, v91
  s_nop 0
  v_cvt_pk_bf16_f32 v73, v26, v27
  v_add_f32 v26, v26, v27
  v_add_f32 v10, v24, v26
  v_sub_f32 v92, v92, v3
  v_sub_f32 v93, v93, v3
  v_sub_f32 v94, v94, v3
  v_sub_f32 v95, v95, v3
  v_exp_f32 v28, v92
  v_exp_f32 v29, v93
  v_exp_f32 v30, v94
  v_cvt_pk_bf16_f32 v76, v28, v29
  v_add_f32 v28, v28, v29
  v_exp_f32 v31, v95
  s_nop 0
  v_cvt_pk_bf16_f32 v77, v30, v31
  v_add_f32 v30, v30, v31
  v_add_f32 v11, v28, v30
  v_sub_f32 v104, v104, v1
  v_sub_f32 v105, v105, v1
  v_sub_f32 v106, v106, v1
  v_sub_f32 v107, v107, v1
  v_exp_f32 v24, v104
  v_exp_f32 v25, v105
  v_exp_f32 v26, v106
  v_cvt_pk_bf16_f32 v74, v24, v25
  v_add_f32 v24, v24, v25
  v_exp_f32 v27, v107
  v_add_f32 v10, v10, v24
  v_cvt_pk_bf16_f32 v75, v26, v27
  v_add_f32 v26, v26, v27
  v_add_f32 v10, v10, v26
  v_sub_f32 v108, v108, v3
  v_sub_f32 v109, v109, v3
  v_sub_f32 v110, v110, v3
  v_sub_f32 v111, v111, v3
  v_exp_f32 v28, v108
  v_exp_f32 v29, v109
  v_exp_f32 v30, v110
  v_cvt_pk_bf16_f32 v78, v28, v29
  v_add_f32 v28, v28, v29
  v_exp_f32 v31, v111
  v_add_f32 v11, v11, v28
  v_cvt_pk_bf16_f32 v79, v30, v31
  v_add_f32 v30, v30, v31
  v_add_f32 v11, v11, v30
  s_branch L_ret_a15
L_rare_af1:
  v_max3_f32 v1, v96, v97, v98
  v_max3_f32 v2, v99, v104, v105
  v_max3_f32 v1, v1, v106, v107
  v_max_f32 v1, v1, v2
  v_mov_b32 v2, v1
  s_nop 1
  v_permlane32_swap_b32 v1, v2
  v_max_f32 v1, v1, v2
  v_mov_b32 v2, v1
  s_nop 1
  v_permlane16_swap_b32 v1, v2
  v_max_f32 v1, v1, v2
  v_max3_f32 v3, v100, v101, v102
  v_max3_f32 v4, v103, v108, v109
  v_max3_f32 v3, v3, v110, v111
  v_max_f32 v3, v3, v4
  v_mov_b32 v4, v3
  s_nop 1
  v_permlane32_swap_b32 v3, v4
  v_max_f32 v3, v3, v4
  v_mov_b32 v4, v3
  s_nop 1
  v_permlane16_swap_b32 v3, v4
  v_max_f32 v3, v3, v4
  v_max_f32 v1, 0, v1
  v_sub_f32 v2, 0, v1
  v_exp_f32 v2, v2
  v_sub_f32 v64, v64, v1
  v_sub_f32 v65, v65, v1
  v_sub_f32 v66, v66, v1
  v_sub_f32 v67, v67, v1
  v_mul_f32 v8, v8, v2
  v_mul_f32 v160, v160, v2
  v_mul_f32 v161, v161, v2
  v_mul_f32 v162, v162, v2
  v_mul_f32 v163, v163, v2
  v_mul_f32 v168, v168, v2
  v_mul_f32 v169, v169, v2
  v_mul_f32 v170, v170, v2
  v_mul_f32 v171, v171, v2
  v_mul_f32 v176, v176, v2
  v_mul_f32 v177, v177, v2
  v_mul_f32 v178, v178, v2
  v_mul_f32 v179, v179, v2
  v_mul_f32 v184, v184, v2
  v_mul_f32 v185, v185, v2
  v_mul_f32 v186, v186, v2
  v_mul_f32 v187, v187, v2
  v_mul_f32 v192, v192, v2
  v_mul_f32 v193, v193, v2
  v_mul_f32 v194, v194, v2
  v_mul_f32 v195, v195, v2
  v_mul_f32 v200, v200, v2
  v_mul_f32 v201, v201, v2
  v_mul_f32 v202, v202, v2
  v_mul_f32 v203, v203, v2
  v_mul_f32 v208, v208, v2
  v_mul_f32 v209, v209, v2
  v_mul_f32 v210, v210, v2
  v_mul_f32 v211, v211, v2
  v_mul_f32 v216, v216, v2
  v_mul_f32 v217, v217, v2
  v_mul_f32 v218, v218, v2
  v_mul_f32 v219, v219, v2
  v_mul_f32 v224, v224, v2
  v_mul_f32 v225, v225, v2
  v_mul_f32 v226, v226, v2
  v_mul_f32 v227, v227, v2
  v_mul_f32 v232, v232, v2
  v_mul_f32 v233, v233, v2
  v_mul_f32 v234, v234, v2
  v_mul_f32 v235, v235, v2
  v_mul_f32 v240, v240, v2
  v_mul_f32 v241, v241, v2
  v_mul_f32 v242, v242, v2
  v_mul_f32 v243, v243, v2
  v_mul_f32 v248, v248, v2
  v_mul_f32 v249, v249, v2
  v_mul_f32 v250, v250, v2
  v_mul_f32 v251, v251, v2
  v_max_f32 v3, 0, v3
  v_sub_f32 v4, 0, v3
  v_exp_f32 v4, v4
  v_sub_f32 v68, v68, v3
  v_sub_f32 v69, v69, v3
  v_sub_f32 v70, v70, v3
  v_sub_f32 v71, v71, v3
  v_mul_f32 v9, v9, v4
  v_mul_f32 v164, v164, v4
  v_mul_f32 v165, v165, v4
  v_mul_f32 v166, v166, v4
  v_mul_f32 v167, v167, v4
  v_mul_f32 v172, v172, v4
  v_mul_f32 v173, v173, v4
  v_mul_f32 v174, v174, v4
  v_mul_f32 v175, v175, v4
  v_mul_f32 v180, v180, v4
  v_mul_f32 v181, v181, v4
  v_mul_f32 v182, v182, v4
  v_mul_f32 v183, v183, v4
  v_mul_f32 v188, v188, v4
  v_mul_f32 v189, v189, v4
  v_mul_f32 v190, v190, v4
  v_mul_f32 v191, v191, v4
  v_mul_f32 v196, v196, v4
  v_mul_f32 v197, v197, v4
  v_mul_f32 v198, v198, v4
  v_mul_f32 v199, v199, v4
  v_mul_f32 v204, v204, v4
  v_mul_f32 v205, v205, v4
  v_mul_f32 v206, v206, v4
  v_mul_f32 v207, v207, v4
  v_mul_f32 v212, v212, v4
  v_mul_f32 v213, v213, v4
  v_mul_f32 v214, v214, v4
  v_mul_f32 v215, v215, v4
  v_mul_f32 v220, v220, v4
  v_mul_f32 v221, v221, v4
  v_mul_f32 v222, v222, v4
  v_mul_f32 v223, v223, v4
  v_mul_f32 v228, v228, v4
  v_mul_f32 v229, v229, v4
  v_mul_f32 v230, v230, v4
  v_mul_f32 v231, v231, v4
  v_mul_f32 v236, v236, v4
  v_mul_f32 v237, v237, v4
  v_mul_f32 v238, v238, v4
  v_mul_f32 v239, v239, v4
  v_mul_f32 v244, v244, v4
  v_mul_f32 v245, v245, v4
  v_mul_f32 v246, v246, v4
  v_mul_f32 v247, v247, v4
  v_mul_f32 v252, v252, v4
  v_mul_f32 v253, v253, v4
  v_mul_f32 v254, v254, v4
  v_mul_f32 v255, v255, v4
  v_sub_f32 v96, v96, v1
  v_sub_f32 v97, v97, v1
  v_sub_f32 v98, v98, v1
  v_sub_f32 v99, v99, v1
  v_exp_f32 v24, v96
  v_exp_f32 v25, v97
  v_exp_f32 v26, v98
  v_cvt_pk_bf16_f32 v80, v24, v25
  v_add_f32 v24, v24, v25
  v_exp_f32 v27, v99
  s_nop 0
  v_cvt_pk_bf16_f32 v81, v26, v27
  v_add_f32 v26, v26, v27
  v_add_f32 v10, v24, v26
  v_sub_f32 v100, v100, v3
  v_sub_f32 v101, v101, v3
  v_sub_f32 v102, v102, v3
  v_sub_f32 v103, v103, v3
  v_exp_f32 v28, v100
  v_exp_f32 v29, v101
  v_exp_f32 v30, v102
  v_cvt_pk_bf16_f32 v84, v28, v29
  v_add_f32 v28, v28, v29
  v_exp_f32 v31, v103
  s_nop 0
  v_cvt_pk_bf16_f32 v85, v30, v31
  v_add_f32 v30, v30, v31
  v_add_f32 v11, v28, v30
  v_sub_f32 v104, v104, v1
  v_sub_f32 v105, v105, v1
  v_sub_f32 v106, v106, v1
  v_sub_f32 v107, v107, v1
  v_exp_f32 v24, v104
  v_exp_f32 v25, v105
  v_exp_f32 v26, v106
  v_cvt_pk_bf16_f32 v82, v24, v25
  v_add_f32 v24, v24, v25
  v_exp_f32 v27, v107
  v_add_f32 v10, v10, v24
  v_cvt_pk_bf16_f32 v83, v26, v27
  v_add_f32 v26, v26, v27
  v_add_f32 v10, v10, v26
  v_sub_f32 v108, v108, v3
  v_sub_f32 v109, v109, v3
  v_sub_f32 v110, v110, v3
  v_sub_f32 v111, v111, v3
  v_exp_f32 v28, v108
  v_exp_f32 v29, v109
  v_exp_f32 v30, v110
  v_cvt_pk_bf16_f32 v86, v28, v29
  v_add_f32 v28, v28, v29
  v_exp_f32 v31, v111
  v_add_f32 v11, v11, v28
  v_cvt_pk_bf16_f32 v87, v30, v31
  v_add_f32 v30, v30, v31
  v_add_f32 v11, v11, v30
  s_branch L_ret_af1
.p2align 8
.fill 2048, 4, 0xbf800000
.section .rodata,"a"
.p2align 6
.amdhsa_kernel concat_heads__gqa_block_cached__gqa_block_cached__near_ridge_kernel
  .amdhsa_next_free_vgpr 256
  .amdhsa_next_free_sgpr 102
  .amdhsa_accum_offset 256
  .amdhsa_group_segment_fixed_size 0
  .amdhsa_kernarg_size 104
  .amdhsa_user_sgpr_count 2
  .amdhsa_user_sgpr_kernarg_segment_ptr 1
  .amdhsa_system_sgpr_workgroup_id_x 1
.end_amdhsa_kernel
```
